```python
import torch

def _softmax(x, axis=-1):
    return torch.softmax(x, dim=axis)
def _gelu(x):
    return torch.nn.functional.gelu(x, approximate="tanh")
def _silu(x):
    return torch.nn.functional.silu(x)
def _sigmoid(x):
    return torch.sigmoid(x)
def _layernorm(x, axis=-1, eps=1e-5):
    m = x.mean(dim=axis, keepdim=True)
    v = x.var(dim=axis, keepdim=True, unbiased=False)
    return (x - m) / torch.sqrt(v + eps)
def _scatter_add(tgt, idx, src, axis=0):
    return tgt.clone().index_add_(axis, idx, src)
def _segment_sum(src, seg, n):
    out = torch.zeros((n,) + src.shape[1:], dtype=src.dtype)
    return out.index_add_(0, seg, src)
def _pad(x, pw):
    flat = tuple(v for pair in reversed(pw) for v in pair)
    return torch.nn.functional.pad(x, flat)

kernel_name = 'recurrent_scan__mha_block_cached__glu_gated_swiglu__prompt'

def setup_inputs():

    _w = (lambda a: (lambda t: t.to(torch.bfloat16) if t.is_floating_point() else t)(torch.as_tensor(a)))
    def _A_setup():
        B, Sq, D = 1, 2048, 640
        H, Sk, Dh = 32, 2048, 192
        return {
            "x": _w((lambda *s: torch.randn(*s, dtype=torch.bfloat16) * 0.05)(B, Sq, D)),
            "k_cache": _w((lambda *s: torch.randn(*s, dtype=torch.bfloat16) * 1.6)(B, H, Sk, Dh)),
            "v_cache": _w((lambda *s: torch.randn(*s, dtype=torch.bfloat16) * 1.6)(B, H, Sk, Dh)),
            "wq": _w((lambda *s: torch.randn(*s, dtype=torch.bfloat16) * 1.6)(D, H * Dh) * (D ** -0.5)),
            "wo": _w((lambda *s: torch.randn(*s, dtype=torch.bfloat16) * 1.6)(H * Dh, D) * ((H * Dh) ** -0.5)),
        }
    _A_in = _A_setup()

    def _B_setup():
        B, S, D, F = 1, 2048, 640, 1536
        return {
            "x": _w((lambda *s: torch.randn(*s, dtype=torch.bfloat16) * 0.05)(B, S, D)),
            "w1": _w((lambda *s: torch.randn(*s, dtype=torch.bfloat16) * 0.2)(D, F) * (2.0 / D) ** 0.5),
            "w3": _w((lambda *s: torch.randn(*s, dtype=torch.bfloat16) * 0.2)(D, F) * (2.0 / D) ** 0.5),
            "w2": _w((lambda *s: torch.randn(*s, dtype=torch.bfloat16) * 0.2)(F, D) * (2.0 / F) ** 0.5),
        }
    _B_in = _B_setup()

    return {
        "A_x": _A_in["x"],
        "A_k_cache": _A_in["k_cache"],
        "A_v_cache": _A_in["v_cache"],
        "A_wq": _A_in["wq"],
        "A_wo": _A_in["wo"],
        "B_x": _B_in["x"],
        "B_w1": _B_in["w1"],
        "B_w3": _B_in["w3"],
        "B_w2": _B_in["w2"],
    }

def reference(A_x, A_k_cache, A_v_cache, A_wq, A_wo, B_x, B_w1, B_w3, B_w2):
    def _A_ref(x, k_cache, v_cache, wq, wo):
        B, Sq, D = x.shape
        H, Dh = 32, 192
        q = (lambda x, *d: x.permute(*d))((x @ wq).reshape(B, Sq, H, Dh), 0, 2, 1, 3)
        scores = torch.einsum("bhqd,bhkd->bhqk", q, k_cache) * (Dh ** -0.5)
        p = _softmax(scores, axis=-1)
        o = torch.einsum("bhqk,bhkd->bhqd", p, v_cache)
        return (lambda x, *d: x.permute(*d))(o, 0, 2, 1, 3).reshape(B, Sq, H * Dh) @ wo

    def _B_ref(x, w1, w3, w2):
        gate = torch.einsum("bsd,df->bsf", x, w1)
        up = torch.einsum("bsd,df->bsf", x, w3)
        h = _silu(gate) * up
        out = torch.einsum("bsf,fd->bsd", h, w2)
        return out

    x = A_x
    xn = _layernorm(x, axis=-1)
    s = _A_ref(xn, A_k_cache, A_v_cache, A_wq, A_wo)
    g = _silu(_B_ref(xn, B_w1, B_w3, B_w2))
    return x + s * g
```

```asm
; @launch grid=(256,1,1) block=(256,1,1) lds=163840
.amdgcn_target "amdgcn-amd-amdhsa--gfx950"
.text
.globl recurrent_scan__mha_block_cached__glu_gated_swiglu__prompt_kernel
.p2align 8
.type recurrent_scan__mha_block_cached__glu_gated_swiglu__prompt_kernel,@function
recurrent_scan__mha_block_cached__glu_gated_swiglu__prompt_kernel:
K2_start:
    s_cmp_ge_u32 s2, 256
    s_cbranch_scc1 K2_done
    s_load_dwordx2 s[76:77], s[0:1], 0
    s_load_dwordx2 s[56:57], s[0:1], 88
    s_load_dwordx2 s[84:85], s[0:1], 80
    s_load_dwordx2 s[48:49], s[0:1], 24
    s_load_dwordx4 s[52:55], s[0:1], 48
    s_load_dwordx4 s[44:47], s[0:1], 8
    s_load_dwordx2 s[78:79], s[0:1], 32
    s_load_dwordx2 s[80:81], s[0:1], 64
    s_load_dwordx2 s[82:83], s[0:1], 72
    v_and_b32 v236, 63, v0
    v_lshrrev_b32 v237, 6, v0
    s_and_b32 s40, s2, 6
    s_lshl_b32 s40, s40, 2
    s_lshr_b32 s41, s2, 3
    v_readfirstlane_b32 s28, v237
    s_and_b32 s42, s41, 7
    s_add_u32 s29, s40, s42
    s_and_b32 s40, s2, 1
    s_lshl_b32 s40, s40, 2
    s_lshr_b32 s41, s2, 6
    s_add_u32 s36, s40, s41
    s_lshl_b32 s40, s36, 2
    s_add_u32 s30, s40, s28
    s_mul_i32 s31, s28, 3072
    s_mul_i32 s32, s28, 6144
    v_lshlrev_b32 v212, 4, v236
    v_lshrrev_b32 v2, 5, v236
    v_mul_u32_u24 v1, 1280, v2
    v_and_b32 v3, 31, v236
    v_lshl_add_u32 v1, v3, 4, v1
    v_cmp_gt_u32 vcc, 16, v3
    v_mov_b32 v4, 0x40000000
    s_lshl_b32 s43, s36, 5
    s_add_u32 s43, s43, s29
    s_lshl_b32 s43, s43, 2
    s_add_u32 s43, s43, s28
    v_cndmask_b32 v5, v4, v1, vcc
    v_cndmask_b32_e64 v6, 0, 1.0, vcc
    s_mul_i32 s43, s43, 2560
    v_cmp_eq_u32 vcc, 0, v0
    s_nop 1
    v_cndmask_b32_e64 v249, v4, 0, vcc
    s_waitcnt lgkmcnt(0)
    s_add_u32 s96, s76, s43
    s_addc_u32 s97, s77, 0
    s_mov_b32 s98, 0x00000a00
    s_mov_b32 s99, 0x20000
    s_add_u32 s72, s56, 0x05000000
    s_addc_u32 s73, s57, 0
    s_mov_b32 s74, 0x00008000
    s_mov_b32 s75, 0x20000
    buffer_load_dwordx4 v[8:11], v1, s[96:99], 0 offen
    buffer_load_dwordx4 v[12:15], v1, s[96:99], 0 offen offset:512
    buffer_load_dwordx4 v[16:19], v5, s[96:99], 0 offen offset:1024
    v_mov_b32 v7, 20480
    buffer_load_dword v7, v7, s[72:75], 0 offen sc1
    s_lshl_b32 s40, s36, 2
    s_lshr_b32 s41, s29, 3
    s_add_u32 s40, s40, s41
    s_lshl_b32 s42, s40, 7
    s_and_b32 s41, s29, 7
    s_lshl_b32 s43, s41, 2
    s_add_u32 s39, s42, s43
    s_lshl_b32 s42, s28, 4
    s_mov_b32 s59, 12288
    v_add_u32 v238, 0, v236
    v_mul_u32_u24 v239, 2731, v238
    v_lshrrev_b32 v239, 16, v239
    v_mul_u32_u24 v240, 24, v239
    v_sub_u32 v240, v238, v240
    v_lshlrev_b32 v245, 1, v239
    v_and_b32 v245, 4, v245
    v_xor_b32 v245, v245, v240
    v_add_u32 v238, s42, v239
    v_mul_lo_u32 v238, v238, s59
    v_lshl_add_u32 v213, v245, 4, v238
    v_add_u32 v238, 64, v236
    v_mul_u32_u24 v241, 2731, v238
    v_lshrrev_b32 v241, 16, v241
    v_mul_u32_u24 v242, 24, v241
    v_sub_u32 v242, v238, v242
    v_lshlrev_b32 v245, 1, v241
    v_and_b32 v245, 4, v245
    v_xor_b32 v245, v245, v242
    v_add_u32 v238, s42, v241
    v_mul_lo_u32 v238, v238, s59
    v_lshl_add_u32 v214, v245, 4, v238
    v_add_u32 v238, 128, v236
    v_mul_u32_u24 v243, 2731, v238
    v_lshrrev_b32 v243, 16, v243
    v_mul_u32_u24 v244, 24, v243
    v_sub_u32 v244, v238, v244
    v_lshlrev_b32 v245, 1, v243
    v_and_b32 v245, 4, v245
    v_xor_b32 v245, v245, v244
    v_add_u32 v238, s42, v243
    v_mul_lo_u32 v238, v238, s59
    v_lshl_add_u32 v215, v245, 4, v238
    s_and_b32 s59, s28, 1
    s_mul_i32 s59, s59, 192
    v_add_u32 v238, 0, v236
    v_add_u32 v238, s59, v238
    v_mul_u32_u24 v245, 10923, v238
    v_lshrrev_b32 v245, 16, v245
    v_mul_u32_u24 v246, 6, v245
    v_sub_u32 v246, v238, v246
    v_mul_u32_u24 v245, 3072, v245
    v_lshl_add_u32 v216, v246, 4, v245
    v_add_u32 v238, 64, v236
    v_add_u32 v238, s59, v238
    v_mul_u32_u24 v245, 10923, v238
    v_lshrrev_b32 v245, 16, v245
    v_mul_u32_u24 v246, 6, v245
    v_sub_u32 v246, v238, v246
    v_mul_u32_u24 v245, 3072, v245
    v_lshl_add_u32 v217, v246, 4, v245
    v_add_u32 v238, 128, v236
    v_add_u32 v238, s59, v238
    v_mul_u32_u24 v245, 10923, v238
    v_lshrrev_b32 v245, 16, v245
    v_mul_u32_u24 v246, 6, v245
    v_sub_u32 v246, v238, v246
    v_mul_u32_u24 v245, 3072, v245
    v_lshl_add_u32 v218, v246, 4, v245
    s_cmp_lt_u32 s28, 2
    s_cselect_b32 s50, s52, s54
    s_cselect_b32 s51, s53, s55
    s_mul_i32 s40, s29, 96
    s_sub_u32 s41, 1966080, s40
    s_add_u32 s8, s50, s40
    s_addc_u32 s9, s51, 0
    s_mov_b32 s10, s41
    s_mov_b32 s11, 0x20000
    s_mul_i32 s40, s30, 81920
    s_add_u32 s12, s56, s40
    s_addc_u32 s13, s57, 0
    s_mov_b32 s14, 0x00014000
    s_mov_b32 s15, 0x20000
    s_mul_i32 s40, s29, 384
    s_sub_u32 s41, 7864320, s40
    s_add_u32 s4, s48, s40
    s_addc_u32 s5, s49, 0
    s_mov_b32 s6, s41
    s_mov_b32 s7, 0x20000
    s_mov_b32 s33, 0
    s_add_u32 m0, s31, 98304
    s_nop 0
    buffer_load_dwordx4 v216, s[8:11], s33 offen lds
    s_add_u32 m0, s31, 99328
    s_nop 0
    buffer_load_dwordx4 v217, s[8:11], s33 offen lds
    s_add_u32 m0, s31, 100352
    s_nop 0
    buffer_load_dwordx4 v218, s[8:11], s33 offen lds
    s_mov_b32 s33, 0
    s_add_u32 m0, s32, 73728
    s_nop 0
    buffer_load_dwordx4 v213, s[4:7], s33 offen lds
    s_add_u32 m0, s32, 74752
    s_nop 0
    buffer_load_dwordx4 v214, s[4:7], s33 offen lds
    s_add_u32 m0, s32, 75776
    s_nop 0
    buffer_load_dwordx4 v215, s[4:7], s33 offen lds
    s_mov_b32 s33, 98304
    s_add_u32 m0, s32, 76800
    s_nop 0
    buffer_load_dwordx4 v213, s[4:7], s33 offen lds
    s_add_u32 m0, s32, 77824
    s_nop 0
    buffer_load_dwordx4 v214, s[4:7], s33 offen lds
    s_add_u32 m0, s32, 78848
    s_nop 0
    buffer_load_dwordx4 v215, s[4:7], s33 offen lds
    s_getpc_b64 s[86:87]
K2_pc:
    s_sub_u32 s86, s86, K2_pc-K2_start
    s_subb_u32 s87, s87, 0
    v_lshlrev_b32 v228, 3, v212
    s_lshl_b32 s40, s28, 13
    v_add_u32 v228, s40, v228
    v_add_u32 v229, 32768, v228
    v_min_u32 v228, K2_end-K2_start-4, v228
    v_min_u32 v229, K2_end-K2_start-4, v229
    global_load_dword v230, v228, s[86:87]
    global_load_dword v231, v229, s[86:87]
    s_waitcnt vmcnt(11)
    s_lshl_b32 s40, s36, 2
    s_lshr_b32 s41, s29, 3
    s_add_u32 s40, s40, s41
    s_and_b32 s41, s29, 7
    v_and_b32 v7, 0x7ffffff8, v7
    v_add_u32 v7, 8, v7
    v_or_b32 v46, 0x80000000, v7
    s_mov_b32 s42, 0xffff0000
    v_readfirstlane_b32 s58, v46
    v_lshlrev_b32 v20, 16, v8
    v_and_b32 v21, s42, v8
    v_lshlrev_b32 v22, 16, v9
    v_and_b32 v23, s42, v9
    v_lshlrev_b32 v24, 16, v10
    v_and_b32 v25, s42, v10
    v_lshlrev_b32 v26, 16, v11
    v_and_b32 v27, s42, v11
    v_lshlrev_b32 v28, 16, v12
    v_and_b32 v29, s42, v12
    v_lshlrev_b32 v30, 16, v13
    v_and_b32 v31, s42, v13
    v_lshlrev_b32 v32, 16, v14
    v_and_b32 v33, s42, v14
    v_lshlrev_b32 v34, 16, v15
    v_and_b32 v35, s42, v15
    v_lshlrev_b32 v36, 16, v16
    v_and_b32 v37, s42, v16
    v_lshlrev_b32 v38, 16, v17
    v_and_b32 v39, s42, v17
    v_lshlrev_b32 v40, 16, v18
    v_and_b32 v41, s42, v18
    v_lshlrev_b32 v42, 16, v19
    v_and_b32 v43, s42, v19
    v_pk_add_f32 v[8:9], v[20:21], v[22:23]
    v_pk_add_f32 v[8:9], v[8:9], v[24:25]
    v_pk_add_f32 v[8:9], v[8:9], v[26:27]
    v_pk_add_f32 v[8:9], v[8:9], v[28:29]
    v_pk_add_f32 v[8:9], v[8:9], v[30:31]
    v_pk_add_f32 v[8:9], v[8:9], v[32:33]
    v_pk_add_f32 v[8:9], v[8:9], v[34:35]
    v_pk_add_f32 v[8:9], v[8:9], v[36:37]
    v_pk_add_f32 v[8:9], v[8:9], v[38:39]
    v_pk_add_f32 v[8:9], v[8:9], v[40:41]
    v_pk_add_f32 v[8:9], v[8:9], v[42:43]
    v_add_f32 v8, v8, v9
    s_nop 1
    v_add_f32_dpp v8, v8, v8 row_ror:8 row_mask:0xf bank_mask:0xf
    s_nop 1
    v_add_f32_dpp v8, v8, v8 row_ror:4 row_mask:0xf bank_mask:0xf
    s_nop 1
    v_add_f32_dpp v8, v8, v8 row_ror:2 row_mask:0xf bank_mask:0xf
    s_nop 1
    v_add_f32_dpp v8, v8, v8 row_ror:1 row_mask:0xf bank_mask:0xf
    v_mov_b32 v9, v8
    s_nop 1
    v_permlane16_swap_b32 v9, v8
    v_add_f32 v8, v8, v9
    v_mul_f32 v8, 0x3acccccd, v8
    v_mul_f32 v6, v6, v8
    v_pk_add_f32 v[48:49], v[20:21], v[8:9] op_sel_hi:[1,0] neg_lo:[0,1] neg_hi:[0,1]
    v_pk_add_f32 v[50:51], v[22:23], v[8:9] op_sel_hi:[1,0] neg_lo:[0,1] neg_hi:[0,1]
    v_pk_add_f32 v[52:53], v[24:25], v[8:9] op_sel_hi:[1,0] neg_lo:[0,1] neg_hi:[0,1]
    v_pk_add_f32 v[54:55], v[26:27], v[8:9] op_sel_hi:[1,0] neg_lo:[0,1] neg_hi:[0,1]
    v_pk_add_f32 v[56:57], v[28:29], v[8:9] op_sel_hi:[1,0] neg_lo:[0,1] neg_hi:[0,1]
    v_pk_add_f32 v[58:59], v[30:31], v[8:9] op_sel_hi:[1,0] neg_lo:[0,1] neg_hi:[0,1]
    v_pk_add_f32 v[60:61], v[32:33], v[8:9] op_sel_hi:[1,0] neg_lo:[0,1] neg_hi:[0,1]
    v_pk_add_f32 v[62:63], v[34:35], v[8:9] op_sel_hi:[1,0] neg_lo:[0,1] neg_hi:[0,1]
    v_pk_add_f32 v[64:65], v[36:37], v[6:7] op_sel_hi:[1,0] neg_lo:[0,1] neg_hi:[0,1]
    v_pk_add_f32 v[66:67], v[38:39], v[6:7] op_sel_hi:[1,0] neg_lo:[0,1] neg_hi:[0,1]
    v_pk_add_f32 v[68:69], v[40:41], v[6:7] op_sel_hi:[1,0] neg_lo:[0,1] neg_hi:[0,1]
    v_pk_add_f32 v[70:71], v[42:43], v[6:7] op_sel_hi:[1,0] neg_lo:[0,1] neg_hi:[0,1]
    v_pk_mul_f32 v[10:11], v[48:49], v[48:49]
    v_pk_fma_f32 v[10:11], v[50:51], v[50:51], v[10:11]
    v_pk_fma_f32 v[10:11], v[52:53], v[52:53], v[10:11]
    v_pk_fma_f32 v[10:11], v[54:55], v[54:55], v[10:11]
    v_pk_fma_f32 v[10:11], v[56:57], v[56:57], v[10:11]
    v_pk_fma_f32 v[10:11], v[58:59], v[58:59], v[10:11]
    v_pk_fma_f32 v[10:11], v[60:61], v[60:61], v[10:11]
    v_pk_fma_f32 v[10:11], v[62:63], v[62:63], v[10:11]
    v_pk_fma_f32 v[10:11], v[64:65], v[64:65], v[10:11]
    v_pk_fma_f32 v[10:11], v[66:67], v[66:67], v[10:11]
    v_pk_fma_f32 v[10:11], v[68:69], v[68:69], v[10:11]
    v_pk_fma_f32 v[10:11], v[70:71], v[70:71], v[10:11]
    v_add_f32 v10, v10, v11
    s_nop 1
    v_add_f32_dpp v10, v10, v10 row_ror:8 row_mask:0xf bank_mask:0xf
    s_nop 1
    v_add_f32_dpp v10, v10, v10 row_ror:4 row_mask:0xf bank_mask:0xf
    s_nop 1
    v_add_f32_dpp v10, v10, v10 row_ror:2 row_mask:0xf bank_mask:0xf
    s_nop 1
    v_add_f32_dpp v10, v10, v10 row_ror:1 row_mask:0xf bank_mask:0xf
    v_mov_b32 v11, v10
    s_nop 1
    v_permlane16_swap_b32 v11, v10
    v_add_f32 v10, v10, v11
    v_mul_f32 v10, 0x3acccccd, v10
    v_cvt_pk_bf16_f32 v9, v8, v10
    v_lshlrev_b32 v8, 16, v9
    v_and_b32 v10, s42, v9
    v_add_f32 v10, 0x3727c5ac, v10
    v_cvt_pk_bf16_f32 v10, v10, v10
    v_and_b32 v10, s42, v10
    v_sqrt_f32 v10, v10
    v_pk_add_f32 v[48:49], v[20:21], v[8:9] op_sel_hi:[1,0] neg_lo:[0,1] neg_hi:[0,1]
    v_pk_add_f32 v[50:51], v[22:23], v[8:9] op_sel_hi:[1,0] neg_lo:[0,1] neg_hi:[0,1]
    v_pk_add_f32 v[52:53], v[24:25], v[8:9] op_sel_hi:[1,0] neg_lo:[0,1] neg_hi:[0,1]
    v_pk_add_f32 v[54:55], v[26:27], v[8:9] op_sel_hi:[1,0] neg_lo:[0,1] neg_hi:[0,1]
    v_pk_add_f32 v[56:57], v[28:29], v[8:9] op_sel_hi:[1,0] neg_lo:[0,1] neg_hi:[0,1]
    v_pk_add_f32 v[58:59], v[30:31], v[8:9] op_sel_hi:[1,0] neg_lo:[0,1] neg_hi:[0,1]
    v_pk_add_f32 v[60:61], v[32:33], v[8:9] op_sel_hi:[1,0] neg_lo:[0,1] neg_hi:[0,1]
    v_pk_add_f32 v[62:63], v[34:35], v[8:9] op_sel_hi:[1,0] neg_lo:[0,1] neg_hi:[0,1]
    v_pk_add_f32 v[64:65], v[36:37], v[8:9] op_sel_hi:[1,0] neg_lo:[0,1] neg_hi:[0,1]
    v_pk_add_f32 v[66:67], v[38:39], v[8:9] op_sel_hi:[1,0] neg_lo:[0,1] neg_hi:[0,1]
    v_pk_add_f32 v[68:69], v[40:41], v[8:9] op_sel_hi:[1,0] neg_lo:[0,1] neg_hi:[0,1]
    v_pk_add_f32 v[70:71], v[42:43], v[8:9] op_sel_hi:[1,0] neg_lo:[0,1] neg_hi:[0,1]
    v_cvt_pk_bf16_f32 v10, v10, v10
    v_and_b32 v10, s42, v10
    v_rcp_f32 v10, v10
    v_cvt_pk_bf16_f32 v20, v48, v49
    v_cvt_pk_bf16_f32 v21, v50, v51
    v_cvt_pk_bf16_f32 v22, v52, v53
    v_cvt_pk_bf16_f32 v23, v54, v55
    v_cvt_pk_bf16_f32 v24, v56, v57
    v_cvt_pk_bf16_f32 v25, v58, v59
    v_cvt_pk_bf16_f32 v26, v60, v61
    v_cvt_pk_bf16_f32 v27, v62, v63
    v_cvt_pk_bf16_f32 v28, v64, v65
    v_cvt_pk_bf16_f32 v29, v66, v67
    v_cvt_pk_bf16_f32 v30, v68, v69
    v_cvt_pk_bf16_f32 v31, v70, v71
    v_lshlrev_b32 v48, 16, v20
    v_and_b32 v49, s42, v20
    v_lshlrev_b32 v50, 16, v21
    v_and_b32 v51, s42, v21
    v_lshlrev_b32 v52, 16, v22
    v_and_b32 v53, s42, v22
    v_lshlrev_b32 v54, 16, v23
    v_and_b32 v55, s42, v23
    v_lshlrev_b32 v56, 16, v24
    v_and_b32 v57, s42, v24
    v_lshlrev_b32 v58, 16, v25
    v_and_b32 v59, s42, v25
    v_lshlrev_b32 v60, 16, v26
    v_and_b32 v61, s42, v26
    v_lshlrev_b32 v62, 16, v27
    v_and_b32 v63, s42, v27
    v_lshlrev_b32 v64, 16, v28
    v_and_b32 v65, s42, v28
    v_lshlrev_b32 v66, 16, v29
    v_and_b32 v67, s42, v29
    v_lshlrev_b32 v68, 16, v30
    v_and_b32 v69, s42, v30
    v_lshlrev_b32 v70, 16, v31
    v_and_b32 v71, s42, v31
    v_pk_mul_f32 v[48:49], v[48:49], v[10:11] op_sel_hi:[1,0]
    v_pk_mul_f32 v[50:51], v[50:51], v[10:11] op_sel_hi:[1,0]
    v_pk_mul_f32 v[52:53], v[52:53], v[10:11] op_sel_hi:[1,0]
    v_pk_mul_f32 v[54:55], v[54:55], v[10:11] op_sel_hi:[1,0]
    v_pk_mul_f32 v[56:57], v[56:57], v[10:11] op_sel_hi:[1,0]
    v_pk_mul_f32 v[58:59], v[58:59], v[10:11] op_sel_hi:[1,0]
    v_pk_mul_f32 v[60:61], v[60:61], v[10:11] op_sel_hi:[1,0]
    v_pk_mul_f32 v[62:63], v[62:63], v[10:11] op_sel_hi:[1,0]
    v_pk_mul_f32 v[64:65], v[64:65], v[10:11] op_sel_hi:[1,0]
    v_pk_mul_f32 v[66:67], v[66:67], v[10:11] op_sel_hi:[1,0]
    v_pk_mul_f32 v[68:69], v[68:69], v[10:11] op_sel_hi:[1,0]
    v_pk_mul_f32 v[70:71], v[70:71], v[10:11] op_sel_hi:[1,0]
    v_cvt_pk_bf16_f32 v20, v48, v49
    v_cvt_pk_bf16_f32 v21, v50, v51
    v_cvt_pk_bf16_f32 v22, v52, v53
    v_cvt_pk_bf16_f32 v23, v54, v55
    v_cvt_pk_bf16_f32 v24, v56, v57
    v_cvt_pk_bf16_f32 v25, v58, v59
    v_cvt_pk_bf16_f32 v26, v60, v61
    v_cvt_pk_bf16_f32 v27, v62, v63
    v_cvt_pk_bf16_f32 v28, v64, v65
    v_cvt_pk_bf16_f32 v29, v66, v67
    v_cvt_pk_bf16_f32 v30, v68, v69
    v_cvt_pk_bf16_f32 v31, v70, v71
    s_lshl_b32 s42, s28, 1
    v_add_u32 v1, s42, v2
    v_xor_b32 v1, v1, v3
    v_and_b32 v1, 7, v1
    v_lshlrev_b32 v1, 4, v1
    v_lshl_add_u32 v1, v3, 7, v1
    v_add_u32 v1, 147456, v1
    ds_write_b128 v1, v[20:23] offset:0
    ds_write_b128 v1, v[24:27] offset:4096
    ds_write_b128 v1, v[28:31] offset:8192
    s_lshl_b32 s42, s28, 10
    s_add_u32 s42, s42, 147456
    v_lshrrev_b32 v1, 3, v212
    v_and_b32 v1, 0x70, v1
    v_xor_b32 v1, v1, v212
    v_add_u32 v1, s42, v1
    v_lshlrev_b32 v4, 12, v2
    v_bfe_u32 v5, v236, 3, 2
    v_lshl_add_u32 v4, v5, 8, v4
    v_and_b32 v5, 7, v236
    v_lshl_add_u32 v4, v5, 4, v4
    s_mul_i32 s40, s40, 81920
    s_lshr_b32 s42, s41, 1
    s_lshl_b32 s42, s42, 10
    s_add_u32 s40, s40, s42
    s_and_b32 s41, s41, 1
    s_lshl_b32 s41, s41, 7
    s_add_u32 s40, s40, s41
    s_lshl_b32 s41, s28, 13
    s_add_u32 s40, s40, s41
    s_mov_b32 s96, s56
    s_mov_b32 s97, s57
    s_mov_b32 s98, 0x00280000
    s_mov_b32 s99, 0x20000
    s_waitcnt lgkmcnt(0)
    s_barrier
    ds_read_b128 v[20:23], v1 offset:0
    ds_read_b128 v[24:27], v1 offset:4096
    ds_read_b128 v[28:31], v1 offset:8192
    s_add_u32 s41, s40, 32768
    s_add_u32 s42, s40, 65536
    s_cmp_lt_u32 s28, 2
    s_cselect_b32 s42, s42, 0x40000000
    s_waitcnt lgkmcnt(2)
    buffer_store_dwordx4 v[20:23], v4, s[96:99], s40 offen sc1
    s_waitcnt lgkmcnt(1)
    buffer_store_dwordx4 v[24:27], v4, s[96:99], s41 offen sc1
    s_waitcnt lgkmcnt(0)
    buffer_store_dwordx4 v[28:31], v4, s[96:99], s42 offen sc1
    s_mov_b32 s38, 0
    s_lshr_b32 s40, s2, 6
    v_mov_b32 v233, 0x40000000
    s_mov_b32 s67, 0x20000
    s_cmp_eq_u32 s28, 0
    s_cbranch_scc1 K2_pf0
    s_cmp_eq_u32 s28, 3
    s_cbranch_scc1 K2_pf3
    s_mov_b32 s64, s8
    s_mov_b32 s65, s9
    s_mov_b32 s66, s10
    s_mov_b32 s90, 196608
    v_lshrrev_b32 v232, 1, v236
    v_lshl_add_u32 v232, v232, 2, s40
    v_mul_u32_u24 v232, 3072, v232
    v_and_b32 v234, 1, v236
    v_mul_u32_u24 v234, 92, v234
    v_cmp_gt_u32 vcc, 32, v236
    s_branch K2_pfe
K2_pf0:
    s_mov_b32 s64, s4
    s_mov_b32 s65, s5
    s_mov_b32 s66, s6
    s_mov_b32 s90, 786432
    v_mul_u32_u24 v232, 86, v236
    v_lshrrev_b32 v232, 8, v232
    v_mul_u32_u24 v234, 3, v232
    v_sub_u32 v234, v236, v234
    v_lshl_add_u32 v232, v232, 2, s40
    v_mul_u32_u24 v232, 12288, v232
    v_lshlrev_b32 v234, 7, v234
    v_cmp_gt_u32 vcc, 48, v236
    s_branch K2_pfe
K2_pf3:
    s_sub_u32 s64, s12, 245760
    s_subb_u32 s65, s13, 0
    s_mov_b32 s66, 327680
    s_mov_b32 s90, 8192
    v_lshrrev_b32 v232, 3, v236
    s_mov_b32 s41, 81920
    v_mul_lo_u32 v232, v232, s41
    v_and_b32 v234, 7, v236
    s_and_b32 s41, s29, 7
    v_lshl_add_u32 v234, v234, 3, s41
    v_lshlrev_b32 v234, 7, v234
    v_cmp_gt_u32 vcc, 32, v236
K2_pfe:
    v_add_u32 v232, v232, v234
    s_lshl_b32 s91, s90, 1
    v_cndmask_b32 v232, v233, v232, vcc
    s_cmp_eq_u32 s28, 3
    s_cselect_b32 s91, s90, s91
    v_lshrrev_b32 v247, 4, v236
    v_and_b32 v248, 15, v236
    v_and_b32 v237, 3, v236
    v_lshrrev_b32 v238, 2, v248
    v_lshl_add_u32 v238, v247, 3, v238
    v_mul_u32_u24 v245, 384, v238
    v_lshl_add_u32 v245, v237, 4, v245
    v_lshrrev_b32 v246, 3, v248
    v_lshl_add_u32 v219, v246, 6, v245
    v_xor_b32 v246, 1, v246
    v_lshl_add_u32 v220, v246, 6, v245
    v_add_u32 v221, 73728, v219
    v_add_u32 v222, 73728, v220
    v_mul_u32_u24 v245, 96, v238
    v_lshl_add_u32 v245, v237, 3, v245
    v_add_u32 v223, 24576, v245
    v_add_u32 v224, 98304, v245
    s_mov_b32 s49, s39
    s_waitcnt vmcnt(0)
    s_add_u32 s40, s49, 12288
    s_barrier
    buffer_store_dword v46, v249, s[72:75], s40 offen sc1
    v_bfe_u32 v5, v236, 3, 2
    v_and_b32 v4, 7, v236
    v_lshlrev_b32 v4, 2, v4
    v_lshl_add_u32 v5, v5, 7, v4
    s_lshl_b32 s40, s36, 9
    s_add_u32 s40, s40, 12288
    s_cmp_lg_u32 s28, 0
    s_cbranch_scc1 K2_xok0
    buffer_load_dword v6, v5, s[72:75], s40 offen sc1
    s_sleep 6
K2_xpoll0:
    buffer_load_dword v8, v5, s[72:75], s40 offen sc1
    s_add_u32 s38, s38, 1
    s_waitcnt vmcnt(1)
    v_cmp_ne_u32 vcc, s58, v6
    s_cbranch_vccz K2_xok0
    buffer_load_dword v6, v5, s[72:75], s40 offen sc1
    s_cmp_gt_u32 s38, 524288
    s_waitcnt vmcnt(1)
    v_cmp_ne_u32 vcc, s58, v8
    s_cbranch_scc1 K2_xok0
    s_cbranch_vccnz K2_xpoll0
K2_xok0:
    s_mov_b32 s33, 196608
    s_add_u32 m0, s31, 135168
    s_nop 0
    buffer_load_dwordx4 v216, s[8:11], s33 offen lds
    s_add_u32 m0, s31, 136192
    s_nop 0
    buffer_load_dwordx4 v217, s[8:11], s33 offen lds
    s_add_u32 m0, s31, 137216
    s_nop 0
    buffer_load_dwordx4 v218, s[8:11], s33 offen lds
    s_mov_b32 s33, 786432
    s_add_u32 m0, s32, 110592
    s_nop 0
    buffer_load_dwordx4 v213, s[4:7], s33 offen lds
    s_add_u32 m0, s32, 111616
    s_nop 0
    buffer_load_dwordx4 v214, s[4:7], s33 offen lds
    s_add_u32 m0, s32, 112640
    s_nop 0
    buffer_load_dwordx4 v215, s[4:7], s33 offen lds
    s_mov_b32 s33, 884736
    s_add_u32 m0, s32, 113664
    s_nop 0
    buffer_load_dwordx4 v213, s[4:7], s33 offen lds
    s_add_u32 m0, s32, 114688
    s_nop 0
    buffer_load_dwordx4 v214, s[4:7], s33 offen lds
    s_add_u32 m0, s32, 115712
    s_nop 0
    buffer_load_dwordx4 v215, s[4:7], s33 offen lds
    s_barrier
    s_mov_b32 s34, 0
    buffer_load_dwordx4 a[96:99], v212, s[12:15], s34 offen offset:0
    buffer_load_dwordx4 a[100:103], v212, s[12:15], s34 offen offset:1024
    buffer_load_dwordx4 a[104:107], v212, s[12:15], s34 offen offset:2048
    buffer_load_dwordx4 a[108:111], v212, s[12:15], s34 offen offset:3072
    s_mov_b32 s34, 4096
    buffer_load_dwordx4 a[112:115], v212, s[12:15], s34 offen offset:0
    buffer_load_dwordx4 a[116:119], v212, s[12:15], s34 offen offset:1024
    buffer_load_dwordx4 a[120:123], v212, s[12:15], s34 offen offset:2048
    buffer_load_dwordx4 a[124:127], v212, s[12:15], s34 offen offset:3072
    buffer_load_dword v252, v232, s[64:67], s91 offen
    s_add_u32 s91, s91, s90
    buffer_load_dword v252, v232, s[64:67], s91 offen
    s_waitcnt vmcnt(2)
    ds_read_b64_tr_b16 a[224:225], v224 offset:0
    ds_read_b64_tr_b16 a[226:227], v224 offset:384
    ds_read_b64_tr_b16 a[228:229], v224 offset:3072
    ds_read_b64_tr_b16 a[230:231], v224 offset:3456
    ds_read_b64_tr_b16 a[232:233], v224 offset:6144
    ds_read_b64_tr_b16 a[234:235], v224 offset:6528
    ds_read_b64_tr_b16 a[236:237], v224 offset:9216
    ds_read_b64_tr_b16 a[238:239], v224 offset:9600
    s_waitcnt lgkmcnt(4)
    v_mfma_f32_16x16x32_bf16 a[0:3], a[224:227], a[96:99], 0
    ds_read_b64_tr_b16 a[240:241], v224 offset:32
    v_mfma_f32_16x16x32_bf16 a[0:3], a[228:231], a[112:115], a[0:3]
    v_mfma_f32_16x16x32_bf16 a[4:7], a[224:227], a[100:103], 0
    ds_read_b64_tr_b16 a[242:243], v224 offset:416
    v_mfma_f32_16x16x32_bf16 a[4:7], a[228:231], a[116:119], a[4:7]
    v_mfma_f32_16x16x32_bf16 a[8:11], a[224:227], a[104:107], 0
    ds_read_b64_tr_b16 a[244:245], v224 offset:3104
    v_mfma_f32_16x16x32_bf16 a[8:11], a[228:231], a[120:123], a[8:11]
    v_mfma_f32_16x16x32_bf16 a[12:15], a[224:227], a[108:111], 0
    ds_read_b64_tr_b16 a[246:247], v224 offset:3488
    v_mfma_f32_16x16x32_bf16 a[12:15], a[228:231], a[124:127], a[12:15]
    s_waitcnt lgkmcnt(4)
    v_mfma_f32_16x16x32_bf16 a[48:51], a[232:235], a[96:99], 0
    ds_read_b64_tr_b16 a[224:225], v224 offset:6176
    s_add_u32 s91, s91, s90
    v_mfma_f32_16x16x32_bf16 a[48:51], a[236:239], a[112:115], a[48:51]
    buffer_load_dword v252, v232, s[64:67], s91 offen
    v_mfma_f32_16x16x32_bf16 a[52:55], a[232:235], a[100:103], 0
    ds_read_b64_tr_b16 a[226:227], v224 offset:6560
    v_mfma_f32_16x16x32_bf16 a[52:55], a[236:239], a[116:119], a[52:55]
    v_mfma_f32_16x16x32_bf16 a[56:59], a[232:235], a[104:107], 0
    ds_read_b64_tr_b16 a[228:229], v224 offset:9248
    v_mfma_f32_16x16x32_bf16 a[56:59], a[236:239], a[120:123], a[56:59]
    v_mfma_f32_16x16x32_bf16 a[60:63], a[232:235], a[108:111], 0
    ds_read_b64_tr_b16 a[230:231], v224 offset:9632
    v_mfma_f32_16x16x32_bf16 a[60:63], a[236:239], a[124:127], a[60:63]
    s_waitcnt lgkmcnt(4)
    v_mfma_f32_16x16x32_bf16 a[16:19], a[240:243], a[96:99], 0
    ds_read_b64_tr_b16 a[232:233], v224 offset:64
    s_mov_b32 s34, 8192
    v_mfma_f32_16x16x32_bf16 a[16:19], a[244:247], a[112:115], a[16:19]
    buffer_load_dwordx4 a[128:131], v212, s[12:15], s34 offen offset:0
    v_mfma_f32_16x16x32_bf16 a[20:23], a[240:243], a[100:103], 0
    ds_read_b64_tr_b16 a[234:235], v224 offset:448
    v_mfma_f32_16x16x32_bf16 a[20:23], a[244:247], a[116:119], a[20:23]
    v_mfma_f32_16x16x32_bf16 a[24:27], a[240:243], a[104:107], 0
    ds_read_b64_tr_b16 a[236:237], v224 offset:3136
    v_mfma_f32_16x16x32_bf16 a[24:27], a[244:247], a[120:123], a[24:27]
    buffer_load_dwordx4 a[132:135], v212, s[12:15], s34 offen offset:1024
    v_mfma_f32_16x16x32_bf16 a[28:31], a[240:243], a[108:111], 0
    ds_read_b64_tr_b16 a[238:239], v224 offset:3520
    v_mfma_f32_16x16x32_bf16 a[28:31], a[244:247], a[124:127], a[28:31]
    s_waitcnt lgkmcnt(4)
    v_mfma_f32_16x16x32_bf16 a[64:67], a[224:227], a[96:99], 0
    ds_read_b64_tr_b16 a[240:241], v224 offset:6208
    v_mfma_f32_16x16x32_bf16 a[64:67], a[228:231], a[112:115], a[64:67]
    buffer_load_dwordx4 a[136:139], v212, s[12:15], s34 offen offset:2048
    v_mfma_f32_16x16x32_bf16 a[68:71], a[224:227], a[100:103], 0
    ds_read_b64_tr_b16 a[242:243], v224 offset:6592
    v_mfma_f32_16x16x32_bf16 a[68:71], a[228:231], a[116:119], a[68:71]
    v_mfma_f32_16x16x32_bf16 a[72:75], a[224:227], a[104:107], 0
    ds_read_b64_tr_b16 a[244:245], v224 offset:9280
    v_mfma_f32_16x16x32_bf16 a[72:75], a[228:231], a[120:123], a[72:75]
    buffer_load_dwordx4 a[140:143], v212, s[12:15], s34 offen offset:3072
    v_mfma_f32_16x16x32_bf16 a[76:79], a[224:227], a[108:111], 0
    ds_read_b64_tr_b16 a[246:247], v224 offset:9664
    v_mfma_f32_16x16x32_bf16 a[76:79], a[228:231], a[124:127], a[76:79]
    s_waitcnt lgkmcnt(4)
    v_mfma_f32_16x16x32_bf16 a[32:35], a[232:235], a[96:99], 0
    ds_read_b64_tr_b16 a[224:225], v221 offset:0
    s_mov_b32 s34, 12288
    v_mfma_f32_16x16x32_bf16 a[32:35], a[236:239], a[112:115], a[32:35]
    buffer_load_dwordx4 a[144:147], v212, s[12:15], s34 offen offset:0
    v_mfma_f32_16x16x32_bf16 a[36:39], a[232:235], a[100:103], 0
    ds_read_b64_tr_b16 a[226:227], v221 offset:1536
    v_mfma_f32_16x16x32_bf16 a[36:39], a[236:239], a[116:119], a[36:39]
    v_mfma_f32_16x16x32_bf16 a[40:43], a[232:235], a[104:107], 0
    ds_read_b64_tr_b16 a[228:229], v221 offset:12288
    v_mfma_f32_16x16x32_bf16 a[40:43], a[236:239], a[120:123], a[40:43]
    buffer_load_dwordx4 a[148:151], v212, s[12:15], s34 offen offset:1024
    v_mfma_f32_16x16x32_bf16 a[44:47], a[232:235], a[108:111], 0
    ds_read_b64_tr_b16 a[230:231], v221 offset:13824
    v_mfma_f32_16x16x32_bf16 a[44:47], a[236:239], a[124:127], a[44:47]
    s_waitcnt lgkmcnt(4)
    v_mfma_f32_16x16x32_bf16 a[80:83], a[240:243], a[96:99], 0
    ds_read_b64_tr_b16 a[232:233], v221 offset:8
    v_mfma_f32_16x16x32_bf16 a[80:83], a[244:247], a[112:115], a[80:83]
    buffer_load_dwordx4 a[152:155], v212, s[12:15], s34 offen offset:2048
    v_mfma_f32_16x16x32_bf16 a[84:87], a[240:243], a[100:103], 0
    ds_read_b64_tr_b16 a[234:235], v221 offset:1544
    v_mfma_f32_16x16x32_bf16 a[84:87], a[244:247], a[116:119], a[84:87]
    v_mfma_f32_16x16x32_bf16 a[88:91], a[240:243], a[104:107], 0
    ds_read_b64_tr_b16 a[236:237], v221 offset:12296
    v_mfma_f32_16x16x32_bf16 a[88:91], a[244:247], a[120:123], a[88:91]
    buffer_load_dwordx4 a[156:159], v212, s[12:15], s34 offen offset:3072
    v_mfma_f32_16x16x32_bf16 a[92:95], a[240:243], a[108:111], 0
    ds_read_b64_tr_b16 a[238:239], v221 offset:13832
    v_mfma_f32_16x16x32_bf16 a[92:95], a[244:247], a[124:127], a[92:95]
    s_waitcnt lgkmcnt(4)
    v_mfma_f32_16x16x32_bf16 v[0:3], a[224:227], a[96:99], 0
    ds_read_b64_tr_b16 a[240:241], v222 offset:0
    s_add_u32 s91, s91, s90
    v_mfma_f32_16x16x32_bf16 v[0:3], a[228:231], a[112:115], v[0:3]
    buffer_load_dword v252, v232, s[64:67], s91 offen
    v_mfma_f32_16x16x32_bf16 v[48:51], a[224:227], a[100:103], 0
    ds_read_b64_tr_b16 a[242:243], v222 offset:1536
    v_mfma_f32_16x16x32_bf16 v[48:51], a[228:231], a[116:119], v[48:51]
    v_mfma_f32_16x16x32_bf16 v[96:99], a[224:227], a[104:107], 0
    ds_read_b64_tr_b16 a[244:245], v222 offset:12288
    v_mfma_f32_16x16x32_bf16 v[96:99], a[228:231], a[120:123], v[96:99]
    v_mfma_f32_16x16x32_bf16 v[144:147], a[224:227], a[108:111], 0
    ds_read_b64_tr_b16 a[246:247], v222 offset:13824
    v_mfma_f32_16x16x32_bf16 v[144:147], a[228:231], a[124:127], v[144:147]
    s_waitcnt lgkmcnt(4)
    v_mfma_f32_16x16x32_bf16 v[4:7], a[232:235], a[96:99], 0
    ds_read_b64_tr_b16 a[224:225], v222 offset:8
    v_mfma_f32_16x16x32_bf16 v[4:7], a[236:239], a[112:115], v[4:7]
    v_mfma_f32_16x16x32_bf16 v[52:55], a[232:235], a[100:103], 0
    ds_read_b64_tr_b16 a[226:227], v222 offset:1544
    v_mfma_f32_16x16x32_bf16 v[52:55], a[236:239], a[116:119], v[52:55]
    v_mfma_f32_16x16x32_bf16 v[100:103], a[232:235], a[104:107], 0
    ds_read_b64_tr_b16 a[228:229], v222 offset:12296
    v_mfma_f32_16x16x32_bf16 v[100:103], a[236:239], a[120:123], v[100:103]
    v_mfma_f32_16x16x32_bf16 v[148:151], a[232:235], a[108:111], 0
    ds_read_b64_tr_b16 a[230:231], v222 offset:13832
    v_mfma_f32_16x16x32_bf16 v[148:151], a[236:239], a[124:127], v[148:151]
    s_waitcnt lgkmcnt(4)
    v_mfma_f32_16x16x32_bf16 v[8:11], a[240:243], a[96:99], 0
    ds_read_b64_tr_b16 a[232:233], v221 offset:128
    v_mfma_f32_16x16x32_bf16 v[8:11], a[244:247], a[112:115], v[8:11]
    v_mfma_f32_16x16x32_bf16 v[56:59], a[240:243], a[100:103], 0
    ds_read_b64_tr_b16 a[234:235], v221 offset:1664
    v_mfma_f32_16x16x32_bf16 v[56:59], a[244:247], a[116:119], v[56:59]
    v_mfma_f32_16x16x32_bf16 v[104:107], a[240:243], a[104:107], 0
    ds_read_b64_tr_b16 a[236:237], v221 offset:12416
    v_mfma_f32_16x16x32_bf16 v[104:107], a[244:247], a[120:123], v[104:107]
    v_mfma_f32_16x16x32_bf16 v[152:155], a[240:243], a[108:111], 0
    ds_read_b64_tr_b16 a[238:239], v221 offset:13952
    v_mfma_f32_16x16x32_bf16 v[152:155], a[244:247], a[124:127], v[152:155]
    s_waitcnt lgkmcnt(4)
    v_mfma_f32_16x16x32_bf16 v[12:15], a[224:227], a[96:99], 0
    ds_read_b64_tr_b16 a[240:241], v221 offset:136
    v_mfma_f32_16x16x32_bf16 v[12:15], a[228:231], a[112:115], v[12:15]
    v_mfma_f32_16x16x32_bf16 v[60:63], a[224:227], a[100:103], 0
    ds_read_b64_tr_b16 a[242:243], v221 offset:1672
    v_mfma_f32_16x16x32_bf16 v[60:63], a[228:231], a[116:119], v[60:63]
    v_mfma_f32_16x16x32_bf16 v[108:111], a[224:227], a[104:107], 0
    ds_read_b64_tr_b16 a[244:245], v221 offset:12424
    v_mfma_f32_16x16x32_bf16 v[108:111], a[228:231], a[120:123], v[108:111]
    v_mfma_f32_16x16x32_bf16 v[156:159], a[224:227], a[108:111], 0
    ds_read_b64_tr_b16 a[246:247], v221 offset:13960
    v_mfma_f32_16x16x32_bf16 v[156:159], a[228:231], a[124:127], v[156:159]
    s_waitcnt lgkmcnt(4)
    v_mfma_f32_16x16x32_bf16 v[16:19], a[232:235], a[96:99], 0
    ds_read_b64_tr_b16 a[224:225], v222 offset:128
    v_mfma_f32_16x16x32_bf16 v[16:19], a[236:239], a[112:115], v[16:19]
    v_mfma_f32_16x16x32_bf16 v[64:67], a[232:235], a[100:103], 0
    ds_read_b64_tr_b16 a[226:227], v222 offset:1664
    v_mfma_f32_16x16x32_bf16 v[64:67], a[236:239], a[116:119], v[64:67]
    v_mfma_f32_16x16x32_bf16 v[112:115], a[232:235], a[104:107], 0
    ds_read_b64_tr_b16 a[228:229], v222 offset:12416
    v_mfma_f32_16x16x32_bf16 v[112:115], a[236:239], a[120:123], v[112:115]
    v_mfma_f32_16x16x32_bf16 v[160:163], a[232:235], a[108:111], 0
    ds_read_b64_tr_b16 a[230:231], v222 offset:13952
    v_mfma_f32_16x16x32_bf16 v[160:163], a[236:239], a[124:127], v[160:163]
    s_waitcnt lgkmcnt(4)
    v_mfma_f32_16x16x32_bf16 v[20:23], a[240:243], a[96:99], 0
    ds_read_b64_tr_b16 a[232:233], v222 offset:136
    v_mfma_f32_16x16x32_bf16 v[20:23], a[244:247], a[112:115], v[20:23]
    v_mfma_f32_16x16x32_bf16 v[68:71], a[240:243], a[100:103], 0
    ds_read_b64_tr_b16 a[234:235], v222 offset:1672
    v_mfma_f32_16x16x32_bf16 v[68:71], a[244:247], a[116:119], v[68:71]
    v_mfma_f32_16x16x32_bf16 v[116:119], a[240:243], a[104:107], 0
    ds_read_b64_tr_b16 a[236:237], v222 offset:12424
    v_mfma_f32_16x16x32_bf16 v[116:119], a[244:247], a[120:123], v[116:119]
    v_mfma_f32_16x16x32_bf16 v[164:167], a[240:243], a[108:111], 0
    ds_read_b64_tr_b16 a[238:239], v222 offset:13960
    v_mfma_f32_16x16x32_bf16 v[164:167], a[244:247], a[124:127], v[164:167]
    s_waitcnt lgkmcnt(4)
    v_mfma_f32_16x16x32_bf16 v[24:27], a[224:227], a[96:99], 0
    ds_read_b64_tr_b16 a[240:241], v221 offset:256
    v_mfma_f32_16x16x32_bf16 v[24:27], a[228:231], a[112:115], v[24:27]
    v_mfma_f32_16x16x32_bf16 v[72:75], a[224:227], a[100:103], 0
    ds_read_b64_tr_b16 a[242:243], v221 offset:1792
    v_mfma_f32_16x16x32_bf16 v[72:75], a[228:231], a[116:119], v[72:75]
    v_mfma_f32_16x16x32_bf16 v[120:123], a[224:227], a[104:107], 0
    ds_read_b64_tr_b16 a[244:245], v221 offset:12544
    v_mfma_f32_16x16x32_bf16 v[120:123], a[228:231], a[120:123], v[120:123]
    v_mfma_f32_16x16x32_bf16 v[168:171], a[224:227], a[108:111], 0
    ds_read_b64_tr_b16 a[246:247], v221 offset:14080
    v_mfma_f32_16x16x32_bf16 v[168:171], a[228:231], a[124:127], v[168:171]
    s_waitcnt lgkmcnt(4)
    v_mfma_f32_16x16x32_bf16 v[28:31], a[232:235], a[96:99], 0
    ds_read_b64_tr_b16 a[224:225], v221 offset:264
    v_mfma_f32_16x16x32_bf16 v[28:31], a[236:239], a[112:115], v[28:31]
    v_mfma_f32_16x16x32_bf16 v[76:79], a[232:235], a[100:103], 0
    ds_read_b64_tr_b16 a[226:227], v221 offset:1800
    v_mfma_f32_16x16x32_bf16 v[76:79], a[236:239], a[116:119], v[76:79]
    v_mfma_f32_16x16x32_bf16 v[124:127], a[232:235], a[104:107], 0
    ds_read_b64_tr_b16 a[228:229], v221 offset:12552
    v_mfma_f32_16x16x32_bf16 v[124:127], a[236:239], a[120:123], v[124:127]
    v_mfma_f32_16x16x32_bf16 v[172:175], a[232:235], a[108:111], 0
    ds_read_b64_tr_b16 a[230:231], v221 offset:14088
    v_mfma_f32_16x16x32_bf16 v[172:175], a[236:239], a[124:127], v[172:175]
    s_waitcnt lgkmcnt(4)
    v_mfma_f32_16x16x32_bf16 v[32:35], a[240:243], a[96:99], 0
    ds_read_b64_tr_b16 a[232:233], v222 offset:256
    v_mfma_f32_16x16x32_bf16 v[32:35], a[244:247], a[112:115], v[32:35]
    v_mfma_f32_16x16x32_bf16 v[80:83], a[240:243], a[100:103], 0
    ds_read_b64_tr_b16 a[234:235], v222 offset:1792
    v_mfma_f32_16x16x32_bf16 v[80:83], a[244:247], a[116:119], v[80:83]
    v_mfma_f32_16x16x32_bf16 v[128:131], a[240:243], a[104:107], 0
    ds_read_b64_tr_b16 a[236:237], v222 offset:12544
    v_mfma_f32_16x16x32_bf16 v[128:131], a[244:247], a[120:123], v[128:131]
    v_mfma_f32_16x16x32_bf16 v[176:179], a[240:243], a[108:111], 0
    ds_read_b64_tr_b16 a[238:239], v222 offset:14080
    v_mfma_f32_16x16x32_bf16 v[176:179], a[244:247], a[124:127], v[176:179]
    s_waitcnt lgkmcnt(4)
    v_mfma_f32_16x16x32_bf16 v[36:39], a[224:227], a[96:99], 0
    ds_read_b64_tr_b16 a[240:241], v222 offset:264
    v_mfma_f32_16x16x32_bf16 v[36:39], a[228:231], a[112:115], v[36:39]
    v_mfma_f32_16x16x32_bf16 v[84:87], a[224:227], a[100:103], 0
    ds_read_b64_tr_b16 a[242:243], v222 offset:1800
    v_mfma_f32_16x16x32_bf16 v[84:87], a[228:231], a[116:119], v[84:87]
    v_mfma_f32_16x16x32_bf16 v[132:135], a[224:227], a[104:107], 0
    ds_read_b64_tr_b16 a[244:245], v222 offset:12552
    v_mfma_f32_16x16x32_bf16 v[132:135], a[228:231], a[120:123], v[132:135]
    v_mfma_f32_16x16x32_bf16 v[180:183], a[224:227], a[108:111], 0
    ds_read_b64_tr_b16 a[246:247], v222 offset:14088
    v_mfma_f32_16x16x32_bf16 v[180:183], a[228:231], a[124:127], v[180:183]
    s_waitcnt lgkmcnt(4)
    s_barrier
    v_mfma_f32_16x16x32_bf16 v[40:43], a[232:235], a[96:99], 0
    ds_read_b64_tr_b16 a[224:225], v224 offset:36864
    v_mfma_f32_16x16x32_bf16 v[40:43], a[236:239], a[112:115], v[40:43]
    v_mfma_f32_16x16x32_bf16 v[88:91], a[232:235], a[100:103], 0
    ds_read_b64_tr_b16 a[226:227], v224 offset:37248
    v_mfma_f32_16x16x32_bf16 v[88:91], a[236:239], a[116:119], v[88:91]
    v_mfma_f32_16x16x32_bf16 v[136:139], a[232:235], a[104:107], 0
    ds_read_b64_tr_b16 a[228:229], v224 offset:39936
    v_mfma_f32_16x16x32_bf16 v[136:139], a[236:239], a[120:123], v[136:139]
    v_mfma_f32_16x16x32_bf16 v[184:187], a[232:235], a[108:111], 0
    ds_read_b64_tr_b16 a[230:231], v224 offset:40320
    v_mfma_f32_16x16x32_bf16 v[184:187], a[236:239], a[124:127], v[184:187]
    s_waitcnt lgkmcnt(4)
    v_mfma_f32_16x16x32_bf16 v[44:47], a[240:243], a[96:99], 0
    ds_read_b64_tr_b16 a[232:233], v224 offset:43008
    v_mfma_f32_16x16x32_bf16 v[44:47], a[244:247], a[112:115], v[44:47]
    v_mfma_f32_16x16x32_bf16 v[92:95], a[240:243], a[100:103], 0
    ds_read_b64_tr_b16 a[234:235], v224 offset:43392
    v_mfma_f32_16x16x32_bf16 v[92:95], a[244:247], a[116:119], v[92:95]
    v_mfma_f32_16x16x32_bf16 v[140:143], a[240:243], a[104:107], 0
    ds_read_b64_tr_b16 a[236:237], v224 offset:46080
    v_mfma_f32_16x16x32_bf16 v[140:143], a[244:247], a[120:123], v[140:143]
    v_mfma_f32_16x16x32_bf16 v[188:191], a[240:243], a[108:111], 0
    ds_read_b64_tr_b16 a[238:239], v224 offset:46464
    s_mov_b32 s33, 393216
    v_mfma_f32_16x16x32_bf16 v[188:191], a[244:247], a[124:127], v[188:191]
    s_waitcnt vmcnt(1) lgkmcnt(4)
    v_mfma_f32_16x16x32_bf16 a[0:3], a[224:227], a[128:131], a[0:3]
    ds_read_b64_tr_b16 a[240:241], v224 offset:36896
    s_add_u32 m0, s31, 24576
    v_mfma_f32_16x16x32_bf16 a[0:3], a[228:231], a[144:147], a[0:3]
    buffer_load_dwordx4 v216, s[8:11], s33 offen lds
    v_mfma_f32_16x16x32_bf16 a[4:7], a[224:227], a[132:135], a[4:7]
    ds_read_b64_tr_b16 a[242:243], v224 offset:37280
    s_mul_i32 s40, s29, 786432
    v_mfma_f32_16x16x32_bf16 a[4:7], a[228:231], a[148:151], a[4:7]
    s_add_u32 s16, s44, s40
    s_addc_u32 s17, s45, 0
    v_mfma_f32_16x16x32_bf16 a[8:11], a[224:227], a[136:139], a[8:11]
    ds_read_b64_tr_b16 a[244:245], v224 offset:39968
    s_add_u32 m0, s31, 25600
    v_mfma_f32_16x16x32_bf16 a[8:11], a[228:231], a[152:155], a[8:11]
    buffer_load_dwordx4 v217, s[8:11], s33 offen lds
    v_mfma_f32_16x16x32_bf16 a[12:15], a[224:227], a[140:143], a[12:15]
    ds_read_b64_tr_b16 a[246:247], v224 offset:40352
    s_mov_b32 s18, 0x000c0000
    v_mfma_f32_16x16x32_bf16 a[12:15], a[228:231], a[156:159], a[12:15]
    s_waitcnt lgkmcnt(4)
    s_mov_b32 s19, 0x20000
    v_mfma_f32_16x16x32_bf16 a[48:51], a[232:235], a[128:131], a[48:51]
    ds_read_b64_tr_b16 a[224:225], v224 offset:43040
    s_add_u32 m0, s31, 26624
    v_mfma_f32_16x16x32_bf16 a[48:51], a[236:239], a[144:147], a[48:51]
    buffer_load_dwordx4 v218, s[8:11], s33 offen lds
    v_mfma_f32_16x16x32_bf16 a[52:55], a[232:235], a[132:135], a[52:55]
    ds_read_b64_tr_b16 a[226:227], v224 offset:43424
    v_mfma_f32_16x16x32_bf16 a[52:55], a[236:239], a[148:151], a[52:55]
    s_mov_b32 s33, 1572864
    s_add_u32 s20, s46, s40
    s_addc_u32 s21, s47, 0
    v_mfma_f32_16x16x32_bf16 a[56:59], a[232:235], a[136:139], a[56:59]
    ds_read_b64_tr_b16 a[228:229], v224 offset:46112
    s_add_u32 m0, s32, 0
    v_mfma_f32_16x16x32_bf16 a[56:59], a[236:239], a[152:155], a[56:59]
    buffer_load_dwordx4 v213, s[4:7], s33 offen lds
    v_mfma_f32_16x16x32_bf16 a[60:63], a[232:235], a[140:143], a[60:63]
    ds_read_b64_tr_b16 a[230:231], v224 offset:46496
    s_mov_b32 s22, 0x000c0000
    v_mfma_f32_16x16x32_bf16 a[60:63], a[236:239], a[156:159], a[60:63]
    s_waitcnt lgkmcnt(4)
    s_mov_b32 s23, 0x20000
    v_mfma_f32_16x16x32_bf16 a[16:19], a[240:243], a[128:131], a[16:19]
    ds_read_b64_tr_b16 a[232:233], v224 offset:36928
    s_add_u32 m0, s32, 1024
    v_mfma_f32_16x16x32_bf16 a[16:19], a[244:247], a[144:147], a[16:19]
    buffer_load_dwordx4 v214, s[4:7], s33 offen lds
    v_mfma_f32_16x16x32_bf16 a[20:23], a[240:243], a[132:135], a[20:23]
    ds_read_b64_tr_b16 a[234:235], v224 offset:37312
    s_mul_i32 s40, s30, 983040
    v_mfma_f32_16x16x32_bf16 a[20:23], a[244:247], a[148:151], a[20:23]
    s_add_u32 s40, s40, 0x00400000
    v_mfma_f32_16x16x32_bf16 a[24:27], a[240:243], a[136:139], a[24:27]
    ds_read_b64_tr_b16 a[236:237], v224 offset:40000
    s_add_u32 m0, s32, 2048
    v_mfma_f32_16x16x32_bf16 a[24:27], a[244:247], a[152:155], a[24:27]
    buffer_load_dwordx4 v215, s[4:7], s33 offen lds
    v_mfma_f32_16x16x32_bf16 a[28:31], a[240:243], a[140:143], a[28:31]
    ds_read_b64_tr_b16 a[238:239], v224 offset:40384
    s_mov_b32 s33, 1671168
    v_mfma_f32_16x16x32_bf16 a[28:31], a[244:247], a[156:159], a[28:31]
    s_waitcnt lgkmcnt(4)
    s_add_u32 s24, s56, s40
    s_addc_u32 s25, s57, 0
    v_mfma_f32_16x16x32_bf16 a[64:67], a[224:227], a[128:131], a[64:67]
    ds_read_b64_tr_b16 a[240:241], v224 offset:43072
    s_add_u32 m0, s32, 3072
    v_mfma_f32_16x16x32_bf16 a[64:67], a[228:231], a[144:147], a[64:67]
    buffer_load_dwordx4 v213, s[4:7], s33 offen lds
    v_mfma_f32_16x16x32_bf16 a[68:71], a[224:227], a[132:135], a[68:71]
    ds_read_b64_tr_b16 a[242:243], v224 offset:43456
    s_mov_b32 s26, 0x000f0000
    v_mfma_f32_16x16x32_bf16 a[68:71], a[228:231], a[148:151], a[68:71]
    s_mov_b32 s27, 0x20000
    v_mfma_f32_16x16x32_bf16 a[72:75], a[224:227], a[136:139], a[72:75]
    ds_read_b64_tr_b16 a[244:245], v224 offset:46144
    s_add_u32 m0, s32, 4096
    v_mfma_f32_16x16x32_bf16 a[72:75], a[228:231], a[152:155], a[72:75]
    buffer_load_dwordx4 v214, s[4:7], s33 offen lds
    v_mfma_f32_16x16x32_bf16 a[76:79], a[224:227], a[140:143], a[76:79]
    ds_read_b64_tr_b16 a[246:247], v224 offset:46528
    s_mov_b32 s37, 0x47800000
    v_mfma_f32_16x16x32_bf16 a[76:79], a[228:231], a[156:159], a[76:79]
    s_waitcnt lgkmcnt(4)
    s_mov_b32 s95, 0xbfb8aa3b
    v_mfma_f32_16x16x32_bf16 a[32:35], a[232:235], a[128:131], a[32:35]
    ds_read_b64_tr_b16 a[224:225], v221 offset:36864
    s_add_u32 m0, s32, 5120
    v_mfma_f32_16x16x32_bf16 a[32:35], a[236:239], a[144:147], a[32:35]
    buffer_load_dwordx4 v215, s[4:7], s33 offen lds
    v_mfma_f32_16x16x32_bf16 a[36:39], a[232:235], a[132:135], a[36:39]
    ds_read_b64_tr_b16 a[226:227], v221 offset:38400
    v_mfma_f32_16x16x32_bf16 a[36:39], a[236:239], a[148:151], a[36:39]
    s_cmp_lt_u32 s2, 240
    s_cselect_b32 s41, 10240, 0
    v_mfma_f32_16x16x32_bf16 a[40:43], a[232:235], a[136:139], a[40:43]
    ds_read_b64_tr_b16 a[228:229], v221 offset:49152
    s_mov_b32 s34, 16384
    v_mfma_f32_16x16x32_bf16 a[40:43], a[236:239], a[152:155], a[40:43]
    buffer_load_dwordx4 a[160:163], v212, s[12:15], s34 offen offset:0
    v_mfma_f32_16x16x32_bf16 a[44:47], a[232:235], a[140:143], a[44:47]
    ds_read_b64_tr_b16 a[230:231], v221 offset:50688
    s_sub_u32 s42, s2, 48
    v_mfma_f32_16x16x32_bf16 a[44:47], a[236:239], a[156:159], a[44:47]
    s_waitcnt lgkmcnt(4)
    s_mul_i32 s43, s42, 171
    v_mfma_f32_16x16x32_bf16 a[80:83], a[240:243], a[128:131], a[80:83]
    ds_read_b64_tr_b16 a[232:233], v221 offset:36872
    s_lshr_b32 s43, s43, 10
    v_mfma_f32_16x16x32_bf16 a[80:83], a[244:247], a[144:147], a[80:83]
    buffer_load_dwordx4 a[164:167], v212, s[12:15], s34 offen offset:1024
    v_mfma_f32_16x16x32_bf16 a[84:87], a[240:243], a[132:135], a[84:87]
    ds_read_b64_tr_b16 a[234:235], v221 offset:38408
    s_mul_i32 s50, s43, 6
    v_mfma_f32_16x16x32_bf16 a[84:87], a[244:247], a[148:151], a[84:87]
    s_sub_u32 s42, s42, s50
    v_mfma_f32_16x16x32_bf16 a[88:91], a[240:243], a[136:139], a[88:91]
    ds_read_b64_tr_b16 a[236:237], v221 offset:49160
    s_lshl_b32 s42, s42, 3
    v_mfma_f32_16x16x32_bf16 a[88:91], a[244:247], a[152:155], a[88:91]
    buffer_load_dwordx4 a[168:171], v212, s[12:15], s34 offen offset:2048
    v_mfma_f32_16x16x32_bf16 a[92:95], a[240:243], a[140:143], a[92:95]
    ds_read_b64_tr_b16 a[238:239], v221 offset:50696
    s_lshr_b32 s50, s43, 3
    v_mfma_f32_16x16x32_bf16 a[92:95], a[244:247], a[156:159], a[92:95]
    s_waitcnt lgkmcnt(4)
    s_mul_i32 s50, s50, 40
    v_mfma_f32_16x16x32_bf16 v[0:3], a[224:227], a[128:131], v[0:3]
    ds_read_b64_tr_b16 a[240:241], v222 offset:36864
    s_add_u32 s42, s42, s50
    v_mfma_f32_16x16x32_bf16 v[0:3], a[228:231], a[144:147], v[0:3]
    buffer_load_dwordx4 a[172:175], v212, s[12:15], s34 offen offset:3072
    v_mfma_f32_16x16x32_bf16 v[48:51], a[224:227], a[132:135], v[48:51]
    ds_read_b64_tr_b16 a[242:243], v222 offset:38400
    s_add_u32 s42, s42, s43
    v_mfma_f32_16x16x32_bf16 v[48:51], a[228:231], a[148:151], v[48:51]
    s_add_u32 s42, s42, 48
    v_mfma_f32_16x16x32_bf16 v[96:99], a[224:227], a[136:139], v[96:99]
    ds_read_b64_tr_b16 a[244:245], v222 offset:49152
    s_mov_b32 s34, 20480
    v_mfma_f32_16x16x32_bf16 v[96:99], a[228:231], a[152:155], v[96:99]
    buffer_load_dwordx4 a[176:179], v212, s[12:15], s34 offen offset:0
    v_mfma_f32_16x16x32_bf16 v[144:147], a[224:227], a[140:143], v[144:147]
    ds_read_b64_tr_b16 a[246:247], v222 offset:50688
    v_mfma_f32_16x16x32_bf16 v[144:147], a[228:231], a[156:159], v[144:147]
    s_waitcnt lgkmcnt(4)
    s_cmp_lt_u32 s2, 48
    s_cselect_b32 s42, s2, s42
    v_mfma_f32_16x16x32_bf16 v[4:7], a[232:235], a[128:131], v[4:7]
    ds_read_b64_tr_b16 a[224:225], v222 offset:36872
    s_mul_i32 s40, s42, 40960
    v_mfma_f32_16x16x32_bf16 v[4:7], a[236:239], a[144:147], v[4:7]
    buffer_load_dwordx4 a[180:183], v212, s[12:15], s34 offen offset:1024
    v_mfma_f32_16x16x32_bf16 v[52:55], a[232:235], a[132:135], v[52:55]
    ds_read_b64_tr_b16 a[226:227], v222 offset:38408
    s_add_u32 s40, s40, 0x02800000
    v_mfma_f32_16x16x32_bf16 v[52:55], a[236:239], a[148:151], v[52:55]
    s_mul_i32 s42, s28, 10240
    v_mfma_f32_16x16x32_bf16 v[100:103], a[232:235], a[136:139], v[100:103]
    ds_read_b64_tr_b16 a[228:229], v222 offset:49160
    s_add_u32 s40, s40, s42
    v_mfma_f32_16x16x32_bf16 v[100:103], a[236:239], a[152:155], v[100:103]
    buffer_load_dwordx4 a[184:187], v212, s[12:15], s34 offen offset:2048
    v_mfma_f32_16x16x32_bf16 v[148:151], a[232:235], a[140:143], v[148:151]
    ds_read_b64_tr_b16 a[230:231], v222 offset:50696
    v_mfma_f32_16x16x32_bf16 v[148:151], a[236:239], a[156:159], v[148:151]
    s_waitcnt lgkmcnt(4)
    s_add_u32 s68, s56, s40
    s_addc_u32 s69, s57, 0
    v_mfma_f32_16x16x32_bf16 v[8:11], a[240:243], a[128:131], v[8:11]
    ds_read_b64_tr_b16 a[232:233], v221 offset:36992
    s_mov_b32 s70, s41
    v_mfma_f32_16x16x32_bf16 v[8:11], a[244:247], a[144:147], v[8:11]
    buffer_load_dwordx4 a[188:191], v212, s[12:15], s34 offen offset:3072
    v_mfma_f32_16x16x32_bf16 v[56:59], a[240:243], a[132:135], v[56:59]
    ds_read_b64_tr_b16 a[234:235], v221 offset:38528
    s_mov_b32 s71, 0x20000
    v_mfma_f32_16x16x32_bf16 v[56:59], a[244:247], a[148:151], v[56:59]
    s_and_b32 s40, s2, 1
    v_mfma_f32_16x16x32_bf16 v[104:107], a[240:243], a[136:139], v[104:107]
    ds_read_b64_tr_b16 a[236:237], v221 offset:49280
    s_add_u32 s91, s91, s90
    v_mfma_f32_16x16x32_bf16 v[104:107], a[244:247], a[152:155], v[104:107]
    buffer_load_dword v252, v232, s[64:67], s91 offen
    v_mfma_f32_16x16x32_bf16 v[152:155], a[240:243], a[140:143], v[152:155]
    ds_read_b64_tr_b16 a[238:239], v221 offset:50816
    s_lshl_b32 s40, s40, 3
    v_mfma_f32_16x16x32_bf16 v[152:155], a[244:247], a[156:159], v[152:155]
    s_waitcnt lgkmcnt(4)
    s_lshr_b32 s41, s2, 3
    v_mfma_f32_16x16x32_bf16 v[12:15], a[224:227], a[128:131], v[12:15]
    ds_read_b64_tr_b16 a[240:241], v221 offset:37000
    s_add_u32 s91, s91, s90
    v_mfma_f32_16x16x32_bf16 v[12:15], a[228:231], a[144:147], v[12:15]
    buffer_load_dword v252, v232, s[64:67], s91 offen
    v_mfma_f32_16x16x32_bf16 v[60:63], a[224:227], a[132:135], v[60:63]
    ds_read_b64_tr_b16 a[242:243], v221 offset:38536
    s_and_b32 s42, s41, 7
    v_mfma_f32_16x16x32_bf16 v[60:63], a[228:231], a[148:151], v[60:63]
    s_add_u32 s40, s40, s42
    v_mfma_f32_16x16x32_bf16 v[108:111], a[224:227], a[136:139], v[108:111]
    ds_read_b64_tr_b16 a[244:245], v221 offset:49288
    s_lshr_b32 s41, s41, 3
    v_mfma_f32_16x16x32_bf16 v[108:111], a[228:231], a[152:155], v[108:111]
    s_lshl_b32 s40, s40, 2
    v_mfma_f32_16x16x32_bf16 v[156:159], a[224:227], a[140:143], v[156:159]
    ds_read_b64_tr_b16 a[246:247], v221 offset:50824
    s_add_u32 s40, s40, s41
    v_mfma_f32_16x16x32_bf16 v[156:159], a[228:231], a[156:159], v[156:159]
    s_waitcnt lgkmcnt(4)
    s_mul_i32 s40, s40, 327680
    v_mfma_f32_16x16x32_bf16 v[16:19], a[232:235], a[128:131], v[16:19]
    ds_read_b64_tr_b16 a[224:225], v222 offset:36992
    s_add_u32 s40, s40, 0x03400000
    v_mfma_f32_16x16x32_bf16 v[16:19], a[236:239], a[144:147], v[16:19]
    s_add_u32 s60, s56, s40
    s_addc_u32 s61, s57, 0
    v_mfma_f32_16x16x32_bf16 v[64:67], a[232:235], a[132:135], v[64:67]
    ds_read_b64_tr_b16 a[226:227], v222 offset:38528
    s_mov_b32 s62, 0x00050000
    v_mfma_f32_16x16x32_bf16 v[64:67], a[236:239], a[148:151], v[64:67]
    s_mov_b32 s63, 0x20000
    v_mfma_f32_16x16x32_bf16 v[112:115], a[232:235], a[136:139], v[112:115]
    ds_read_b64_tr_b16 a[228:229], v222 offset:49280
    s_lshl_b32 s43, s28, 3
    v_mfma_f32_16x16x32_bf16 v[112:115], a[236:239], a[152:155], v[112:115]
    v_add_u32 v245, s43, v239
    v_mfma_f32_16x16x32_bf16 v[160:163], a[232:235], a[140:143], v[160:163]
    ds_read_b64_tr_b16 a[230:231], v222 offset:50816
    v_lshrrev_b32 v246, 1, v245
    v_mfma_f32_16x16x32_bf16 v[160:163], a[236:239], a[156:159], v[160:163]
    s_waitcnt lgkmcnt(4)
    v_and_b32 v246, 7, v246
    v_mfma_f32_16x16x32_bf16 v[20:23], a[240:243], a[128:131], v[20:23]
    ds_read_b64_tr_b16 a[232:233], v222 offset:37000
    v_xor_b32 v246, v246, v240
    v_mfma_f32_16x16x32_bf16 v[20:23], a[244:247], a[144:147], v[20:23]
    v_mul_u32_u24 v238, 384, v245
    v_mfma_f32_16x16x32_bf16 v[68:71], a[240:243], a[132:135], v[68:71]
    ds_read_b64_tr_b16 a[234:235], v222 offset:38536
    v_lshl_add_u32 v200, v246, 4, v238
    v_mfma_f32_16x16x32_bf16 v[68:71], a[244:247], a[148:151], v[68:71]
    v_and_b32 v246, 6, v245
    v_mfma_f32_16x16x32_bf16 v[116:119], a[240:243], a[136:139], v[116:119]
    ds_read_b64_tr_b16 a[236:237], v222 offset:49288
    v_xor_b32 v246, v246, v240
    v_mfma_f32_16x16x32_bf16 v[116:119], a[244:247], a[152:155], v[116:119]
    v_lshl_add_u32 v203, v246, 4, v238
    v_mfma_f32_16x16x32_bf16 v[164:167], a[240:243], a[140:143], v[164:167]
    ds_read_b64_tr_b16 a[238:239], v222 offset:50824
    v_add_u32 v245, s43, v241
    v_mfma_f32_16x16x32_bf16 v[164:167], a[244:247], a[156:159], v[164:167]
    s_waitcnt lgkmcnt(4)
    v_lshrrev_b32 v246, 1, v245
    v_mfma_f32_16x16x32_bf16 v[24:27], a[224:227], a[128:131], v[24:27]
    ds_read_b64_tr_b16 a[240:241], v221 offset:37120
    v_and_b32 v246, 7, v246
    v_mfma_f32_16x16x32_bf16 v[24:27], a[228:231], a[144:147], v[24:27]
    v_xor_b32 v246, v246, v242
    v_mfma_f32_16x16x32_bf16 v[72:75], a[224:227], a[132:135], v[72:75]
    ds_read_b64_tr_b16 a[242:243], v221 offset:38656
    v_mul_u32_u24 v238, 384, v245
    v_mfma_f32_16x16x32_bf16 v[72:75], a[228:231], a[148:151], v[72:75]
    v_lshl_add_u32 v201, v246, 4, v238
    v_mfma_f32_16x16x32_bf16 v[120:123], a[224:227], a[136:139], v[120:123]
    ds_read_b64_tr_b16 a[244:245], v221 offset:49408
    v_and_b32 v246, 6, v245
    v_mfma_f32_16x16x32_bf16 v[120:123], a[228:231], a[152:155], v[120:123]
    v_xor_b32 v246, v246, v242
    v_mfma_f32_16x16x32_bf16 v[168:171], a[224:227], a[140:143], v[168:171]
    ds_read_b64_tr_b16 a[246:247], v221 offset:50944
    v_lshl_add_u32 v204, v246, 4, v238
    v_mfma_f32_16x16x32_bf16 v[168:171], a[228:231], a[156:159], v[168:171]
    s_waitcnt lgkmcnt(4)
    v_add_u32 v245, s43, v243
    v_mfma_f32_16x16x32_bf16 v[28:31], a[232:235], a[128:131], v[28:31]
    ds_read_b64_tr_b16 a[224:225], v221 offset:37128
    v_lshrrev_b32 v246, 1, v245
    v_mfma_f32_16x16x32_bf16 v[28:31], a[236:239], a[144:147], v[28:31]
    v_and_b32 v246, 7, v246
    v_mfma_f32_16x16x32_bf16 v[76:79], a[232:235], a[132:135], v[76:79]
    ds_read_b64_tr_b16 a[226:227], v221 offset:38664
    v_xor_b32 v246, v246, v244
    v_mfma_f32_16x16x32_bf16 v[76:79], a[236:239], a[148:151], v[76:79]
    v_mul_u32_u24 v238, 384, v245
    v_mfma_f32_16x16x32_bf16 v[124:127], a[232:235], a[136:139], v[124:127]
    ds_read_b64_tr_b16 a[228:229], v221 offset:49416
    v_lshl_add_u32 v202, v246, 4, v238
    v_mfma_f32_16x16x32_bf16 v[124:127], a[236:239], a[152:155], v[124:127]
    v_and_b32 v246, 6, v245
    v_mfma_f32_16x16x32_bf16 v[172:175], a[232:235], a[140:143], v[172:175]
    ds_read_b64_tr_b16 a[230:231], v221 offset:50952
    v_xor_b32 v246, v246, v244
    v_mfma_f32_16x16x32_bf16 v[172:175], a[236:239], a[156:159], v[172:175]
    s_waitcnt lgkmcnt(4)
    v_lshl_add_u32 v205, v246, 4, v238
    v_mfma_f32_16x16x32_bf16 v[32:35], a[240:243], a[128:131], v[32:35]
    ds_read_b64_tr_b16 a[232:233], v222 offset:37120
    v_lshrrev_b32 v241, 1, v248
    v_mfma_f32_16x16x32_bf16 v[32:35], a[244:247], a[144:147], v[32:35]
    v_xor_b32 v241, v241, v247
    v_mfma_f32_16x16x32_bf16 v[80:83], a[240:243], a[132:135], v[80:83]
    ds_read_b64_tr_b16 a[234:235], v222 offset:38656
    v_mul_u32_u24 v242, 384, v248
    v_mfma_f32_16x16x32_bf16 v[80:83], a[244:247], a[148:151], v[80:83]
    v_lshl_add_u32 v206, v241, 4, v242
    v_mfma_f32_16x16x32_bf16 v[128:131], a[240:243], a[136:139], v[128:131]
    ds_read_b64_tr_b16 a[236:237], v222 offset:49408
    v_xor_b32 v241, 4, v241
    v_mfma_f32_16x16x32_bf16 v[128:131], a[244:247], a[152:155], v[128:131]
    v_lshl_add_u32 v207, v241, 4, v242
    v_mfma_f32_16x16x32_bf16 v[176:179], a[240:243], a[140:143], v[176:179]
    ds_read_b64_tr_b16 a[238:239], v222 offset:50944
    v_lshrrev_b32 v241, 2, v236
    v_mfma_f32_16x16x32_bf16 v[176:179], a[244:247], a[156:159], v[176:179]
    s_waitcnt lgkmcnt(4)
    v_mul_u32_u24 v242, 384, v241
    v_mfma_f32_16x16x32_bf16 v[36:39], a[224:227], a[128:131], v[36:39]
    ds_read_b64_tr_b16 a[240:241], v222 offset:37128
    v_lshl_add_u32 v242, v237, 3, v242
    v_mfma_f32_16x16x32_bf16 v[36:39], a[228:231], a[144:147], v[36:39]
    v_add_u32 v242, 49152, v242
    v_mfma_f32_16x16x32_bf16 v[84:87], a[224:227], a[132:135], v[84:87]
    ds_read_b64_tr_b16 a[242:243], v222 offset:38664
    s_lshl_b32 s40, s28, 10
    v_mfma_f32_16x16x32_bf16 v[84:87], a[228:231], a[148:151], v[84:87]
    s_add_u32 s59, s40, 159744
    v_mfma_f32_16x16x32_bf16 v[132:135], a[224:227], a[136:139], v[132:135]
    ds_read_b64_tr_b16 a[244:245], v222 offset:49416
    v_mfma_f32_16x16x32_bf16 v[132:135], a[228:231], a[152:155], v[132:135]
    s_cmp_lt_u32 s2, 48
    s_cselect_b32 s40, 128, 0
    v_mfma_f32_16x16x32_bf16 v[180:183], a[224:227], a[140:143], v[180:183]
    ds_read_b64_tr_b16 a[246:247], v222 offset:50952
    s_mul_i32 s41, s40, 3
    v_mfma_f32_16x16x32_bf16 v[180:183], a[228:231], a[156:159], v[180:183]
    s_waitcnt lgkmcnt(4)
    s_waitcnt vmcnt(10)
    s_barrier
    v_mfma_f32_16x16x32_bf16 v[40:43], a[232:235], a[128:131], v[40:43]
    ds_read_b64_tr_b16 a[224:225], v223 offset:0
    s_sub_u32 s41, 512, s41
    v_mfma_f32_16x16x32_bf16 v[40:43], a[236:239], a[144:147], v[40:43]
    v_mul_u32_u24 v253, s40, v247
    v_mfma_f32_16x16x32_bf16 v[88:91], a[232:235], a[132:135], v[88:91]
    ds_read_b64_tr_b16 a[226:227], v223 offset:384
    v_lshl_add_u32 v226, v236, 3, v253
    v_mfma_f32_16x16x32_bf16 v[88:91], a[236:239], a[148:151], v[88:91]
    v_add_u32 v226, s59, v226
    v_mfma_f32_16x16x32_bf16 v[136:139], a[232:235], a[136:139], v[136:139]
    ds_read_b64_tr_b16 a[228:229], v223 offset:3072
    v_add_u32 v253, s41, v226
    v_mfma_f32_16x16x32_bf16 v[136:139], a[236:239], a[152:155], v[136:139]
    v_lshrrev_b32 v241, 1, v241
    v_mfma_f32_16x16x32_bf16 v[184:187], a[232:235], a[140:143], v[184:187]
    ds_read_b64_tr_b16 a[230:231], v223 offset:3456
    v_and_b32 v241, 3, v241
    v_mfma_f32_16x16x32_bf16 v[184:187], a[236:239], a[156:159], v[184:187]
    s_waitcnt lgkmcnt(4)
    v_xor_b32 v244, 0, v241
    v_mfma_f32_16x16x32_bf16 v[44:47], a[240:243], a[128:131], v[44:47]
    ds_read_b64_tr_b16 a[232:233], v223 offset:6144
    v_lshl_add_u32 v208, v244, 5, v242
    v_mfma_f32_16x16x32_bf16 v[44:47], a[244:247], a[144:147], v[44:47]
    v_xor_b32 v244, 1, v241
    v_mfma_f32_16x16x32_bf16 v[92:95], a[240:243], a[132:135], v[92:95]
    ds_read_b64_tr_b16 a[234:235], v223 offset:6528
    v_lshl_add_u32 v209, v244, 5, v242
    v_mfma_f32_16x16x32_bf16 v[92:95], a[244:247], a[148:151], v[92:95]
    v_xor_b32 v244, 2, v241
    v_mfma_f32_16x16x32_bf16 v[140:143], a[240:243], a[136:139], v[140:143]
    ds_read_b64_tr_b16 a[236:237], v223 offset:9216
    v_lshl_add_u32 v210, v244, 5, v242
    v_mfma_f32_16x16x32_bf16 v[140:143], a[244:247], a[152:155], v[140:143]
    v_xor_b32 v244, 3, v241
    v_mfma_f32_16x16x32_bf16 v[188:191], a[240:243], a[140:143], v[188:191]
    ds_read_b64_tr_b16 a[238:239], v223 offset:9600
    s_mov_b32 s33, 589824
    v_mfma_f32_16x16x32_bf16 v[188:191], a[244:247], a[156:159], v[188:191]
    s_waitcnt vmcnt(2) lgkmcnt(4)
    v_lshl_add_u32 v211, v244, 5, v242
    v_mfma_f32_16x16x32_bf16 a[0:3], a[224:227], a[160:163], a[0:3]
    ds_read_b64_tr_b16 a[240:241], v223 offset:32
    s_add_u32 m0, s31, 61440
    v_mfma_f32_16x16x32_bf16 a[0:3], a[228:231], a[176:179], a[0:3]
    buffer_load_dwordx4 v216, s[8:11], s33 offen lds
    v_mfma_f32_16x16x32_bf16 a[4:7], a[224:227], a[164:167], a[4:7]
    ds_read_b64_tr_b16 a[242:243], v223 offset:416
    v_lshrrev_b32 v241, 1, v236
    v_mfma_f32_16x16x32_bf16 a[4:7], a[228:231], a[180:183], a[4:7]
    v_mul_u32_u24 v241, 1280, v241
    v_mfma_f32_16x16x32_bf16 a[8:11], a[224:227], a[168:171], a[8:11]
    ds_read_b64_tr_b16 a[244:245], v223 offset:3104
    s_add_u32 m0, s31, 62464
    v_mfma_f32_16x16x32_bf16 a[8:11], a[228:231], a[184:187], a[8:11]
    buffer_load_dwordx4 v217, s[8:11], s33 offen lds
    v_mfma_f32_16x16x32_bf16 a[12:15], a[224:227], a[172:175], a[12:15]
    ds_read_b64_tr_b16 a[246:247], v223 offset:3488
    v_and_b32 v242, 1, v236
    v_mfma_f32_16x16x32_bf16 a[12:15], a[228:231], a[188:191], a[12:15]
    s_waitcnt lgkmcnt(4)
    v_lshl_add_u32 v225, v242, 4, v241
    v_mfma_f32_16x16x32_bf16 a[48:51], a[232:235], a[160:163], a[48:51]
    ds_read_b64_tr_b16 a[224:225], v223 offset:6176
    s_add_u32 m0, s31, 63488
    v_mfma_f32_16x16x32_bf16 a[48:51], a[236:239], a[176:179], a[48:51]
    buffer_load_dwordx4 v218, s[8:11], s33 offen lds
    v_mfma_f32_16x16x32_bf16 a[52:55], a[232:235], a[164:167], a[52:55]
    ds_read_b64_tr_b16 a[226:227], v223 offset:6560
    s_mul_i32 s40, s28, 320
    v_mfma_f32_16x16x32_bf16 a[52:55], a[236:239], a[180:183], a[52:55]
    s_mov_b32 s33, 2359296
    v_add_u32 v225, s40, v225
    v_mfma_f32_16x16x32_bf16 a[56:59], a[232:235], a[168:171], a[56:59]
    ds_read_b64_tr_b16 a[228:229], v223 offset:9248
    s_add_u32 m0, s32, 36864
    v_mfma_f32_16x16x32_bf16 a[56:59], a[236:239], a[184:187], a[56:59]
    buffer_load_dwordx4 v213, s[4:7], s33 offen lds
    v_mfma_f32_16x16x32_bf16 a[60:63], a[232:235], a[172:175], a[60:63]
    ds_read_b64_tr_b16 a[230:231], v223 offset:9632
    s_and_b32 s40, s2, 7
    v_mfma_f32_16x16x32_bf16 a[60:63], a[236:239], a[188:191], a[60:63]
    s_waitcnt lgkmcnt(4)
    s_lshr_b32 s40, s40, 1
    v_mfma_f32_16x16x32_bf16 a[16:19], a[240:243], a[160:163], a[16:19]
    ds_read_b64_tr_b16 a[232:233], v223 offset:64
    s_add_u32 m0, s32, 37888
    v_mfma_f32_16x16x32_bf16 a[16:19], a[244:247], a[176:179], a[16:19]
    buffer_load_dwordx4 v214, s[4:7], s33 offen lds
    v_mfma_f32_16x16x32_bf16 a[20:23], a[240:243], a[164:167], a[20:23]
    ds_read_b64_tr_b16 a[234:235], v223 offset:448
    s_mul_i32 s42, s40, 81920
    v_mfma_f32_16x16x32_bf16 a[20:23], a[244:247], a[180:183], a[20:23]
    s_cmp_eq_u32 s40, s28
    s_cselect_b32 s41, 0, 10240
    v_mfma_f32_16x16x32_bf16 a[24:27], a[240:243], a[168:171], a[24:27]
    ds_read_b64_tr_b16 a[236:237], v223 offset:3136
    s_add_u32 m0, s32, 38912
    v_mfma_f32_16x16x32_bf16 a[24:27], a[244:247], a[184:187], a[24:27]
    buffer_load_dwordx4 v215, s[4:7], s33 offen lds
    v_mfma_f32_16x16x32_bf16 a[28:31], a[240:243], a[172:175], a[28:31]
    ds_read_b64_tr_b16 a[238:239], v223 offset:3520
    s_mov_b32 s33, 2457600
    v_mfma_f32_16x16x32_bf16 a[28:31], a[244:247], a[188:191], a[28:31]
    s_waitcnt lgkmcnt(4)
    s_mul_i32 s40, s28, 10240
    v_mfma_f32_16x16x32_bf16 a[64:67], a[224:227], a[160:163], a[64:67]
    ds_read_b64_tr_b16 a[240:241], v223 offset:6208
    s_add_u32 m0, s32, 39936
    v_mfma_f32_16x16x32_bf16 a[64:67], a[228:231], a[176:179], a[64:67]
    buffer_load_dwordx4 v213, s[4:7], s33 offen lds
    v_mfma_f32_16x16x32_bf16 a[68:71], a[224:227], a[164:167], a[68:71]
    ds_read_b64_tr_b16 a[242:243], v223 offset:6592
    s_add_u32 s42, s42, s40
    v_mfma_f32_16x16x32_bf16 a[68:71], a[228:231], a[180:183], a[68:71]
    s_add_u32 s44, s60, s42
    s_addc_u32 s45, s61, 0
    v_mfma_f32_16x16x32_bf16 a[72:75], a[224:227], a[168:171], a[72:75]
    ds_read_b64_tr_b16 a[244:245], v223 offset:9280
    s_add_u32 m0, s32, 40960
    v_mfma_f32_16x16x32_bf16 a[72:75], a[228:231], a[184:187], a[72:75]
    buffer_load_dwordx4 v214, s[4:7], s33 offen lds
    v_mfma_f32_16x16x32_bf16 a[76:79], a[224:227], a[172:175], a[76:79]
    ds_read_b64_tr_b16 a[246:247], v223 offset:9664
    s_mov_b32 s46, s41
    v_mfma_f32_16x16x32_bf16 a[76:79], a[228:231], a[188:191], a[76:79]
    s_waitcnt lgkmcnt(4)
    s_mov_b32 s47, 0x20000
    v_mfma_f32_16x16x32_bf16 a[32:35], a[232:235], a[160:163], a[32:35]
    ds_read_b64_tr_b16 a[224:225], v219 offset:0
    s_add_u32 m0, s32, 41984
    v_mfma_f32_16x16x32_bf16 a[32:35], a[236:239], a[176:179], a[32:35]
    buffer_load_dwordx4 v215, s[4:7], s33 offen lds
    v_mfma_f32_16x16x32_bf16 a[36:39], a[232:235], a[164:167], a[36:39]
    ds_read_b64_tr_b16 a[226:227], v219 offset:1536
    s_mov_b32 s48, 0
    v_mfma_f32_16x16x32_bf16 a[36:39], a[236:239], a[180:183], a[36:39]
    s_mul_i32 s41, s29, 3
    v_mfma_f32_16x16x32_bf16 a[40:43], a[232:235], a[168:171], a[40:43]
    ds_read_b64_tr_b16 a[228:229], v219 offset:12288
    s_mov_b32 s34, 24576
    v_mfma_f32_16x16x32_bf16 a[40:43], a[236:239], a[184:187], a[40:43]
    buffer_load_dwordx4 a[192:195], v212, s[12:15], s34 offen offset:0
    v_mfma_f32_16x16x32_bf16 a[44:47], a[232:235], a[172:175], a[44:47]
    ds_read_b64_tr_b16 a[230:231], v219 offset:13824
    s_add_u32 s41, s41, 0
    v_mfma_f32_16x16x32_bf16 a[44:47], a[236:239], a[188:191], a[44:47]
    s_waitcnt lgkmcnt(4)
    s_and_b32 s42, s41, 1
    v_mfma_f32_16x16x32_bf16 a[80:83], a[240:243], a[160:163], a[80:83]
    ds_read_b64_tr_b16 a[232:233], v219 offset:8
    s_lshl_b32 s42, s42, 9
    v_mfma_f32_16x16x32_bf16 a[80:83], a[244:247], a[176:179], a[80:83]
    buffer_load_dwordx4 a[196:199], v212, s[12:15], s34 offen offset:1024
    v_mfma_f32_16x16x32_bf16 a[84:87], a[240:243], a[164:167], a[84:87]
    ds_read_b64_tr_b16 a[234:235], v219 offset:1544
    s_lshr_b32 s41, s41, 1
    v_mfma_f32_16x16x32_bf16 a[84:87], a[244:247], a[180:183], a[84:87]
    s_lshl_b32 s41, s41, 12
    v_mfma_f32_16x16x32_bf16 a[88:91], a[240:243], a[168:171], a[88:91]
    ds_read_b64_tr_b16 a[236:237], v219 offset:12296
    s_add_u32 s92, s41, s42
    v_mfma_f32_16x16x32_bf16 a[88:91], a[244:247], a[184:187], a[88:91]
    buffer_load_dwordx4 a[200:203], v212, s[12:15], s34 offen offset:2048
    v_mfma_f32_16x16x32_bf16 a[92:95], a[240:243], a[172:175], a[92:95]
    ds_read_b64_tr_b16 a[238:239], v219 offset:13832
    s_mul_i32 s41, s29, 3
    v_mfma_f32_16x16x32_bf16 a[92:95], a[244:247], a[188:191], a[92:95]
    s_waitcnt lgkmcnt(4)
    s_add_u32 s41, s41, 1
    v_mfma_f32_16x16x32_bf16 v[0:3], a[224:227], a[160:163], v[0:3]
    ds_read_b64_tr_b16 a[240:241], v220 offset:0
    s_and_b32 s42, s41, 1
    v_mfma_f32_16x16x32_bf16 v[0:3], a[228:231], a[176:179], v[0:3]
    buffer_load_dwordx4 a[204:207], v212, s[12:15], s34 offen offset:3072
    v_mfma_f32_16x16x32_bf16 v[48:51], a[224:227], a[164:167], v[48:51]
    ds_read_b64_tr_b16 a[242:243], v220 offset:1536
    s_lshl_b32 s42, s42, 9
    v_mfma_f32_16x16x32_bf16 v[48:51], a[228:231], a[180:183], v[48:51]
    s_lshr_b32 s41, s41, 1
    v_mfma_f32_16x16x32_bf16 v[96:99], a[224:227], a[168:171], v[96:99]
    ds_read_b64_tr_b16 a[244:245], v220 offset:12288
    s_mov_b32 s34, 28672
    v_mfma_f32_16x16x32_bf16 v[96:99], a[228:231], a[184:187], v[96:99]
    buffer_load_dwordx4 a[208:211], v212, s[12:15], s34 offen offset:0
    v_mfma_f32_16x16x32_bf16 v[144:147], a[224:227], a[172:175], v[144:147]
    ds_read_b64_tr_b16 a[246:247], v220 offset:13824
    s_lshl_b32 s41, s41, 12
    v_mfma_f32_16x16x32_bf16 v[144:147], a[228:231], a[188:191], v[144:147]
    s_waitcnt lgkmcnt(4)
    s_add_u32 s93, s41, s42
    v_mfma_f32_16x16x32_bf16 v[4:7], a[232:235], a[160:163], v[4:7]
    ds_read_b64_tr_b16 a[224:225], v220 offset:8
    s_mul_i32 s41, s29, 3
    v_mfma_f32_16x16x32_bf16 v[4:7], a[236:239], a[176:179], v[4:7]
    buffer_load_dwordx4 a[212:215], v212, s[12:15], s34 offen offset:1024
    v_mfma_f32_16x16x32_bf16 v[52:55], a[232:235], a[164:167], v[52:55]
    ds_read_b64_tr_b16 a[226:227], v220 offset:1544
    s_add_u32 s41, s41, 2
    v_mfma_f32_16x16x32_bf16 v[52:55], a[236:239], a[180:183], v[52:55]
    s_and_b32 s42, s41, 1
    v_mfma_f32_16x16x32_bf16 v[100:103], a[232:235], a[168:171], v[100:103]
    ds_read_b64_tr_b16 a[228:229], v220 offset:12296
    s_lshl_b32 s42, s42, 9
    v_mfma_f32_16x16x32_bf16 v[100:103], a[236:239], a[184:187], v[100:103]
    buffer_load_dwordx4 a[216:219], v212, s[12:15], s34 offen offset:2048
    v_mfma_f32_16x16x32_bf16 v[148:151], a[232:235], a[172:175], v[148:151]
    ds_read_b64_tr_b16 a[230:231], v220 offset:13832
    s_lshr_b32 s41, s41, 1
    v_mfma_f32_16x16x32_bf16 v[148:151], a[236:239], a[188:191], v[148:151]
    s_waitcnt lgkmcnt(4)
    s_lshl_b32 s41, s41, 12
    v_mfma_f32_16x16x32_bf16 v[8:11], a[240:243], a[160:163], v[8:11]
    ds_read_b64_tr_b16 a[232:233], v219 offset:128
    s_add_u32 s94, s41, s42
    v_mfma_f32_16x16x32_bf16 v[8:11], a[244:247], a[176:179], v[8:11]
    buffer_load_dwordx4 a[220:223], v212, s[12:15], s34 offen offset:3072
    v_mfma_f32_16x16x32_bf16 v[56:59], a[240:243], a[164:167], v[56:59]
    ds_read_b64_tr_b16 a[234:235], v219 offset:1664
    v_and_b32 v255, 512, v212
    v_mfma_f32_16x16x32_bf16 v[56:59], a[244:247], a[180:183], v[56:59]
    v_add_u32 v255, v255, v212
    v_mfma_f32_16x16x32_bf16 v[104:107], a[240:243], a[168:171], v[104:107]
    ds_read_b64_tr_b16 a[236:237], v219 offset:12416
    s_add_u32 s91, s91, s90
    v_mfma_f32_16x16x32_bf16 v[104:107], a[244:247], a[184:187], v[104:107]
    buffer_load_dword v252, v232, s[64:67], s91 offen
    v_mfma_f32_16x16x32_bf16 v[152:155], a[240:243], a[172:175], v[152:155]
    ds_read_b64_tr_b16 a[238:239], v219 offset:13952
    v_mfma_f32_16x16x32_bf16 v[152:155], a[244:247], a[188:191], v[152:155]
    s_waitcnt lgkmcnt(4)
    v_mfma_f32_16x16x32_bf16 v[12:15], a[224:227], a[160:163], v[12:15]
    ds_read_b64_tr_b16 a[240:241], v219 offset:136
    s_add_u32 s91, s91, s90
    v_mfma_f32_16x16x32_bf16 v[12:15], a[228:231], a[176:179], v[12:15]
    buffer_load_dword v252, v232, s[64:67], s91 offen
    v_mfma_f32_16x16x32_bf16 v[60:63], a[224:227], a[164:167], v[60:63]
    ds_read_b64_tr_b16 a[242:243], v219 offset:1672
    v_mfma_f32_16x16x32_bf16 v[60:63], a[228:231], a[180:183], v[60:63]
    v_mfma_f32_16x16x32_bf16 v[108:111], a[224:227], a[168:171], v[108:111]
    ds_read_b64_tr_b16 a[244:245], v219 offset:12424
    v_mfma_f32_16x16x32_bf16 v[108:111], a[228:231], a[184:187], v[108:111]
    v_mfma_f32_16x16x32_bf16 v[156:159], a[224:227], a[172:175], v[156:159]
    ds_read_b64_tr_b16 a[246:247], v219 offset:13960
    v_mfma_f32_16x16x32_bf16 v[156:159], a[228:231], a[188:191], v[156:159]
    s_waitcnt lgkmcnt(4)
    v_mfma_f32_16x16x32_bf16 v[16:19], a[232:235], a[160:163], v[16:19]
    ds_read_b64_tr_b16 a[224:225], v220 offset:128
    v_mfma_f32_16x16x32_bf16 v[16:19], a[236:239], a[176:179], v[16:19]
    v_mfma_f32_16x16x32_bf16 v[64:67], a[232:235], a[164:167], v[64:67]
    ds_read_b64_tr_b16 a[226:227], v220 offset:1664
    v_mfma_f32_16x16x32_bf16 v[64:67], a[236:239], a[180:183], v[64:67]
    v_mfma_f32_16x16x32_bf16 v[112:115], a[232:235], a[168:171], v[112:115]
    ds_read_b64_tr_b16 a[228:229], v220 offset:12416
    v_mfma_f32_16x16x32_bf16 v[112:115], a[236:239], a[184:187], v[112:115]
    v_mfma_f32_16x16x32_bf16 v[160:163], a[232:235], a[172:175], v[160:163]
    ds_read_b64_tr_b16 a[230:231], v220 offset:13952
    v_mfma_f32_16x16x32_bf16 v[160:163], a[236:239], a[188:191], v[160:163]
    s_waitcnt lgkmcnt(4)
    v_mfma_f32_16x16x32_bf16 v[20:23], a[240:243], a[160:163], v[20:23]
    ds_read_b64_tr_b16 a[232:233], v220 offset:136
    v_mfma_f32_16x16x32_bf16 v[20:23], a[244:247], a[176:179], v[20:23]
    v_mfma_f32_16x16x32_bf16 v[68:71], a[240:243], a[164:167], v[68:71]
    ds_read_b64_tr_b16 a[234:235], v220 offset:1672
    v_mfma_f32_16x16x32_bf16 v[68:71], a[244:247], a[180:183], v[68:71]
    v_mfma_f32_16x16x32_bf16 v[116:119], a[240:243], a[168:171], v[116:119]
    ds_read_b64_tr_b16 a[236:237], v220 offset:12424
    v_mfma_f32_16x16x32_bf16 v[116:119], a[244:247], a[184:187], v[116:119]
    v_mfma_f32_16x16x32_bf16 v[164:167], a[240:243], a[172:175], v[164:167]
    ds_read_b64_tr_b16 a[238:239], v220 offset:13960
    v_mfma_f32_16x16x32_bf16 v[164:167], a[244:247], a[188:191], v[164:167]
    s_waitcnt lgkmcnt(4)
    v_mfma_f32_16x16x32_bf16 v[24:27], a[224:227], a[160:163], v[24:27]
    ds_read_b64_tr_b16 a[240:241], v219 offset:256
    v_mfma_f32_16x16x32_bf16 v[24:27], a[228:231], a[176:179], v[24:27]
    v_mfma_f32_16x16x32_bf16 v[72:75], a[224:227], a[164:167], v[72:75]
    ds_read_b64_tr_b16 a[242:243], v219 offset:1792
    v_mfma_f32_16x16x32_bf16 v[72:75], a[228:231], a[180:183], v[72:75]
    v_mfma_f32_16x16x32_bf16 v[120:123], a[224:227], a[168:171], v[120:123]
    ds_read_b64_tr_b16 a[244:245], v219 offset:12544
    v_mfma_f32_16x16x32_bf16 v[120:123], a[228:231], a[184:187], v[120:123]
    v_mfma_f32_16x16x32_bf16 v[168:171], a[224:227], a[172:175], v[168:171]
    ds_read_b64_tr_b16 a[246:247], v219 offset:14080
    v_mfma_f32_16x16x32_bf16 v[168:171], a[228:231], a[188:191], v[168:171]
    s_waitcnt lgkmcnt(4)
    v_mfma_f32_16x16x32_bf16 v[28:31], a[232:235], a[160:163], v[28:31]
    ds_read_b64_tr_b16 a[224:225], v219 offset:264
    v_mfma_f32_16x16x32_bf16 v[28:31], a[236:239], a[176:179], v[28:31]
    v_mfma_f32_16x16x32_bf16 v[76:79], a[232:235], a[164:167], v[76:79]
    ds_read_b64_tr_b16 a[226:227], v219 offset:1800
    v_mfma_f32_16x16x32_bf16 v[76:79], a[236:239], a[180:183], v[76:79]
    v_mfma_f32_16x16x32_bf16 v[124:127], a[232:235], a[168:171], v[124:127]
    ds_read_b64_tr_b16 a[228:229], v219 offset:12552
    v_mfma_f32_16x16x32_bf16 v[124:127], a[236:239], a[184:187], v[124:127]
    v_mfma_f32_16x16x32_bf16 v[172:175], a[232:235], a[172:175], v[172:175]
    ds_read_b64_tr_b16 a[230:231], v219 offset:14088
    v_mfma_f32_16x16x32_bf16 v[172:175], a[236:239], a[188:191], v[172:175]
    s_waitcnt lgkmcnt(4)
    v_mfma_f32_16x16x32_bf16 v[32:35], a[240:243], a[160:163], v[32:35]
    ds_read_b64_tr_b16 a[232:233], v220 offset:256
    v_mfma_f32_16x16x32_bf16 v[32:35], a[244:247], a[176:179], v[32:35]
    v_mfma_f32_16x16x32_bf16 v[80:83], a[240:243], a[164:167], v[80:83]
    ds_read_b64_tr_b16 a[234:235], v220 offset:1792
    v_mfma_f32_16x16x32_bf16 v[80:83], a[244:247], a[180:183], v[80:83]
    v_mfma_f32_16x16x32_bf16 v[128:131], a[240:243], a[168:171], v[128:131]
    ds_read_b64_tr_b16 a[236:237], v220 offset:12544
    v_mfma_f32_16x16x32_bf16 v[128:131], a[244:247], a[184:187], v[128:131]
    v_mfma_f32_16x16x32_bf16 v[176:179], a[240:243], a[172:175], v[176:179]
    ds_read_b64_tr_b16 a[238:239], v220 offset:14080
    v_mfma_f32_16x16x32_bf16 v[176:179], a[244:247], a[188:191], v[176:179]
    s_waitcnt lgkmcnt(4)
    v_mfma_f32_16x16x32_bf16 v[36:39], a[224:227], a[160:163], v[36:39]
    ds_read_b64_tr_b16 a[240:241], v220 offset:264
    v_mfma_f32_16x16x32_bf16 v[36:39], a[228:231], a[176:179], v[36:39]
    v_mfma_f32_16x16x32_bf16 v[84:87], a[224:227], a[164:167], v[84:87]
    ds_read_b64_tr_b16 a[242:243], v220 offset:1800
    v_mfma_f32_16x16x32_bf16 v[84:87], a[228:231], a[180:183], v[84:87]
    v_mfma_f32_16x16x32_bf16 v[132:135], a[224:227], a[168:171], v[132:135]
    ds_read_b64_tr_b16 a[244:245], v220 offset:12552
    v_mfma_f32_16x16x32_bf16 v[132:135], a[228:231], a[184:187], v[132:135]
    v_mfma_f32_16x16x32_bf16 v[180:183], a[224:227], a[172:175], v[180:183]
    ds_read_b64_tr_b16 a[246:247], v220 offset:14088
    v_mfma_f32_16x16x32_bf16 v[180:183], a[228:231], a[188:191], v[180:183]
    s_waitcnt lgkmcnt(4)
    s_waitcnt vmcnt(10)
    s_barrier
    v_mfma_f32_16x16x32_bf16 v[40:43], a[232:235], a[160:163], v[40:43]
    ds_read_b64_tr_b16 a[224:225], v223 offset:36864
    v_mfma_f32_16x16x32_bf16 v[40:43], a[236:239], a[176:179], v[40:43]
    v_mfma_f32_16x16x32_bf16 v[88:91], a[232:235], a[164:167], v[88:91]
    ds_read_b64_tr_b16 a[226:227], v223 offset:37248
    v_mfma_f32_16x16x32_bf16 v[88:91], a[236:239], a[180:183], v[88:91]
    v_mfma_f32_16x16x32_bf16 v[136:139], a[232:235], a[168:171], v[136:139]
    ds_read_b64_tr_b16 a[228:229], v223 offset:39936
    v_mfma_f32_16x16x32_bf16 v[136:139], a[236:239], a[184:187], v[136:139]
    v_mfma_f32_16x16x32_bf16 v[184:187], a[232:235], a[172:175], v[184:187]
    ds_read_b64_tr_b16 a[230:231], v223 offset:40320
    v_mfma_f32_16x16x32_bf16 v[184:187], a[236:239], a[188:191], v[184:187]
    s_waitcnt lgkmcnt(4)
    v_mfma_f32_16x16x32_bf16 v[44:47], a[240:243], a[160:163], v[44:47]
    ds_read_b64_tr_b16 a[232:233], v223 offset:43008
    v_mfma_f32_16x16x32_bf16 v[44:47], a[244:247], a[176:179], v[44:47]
    v_mfma_f32_16x16x32_bf16 v[92:95], a[240:243], a[164:167], v[92:95]
    ds_read_b64_tr_b16 a[234:235], v223 offset:43392
    v_mfma_f32_16x16x32_bf16 v[92:95], a[244:247], a[180:183], v[92:95]
    v_mfma_f32_16x16x32_bf16 v[140:143], a[240:243], a[168:171], v[140:143]
    ds_read_b64_tr_b16 a[236:237], v223 offset:46080
    v_mfma_f32_16x16x32_bf16 v[140:143], a[244:247], a[184:187], v[140:143]
    v_mfma_f32_16x16x32_bf16 v[188:191], a[240:243], a[172:175], v[188:191]
    ds_read_b64_tr_b16 a[238:239], v223 offset:46464
    s_mov_b32 s33, 786432
    v_mfma_f32_16x16x32_bf16 v[188:191], a[244:247], a[188:191], v[188:191]
    s_waitcnt vmcnt(2) lgkmcnt(4)
    v_mfma_f32_16x16x32_bf16 a[0:3], a[224:227], a[192:195], a[0:3]
    ds_read_b64_tr_b16 a[240:241], v223 offset:36896
    s_add_u32 m0, s31, 98304
    v_mfma_f32_16x16x32_bf16 a[0:3], a[228:231], a[208:211], a[0:3]
    buffer_load_dwordx4 v216, s[8:11], s33 offen lds
    v_mfma_f32_16x16x32_bf16 a[4:7], a[224:227], a[196:199], a[4:7]
    ds_read_b64_tr_b16 a[242:243], v223 offset:37280
    v_mfma_f32_16x16x32_bf16 a[4:7], a[228:231], a[212:215], a[4:7]
    v_mfma_f32_16x16x32_bf16 a[8:11], a[224:227], a[200:203], a[8:11]
    ds_read_b64_tr_b16 a[244:245], v223 offset:39968
    s_add_u32 m0, s31, 99328
    v_mfma_f32_16x16x32_bf16 a[8:11], a[228:231], a[216:219], a[8:11]
    buffer_load_dwordx4 v217, s[8:11], s33 offen lds
    v_mfma_f32_16x16x32_bf16 a[12:15], a[224:227], a[204:207], a[12:15]
    ds_read_b64_tr_b16 a[246:247], v223 offset:40352
    v_mfma_f32_16x16x32_bf16 a[12:15], a[228:231], a[220:223], a[12:15]
    s_waitcnt lgkmcnt(4)
    v_mfma_f32_16x16x32_bf16 a[48:51], a[232:235], a[192:195], a[48:51]
    ds_read_b64_tr_b16 a[224:225], v223 offset:43040
    s_add_u32 m0, s31, 100352
    v_mfma_f32_16x16x32_bf16 a[48:51], a[236:239], a[208:211], a[48:51]
    buffer_load_dwordx4 v218, s[8:11], s33 offen lds
    v_mfma_f32_16x16x32_bf16 a[52:55], a[232:235], a[196:199], a[52:55]
    ds_read_b64_tr_b16 a[226:227], v223 offset:43424
    v_mfma_f32_16x16x32_bf16 a[52:55], a[236:239], a[212:215], a[52:55]
    s_mov_b32 s33, 3145728
    v_mfma_f32_16x16x32_bf16 a[56:59], a[232:235], a[200:203], a[56:59]
    ds_read_b64_tr_b16 a[228:229], v223 offset:46112
    s_add_u32 m0, s32, 73728
    v_mfma_f32_16x16x32_bf16 a[56:59], a[236:239], a[216:219], a[56:59]
    buffer_load_dwordx4 v213, s[4:7], s33 offen lds
    v_mfma_f32_16x16x32_bf16 a[60:63], a[232:235], a[204:207], a[60:63]
    ds_read_b64_tr_b16 a[230:231], v223 offset:46496
    v_mfma_f32_16x16x32_bf16 a[60:63], a[236:239], a[220:223], a[60:63]
    s_waitcnt lgkmcnt(4)
    v_mfma_f32_16x16x32_bf16 a[16:19], a[240:243], a[192:195], a[16:19]
    ds_read_b64_tr_b16 a[232:233], v223 offset:36928
    s_add_u32 m0, s32, 74752
    v_mfma_f32_16x16x32_bf16 a[16:19], a[244:247], a[208:211], a[16:19]
    buffer_load_dwordx4 v214, s[4:7], s33 offen lds
    v_mfma_f32_16x16x32_bf16 a[20:23], a[240:243], a[196:199], a[20:23]
    ds_read_b64_tr_b16 a[234:235], v223 offset:37312
    v_mfma_f32_16x16x32_bf16 a[20:23], a[244:247], a[212:215], a[20:23]
    v_mfma_f32_16x16x32_bf16 a[24:27], a[240:243], a[200:203], a[24:27]
    ds_read_b64_tr_b16 a[236:237], v223 offset:40000
    s_add_u32 m0, s32, 75776
    v_mfma_f32_16x16x32_bf16 a[24:27], a[244:247], a[216:219], a[24:27]
    buffer_load_dwordx4 v215, s[4:7], s33 offen lds
    v_mfma_f32_16x16x32_bf16 a[28:31], a[240:243], a[204:207], a[28:31]
    ds_read_b64_tr_b16 a[238:239], v223 offset:40384
    s_mov_b32 s33, 3244032
    v_mfma_f32_16x16x32_bf16 a[28:31], a[244:247], a[220:223], a[28:31]
    s_waitcnt lgkmcnt(4)
    v_mfma_f32_16x16x32_bf16 a[64:67], a[224:227], a[192:195], a[64:67]
    ds_read_b64_tr_b16 a[240:241], v223 offset:43072
    s_add_u32 m0, s32, 76800
    v_mfma_f32_16x16x32_bf16 a[64:67], a[228:231], a[208:211], a[64:67]
    buffer_load_dwordx4 v213, s[4:7], s33 offen lds
    v_mfma_f32_16x16x32_bf16 a[68:71], a[224:227], a[196:199], a[68:71]
    ds_read_b64_tr_b16 a[242:243], v223 offset:43456
    v_mfma_f32_16x16x32_bf16 a[68:71], a[228:231], a[212:215], a[68:71]
    v_mfma_f32_16x16x32_bf16 a[72:75], a[224:227], a[200:203], a[72:75]
    ds_read_b64_tr_b16 a[244:245], v223 offset:46144
    s_add_u32 m0, s32, 77824
    v_mfma_f32_16x16x32_bf16 a[72:75], a[228:231], a[216:219], a[72:75]
    buffer_load_dwordx4 v214, s[4:7], s33 offen lds
    v_mfma_f32_16x16x32_bf16 a[76:79], a[224:227], a[204:207], a[76:79]
    ds_read_b64_tr_b16 a[246:247], v223 offset:46528
    v_mfma_f32_16x16x32_bf16 a[76:79], a[228:231], a[220:223], a[76:79]
    s_waitcnt lgkmcnt(4)
    v_mfma_f32_16x16x32_bf16 a[32:35], a[232:235], a[192:195], a[32:35]
    ds_read_b64_tr_b16 a[224:225], v219 offset:36864
    s_add_u32 m0, s32, 78848
    v_mfma_f32_16x16x32_bf16 a[32:35], a[236:239], a[208:211], a[32:35]
    buffer_load_dwordx4 v215, s[4:7], s33 offen lds
    v_mfma_f32_16x16x32_bf16 a[36:39], a[232:235], a[196:199], a[36:39]
    ds_read_b64_tr_b16 a[226:227], v219 offset:38400
    v_mfma_f32_16x16x32_bf16 a[36:39], a[236:239], a[212:215], a[36:39]
    v_mfma_f32_16x16x32_bf16 a[40:43], a[232:235], a[200:203], a[40:43]
    ds_read_b64_tr_b16 a[228:229], v219 offset:49152
    s_mov_b32 s34, 32768
    v_mfma_f32_16x16x32_bf16 a[40:43], a[236:239], a[216:219], a[40:43]
    buffer_load_dwordx4 a[96:99], v212, s[12:15], s34 offen offset:0
    v_mfma_f32_16x16x32_bf16 a[44:47], a[232:235], a[204:207], a[44:47]
    ds_read_b64_tr_b16 a[230:231], v219 offset:50688
    v_mfma_f32_16x16x32_bf16 a[44:47], a[236:239], a[220:223], a[44:47]
    s_waitcnt lgkmcnt(4)
    v_mfma_f32_16x16x32_bf16 a[80:83], a[240:243], a[192:195], a[80:83]
    ds_read_b64_tr_b16 a[232:233], v219 offset:36872
    v_mfma_f32_16x16x32_bf16 a[80:83], a[244:247], a[208:211], a[80:83]
    buffer_load_dwordx4 a[100:103], v212, s[12:15], s34 offen offset:1024
    v_mfma_f32_16x16x32_bf16 a[84:87], a[240:243], a[196:199], a[84:87]
    ds_read_b64_tr_b16 a[234:235], v219 offset:38408
    v_mfma_f32_16x16x32_bf16 a[84:87], a[244:247], a[212:215], a[84:87]
    v_mfma_f32_16x16x32_bf16 a[88:91], a[240:243], a[200:203], a[88:91]
    ds_read_b64_tr_b16 a[236:237], v219 offset:49160
    v_mfma_f32_16x16x32_bf16 a[88:91], a[244:247], a[216:219], a[88:91]
    buffer_load_dwordx4 a[104:107], v212, s[12:15], s34 offen offset:2048
    v_mfma_f32_16x16x32_bf16 a[92:95], a[240:243], a[204:207], a[92:95]
    ds_read_b64_tr_b16 a[238:239], v219 offset:50696
    v_mfma_f32_16x16x32_bf16 a[92:95], a[244:247], a[220:223], a[92:95]
    s_waitcnt lgkmcnt(4)
    v_mfma_f32_16x16x32_bf16 v[0:3], a[224:227], a[192:195], v[0:3]
    ds_read_b64_tr_b16 a[240:241], v220 offset:36864
    v_mfma_f32_16x16x32_bf16 v[0:3], a[228:231], a[208:211], v[0:3]
    buffer_load_dwordx4 a[108:111], v212, s[12:15], s34 offen offset:3072
    v_mfma_f32_16x16x32_bf16 v[48:51], a[224:227], a[196:199], v[48:51]
    ds_read_b64_tr_b16 a[242:243], v220 offset:38400
    v_mfma_f32_16x16x32_bf16 v[48:51], a[228:231], a[212:215], v[48:51]
    v_mfma_f32_16x16x32_bf16 v[96:99], a[224:227], a[200:203], v[96:99]
    ds_read_b64_tr_b16 a[244:245], v220 offset:49152
    s_mov_b32 s34, 36864
    v_mfma_f32_16x16x32_bf16 v[96:99], a[228:231], a[216:219], v[96:99]
    buffer_load_dwordx4 a[112:115], v212, s[12:15], s34 offen offset:0
    v_mfma_f32_16x16x32_bf16 v[144:147], a[224:227], a[204:207], v[144:147]
    ds_read_b64_tr_b16 a[246:247], v220 offset:50688
    v_mfma_f32_16x16x32_bf16 v[144:147], a[228:231], a[220:223], v[144:147]
    s_waitcnt lgkmcnt(4)
    v_mfma_f32_16x16x32_bf16 v[4:7], a[232:235], a[192:195], v[4:7]
    ds_read_b64_tr_b16 a[224:225], v220 offset:36872
    v_mfma_f32_16x16x32_bf16 v[4:7], a[236:239], a[208:211], v[4:7]
    buffer_load_dwordx4 a[116:119], v212, s[12:15], s34 offen offset:1024
    v_mfma_f32_16x16x32_bf16 v[52:55], a[232:235], a[196:199], v[52:55]
    ds_read_b64_tr_b16 a[226:227], v220 offset:38408
    v_mfma_f32_16x16x32_bf16 v[52:55], a[236:239], a[212:215], v[52:55]
    v_mfma_f32_16x16x32_bf16 v[100:103], a[232:235], a[200:203], v[100:103]
    ds_read_b64_tr_b16 a[228:229], v220 offset:49160
    v_mfma_f32_16x16x32_bf16 v[100:103], a[236:239], a[216:219], v[100:103]
    buffer_load_dwordx4 a[120:123], v212, s[12:15], s34 offen offset:2048
    v_mfma_f32_16x16x32_bf16 v[148:151], a[232:235], a[204:207], v[148:151]
    ds_read_b64_tr_b16 a[230:231], v220 offset:50696
    v_mfma_f32_16x16x32_bf16 v[148:151], a[236:239], a[220:223], v[148:151]
    s_waitcnt lgkmcnt(4)
    v_mfma_f32_16x16x32_bf16 v[8:11], a[240:243], a[192:195], v[8:11]
    ds_read_b64_tr_b16 a[232:233], v219 offset:36992
    v_mfma_f32_16x16x32_bf16 v[8:11], a[244:247], a[208:211], v[8:11]
    buffer_load_dwordx4 a[124:127], v212, s[12:15], s34 offen offset:3072
    v_mfma_f32_16x16x32_bf16 v[56:59], a[240:243], a[196:199], v[56:59]
    ds_read_b64_tr_b16 a[234:235], v219 offset:38528
    v_mfma_f32_16x16x32_bf16 v[56:59], a[244:247], a[212:215], v[56:59]
    v_mfma_f32_16x16x32_bf16 v[104:107], a[240:243], a[200:203], v[104:107]
    ds_read_b64_tr_b16 a[236:237], v219 offset:49280
    s_add_u32 s91, s91, s90
    v_mfma_f32_16x16x32_bf16 v[104:107], a[244:247], a[216:219], v[104:107]
    buffer_load_dword v252, v232, s[64:67], s91 offen
    v_mfma_f32_16x16x32_bf16 v[152:155], a[240:243], a[204:207], v[152:155]
    ds_read_b64_tr_b16 a[238:239], v219 offset:50816
    v_mfma_f32_16x16x32_bf16 v[152:155], a[244:247], a[220:223], v[152:155]
    s_waitcnt lgkmcnt(4)
    v_mfma_f32_16x16x32_bf16 v[12:15], a[224:227], a[192:195], v[12:15]
    ds_read_b64_tr_b16 a[240:241], v219 offset:37000
    v_mfma_f32_16x16x32_bf16 v[12:15], a[228:231], a[208:211], v[12:15]
    v_mfma_f32_16x16x32_bf16 v[60:63], a[224:227], a[196:199], v[60:63]
    ds_read_b64_tr_b16 a[242:243], v219 offset:38536
    v_mfma_f32_16x16x32_bf16 v[60:63], a[228:231], a[212:215], v[60:63]
    v_mfma_f32_16x16x32_bf16 v[108:111], a[224:227], a[200:203], v[108:111]
    ds_read_b64_tr_b16 a[244:245], v219 offset:49288
    v_mfma_f32_16x16x32_bf16 v[108:111], a[228:231], a[216:219], v[108:111]
    v_mfma_f32_16x16x32_bf16 v[156:159], a[224:227], a[204:207], v[156:159]
    ds_read_b64_tr_b16 a[246:247], v219 offset:50824
    v_mfma_f32_16x16x32_bf16 v[156:159], a[228:231], a[220:223], v[156:159]
    s_waitcnt lgkmcnt(4)
    v_mfma_f32_16x16x32_bf16 v[16:19], a[232:235], a[192:195], v[16:19]
    ds_read_b64_tr_b16 a[224:225], v220 offset:36992
    v_mfma_f32_16x16x32_bf16 v[16:19], a[236:239], a[208:211], v[16:19]
    v_mfma_f32_16x16x32_bf16 v[64:67], a[232:235], a[196:199], v[64:67]
    ds_read_b64_tr_b16 a[226:227], v220 offset:38528
    v_mfma_f32_16x16x32_bf16 v[64:67], a[236:239], a[212:215], v[64:67]
    v_mfma_f32_16x16x32_bf16 v[112:115], a[232:235], a[200:203], v[112:115]
    ds_read_b64_tr_b16 a[228:229], v220 offset:49280
    v_mfma_f32_16x16x32_bf16 v[112:115], a[236:239], a[216:219], v[112:115]
    v_mfma_f32_16x16x32_bf16 v[160:163], a[232:235], a[204:207], v[160:163]
    ds_read_b64_tr_b16 a[230:231], v220 offset:50816
    v_mfma_f32_16x16x32_bf16 v[160:163], a[236:239], a[220:223], v[160:163]
    s_waitcnt lgkmcnt(4)
    v_mfma_f32_16x16x32_bf16 v[20:23], a[240:243], a[192:195], v[20:23]
    ds_read_b64_tr_b16 a[232:233], v220 offset:37000
    v_mfma_f32_16x16x32_bf16 v[20:23], a[244:247], a[208:211], v[20:23]
    v_mfma_f32_16x16x32_bf16 v[68:71], a[240:243], a[196:199], v[68:71]
    ds_read_b64_tr_b16 a[234:235], v220 offset:38536
    v_mfma_f32_16x16x32_bf16 v[68:71], a[244:247], a[212:215], v[68:71]
    v_mfma_f32_16x16x32_bf16 v[116:119], a[240:243], a[200:203], v[116:119]
    ds_read_b64_tr_b16 a[236:237], v220 offset:49288
    v_mfma_f32_16x16x32_bf16 v[116:119], a[244:247], a[216:219], v[116:119]
    v_mfma_f32_16x16x32_bf16 v[164:167], a[240:243], a[204:207], v[164:167]
    ds_read_b64_tr_b16 a[238:239], v220 offset:50824
    v_mfma_f32_16x16x32_bf16 v[164:167], a[244:247], a[220:223], v[164:167]
    s_waitcnt lgkmcnt(4)
    v_mfma_f32_16x16x32_bf16 v[24:27], a[224:227], a[192:195], v[24:27]
    ds_read_b64_tr_b16 a[240:241], v219 offset:37120
    v_mfma_f32_16x16x32_bf16 v[24:27], a[228:231], a[208:211], v[24:27]
    v_mfma_f32_16x16x32_bf16 v[72:75], a[224:227], a[196:199], v[72:75]
    ds_read_b64_tr_b16 a[242:243], v219 offset:38656
    v_mfma_f32_16x16x32_bf16 v[72:75], a[228:231], a[212:215], v[72:75]
    v_mfma_f32_16x16x32_bf16 v[120:123], a[224:227], a[200:203], v[120:123]
    ds_read_b64_tr_b16 a[244:245], v219 offset:49408
    v_mfma_f32_16x16x32_bf16 v[120:123], a[228:231], a[216:219], v[120:123]
    v_mfma_f32_16x16x32_bf16 v[168:171], a[224:227], a[204:207], v[168:171]
    ds_read_b64_tr_b16 a[246:247], v219 offset:50944
    v_mfma_f32_16x16x32_bf16 v[168:171], a[228:231], a[220:223], v[168:171]
    s_waitcnt lgkmcnt(4)
    v_mfma_f32_16x16x32_bf16 v[28:31], a[232:235], a[192:195], v[28:31]
    ds_read_b64_tr_b16 a[224:225], v219 offset:37128
    v_mfma_f32_16x16x32_bf16 v[28:31], a[236:239], a[208:211], v[28:31]
    v_mfma_f32_16x16x32_bf16 v[76:79], a[232:235], a[196:199], v[76:79]
    ds_read_b64_tr_b16 a[226:227], v219 offset:38664
    v_mfma_f32_16x16x32_bf16 v[76:79], a[236:239], a[212:215], v[76:79]
    v_mfma_f32_16x16x32_bf16 v[124:127], a[232:235], a[200:203], v[124:127]
    ds_read_b64_tr_b16 a[228:229], v219 offset:49416
    v_mfma_f32_16x16x32_bf16 v[124:127], a[236:239], a[216:219], v[124:127]
    v_mfma_f32_16x16x32_bf16 v[172:175], a[232:235], a[204:207], v[172:175]
    ds_read_b64_tr_b16 a[230:231], v219 offset:50952
    v_mfma_f32_16x16x32_bf16 v[172:175], a[236:239], a[220:223], v[172:175]
    s_waitcnt lgkmcnt(4)
    v_mfma_f32_16x16x32_bf16 v[32:35], a[240:243], a[192:195], v[32:35]
    ds_read_b64_tr_b16 a[232:233], v220 offset:37120
    v_mfma_f32_16x16x32_bf16 v[32:35], a[244:247], a[208:211], v[32:35]
    v_mfma_f32_16x16x32_bf16 v[80:83], a[240:243], a[196:199], v[80:83]
    ds_read_b64_tr_b16 a[234:235], v220 offset:38656
    v_mfma_f32_16x16x32_bf16 v[80:83], a[244:247], a[212:215], v[80:83]
    v_mfma_f32_16x16x32_bf16 v[128:131], a[240:243], a[200:203], v[128:131]
    ds_read_b64_tr_b16 a[236:237], v220 offset:49408
    v_mfma_f32_16x16x32_bf16 v[128:131], a[244:247], a[216:219], v[128:131]
    v_mfma_f32_16x16x32_bf16 v[176:179], a[240:243], a[204:207], v[176:179]
    ds_read_b64_tr_b16 a[238:239], v220 offset:50944
    v_mfma_f32_16x16x32_bf16 v[176:179], a[244:247], a[220:223], v[176:179]
    s_waitcnt lgkmcnt(4)
    v_mfma_f32_16x16x32_bf16 v[36:39], a[224:227], a[192:195], v[36:39]
    ds_read_b64_tr_b16 a[240:241], v220 offset:37128
    v_mfma_f32_16x16x32_bf16 v[36:39], a[228:231], a[208:211], v[36:39]
    v_mfma_f32_16x16x32_bf16 v[84:87], a[224:227], a[196:199], v[84:87]
    ds_read_b64_tr_b16 a[242:243], v220 offset:38664
    v_mfma_f32_16x16x32_bf16 v[84:87], a[228:231], a[212:215], v[84:87]
    v_mfma_f32_16x16x32_bf16 v[132:135], a[224:227], a[200:203], v[132:135]
    ds_read_b64_tr_b16 a[244:245], v220 offset:49416
    v_mfma_f32_16x16x32_bf16 v[132:135], a[228:231], a[216:219], v[132:135]
    v_mfma_f32_16x16x32_bf16 v[180:183], a[224:227], a[204:207], v[180:183]
    ds_read_b64_tr_b16 a[246:247], v220 offset:50952
    v_mfma_f32_16x16x32_bf16 v[180:183], a[228:231], a[220:223], v[180:183]
    s_waitcnt lgkmcnt(4)
    s_waitcnt vmcnt(9)
    s_barrier
    v_mfma_f32_16x16x32_bf16 v[40:43], a[232:235], a[192:195], v[40:43]
    ds_read_b64_tr_b16 a[224:225], v224 offset:0
    v_mfma_f32_16x16x32_bf16 v[40:43], a[236:239], a[208:211], v[40:43]
    v_mfma_f32_16x16x32_bf16 v[88:91], a[232:235], a[196:199], v[88:91]
    ds_read_b64_tr_b16 a[226:227], v224 offset:384
    v_mfma_f32_16x16x32_bf16 v[88:91], a[236:239], a[212:215], v[88:91]
    v_mfma_f32_16x16x32_bf16 v[136:139], a[232:235], a[200:203], v[136:139]
    ds_read_b64_tr_b16 a[228:229], v224 offset:3072
    v_mfma_f32_16x16x32_bf16 v[136:139], a[236:239], a[216:219], v[136:139]
    v_mfma_f32_16x16x32_bf16 v[184:187], a[232:235], a[204:207], v[184:187]
    ds_read_b64_tr_b16 a[230:231], v224 offset:3456
    v_mfma_f32_16x16x32_bf16 v[184:187], a[236:239], a[220:223], v[184:187]
    s_waitcnt lgkmcnt(4)
    v_mfma_f32_16x16x32_bf16 v[44:47], a[240:243], a[192:195], v[44:47]
    ds_read_b64_tr_b16 a[232:233], v224 offset:6144
    v_mfma_f32_16x16x32_bf16 v[44:47], a[244:247], a[208:211], v[44:47]
    v_mfma_f32_16x16x32_bf16 v[92:95], a[240:243], a[196:199], v[92:95]
    ds_read_b64_tr_b16 a[234:235], v224 offset:6528
    v_mfma_f32_16x16x32_bf16 v[92:95], a[244:247], a[212:215], v[92:95]
    v_mfma_f32_16x16x32_bf16 v[140:143], a[240:243], a[200:203], v[140:143]
    ds_read_b64_tr_b16 a[236:237], v224 offset:9216
    v_mfma_f32_16x16x32_bf16 v[140:143], a[244:247], a[216:219], v[140:143]
    v_mfma_f32_16x16x32_bf16 v[188:191], a[240:243], a[204:207], v[188:191]
    ds_read_b64_tr_b16 a[238:239], v224 offset:9600
    s_mov_b32 s33, 983040
    v_mfma_f32_16x16x32_bf16 v[188:191], a[244:247], a[220:223], v[188:191]
    s_waitcnt vmcnt(1) lgkmcnt(4)
    v_mfma_f32_16x16x32_bf16 a[0:3], a[224:227], a[96:99], a[0:3]
    ds_read_b64_tr_b16 a[240:241], v224 offset:32
    s_add_u32 m0, s31, 135168
    v_mfma_f32_16x16x32_bf16 a[0:3], a[228:231], a[112:115], a[0:3]
    buffer_load_dwordx4 v216, s[8:11], s33 offen lds
    v_mfma_f32_16x16x32_bf16 a[4:7], a[224:227], a[100:103], a[4:7]
    ds_read_b64_tr_b16 a[242:243], v224 offset:416
    v_mfma_f32_16x16x32_bf16 a[4:7], a[228:231], a[116:119], a[4:7]
    v_mfma_f32_16x16x32_bf16 a[8:11], a[224:227], a[104:107], a[8:11]
    ds_read_b64_tr_b16 a[244:245], v224 offset:3104
    s_add_u32 m0, s31, 136192
    v_mfma_f32_16x16x32_bf16 a[8:11], a[228:231], a[120:123], a[8:11]
    buffer_load_dwordx4 v217, s[8:11], s33 offen lds
    v_mfma_f32_16x16x32_bf16 a[12:15], a[224:227], a[108:111], a[12:15]
    ds_read_b64_tr_b16 a[246:247], v224 offset:3488
    v_mfma_f32_16x16x32_bf16 a[12:15], a[228:231], a[124:127], a[12:15]
    s_waitcnt lgkmcnt(4)
    v_mfma_f32_16x16x32_bf16 a[48:51], a[232:235], a[96:99], a[48:51]
    ds_read_b64_tr_b16 a[224:225], v224 offset:6176
    s_add_u32 m0, s31, 137216
    v_mfma_f32_16x16x32_bf16 a[48:51], a[236:239], a[112:115], a[48:51]
    buffer_load_dwordx4 v218, s[8:11], s33 offen lds
    v_mfma_f32_16x16x32_bf16 a[52:55], a[232:235], a[100:103], a[52:55]
    ds_read_b64_tr_b16 a[226:227], v224 offset:6560
    v_mfma_f32_16x16x32_bf16 a[52:55], a[236:239], a[116:119], a[52:55]
    s_mov_b32 s33, 3932160
    v_mfma_f32_16x16x32_bf16 a[56:59], a[232:235], a[104:107], a[56:59]
    ds_read_b64_tr_b16 a[228:229], v224 offset:9248
    s_add_u32 m0, s32, 110592
    v_mfma_f32_16x16x32_bf16 a[56:59], a[236:239], a[120:123], a[56:59]
    buffer_load_dwordx4 v213, s[4:7], s33 offen lds
    v_mfma_f32_16x16x32_bf16 a[60:63], a[232:235], a[108:111], a[60:63]
    ds_read_b64_tr_b16 a[230:231], v224 offset:9632
    v_mfma_f32_16x16x32_bf16 a[60:63], a[236:239], a[124:127], a[60:63]
    s_waitcnt lgkmcnt(4)
    v_mfma_f32_16x16x32_bf16 a[16:19], a[240:243], a[96:99], a[16:19]
    ds_read_b64_tr_b16 a[232:233], v224 offset:64
    s_add_u32 m0, s32, 111616
    v_mfma_f32_16x16x32_bf16 a[16:19], a[244:247], a[112:115], a[16:19]
    buffer_load_dwordx4 v214, s[4:7], s33 offen lds
    v_mfma_f32_16x16x32_bf16 a[20:23], a[240:243], a[100:103], a[20:23]
    ds_read_b64_tr_b16 a[234:235], v224 offset:448
    v_mfma_f32_16x16x32_bf16 a[20:23], a[244:247], a[116:119], a[20:23]
    v_mfma_f32_16x16x32_bf16 a[24:27], a[240:243], a[104:107], a[24:27]
    ds_read_b64_tr_b16 a[236:237], v224 offset:3136
    s_add_u32 m0, s32, 112640
    v_mfma_f32_16x16x32_bf16 a[24:27], a[244:247], a[120:123], a[24:27]
    buffer_load_dwordx4 v215, s[4:7], s33 offen lds
    v_mfma_f32_16x16x32_bf16 a[28:31], a[240:243], a[108:111], a[28:31]
    ds_read_b64_tr_b16 a[238:239], v224 offset:3520
    s_mov_b32 s33, 4030464
    v_mfma_f32_16x16x32_bf16 a[28:31], a[244:247], a[124:127], a[28:31]
    s_waitcnt lgkmcnt(4)
    v_mfma_f32_16x16x32_bf16 a[64:67], a[224:227], a[96:99], a[64:67]
    ds_read_b64_tr_b16 a[240:241], v224 offset:6208
    s_add_u32 m0, s32, 113664
    v_mfma_f32_16x16x32_bf16 a[64:67], a[228:231], a[112:115], a[64:67]
    buffer_load_dwordx4 v213, s[4:7], s33 offen lds
    v_mfma_f32_16x16x32_bf16 a[68:71], a[224:227], a[100:103], a[68:71]
    ds_read_b64_tr_b16 a[242:243], v224 offset:6592
    v_mfma_f32_16x16x32_bf16 a[68:71], a[228:231], a[116:119], a[68:71]
    v_mfma_f32_16x16x32_bf16 a[72:75], a[224:227], a[104:107], a[72:75]
    ds_read_b64_tr_b16 a[244:245], v224 offset:9280
    s_add_u32 m0, s32, 114688
    v_mfma_f32_16x16x32_bf16 a[72:75], a[228:231], a[120:123], a[72:75]
    buffer_load_dwordx4 v214, s[4:7], s33 offen lds
    v_mfma_f32_16x16x32_bf16 a[76:79], a[224:227], a[108:111], a[76:79]
    ds_read_b64_tr_b16 a[246:247], v224 offset:9664
    v_mfma_f32_16x16x32_bf16 a[76:79], a[228:231], a[124:127], a[76:79]
    s_waitcnt lgkmcnt(4)
    v_mfma_f32_16x16x32_bf16 a[32:35], a[232:235], a[96:99], a[32:35]
    ds_read_b64_tr_b16 a[224:225], v221 offset:0
    s_add_u32 m0, s32, 115712
    v_mfma_f32_16x16x32_bf16 a[32:35], a[236:239], a[112:115], a[32:35]
    buffer_load_dwordx4 v215, s[4:7], s33 offen lds
    v_mfma_f32_16x16x32_bf16 a[36:39], a[232:235], a[100:103], a[36:39]
    ds_read_b64_tr_b16 a[226:227], v221 offset:1536
    v_mfma_f32_16x16x32_bf16 a[36:39], a[236:239], a[116:119], a[36:39]
    v_mfma_f32_16x16x32_bf16 a[40:43], a[232:235], a[104:107], a[40:43]
    ds_read_b64_tr_b16 a[228:229], v221 offset:12288
    s_mov_b32 s34, 40960
    v_mfma_f32_16x16x32_bf16 a[40:43], a[236:239], a[120:123], a[40:43]
    buffer_load_dwordx4 a[128:131], v212, s[12:15], s34 offen offset:0
    v_mfma_f32_16x16x32_bf16 a[44:47], a[232:235], a[108:111], a[44:47]
    ds_read_b64_tr_b16 a[230:231], v221 offset:13824
    v_mfma_f32_16x16x32_bf16 a[44:47], a[236:239], a[124:127], a[44:47]
    s_waitcnt lgkmcnt(4)
    v_mfma_f32_16x16x32_bf16 a[80:83], a[240:243], a[96:99], a[80:83]
    ds_read_b64_tr_b16 a[232:233], v221 offset:8
    v_mfma_f32_16x16x32_bf16 a[80:83], a[244:247], a[112:115], a[80:83]
    buffer_load_dwordx4 a[132:135], v212, s[12:15], s34 offen offset:1024
    v_mfma_f32_16x16x32_bf16 a[84:87], a[240:243], a[100:103], a[84:87]
    ds_read_b64_tr_b16 a[234:235], v221 offset:1544
    v_mfma_f32_16x16x32_bf16 a[84:87], a[244:247], a[116:119], a[84:87]
    v_mfma_f32_16x16x32_bf16 a[88:91], a[240:243], a[104:107], a[88:91]
    ds_read_b64_tr_b16 a[236:237], v221 offset:12296
    v_mfma_f32_16x16x32_bf16 a[88:91], a[244:247], a[120:123], a[88:91]
    buffer_load_dwordx4 a[136:139], v212, s[12:15], s34 offen offset:2048
    v_mfma_f32_16x16x32_bf16 a[92:95], a[240:243], a[108:111], a[92:95]
    ds_read_b64_tr_b16 a[238:239], v221 offset:13832
    v_mfma_f32_16x16x32_bf16 a[92:95], a[244:247], a[124:127], a[92:95]
    s_waitcnt lgkmcnt(4)
    v_mfma_f32_16x16x32_bf16 v[0:3], a[224:227], a[96:99], v[0:3]
    ds_read_b64_tr_b16 a[240:241], v222 offset:0
    v_mfma_f32_16x16x32_bf16 v[0:3], a[228:231], a[112:115], v[0:3]
    buffer_load_dwordx4 a[140:143], v212, s[12:15], s34 offen offset:3072
    v_mfma_f32_16x16x32_bf16 v[48:51], a[224:227], a[100:103], v[48:51]
    ds_read_b64_tr_b16 a[242:243], v222 offset:1536
    v_mfma_f32_16x16x32_bf16 v[48:51], a[228:231], a[116:119], v[48:51]
    v_mfma_f32_16x16x32_bf16 v[96:99], a[224:227], a[104:107], v[96:99]
    ds_read_b64_tr_b16 a[244:245], v222 offset:12288
    s_mov_b32 s34, 45056
    v_mfma_f32_16x16x32_bf16 v[96:99], a[228:231], a[120:123], v[96:99]
    buffer_load_dwordx4 a[144:147], v212, s[12:15], s34 offen offset:0
    v_mfma_f32_16x16x32_bf16 v[144:147], a[224:227], a[108:111], v[144:147]
    ds_read_b64_tr_b16 a[246:247], v222 offset:13824
    v_mfma_f32_16x16x32_bf16 v[144:147], a[228:231], a[124:127], v[144:147]
    s_waitcnt lgkmcnt(4)
    v_mfma_f32_16x16x32_bf16 v[4:7], a[232:235], a[96:99], v[4:7]
    ds_read_b64_tr_b16 a[224:225], v222 offset:8
    v_mfma_f32_16x16x32_bf16 v[4:7], a[236:239], a[112:115], v[4:7]
    buffer_load_dwordx4 a[148:151], v212, s[12:15], s34 offen offset:1024
    v_mfma_f32_16x16x32_bf16 v[52:55], a[232:235], a[100:103], v[52:55]
    ds_read_b64_tr_b16 a[226:227], v222 offset:1544
    v_mfma_f32_16x16x32_bf16 v[52:55], a[236:239], a[116:119], v[52:55]
    v_mfma_f32_16x16x32_bf16 v[100:103], a[232:235], a[104:107], v[100:103]
    ds_read_b64_tr_b16 a[228:229], v222 offset:12296
    v_mfma_f32_16x16x32_bf16 v[100:103], a[236:239], a[120:123], v[100:103]
    buffer_load_dwordx4 a[152:155], v212, s[12:15], s34 offen offset:2048
    v_mfma_f32_16x16x32_bf16 v[148:151], a[232:235], a[108:111], v[148:151]
    ds_read_b64_tr_b16 a[230:231], v222 offset:13832
    v_mfma_f32_16x16x32_bf16 v[148:151], a[236:239], a[124:127], v[148:151]
    s_waitcnt lgkmcnt(4)
    v_mfma_f32_16x16x32_bf16 v[8:11], a[240:243], a[96:99], v[8:11]
    ds_read_b64_tr_b16 a[232:233], v221 offset:128
    v_mfma_f32_16x16x32_bf16 v[8:11], a[244:247], a[112:115], v[8:11]
    buffer_load_dwordx4 a[156:159], v212, s[12:15], s34 offen offset:3072
    v_mfma_f32_16x16x32_bf16 v[56:59], a[240:243], a[100:103], v[56:59]
    ds_read_b64_tr_b16 a[234:235], v221 offset:1664
    v_mfma_f32_16x16x32_bf16 v[56:59], a[244:247], a[116:119], v[56:59]
    s_mov_b32 s33, 1179648
    v_mfma_f32_16x16x32_bf16 v[104:107], a[240:243], a[104:107], v[104:107]
    ds_read_b64_tr_b16 a[236:237], v221 offset:12416
    s_add_u32 m0, s31, 24576
    v_mfma_f32_16x16x32_bf16 v[104:107], a[244:247], a[120:123], v[104:107]
    buffer_load_dwordx4 v216, s[8:11], s33 offen lds
    v_mfma_f32_16x16x32_bf16 v[152:155], a[240:243], a[108:111], v[152:155]
    ds_read_b64_tr_b16 a[238:239], v221 offset:13952
    v_mfma_f32_16x16x32_bf16 v[152:155], a[244:247], a[124:127], v[152:155]
    s_waitcnt lgkmcnt(4)
    v_mfma_f32_16x16x32_bf16 v[12:15], a[224:227], a[96:99], v[12:15]
    ds_read_b64_tr_b16 a[240:241], v221 offset:136
    s_add_u32 m0, s31, 25600
    v_mfma_f32_16x16x32_bf16 v[12:15], a[228:231], a[112:115], v[12:15]
    buffer_load_dwordx4 v217, s[8:11], s33 offen lds
    v_mfma_f32_16x16x32_bf16 v[60:63], a[224:227], a[100:103], v[60:63]
    ds_read_b64_tr_b16 a[242:243], v221 offset:1672
    v_mfma_f32_16x16x32_bf16 v[60:63], a[228:231], a[116:119], v[60:63]
    v_mfma_f32_16x16x32_bf16 v[108:111], a[224:227], a[104:107], v[108:111]
    ds_read_b64_tr_b16 a[244:245], v221 offset:12424
    s_add_u32 m0, s31, 26624
    v_mfma_f32_16x16x32_bf16 v[108:111], a[228:231], a[120:123], v[108:111]
    buffer_load_dwordx4 v218, s[8:11], s33 offen lds
    v_mfma_f32_16x16x32_bf16 v[156:159], a[224:227], a[108:111], v[156:159]
    ds_read_b64_tr_b16 a[246:247], v221 offset:13960
    v_mfma_f32_16x16x32_bf16 v[156:159], a[228:231], a[124:127], v[156:159]
    s_waitcnt lgkmcnt(4)
    v_mfma_f32_16x16x32_bf16 v[16:19], a[232:235], a[96:99], v[16:19]
    ds_read_b64_tr_b16 a[224:225], v222 offset:128
    s_mov_b32 s34, 49152
    v_mfma_f32_16x16x32_bf16 v[16:19], a[236:239], a[112:115], v[16:19]
    buffer_load_dwordx4 a[160:163], v212, s[12:15], s34 offen offset:0
    v_mfma_f32_16x16x32_bf16 v[64:67], a[232:235], a[100:103], v[64:67]
    ds_read_b64_tr_b16 a[226:227], v222 offset:1664
    v_mfma_f32_16x16x32_bf16 v[64:67], a[236:239], a[116:119], v[64:67]
    v_mfma_f32_16x16x32_bf16 v[112:115], a[232:235], a[104:107], v[112:115]
    ds_read_b64_tr_b16 a[228:229], v222 offset:12416
    v_mfma_f32_16x16x32_bf16 v[112:115], a[236:239], a[120:123], v[112:115]
    buffer_load_dwordx4 a[164:167], v212, s[12:15], s34 offen offset:1024
    v_mfma_f32_16x16x32_bf16 v[160:163], a[232:235], a[108:111], v[160:163]
    ds_read_b64_tr_b16 a[230:231], v222 offset:13952
    v_mfma_f32_16x16x32_bf16 v[160:163], a[236:239], a[124:127], v[160:163]
    s_waitcnt lgkmcnt(4)
    v_mfma_f32_16x16x32_bf16 v[20:23], a[240:243], a[96:99], v[20:23]
    ds_read_b64_tr_b16 a[232:233], v222 offset:136
    v_mfma_f32_16x16x32_bf16 v[20:23], a[244:247], a[112:115], v[20:23]
    buffer_load_dwordx4 a[168:171], v212, s[12:15], s34 offen offset:2048
    v_mfma_f32_16x16x32_bf16 v[68:71], a[240:243], a[100:103], v[68:71]
    ds_read_b64_tr_b16 a[234:235], v222 offset:1672
    v_mfma_f32_16x16x32_bf16 v[68:71], a[244:247], a[116:119], v[68:71]
    v_mfma_f32_16x16x32_bf16 v[116:119], a[240:243], a[104:107], v[116:119]
    ds_read_b64_tr_b16 a[236:237], v222 offset:12424
    v_mfma_f32_16x16x32_bf16 v[116:119], a[244:247], a[120:123], v[116:119]
    buffer_load_dwordx4 a[172:175], v212, s[12:15], s34 offen offset:3072
    v_mfma_f32_16x16x32_bf16 v[164:167], a[240:243], a[108:111], v[164:167]
    ds_read_b64_tr_b16 a[238:239], v222 offset:13960
    v_mfma_f32_16x16x32_bf16 v[164:167], a[244:247], a[124:127], v[164:167]
    s_waitcnt lgkmcnt(4)
    v_mfma_f32_16x16x32_bf16 v[24:27], a[224:227], a[96:99], v[24:27]
    ds_read_b64_tr_b16 a[240:241], v221 offset:256
    s_mov_b32 s34, 53248
    v_mfma_f32_16x16x32_bf16 v[24:27], a[228:231], a[112:115], v[24:27]
    buffer_load_dwordx4 a[176:179], v212, s[12:15], s34 offen offset:0
    v_mfma_f32_16x16x32_bf16 v[72:75], a[224:227], a[100:103], v[72:75]
    ds_read_b64_tr_b16 a[242:243], v221 offset:1792
    v_mfma_f32_16x16x32_bf16 v[72:75], a[228:231], a[116:119], v[72:75]
    v_mfma_f32_16x16x32_bf16 v[120:123], a[224:227], a[104:107], v[120:123]
    ds_read_b64_tr_b16 a[244:245], v221 offset:12544
    v_mfma_f32_16x16x32_bf16 v[120:123], a[228:231], a[120:123], v[120:123]
    buffer_load_dwordx4 a[180:183], v212, s[12:15], s34 offen offset:1024
    v_mfma_f32_16x16x32_bf16 v[168:171], a[224:227], a[108:111], v[168:171]
    ds_read_b64_tr_b16 a[246:247], v221 offset:14080
    v_mfma_f32_16x16x32_bf16 v[168:171], a[228:231], a[124:127], v[168:171]
    s_waitcnt lgkmcnt(4)
    v_mfma_f32_16x16x32_bf16 v[28:31], a[232:235], a[96:99], v[28:31]
    ds_read_b64_tr_b16 a[224:225], v221 offset:264
    v_mfma_f32_16x16x32_bf16 v[28:31], a[236:239], a[112:115], v[28:31]
    buffer_load_dwordx4 a[184:187], v212, s[12:15], s34 offen offset:2048
    v_mfma_f32_16x16x32_bf16 v[76:79], a[232:235], a[100:103], v[76:79]
    ds_read_b64_tr_b16 a[226:227], v221 offset:1800
    v_mfma_f32_16x16x32_bf16 v[76:79], a[236:239], a[116:119], v[76:79]
    v_mfma_f32_16x16x32_bf16 v[124:127], a[232:235], a[104:107], v[124:127]
    ds_read_b64_tr_b16 a[228:229], v221 offset:12552
    v_mfma_f32_16x16x32_bf16 v[124:127], a[236:239], a[120:123], v[124:127]
    buffer_load_dwordx4 a[188:191], v212, s[12:15], s34 offen offset:3072
    v_mfma_f32_16x16x32_bf16 v[172:175], a[232:235], a[108:111], v[172:175]
    ds_read_b64_tr_b16 a[230:231], v221 offset:14088
    v_mfma_f32_16x16x32_bf16 v[172:175], a[236:239], a[124:127], v[172:175]
    s_waitcnt lgkmcnt(4)
    v_mfma_f32_16x16x32_bf16 v[32:35], a[240:243], a[96:99], v[32:35]
    ds_read_b64_tr_b16 a[232:233], v222 offset:256
    v_mfma_f32_16x16x32_bf16 v[32:35], a[244:247], a[112:115], v[32:35]
    v_mfma_f32_16x16x32_bf16 v[80:83], a[240:243], a[100:103], v[80:83]
    ds_read_b64_tr_b16 a[234:235], v222 offset:1792
    v_mfma_f32_16x16x32_bf16 v[80:83], a[244:247], a[116:119], v[80:83]
    v_mfma_f32_16x16x32_bf16 v[128:131], a[240:243], a[104:107], v[128:131]
    ds_read_b64_tr_b16 a[236:237], v222 offset:12544
    v_mfma_f32_16x16x32_bf16 v[128:131], a[244:247], a[120:123], v[128:131]
    v_mfma_f32_16x16x32_bf16 v[176:179], a[240:243], a[108:111], v[176:179]
    ds_read_b64_tr_b16 a[238:239], v222 offset:14080
    v_mfma_f32_16x16x32_bf16 v[176:179], a[244:247], a[124:127], v[176:179]
    s_waitcnt lgkmcnt(4)
    v_mfma_f32_16x16x32_bf16 v[36:39], a[224:227], a[96:99], v[36:39]
    ds_read_b64_tr_b16 a[240:241], v222 offset:264
    v_mfma_f32_16x16x32_bf16 v[36:39], a[228:231], a[112:115], v[36:39]
    v_mfma_f32_16x16x32_bf16 v[84:87], a[224:227], a[100:103], v[84:87]
    ds_read_b64_tr_b16 a[242:243], v222 offset:1800
    v_mfma_f32_16x16x32_bf16 v[84:87], a[228:231], a[116:119], v[84:87]
    v_mfma_f32_16x16x32_bf16 v[132:135], a[224:227], a[104:107], v[132:135]
    ds_read_b64_tr_b16 a[244:245], v222 offset:12552
    v_mfma_f32_16x16x32_bf16 v[132:135], a[228:231], a[120:123], v[132:135]
    v_mfma_f32_16x16x32_bf16 v[180:183], a[224:227], a[108:111], v[180:183]
    ds_read_b64_tr_b16 a[246:247], v222 offset:14088
    v_mfma_f32_16x16x32_bf16 v[180:183], a[228:231], a[124:127], v[180:183]
    s_waitcnt lgkmcnt(4)
    s_waitcnt vmcnt(19)
    s_barrier
    v_mfma_f32_16x16x32_bf16 v[40:43], a[232:235], a[96:99], v[40:43]
    ds_read_b64_tr_b16 a[224:225], v224 offset:36864
    v_mfma_f32_16x16x32_bf16 v[40:43], a[236:239], a[112:115], v[40:43]
    v_mfma_f32_16x16x32_bf16 v[88:91], a[232:235], a[100:103], v[88:91]
    ds_read_b64_tr_b16 a[226:227], v224 offset:37248
    v_mfma_f32_16x16x32_bf16 v[88:91], a[236:239], a[116:119], v[88:91]
    v_mfma_f32_16x16x32_bf16 v[136:139], a[232:235], a[104:107], v[136:139]
    ds_read_b64_tr_b16 a[228:229], v224 offset:39936
    v_mfma_f32_16x16x32_bf16 v[136:139], a[236:239], a[120:123], v[136:139]
    v_mfma_f32_16x16x32_bf16 v[184:187], a[232:235], a[108:111], v[184:187]
    ds_read_b64_tr_b16 a[230:231], v224 offset:40320
    v_mfma_f32_16x16x32_bf16 v[184:187], a[236:239], a[124:127], v[184:187]
    s_waitcnt lgkmcnt(4)
    v_mfma_f32_16x16x32_bf16 v[44:47], a[240:243], a[96:99], v[44:47]
    ds_read_b64_tr_b16 a[232:233], v224 offset:43008
    v_mfma_f32_16x16x32_bf16 v[44:47], a[244:247], a[112:115], v[44:47]
    v_mfma_f32_16x16x32_bf16 v[92:95], a[240:243], a[100:103], v[92:95]
    ds_read_b64_tr_b16 a[234:235], v224 offset:43392
    v_mfma_f32_16x16x32_bf16 v[92:95], a[244:247], a[116:119], v[92:95]
    v_mfma_f32_16x16x32_bf16 v[140:143], a[240:243], a[104:107], v[140:143]
    ds_read_b64_tr_b16 a[236:237], v224 offset:46080
    v_mfma_f32_16x16x32_bf16 v[140:143], a[244:247], a[120:123], v[140:143]
    v_mfma_f32_16x16x32_bf16 v[188:191], a[240:243], a[108:111], v[188:191]
    ds_read_b64_tr_b16 a[238:239], v224 offset:46464
    s_mov_b32 s33, 4718592
    v_mfma_f32_16x16x32_bf16 v[188:191], a[244:247], a[124:127], v[188:191]
    s_waitcnt vmcnt(11) lgkmcnt(4)
    v_mfma_f32_16x16x32_bf16 a[0:3], a[224:227], a[128:131], a[0:3]
    ds_read_b64_tr_b16 a[240:241], v224 offset:36896
    s_add_u32 m0, s32, 0
    v_mfma_f32_16x16x32_bf16 a[0:3], a[228:231], a[144:147], a[0:3]
    buffer_load_dwordx4 v213, s[4:7], s33 offen lds
    v_mfma_f32_16x16x32_bf16 a[4:7], a[224:227], a[132:135], a[4:7]
    ds_read_b64_tr_b16 a[242:243], v224 offset:37280
    v_mfma_f32_16x16x32_bf16 a[4:7], a[228:231], a[148:151], a[4:7]
    v_mfma_f32_16x16x32_bf16 a[8:11], a[224:227], a[136:139], a[8:11]
    ds_read_b64_tr_b16 a[244:245], v224 offset:39968
    s_add_u32 m0, s32, 1024
    v_mfma_f32_16x16x32_bf16 a[8:11], a[228:231], a[152:155], a[8:11]
    buffer_load_dwordx4 v214, s[4:7], s33 offen lds
    v_mfma_f32_16x16x32_bf16 a[12:15], a[224:227], a[140:143], a[12:15]
    ds_read_b64_tr_b16 a[246:247], v224 offset:40352
    v_mfma_f32_16x16x32_bf16 a[12:15], a[228:231], a[156:159], a[12:15]
    s_waitcnt lgkmcnt(4)
    v_mfma_f32_16x16x32_bf16 a[48:51], a[232:235], a[128:131], a[48:51]
    ds_read_b64_tr_b16 a[224:225], v224 offset:43040
    s_add_u32 m0, s32, 2048
    v_mfma_f32_16x16x32_bf16 a[48:51], a[236:239], a[144:147], a[48:51]
    buffer_load_dwordx4 v215, s[4:7], s33 offen lds
    v_mfma_f32_16x16x32_bf16 a[52:55], a[232:235], a[132:135], a[52:55]
    ds_read_b64_tr_b16 a[226:227], v224 offset:43424
    v_mfma_f32_16x16x32_bf16 a[52:55], a[236:239], a[148:151], a[52:55]
    s_mov_b32 s33, 4816896
    v_mfma_f32_16x16x32_bf16 a[56:59], a[232:235], a[136:139], a[56:59]
    ds_read_b64_tr_b16 a[228:229], v224 offset:46112
    s_add_u32 m0, s32, 3072
    v_mfma_f32_16x16x32_bf16 a[56:59], a[236:239], a[152:155], a[56:59]
    buffer_load_dwordx4 v213, s[4:7], s33 offen lds
    v_mfma_f32_16x16x32_bf16 a[60:63], a[232:235], a[140:143], a[60:63]
    ds_read_b64_tr_b16 a[230:231], v224 offset:46496
    v_mfma_f32_16x16x32_bf16 a[60:63], a[236:239], a[156:159], a[60:63]
    s_waitcnt lgkmcnt(4)
    v_mfma_f32_16x16x32_bf16 a[16:19], a[240:243], a[128:131], a[16:19]
    ds_read_b64_tr_b16 a[232:233], v224 offset:36928
    s_add_u32 m0, s32, 4096
    v_mfma_f32_16x16x32_bf16 a[16:19], a[244:247], a[144:147], a[16:19]
    buffer_load_dwordx4 v214, s[4:7], s33 offen lds
    v_mfma_f32_16x16x32_bf16 a[20:23], a[240:243], a[132:135], a[20:23]
    ds_read_b64_tr_b16 a[234:235], v224 offset:37312
    v_mfma_f32_16x16x32_bf16 a[20:23], a[244:247], a[148:151], a[20:23]
    v_mfma_f32_16x16x32_bf16 a[24:27], a[240:243], a[136:139], a[24:27]
    ds_read_b64_tr_b16 a[236:237], v224 offset:40000
    s_add_u32 m0, s32, 5120
    v_mfma_f32_16x16x32_bf16 a[24:27], a[244:247], a[152:155], a[24:27]
    buffer_load_dwordx4 v215, s[4:7], s33 offen lds
    v_mfma_f32_16x16x32_bf16 a[28:31], a[240:243], a[140:143], a[28:31]
    ds_read_b64_tr_b16 a[238:239], v224 offset:40384
    s_mov_b32 s33, 1376256
    v_mfma_f32_16x16x32_bf16 a[28:31], a[244:247], a[156:159], a[28:31]
    s_waitcnt lgkmcnt(4)
    v_mfma_f32_16x16x32_bf16 a[64:67], a[224:227], a[128:131], a[64:67]
    ds_read_b64_tr_b16 a[240:241], v224 offset:43072
    s_add_u32 m0, s31, 61440
    v_mfma_f32_16x16x32_bf16 a[64:67], a[228:231], a[144:147], a[64:67]
    buffer_load_dwordx4 v216, s[8:11], s33 offen lds
    v_mfma_f32_16x16x32_bf16 a[68:71], a[224:227], a[132:135], a[68:71]
    ds_read_b64_tr_b16 a[242:243], v224 offset:43456
    v_mfma_f32_16x16x32_bf16 a[68:71], a[228:231], a[148:151], a[68:71]
    v_mfma_f32_16x16x32_bf16 a[72:75], a[224:227], a[136:139], a[72:75]
    ds_read_b64_tr_b16 a[244:245], v224 offset:46144
    s_add_u32 m0, s31, 62464
    v_mfma_f32_16x16x32_bf16 a[72:75], a[228:231], a[152:155], a[72:75]
    buffer_load_dwordx4 v217, s[8:11], s33 offen lds
    v_mfma_f32_16x16x32_bf16 a[76:79], a[224:227], a[140:143], a[76:79]
    ds_read_b64_tr_b16 a[246:247], v224 offset:46528
    v_mfma_f32_16x16x32_bf16 a[76:79], a[228:231], a[156:159], a[76:79]
    s_waitcnt lgkmcnt(4)
    v_mfma_f32_16x16x32_bf16 a[32:35], a[232:235], a[128:131], a[32:35]
    ds_read_b64_tr_b16 a[224:225], v221 offset:36864
    s_add_u32 m0, s31, 63488
    v_mfma_f32_16x16x32_bf16 a[32:35], a[236:239], a[144:147], a[32:35]
    buffer_load_dwordx4 v218, s[8:11], s33 offen lds
    v_mfma_f32_16x16x32_bf16 a[36:39], a[232:235], a[132:135], a[36:39]
    ds_read_b64_tr_b16 a[226:227], v221 offset:38400
    v_mfma_f32_16x16x32_bf16 a[36:39], a[236:239], a[148:151], a[36:39]
    v_mfma_f32_16x16x32_bf16 a[40:43], a[232:235], a[136:139], a[40:43]
    ds_read_b64_tr_b16 a[228:229], v221 offset:49152
    s_mov_b32 s34, 57344
    v_mfma_f32_16x16x32_bf16 a[40:43], a[236:239], a[152:155], a[40:43]
    buffer_load_dwordx4 a[192:195], v212, s[12:15], s34 offen offset:0
    v_mfma_f32_16x16x32_bf16 a[44:47], a[232:235], a[140:143], a[44:47]
    ds_read_b64_tr_b16 a[230:231], v221 offset:50688
    v_mfma_f32_16x16x32_bf16 a[44:47], a[236:239], a[156:159], a[44:47]
    s_waitcnt lgkmcnt(4)
    v_mfma_f32_16x16x32_bf16 a[80:83], a[240:243], a[128:131], a[80:83]
    ds_read_b64_tr_b16 a[232:233], v221 offset:36872
    v_mfma_f32_16x16x32_bf16 a[80:83], a[244:247], a[144:147], a[80:83]
    buffer_load_dwordx4 a[196:199], v212, s[12:15], s34 offen offset:1024
    v_mfma_f32_16x16x32_bf16 a[84:87], a[240:243], a[132:135], a[84:87]
    ds_read_b64_tr_b16 a[234:235], v221 offset:38408
    v_mfma_f32_16x16x32_bf16 a[84:87], a[244:247], a[148:151], a[84:87]
    v_mfma_f32_16x16x32_bf16 a[88:91], a[240:243], a[136:139], a[88:91]
    ds_read_b64_tr_b16 a[236:237], v221 offset:49160
    v_mfma_f32_16x16x32_bf16 a[88:91], a[244:247], a[152:155], a[88:91]
    buffer_load_dwordx4 a[200:203], v212, s[12:15], s34 offen offset:2048
    v_mfma_f32_16x16x32_bf16 a[92:95], a[240:243], a[140:143], a[92:95]
    ds_read_b64_tr_b16 a[238:239], v221 offset:50696
    v_mfma_f32_16x16x32_bf16 a[92:95], a[244:247], a[156:159], a[92:95]
    s_waitcnt lgkmcnt(4)
    v_mfma_f32_16x16x32_bf16 v[0:3], a[224:227], a[128:131], v[0:3]
    ds_read_b64_tr_b16 a[240:241], v222 offset:36864
    v_mfma_f32_16x16x32_bf16 v[0:3], a[228:231], a[144:147], v[0:3]
    buffer_load_dwordx4 a[204:207], v212, s[12:15], s34 offen offset:3072
    v_mfma_f32_16x16x32_bf16 v[48:51], a[224:227], a[132:135], v[48:51]
    ds_read_b64_tr_b16 a[242:243], v222 offset:38400
    v_mfma_f32_16x16x32_bf16 v[48:51], a[228:231], a[148:151], v[48:51]
    v_mfma_f32_16x16x32_bf16 v[96:99], a[224:227], a[136:139], v[96:99]
    ds_read_b64_tr_b16 a[244:245], v222 offset:49152
    s_mov_b32 s34, 61440
    v_mfma_f32_16x16x32_bf16 v[96:99], a[228:231], a[152:155], v[96:99]
    buffer_load_dwordx4 a[208:211], v212, s[12:15], s34 offen offset:0
    v_mfma_f32_16x16x32_bf16 v[144:147], a[224:227], a[140:143], v[144:147]
    ds_read_b64_tr_b16 a[246:247], v222 offset:50688
    v_mfma_f32_16x16x32_bf16 v[144:147], a[228:231], a[156:159], v[144:147]
    s_waitcnt lgkmcnt(4)
    v_mfma_f32_16x16x32_bf16 v[4:7], a[232:235], a[128:131], v[4:7]
    ds_read_b64_tr_b16 a[224:225], v222 offset:36872
    v_mfma_f32_16x16x32_bf16 v[4:7], a[236:239], a[144:147], v[4:7]
    buffer_load_dwordx4 a[212:215], v212, s[12:15], s34 offen offset:1024
    v_mfma_f32_16x16x32_bf16 v[52:55], a[232:235], a[132:135], v[52:55]
    ds_read_b64_tr_b16 a[226:227], v222 offset:38408
    v_mfma_f32_16x16x32_bf16 v[52:55], a[236:239], a[148:151], v[52:55]
    v_mfma_f32_16x16x32_bf16 v[100:103], a[232:235], a[136:139], v[100:103]
    ds_read_b64_tr_b16 a[228:229], v222 offset:49160
    v_mfma_f32_16x16x32_bf16 v[100:103], a[236:239], a[152:155], v[100:103]
    buffer_load_dwordx4 a[216:219], v212, s[12:15], s34 offen offset:2048
    v_mfma_f32_16x16x32_bf16 v[148:151], a[232:235], a[140:143], v[148:151]
    ds_read_b64_tr_b16 a[230:231], v222 offset:50696
    v_mfma_f32_16x16x32_bf16 v[148:151], a[236:239], a[156:159], v[148:151]
    s_waitcnt lgkmcnt(4)
    v_mfma_f32_16x16x32_bf16 v[8:11], a[240:243], a[128:131], v[8:11]
    ds_read_b64_tr_b16 a[232:233], v221 offset:36992
    v_mfma_f32_16x16x32_bf16 v[8:11], a[244:247], a[144:147], v[8:11]
    buffer_load_dwordx4 a[220:223], v212, s[12:15], s34 offen offset:3072
    v_mfma_f32_16x16x32_bf16 v[56:59], a[240:243], a[132:135], v[56:59]
    ds_read_b64_tr_b16 a[234:235], v221 offset:38528
    v_mfma_f32_16x16x32_bf16 v[56:59], a[244:247], a[148:151], v[56:59]
    s_mov_b32 s33, 1572864
    v_mfma_f32_16x16x32_bf16 v[104:107], a[240:243], a[136:139], v[104:107]
    ds_read_b64_tr_b16 a[236:237], v221 offset:49280
    s_add_u32 m0, s31, 98304
    v_mfma_f32_16x16x32_bf16 v[104:107], a[244:247], a[152:155], v[104:107]
    buffer_load_dwordx4 v216, s[8:11], s33 offen lds
    v_mfma_f32_16x16x32_bf16 v[152:155], a[240:243], a[140:143], v[152:155]
    ds_read_b64_tr_b16 a[238:239], v221 offset:50816
    v_mfma_f32_16x16x32_bf16 v[152:155], a[244:247], a[156:159], v[152:155]
    s_waitcnt lgkmcnt(4)
    v_mfma_f32_16x16x32_bf16 v[12:15], a[224:227], a[128:131], v[12:15]
    ds_read_b64_tr_b16 a[240:241], v221 offset:37000
    s_add_u32 m0, s31, 99328
    v_mfma_f32_16x16x32_bf16 v[12:15], a[228:231], a[144:147], v[12:15]
    buffer_load_dwordx4 v217, s[8:11], s33 offen lds
    v_mfma_f32_16x16x32_bf16 v[60:63], a[224:227], a[132:135], v[60:63]
    ds_read_b64_tr_b16 a[242:243], v221 offset:38536
    v_mfma_f32_16x16x32_bf16 v[60:63], a[228:231], a[148:151], v[60:63]
    v_mfma_f32_16x16x32_bf16 v[108:111], a[224:227], a[136:139], v[108:111]
    ds_read_b64_tr_b16 a[244:245], v221 offset:49288
    s_add_u32 m0, s31, 100352
    v_mfma_f32_16x16x32_bf16 v[108:111], a[228:231], a[152:155], v[108:111]
    buffer_load_dwordx4 v218, s[8:11], s33 offen lds
    v_mfma_f32_16x16x32_bf16 v[156:159], a[224:227], a[140:143], v[156:159]
    ds_read_b64_tr_b16 a[246:247], v221 offset:50824
    v_mfma_f32_16x16x32_bf16 v[156:159], a[228:231], a[156:159], v[156:159]
    s_waitcnt lgkmcnt(4)
    v_mfma_f32_16x16x32_bf16 v[16:19], a[232:235], a[128:131], v[16:19]
    ds_read_b64_tr_b16 a[224:225], v222 offset:36992
    s_mov_b32 s34, 65536
    v_mfma_f32_16x16x32_bf16 v[16:19], a[236:239], a[144:147], v[16:19]
    buffer_load_dwordx4 a[96:99], v212, s[12:15], s34 offen offset:0
    v_mfma_f32_16x16x32_bf16 v[64:67], a[232:235], a[132:135], v[64:67]
    ds_read_b64_tr_b16 a[226:227], v222 offset:38528
    v_mfma_f32_16x16x32_bf16 v[64:67], a[236:239], a[148:151], v[64:67]
    s_cmp_lt_u32 s2, 48
    s_cselect_b32 s50, s80, s78
    s_cselect_b32 s51, s81, s79
    v_mfma_f32_16x16x32_bf16 v[112:115], a[232:235], a[136:139], v[112:115]
    ds_read_b64_tr_b16 a[228:229], v222 offset:49280
    v_mfma_f32_16x16x32_bf16 v[112:115], a[236:239], a[152:155], v[112:115]
    buffer_load_dwordx4 a[100:103], v212, s[12:15], s34 offen offset:1024
    v_mfma_f32_16x16x32_bf16 v[160:163], a[232:235], a[140:143], v[160:163]
    ds_read_b64_tr_b16 a[230:231], v222 offset:50816
    v_mfma_f32_16x16x32_bf16 v[160:163], a[236:239], a[156:159], v[160:163]
    s_waitcnt lgkmcnt(4)
    s_cmp_lt_u32 s2, 48
    s_cselect_b32 s40, 0, 48
    v_mfma_f32_16x16x32_bf16 v[20:23], a[240:243], a[128:131], v[20:23]
    ds_read_b64_tr_b16 a[232:233], v222 offset:37000
    s_sub_u32 s40, s2, s40
    v_mfma_f32_16x16x32_bf16 v[20:23], a[244:247], a[144:147], v[20:23]
    buffer_load_dwordx4 a[104:107], v212, s[12:15], s34 offen offset:2048
    v_mfma_f32_16x16x32_bf16 v[68:71], a[240:243], a[132:135], v[68:71]
    ds_read_b64_tr_b16 a[234:235], v222 offset:38536
    s_mul_i32 s40, s40, 40960
    v_mfma_f32_16x16x32_bf16 v[68:71], a[244:247], a[148:151], v[68:71]
    s_cmp_lt_u32 s2, 240
    s_cselect_b32 s41, 40960, 0
    s_cselect_b32 s40, s40, 0
    v_mfma_f32_16x16x32_bf16 v[116:119], a[240:243], a[136:139], v[116:119]
    ds_read_b64_tr_b16 a[236:237], v222 offset:49288
    v_mfma_f32_16x16x32_bf16 v[116:119], a[244:247], a[152:155], v[116:119]
    buffer_load_dwordx4 a[108:111], v212, s[12:15], s34 offen offset:3072
    v_mfma_f32_16x16x32_bf16 v[164:167], a[240:243], a[140:143], v[164:167]
    ds_read_b64_tr_b16 a[238:239], v222 offset:50824
    v_mfma_f32_16x16x32_bf16 v[164:167], a[244:247], a[156:159], v[164:167]
    s_waitcnt lgkmcnt(4)
    s_add_u32 s64, s50, s40
    s_addc_u32 s65, s51, 0
    v_mfma_f32_16x16x32_bf16 v[24:27], a[224:227], a[128:131], v[24:27]
    ds_read_b64_tr_b16 a[240:241], v221 offset:37120
    s_mov_b32 s34, 69632
    v_mfma_f32_16x16x32_bf16 v[24:27], a[228:231], a[144:147], v[24:27]
    buffer_load_dwordx4 a[112:115], v212, s[12:15], s34 offen offset:0
    v_mfma_f32_16x16x32_bf16 v[72:75], a[224:227], a[132:135], v[72:75]
    ds_read_b64_tr_b16 a[242:243], v221 offset:38656
    s_mov_b32 s66, s41
    v_mfma_f32_16x16x32_bf16 v[72:75], a[228:231], a[148:151], v[72:75]
    s_mov_b32 s67, 0x20000
    v_mfma_f32_16x16x32_bf16 v[120:123], a[224:227], a[136:139], v[120:123]
    ds_read_b64_tr_b16 a[244:245], v221 offset:49408
    s_mov_b32 s90, 0
    v_mfma_f32_16x16x32_bf16 v[120:123], a[228:231], a[152:155], v[120:123]
    buffer_load_dwordx4 a[116:119], v212, s[12:15], s34 offen offset:1024
    v_mfma_f32_16x16x32_bf16 v[168:171], a[224:227], a[140:143], v[168:171]
    ds_read_b64_tr_b16 a[246:247], v221 offset:50944
    s_mov_b32 s91, 0
    v_mfma_f32_16x16x32_bf16 v[168:171], a[228:231], a[156:159], v[168:171]
    s_waitcnt lgkmcnt(4)
    v_mfma_f32_16x16x32_bf16 v[28:31], a[232:235], a[128:131], v[28:31]
    ds_read_b64_tr_b16 a[224:225], v221 offset:37128
    v_mfma_f32_16x16x32_bf16 v[28:31], a[236:239], a[144:147], v[28:31]
    buffer_load_dwordx4 a[120:123], v212, s[12:15], s34 offen offset:2048
    v_mfma_f32_16x16x32_bf16 v[76:79], a[232:235], a[132:135], v[76:79]
    ds_read_b64_tr_b16 a[226:227], v221 offset:38664
    v_mfma_f32_16x16x32_bf16 v[76:79], a[236:239], a[148:151], v[76:79]
    v_mfma_f32_16x16x32_bf16 v[124:127], a[232:235], a[136:139], v[124:127]
    ds_read_b64_tr_b16 a[228:229], v221 offset:49416
    v_mfma_f32_16x16x32_bf16 v[124:127], a[236:239], a[152:155], v[124:127]
    buffer_load_dwordx4 a[124:127], v212, s[12:15], s34 offen offset:3072
    v_mfma_f32_16x16x32_bf16 v[172:175], a[232:235], a[140:143], v[172:175]
    ds_read_b64_tr_b16 a[230:231], v221 offset:50952
    v_mfma_f32_16x16x32_bf16 v[172:175], a[236:239], a[156:159], v[172:175]
    s_waitcnt lgkmcnt(4)
    v_mfma_f32_16x16x32_bf16 v[32:35], a[240:243], a[128:131], v[32:35]
    ds_read_b64_tr_b16 a[232:233], v222 offset:37120
    v_mfma_f32_16x16x32_bf16 v[32:35], a[244:247], a[144:147], v[32:35]
    v_mfma_f32_16x16x32_bf16 v[80:83], a[240:243], a[132:135], v[80:83]
    ds_read_b64_tr_b16 a[234:235], v222 offset:38656
    v_mfma_f32_16x16x32_bf16 v[80:83], a[244:247], a[148:151], v[80:83]
    v_mfma_f32_16x16x32_bf16 v[128:131], a[240:243], a[136:139], v[128:131]
    ds_read_b64_tr_b16 a[236:237], v222 offset:49408
    v_mfma_f32_16x16x32_bf16 v[128:131], a[244:247], a[152:155], v[128:131]
    v_mfma_f32_16x16x32_bf16 v[176:179], a[240:243], a[140:143], v[176:179]
    ds_read_b64_tr_b16 a[238:239], v222 offset:50944
    v_mfma_f32_16x16x32_bf16 v[176:179], a[244:247], a[156:159], v[176:179]
    s_waitcnt lgkmcnt(4)
    v_mfma_f32_16x16x32_bf16 v[36:39], a[224:227], a[128:131], v[36:39]
    ds_read_b64_tr_b16 a[240:241], v222 offset:37128
    v_mfma_f32_16x16x32_bf16 v[36:39], a[228:231], a[144:147], v[36:39]
    v_mfma_f32_16x16x32_bf16 v[84:87], a[224:227], a[132:135], v[84:87]
    ds_read_b64_tr_b16 a[242:243], v222 offset:38664
    v_mfma_f32_16x16x32_bf16 v[84:87], a[228:231], a[148:151], v[84:87]
    v_mfma_f32_16x16x32_bf16 v[132:135], a[224:227], a[136:139], v[132:135]
    ds_read_b64_tr_b16 a[244:245], v222 offset:49416
    v_mfma_f32_16x16x32_bf16 v[132:135], a[228:231], a[152:155], v[132:135]
    v_mfma_f32_16x16x32_bf16 v[180:183], a[224:227], a[140:143], v[180:183]
    ds_read_b64_tr_b16 a[246:247], v222 offset:50952
    v_mfma_f32_16x16x32_bf16 v[180:183], a[228:231], a[156:159], v[180:183]
    s_waitcnt lgkmcnt(4)
    s_waitcnt vmcnt(22)
    s_barrier
    v_mfma_f32_16x16x32_bf16 v[40:43], a[232:235], a[128:131], v[40:43]
    ds_read_b64_tr_b16 a[224:225], v223 offset:0
    v_mfma_f32_16x16x32_bf16 v[40:43], a[236:239], a[144:147], v[40:43]
    v_mfma_f32_16x16x32_bf16 v[88:91], a[232:235], a[132:135], v[88:91]
    ds_read_b64_tr_b16 a[226:227], v223 offset:384
    v_mfma_f32_16x16x32_bf16 v[88:91], a[236:239], a[148:151], v[88:91]
    v_mfma_f32_16x16x32_bf16 v[136:139], a[232:235], a[136:139], v[136:139]
    ds_read_b64_tr_b16 a[228:229], v223 offset:3072
    v_mfma_f32_16x16x32_bf16 v[136:139], a[236:239], a[152:155], v[136:139]
    v_mfma_f32_16x16x32_bf16 v[184:187], a[232:235], a[140:143], v[184:187]
    ds_read_b64_tr_b16 a[230:231], v223 offset:3456
    v_mfma_f32_16x16x32_bf16 v[184:187], a[236:239], a[156:159], v[184:187]
    s_waitcnt lgkmcnt(4)
    v_mfma_f32_16x16x32_bf16 v[44:47], a[240:243], a[128:131], v[44:47]
    ds_read_b64_tr_b16 a[232:233], v223 offset:6144
    v_mfma_f32_16x16x32_bf16 v[44:47], a[244:247], a[144:147], v[44:47]
    v_mfma_f32_16x16x32_bf16 v[92:95], a[240:243], a[132:135], v[92:95]
    ds_read_b64_tr_b16 a[234:235], v223 offset:6528
    v_mfma_f32_16x16x32_bf16 v[92:95], a[244:247], a[148:151], v[92:95]
    v_mfma_f32_16x16x32_bf16 v[140:143], a[240:243], a[136:139], v[140:143]
    ds_read_b64_tr_b16 a[236:237], v223 offset:9216
    v_mfma_f32_16x16x32_bf16 v[140:143], a[244:247], a[152:155], v[140:143]
    v_mfma_f32_16x16x32_bf16 v[188:191], a[240:243], a[140:143], v[188:191]
    ds_read_b64_tr_b16 a[238:239], v223 offset:9600
    s_mov_b32 s33, 1769472
    v_mfma_f32_16x16x32_bf16 v[188:191], a[244:247], a[156:159], v[188:191]
    s_waitcnt lgkmcnt(4)
    v_mfma_f32_16x16x32_bf16 a[0:3], a[224:227], a[160:163], a[0:3]
    ds_read_b64_tr_b16 a[240:241], v223 offset:32
    s_add_u32 m0, s31, 135168
    v_mfma_f32_16x16x32_bf16 a[0:3], a[228:231], a[176:179], a[0:3]
    buffer_load_dwordx4 v216, s[8:11], s33 offen lds
    v_mfma_f32_16x16x32_bf16 a[4:7], a[224:227], a[164:167], a[4:7]
    ds_read_b64_tr_b16 a[242:243], v223 offset:416
    v_mfma_f32_16x16x32_bf16 a[4:7], a[228:231], a[180:183], a[4:7]
    v_mfma_f32_16x16x32_bf16 a[8:11], a[224:227], a[168:171], a[8:11]
    ds_read_b64_tr_b16 a[244:245], v223 offset:3104
    s_add_u32 m0, s31, 136192
    v_mfma_f32_16x16x32_bf16 a[8:11], a[228:231], a[184:187], a[8:11]
    buffer_load_dwordx4 v217, s[8:11], s33 offen lds
    v_mfma_f32_16x16x32_bf16 a[12:15], a[224:227], a[172:175], a[12:15]
    ds_read_b64_tr_b16 a[246:247], v223 offset:3488
    v_mfma_f32_16x16x32_bf16 a[12:15], a[228:231], a[188:191], a[12:15]
    s_waitcnt lgkmcnt(4)
    v_mfma_f32_16x16x32_bf16 a[48:51], a[232:235], a[160:163], a[48:51]
    ds_read_b64_tr_b16 a[224:225], v223 offset:6176
    s_add_u32 m0, s31, 137216
    v_mfma_f32_16x16x32_bf16 a[48:51], a[236:239], a[176:179], a[48:51]
    buffer_load_dwordx4 v218, s[8:11], s33 offen lds
    v_mfma_f32_16x16x32_bf16 a[52:55], a[232:235], a[164:167], a[52:55]
    ds_read_b64_tr_b16 a[226:227], v223 offset:6560
    v_mfma_f32_16x16x32_bf16 a[52:55], a[236:239], a[180:183], a[52:55]
    v_mfma_f32_16x16x32_bf16 a[56:59], a[232:235], a[168:171], a[56:59]
    ds_read_b64_tr_b16 a[228:229], v223 offset:9248
    s_mov_b32 s34, 73728
    v_mfma_f32_16x16x32_bf16 a[56:59], a[236:239], a[184:187], a[56:59]
    buffer_load_dwordx4 a[128:131], v212, s[12:15], s34 offen offset:0
    v_mfma_f32_16x16x32_bf16 a[60:63], a[232:235], a[172:175], a[60:63]
    ds_read_b64_tr_b16 a[230:231], v223 offset:9632
    v_mfma_f32_16x16x32_bf16 a[60:63], a[236:239], a[188:191], a[60:63]
    s_waitcnt lgkmcnt(4)
    v_mfma_f32_16x16x32_bf16 a[16:19], a[240:243], a[160:163], a[16:19]
    ds_read_b64_tr_b16 a[232:233], v223 offset:64
    v_mfma_f32_16x16x32_bf16 a[16:19], a[244:247], a[176:179], a[16:19]
    buffer_load_dwordx4 a[132:135], v212, s[12:15], s34 offen offset:1024
    v_mfma_f32_16x16x32_bf16 a[20:23], a[240:243], a[164:167], a[20:23]
    ds_read_b64_tr_b16 a[234:235], v223 offset:448
    v_mfma_f32_16x16x32_bf16 a[20:23], a[244:247], a[180:183], a[20:23]
    v_mfma_f32_16x16x32_bf16 a[24:27], a[240:243], a[168:171], a[24:27]
    ds_read_b64_tr_b16 a[236:237], v223 offset:3136
    v_mfma_f32_16x16x32_bf16 a[24:27], a[244:247], a[184:187], a[24:27]
    buffer_load_dwordx4 a[136:139], v212, s[12:15], s34 offen offset:2048
    v_mfma_f32_16x16x32_bf16 a[28:31], a[240:243], a[172:175], a[28:31]
    ds_read_b64_tr_b16 a[238:239], v223 offset:3520
    v_mfma_f32_16x16x32_bf16 a[28:31], a[244:247], a[188:191], a[28:31]
    s_waitcnt lgkmcnt(4)
    v_mfma_f32_16x16x32_bf16 a[64:67], a[224:227], a[160:163], a[64:67]
    ds_read_b64_tr_b16 a[240:241], v223 offset:6208
    v_mfma_f32_16x16x32_bf16 a[64:67], a[228:231], a[176:179], a[64:67]
    buffer_load_dwordx4 a[140:143], v212, s[12:15], s34 offen offset:3072
    v_mfma_f32_16x16x32_bf16 a[68:71], a[224:227], a[164:167], a[68:71]
    ds_read_b64_tr_b16 a[242:243], v223 offset:6592
    v_mfma_f32_16x16x32_bf16 a[68:71], a[228:231], a[180:183], a[68:71]
    v_mfma_f32_16x16x32_bf16 a[72:75], a[224:227], a[168:171], a[72:75]
    ds_read_b64_tr_b16 a[244:245], v223 offset:9280
    s_mov_b32 s34, 77824
    v_mfma_f32_16x16x32_bf16 a[72:75], a[228:231], a[184:187], a[72:75]
    buffer_load_dwordx4 a[144:147], v212, s[12:15], s34 offen offset:0
    v_mfma_f32_16x16x32_bf16 a[76:79], a[224:227], a[172:175], a[76:79]
    ds_read_b64_tr_b16 a[246:247], v223 offset:9664
    v_mfma_f32_16x16x32_bf16 a[76:79], a[228:231], a[188:191], a[76:79]
    s_waitcnt lgkmcnt(4)
    v_mfma_f32_16x16x32_bf16 a[32:35], a[232:235], a[160:163], a[32:35]
    ds_read_b64_tr_b16 a[224:225], v219 offset:0
    v_mfma_f32_16x16x32_bf16 a[32:35], a[236:239], a[176:179], a[32:35]
    buffer_load_dwordx4 a[148:151], v212, s[12:15], s34 offen offset:1024
    v_mfma_f32_16x16x32_bf16 a[36:39], a[232:235], a[164:167], a[36:39]
    ds_read_b64_tr_b16 a[226:227], v219 offset:1536
    v_mfma_f32_16x16x32_bf16 a[36:39], a[236:239], a[180:183], a[36:39]
    v_mfma_f32_16x16x32_bf16 a[40:43], a[232:235], a[168:171], a[40:43]
    ds_read_b64_tr_b16 a[228:229], v219 offset:12288
    v_mfma_f32_16x16x32_bf16 a[40:43], a[236:239], a[184:187], a[40:43]
    buffer_load_dwordx4 a[152:155], v212, s[12:15], s34 offen offset:2048
    v_mfma_f32_16x16x32_bf16 a[44:47], a[232:235], a[172:175], a[44:47]
    ds_read_b64_tr_b16 a[230:231], v219 offset:13824
    v_mfma_f32_16x16x32_bf16 a[44:47], a[236:239], a[188:191], a[44:47]
    s_waitcnt lgkmcnt(4)
    v_mfma_f32_16x16x32_bf16 a[80:83], a[240:243], a[160:163], a[80:83]
    ds_read_b64_tr_b16 a[232:233], v219 offset:8
    v_mfma_f32_16x16x32_bf16 a[80:83], a[244:247], a[176:179], a[80:83]
    buffer_load_dwordx4 a[156:159], v212, s[12:15], s34 offen offset:3072
    v_mfma_f32_16x16x32_bf16 a[84:87], a[240:243], a[164:167], a[84:87]
    ds_read_b64_tr_b16 a[234:235], v219 offset:1544
    v_mfma_f32_16x16x32_bf16 a[84:87], a[244:247], a[180:183], a[84:87]
    s_mov_b32 s33, 5505024
    v_mfma_f32_16x16x32_bf16 a[88:91], a[240:243], a[168:171], a[88:91]
    ds_read_b64_tr_b16 a[236:237], v219 offset:12296
    s_add_u32 m0, s32, 36864
    v_mfma_f32_16x16x32_bf16 a[88:91], a[244:247], a[184:187], a[88:91]
    buffer_load_dwordx4 v213, s[4:7], s33 offen lds
    v_mfma_f32_16x16x32_bf16 a[92:95], a[240:243], a[172:175], a[92:95]
    ds_read_b64_tr_b16 a[238:239], v219 offset:13832
    v_mfma_f32_16x16x32_bf16 a[92:95], a[244:247], a[188:191], a[92:95]
    s_waitcnt lgkmcnt(4)
    v_mfma_f32_16x16x32_bf16 v[0:3], a[224:227], a[160:163], v[0:3]
    ds_read_b64_tr_b16 a[240:241], v220 offset:0
    s_add_u32 m0, s32, 37888
    v_mfma_f32_16x16x32_bf16 v[0:3], a[228:231], a[176:179], v[0:3]
    buffer_load_dwordx4 v214, s[4:7], s33 offen lds
    v_mfma_f32_16x16x32_bf16 v[48:51], a[224:227], a[164:167], v[48:51]
    ds_read_b64_tr_b16 a[242:243], v220 offset:1536
    v_mfma_f32_16x16x32_bf16 v[48:51], a[228:231], a[180:183], v[48:51]
    v_mfma_f32_16x16x32_bf16 v[96:99], a[224:227], a[168:171], v[96:99]
    ds_read_b64_tr_b16 a[244:245], v220 offset:12288
    s_add_u32 m0, s32, 38912
    v_mfma_f32_16x16x32_bf16 v[96:99], a[228:231], a[184:187], v[96:99]
    buffer_load_dwordx4 v215, s[4:7], s33 offen lds
    v_mfma_f32_16x16x32_bf16 v[144:147], a[224:227], a[172:175], v[144:147]
    ds_read_b64_tr_b16 a[246:247], v220 offset:13824
    s_mov_b32 s33, 5603328
    v_mfma_f32_16x16x32_bf16 v[144:147], a[228:231], a[188:191], v[144:147]
    s_waitcnt lgkmcnt(4)
    v_mfma_f32_16x16x32_bf16 v[4:7], a[232:235], a[160:163], v[4:7]
    ds_read_b64_tr_b16 a[224:225], v220 offset:8
    s_add_u32 m0, s32, 39936
    v_mfma_f32_16x16x32_bf16 v[4:7], a[236:239], a[176:179], v[4:7]
    buffer_load_dwordx4 v213, s[4:7], s33 offen lds
    v_mfma_f32_16x16x32_bf16 v[52:55], a[232:235], a[164:167], v[52:55]
    ds_read_b64_tr_b16 a[226:227], v220 offset:1544
    v_mfma_f32_16x16x32_bf16 v[52:55], a[236:239], a[180:183], v[52:55]
    v_mfma_f32_16x16x32_bf16 v[100:103], a[232:235], a[168:171], v[100:103]
    ds_read_b64_tr_b16 a[228:229], v220 offset:12296
    s_add_u32 m0, s32, 40960
    v_mfma_f32_16x16x32_bf16 v[100:103], a[236:239], a[184:187], v[100:103]
    buffer_load_dwordx4 v214, s[4:7], s33 offen lds
    v_mfma_f32_16x16x32_bf16 v[148:151], a[232:235], a[172:175], v[148:151]
    ds_read_b64_tr_b16 a[230:231], v220 offset:13832
    v_mfma_f32_16x16x32_bf16 v[148:151], a[236:239], a[188:191], v[148:151]
    s_waitcnt lgkmcnt(4)
    v_mfma_f32_16x16x32_bf16 v[8:11], a[240:243], a[160:163], v[8:11]
    ds_read_b64_tr_b16 a[232:233], v219 offset:128
    s_add_u32 m0, s32, 41984
    v_mfma_f32_16x16x32_bf16 v[8:11], a[244:247], a[176:179], v[8:11]
    buffer_load_dwordx4 v215, s[4:7], s33 offen lds
    v_mfma_f32_16x16x32_bf16 v[56:59], a[240:243], a[164:167], v[56:59]
    ds_read_b64_tr_b16 a[234:235], v219 offset:1664
    v_mfma_f32_16x16x32_bf16 v[56:59], a[244:247], a[180:183], v[56:59]
    s_mov_b32 s33, 6291456
    v_mfma_f32_16x16x32_bf16 v[104:107], a[240:243], a[168:171], v[104:107]
    ds_read_b64_tr_b16 a[236:237], v219 offset:12416
    s_add_u32 m0, s32, 73728
    v_mfma_f32_16x16x32_bf16 v[104:107], a[244:247], a[184:187], v[104:107]
    buffer_load_dwordx4 v213, s[4:7], s33 offen lds
    v_mfma_f32_16x16x32_bf16 v[152:155], a[240:243], a[172:175], v[152:155]
    ds_read_b64_tr_b16 a[238:239], v219 offset:13952
    v_mfma_f32_16x16x32_bf16 v[152:155], a[244:247], a[188:191], v[152:155]
    s_waitcnt lgkmcnt(4)
    v_mfma_f32_16x16x32_bf16 v[12:15], a[224:227], a[160:163], v[12:15]
    ds_read_b64_tr_b16 a[240:241], v219 offset:136
    s_add_u32 m0, s32, 74752
    v_mfma_f32_16x16x32_bf16 v[12:15], a[228:231], a[176:179], v[12:15]
    buffer_load_dwordx4 v214, s[4:7], s33 offen lds
    v_mfma_f32_16x16x32_bf16 v[60:63], a[224:227], a[164:167], v[60:63]
    ds_read_b64_tr_b16 a[242:243], v219 offset:1672
    v_mfma_f32_16x16x32_bf16 v[60:63], a[228:231], a[180:183], v[60:63]
    v_mfma_f32_16x16x32_bf16 v[108:111], a[224:227], a[168:171], v[108:111]
    ds_read_b64_tr_b16 a[244:245], v219 offset:12424
    s_add_u32 m0, s32, 75776
    v_mfma_f32_16x16x32_bf16 v[108:111], a[228:231], a[184:187], v[108:111]
    buffer_load_dwordx4 v215, s[4:7], s33 offen lds
    v_mfma_f32_16x16x32_bf16 v[156:159], a[224:227], a[172:175], v[156:159]
    ds_read_b64_tr_b16 a[246:247], v219 offset:13960
    s_mov_b32 s33, 6389760
    v_mfma_f32_16x16x32_bf16 v[156:159], a[228:231], a[188:191], v[156:159]
    s_waitcnt lgkmcnt(4)
    v_mfma_f32_16x16x32_bf16 v[16:19], a[232:235], a[160:163], v[16:19]
    ds_read_b64_tr_b16 a[224:225], v220 offset:128
    s_add_u32 m0, s32, 76800
    v_mfma_f32_16x16x32_bf16 v[16:19], a[236:239], a[176:179], v[16:19]
    buffer_load_dwordx4 v213, s[4:7], s33 offen lds
    v_mfma_f32_16x16x32_bf16 v[64:67], a[232:235], a[164:167], v[64:67]
    ds_read_b64_tr_b16 a[226:227], v220 offset:1664
    v_mfma_f32_16x16x32_bf16 v[64:67], a[236:239], a[180:183], v[64:67]
    v_mfma_f32_16x16x32_bf16 v[112:115], a[232:235], a[168:171], v[112:115]
    ds_read_b64_tr_b16 a[228:229], v220 offset:12416
    s_add_u32 m0, s32, 77824
    v_mfma_f32_16x16x32_bf16 v[112:115], a[236:239], a[184:187], v[112:115]
    buffer_load_dwordx4 v214, s[4:7], s33 offen lds
    v_mfma_f32_16x16x32_bf16 v[160:163], a[232:235], a[172:175], v[160:163]
    ds_read_b64_tr_b16 a[230:231], v220 offset:13952
    v_mfma_f32_16x16x32_bf16 v[160:163], a[236:239], a[188:191], v[160:163]
    s_waitcnt lgkmcnt(4)
    v_mfma_f32_16x16x32_bf16 v[20:23], a[240:243], a[160:163], v[20:23]
    ds_read_b64_tr_b16 a[232:233], v220 offset:136
    s_add_u32 m0, s32, 78848
    v_mfma_f32_16x16x32_bf16 v[20:23], a[244:247], a[176:179], v[20:23]
    buffer_load_dwordx4 v215, s[4:7], s33 offen lds
    v_mfma_f32_16x16x32_bf16 v[68:71], a[240:243], a[164:167], v[68:71]
    ds_read_b64_tr_b16 a[234:235], v220 offset:1672
    v_mfma_f32_16x16x32_bf16 v[68:71], a[244:247], a[180:183], v[68:71]
    v_mfma_f32_16x16x32_bf16 v[116:119], a[240:243], a[168:171], v[116:119]
    ds_read_b64_tr_b16 a[236:237], v220 offset:12424
    v_mfma_f32_16x16x32_bf16 v[116:119], a[244:247], a[184:187], v[116:119]
    v_mfma_f32_16x16x32_bf16 v[164:167], a[240:243], a[172:175], v[164:167]
    ds_read_b64_tr_b16 a[238:239], v220 offset:13960
    v_mfma_f32_16x16x32_bf16 v[164:167], a[244:247], a[188:191], v[164:167]
    s_waitcnt lgkmcnt(4)
    v_mfma_f32_16x16x32_bf16 v[24:27], a[224:227], a[160:163], v[24:27]
    ds_read_b64_tr_b16 a[240:241], v219 offset:256
    v_mfma_f32_16x16x32_bf16 v[24:27], a[228:231], a[176:179], v[24:27]
    v_mfma_f32_16x16x32_bf16 v[72:75], a[224:227], a[164:167], v[72:75]
    ds_read_b64_tr_b16 a[242:243], v219 offset:1792
    v_mfma_f32_16x16x32_bf16 v[72:75], a[228:231], a[180:183], v[72:75]
    v_mfma_f32_16x16x32_bf16 v[120:123], a[224:227], a[168:171], v[120:123]
    ds_read_b64_tr_b16 a[244:245], v219 offset:12544
    v_mfma_f32_16x16x32_bf16 v[120:123], a[228:231], a[184:187], v[120:123]
    v_mfma_f32_16x16x32_bf16 v[168:171], a[224:227], a[172:175], v[168:171]
    ds_read_b64_tr_b16 a[246:247], v219 offset:14080
    v_mfma_f32_16x16x32_bf16 v[168:171], a[228:231], a[188:191], v[168:171]
    s_waitcnt lgkmcnt(4)
    v_mfma_f32_16x16x32_bf16 v[28:31], a[232:235], a[160:163], v[28:31]
    ds_read_b64_tr_b16 a[224:225], v219 offset:264
    v_mfma_f32_16x16x32_bf16 v[28:31], a[236:239], a[176:179], v[28:31]
    v_mfma_f32_16x16x32_bf16 v[76:79], a[232:235], a[164:167], v[76:79]
    ds_read_b64_tr_b16 a[226:227], v219 offset:1800
    v_mfma_f32_16x16x32_bf16 v[76:79], a[236:239], a[180:183], v[76:79]
    v_mfma_f32_16x16x32_bf16 v[124:127], a[232:235], a[168:171], v[124:127]
    ds_read_b64_tr_b16 a[228:229], v219 offset:12552
    v_mfma_f32_16x16x32_bf16 v[124:127], a[236:239], a[184:187], v[124:127]
    v_mfma_f32_16x16x32_bf16 v[172:175], a[232:235], a[172:175], v[172:175]
    ds_read_b64_tr_b16 a[230:231], v219 offset:14088
    v_mfma_f32_16x16x32_bf16 v[172:175], a[236:239], a[188:191], v[172:175]
    s_waitcnt lgkmcnt(4)
    v_mfma_f32_16x16x32_bf16 v[32:35], a[240:243], a[160:163], v[32:35]
    ds_read_b64_tr_b16 a[232:233], v220 offset:256
    v_mfma_f32_16x16x32_bf16 v[32:35], a[244:247], a[176:179], v[32:35]
    v_mfma_f32_16x16x32_bf16 v[80:83], a[240:243], a[164:167], v[80:83]
    ds_read_b64_tr_b16 a[234:235], v220 offset:1792
    v_mfma_f32_16x16x32_bf16 v[80:83], a[244:247], a[180:183], v[80:83]
    v_mfma_f32_16x16x32_bf16 v[128:131], a[240:243], a[168:171], v[128:131]
    ds_read_b64_tr_b16 a[236:237], v220 offset:12544
    v_mfma_f32_16x16x32_bf16 v[128:131], a[244:247], a[184:187], v[128:131]
    v_mfma_f32_16x16x32_bf16 v[176:179], a[240:243], a[172:175], v[176:179]
    ds_read_b64_tr_b16 a[238:239], v220 offset:14080
    v_mfma_f32_16x16x32_bf16 v[176:179], a[244:247], a[188:191], v[176:179]
    s_waitcnt lgkmcnt(4)
    v_mfma_f32_16x16x32_bf16 v[36:39], a[224:227], a[160:163], v[36:39]
    ds_read_b64_tr_b16 a[240:241], v220 offset:264
    v_mfma_f32_16x16x32_bf16 v[36:39], a[228:231], a[176:179], v[36:39]
    v_mfma_f32_16x16x32_bf16 v[84:87], a[224:227], a[164:167], v[84:87]
    ds_read_b64_tr_b16 a[242:243], v220 offset:1800
    v_mfma_f32_16x16x32_bf16 v[84:87], a[228:231], a[180:183], v[84:87]
    v_mfma_f32_16x16x32_bf16 v[132:135], a[224:227], a[168:171], v[132:135]
    ds_read_b64_tr_b16 a[244:245], v220 offset:12552
    v_mfma_f32_16x16x32_bf16 v[132:135], a[228:231], a[184:187], v[132:135]
    v_mfma_f32_16x16x32_bf16 v[180:183], a[224:227], a[172:175], v[180:183]
    ds_read_b64_tr_b16 a[246:247], v220 offset:14088
    v_mfma_f32_16x16x32_bf16 v[180:183], a[228:231], a[188:191], v[180:183]
    s_waitcnt lgkmcnt(4)
    s_waitcnt vmcnt(20)
    s_barrier
    v_mfma_f32_16x16x32_bf16 v[40:43], a[232:235], a[160:163], v[40:43]
    ds_read_b64_tr_b16 a[224:225], v223 offset:36864
    v_mfma_f32_16x16x32_bf16 v[40:43], a[236:239], a[176:179], v[40:43]
    v_mfma_f32_16x16x32_bf16 v[88:91], a[232:235], a[164:167], v[88:91]
    ds_read_b64_tr_b16 a[226:227], v223 offset:37248
    v_mfma_f32_16x16x32_bf16 v[88:91], a[236:239], a[180:183], v[88:91]
    v_mfma_f32_16x16x32_bf16 v[136:139], a[232:235], a[168:171], v[136:139]
    ds_read_b64_tr_b16 a[228:229], v223 offset:39936
    v_mfma_f32_16x16x32_bf16 v[136:139], a[236:239], a[184:187], v[136:139]
    v_mfma_f32_16x16x32_bf16 v[184:187], a[232:235], a[172:175], v[184:187]
    ds_read_b64_tr_b16 a[230:231], v223 offset:40320
    v_mfma_f32_16x16x32_bf16 v[184:187], a[236:239], a[188:191], v[184:187]
    s_waitcnt lgkmcnt(4)
    v_mfma_f32_16x16x32_bf16 v[44:47], a[240:243], a[160:163], v[44:47]
    ds_read_b64_tr_b16 a[232:233], v223 offset:43008
    v_mfma_f32_16x16x32_bf16 v[44:47], a[244:247], a[176:179], v[44:47]
    v_mfma_f32_16x16x32_bf16 v[92:95], a[240:243], a[164:167], v[92:95]
    ds_read_b64_tr_b16 a[234:235], v223 offset:43392
    v_mfma_f32_16x16x32_bf16 v[92:95], a[244:247], a[180:183], v[92:95]
    v_mfma_f32_16x16x32_bf16 v[140:143], a[240:243], a[168:171], v[140:143]
    ds_read_b64_tr_b16 a[236:237], v223 offset:46080
    v_mfma_f32_16x16x32_bf16 v[140:143], a[244:247], a[184:187], v[140:143]
    v_mfma_f32_16x16x32_bf16 v[188:191], a[240:243], a[172:175], v[188:191]
    ds_read_b64_tr_b16 a[238:239], v223 offset:46464
    s_mov_b32 s33, 7077888
    v_mfma_f32_16x16x32_bf16 v[188:191], a[244:247], a[188:191], v[188:191]
    s_waitcnt lgkmcnt(4)
    v_mfma_f32_16x16x32_bf16 a[0:3], a[224:227], a[192:195], a[0:3]
    ds_read_b64_tr_b16 a[240:241], v223 offset:36896
    s_add_u32 m0, s32, 110592
    v_mfma_f32_16x16x32_bf16 a[0:3], a[228:231], a[208:211], a[0:3]
    buffer_load_dwordx4 v213, s[4:7], s33 offen lds
    v_mfma_f32_16x16x32_bf16 a[4:7], a[224:227], a[196:199], a[4:7]
    ds_read_b64_tr_b16 a[242:243], v223 offset:37280
    v_mfma_f32_16x16x32_bf16 a[4:7], a[228:231], a[212:215], a[4:7]
    v_mfma_f32_16x16x32_bf16 a[8:11], a[224:227], a[200:203], a[8:11]
    ds_read_b64_tr_b16 a[244:245], v223 offset:39968
    s_add_u32 m0, s32, 111616
    v_mfma_f32_16x16x32_bf16 a[8:11], a[228:231], a[216:219], a[8:11]
    buffer_load_dwordx4 v214, s[4:7], s33 offen lds
    v_mfma_f32_16x16x32_bf16 a[12:15], a[224:227], a[204:207], a[12:15]
    ds_read_b64_tr_b16 a[246:247], v223 offset:40352
    v_mfma_f32_16x16x32_bf16 a[12:15], a[228:231], a[220:223], a[12:15]
    s_waitcnt lgkmcnt(4)
    v_mfma_f32_16x16x32_bf16 a[48:51], a[232:235], a[192:195], a[48:51]
    ds_read_b64_tr_b16 a[224:225], v223 offset:43040
    s_add_u32 m0, s32, 112640
    v_mfma_f32_16x16x32_bf16 a[48:51], a[236:239], a[208:211], a[48:51]
    buffer_load_dwordx4 v215, s[4:7], s33 offen lds
    v_mfma_f32_16x16x32_bf16 a[52:55], a[232:235], a[196:199], a[52:55]
    ds_read_b64_tr_b16 a[226:227], v223 offset:43424
    v_mfma_f32_16x16x32_bf16 a[52:55], a[236:239], a[212:215], a[52:55]
    s_mov_b32 s33, 7176192
    v_mfma_f32_16x16x32_bf16 a[56:59], a[232:235], a[200:203], a[56:59]
    ds_read_b64_tr_b16 a[228:229], v223 offset:46112
    s_add_u32 m0, s32, 113664
    v_mfma_f32_16x16x32_bf16 a[56:59], a[236:239], a[216:219], a[56:59]
    buffer_load_dwordx4 v213, s[4:7], s33 offen lds
    v_mfma_f32_16x16x32_bf16 a[60:63], a[232:235], a[204:207], a[60:63]
    ds_read_b64_tr_b16 a[230:231], v223 offset:46496
    v_mfma_f32_16x16x32_bf16 a[60:63], a[236:239], a[220:223], a[60:63]
    s_waitcnt lgkmcnt(4)
    v_mfma_f32_16x16x32_bf16 a[16:19], a[240:243], a[192:195], a[16:19]
    ds_read_b64_tr_b16 a[232:233], v223 offset:36928
    s_add_u32 m0, s32, 114688
    v_mfma_f32_16x16x32_bf16 a[16:19], a[244:247], a[208:211], a[16:19]
    buffer_load_dwordx4 v214, s[4:7], s33 offen lds
    v_mfma_f32_16x16x32_bf16 a[20:23], a[240:243], a[196:199], a[20:23]
    ds_read_b64_tr_b16 a[234:235], v223 offset:37312
    v_mfma_f32_16x16x32_bf16 a[20:23], a[244:247], a[212:215], a[20:23]
    v_mfma_f32_16x16x32_bf16 a[24:27], a[240:243], a[200:203], a[24:27]
    ds_read_b64_tr_b16 a[236:237], v223 offset:40000
    s_add_u32 m0, s32, 115712
    v_mfma_f32_16x16x32_bf16 a[24:27], a[244:247], a[216:219], a[24:27]
    buffer_load_dwordx4 v215, s[4:7], s33 offen lds
    v_mfma_f32_16x16x32_bf16 a[28:31], a[240:243], a[204:207], a[28:31]
    ds_read_b64_tr_b16 a[238:239], v223 offset:40384
    v_mfma_f32_16x16x32_bf16 a[28:31], a[244:247], a[220:223], a[28:31]
    s_waitcnt lgkmcnt(4)
    v_mfma_f32_16x16x32_bf16 a[64:67], a[224:227], a[192:195], a[64:67]
    ds_read_b64_tr_b16 a[240:241], v223 offset:43072
    v_mfma_f32_16x16x32_bf16 a[64:67], a[228:231], a[208:211], a[64:67]
    v_mfma_f32_16x16x32_bf16 a[68:71], a[224:227], a[196:199], a[68:71]
    ds_read_b64_tr_b16 a[242:243], v223 offset:43456
    v_mfma_f32_16x16x32_bf16 a[68:71], a[228:231], a[212:215], a[68:71]
    v_mfma_f32_16x16x32_bf16 a[72:75], a[224:227], a[200:203], a[72:75]
    ds_read_b64_tr_b16 a[244:245], v223 offset:46144
    v_mfma_f32_16x16x32_bf16 a[72:75], a[228:231], a[216:219], a[72:75]
    v_mfma_f32_16x16x32_bf16 a[76:79], a[224:227], a[204:207], a[76:79]
    ds_read_b64_tr_b16 a[246:247], v223 offset:46528
    v_mfma_f32_16x16x32_bf16 a[76:79], a[228:231], a[220:223], a[76:79]
    s_waitcnt lgkmcnt(4)
    v_mfma_f32_16x16x32_bf16 a[32:35], a[232:235], a[192:195], a[32:35]
    ds_read_b64_tr_b16 a[224:225], v224 offset:0
    s_and_b32 s40, s2, 7
    v_mfma_f32_16x16x32_bf16 a[32:35], a[236:239], a[208:211], a[32:35]
    s_lshr_b32 s12, s40, 1
    v_mfma_f32_16x16x32_bf16 a[36:39], a[232:235], a[196:199], a[36:39]
    ds_read_b64_tr_b16 a[226:227], v224 offset:384
    s_and_b32 s40, s40, 1
    v_mfma_f32_16x16x32_bf16 a[36:39], a[236:239], a[212:215], a[36:39]
    s_lshl_b32 s40, s40, 3
    v_mfma_f32_16x16x32_bf16 a[40:43], a[232:235], a[200:203], a[40:43]
    ds_read_b64_tr_b16 a[228:229], v224 offset:3072
    s_lshr_b32 s41, s2, 3
    v_mfma_f32_16x16x32_bf16 a[40:43], a[236:239], a[216:219], a[40:43]
    s_and_b32 s42, s41, 7
    v_mfma_f32_16x16x32_bf16 a[44:47], a[232:235], a[204:207], a[44:47]
    ds_read_b64_tr_b16 a[230:231], v224 offset:3456
    s_add_u32 s13, s40, s42
    v_mfma_f32_16x16x32_bf16 a[44:47], a[236:239], a[220:223], a[44:47]
    s_waitcnt lgkmcnt(4)
    s_lshr_b32 s14, s41, 3
    v_mfma_f32_16x16x32_bf16 a[80:83], a[240:243], a[192:195], a[80:83]
    ds_read_b64_tr_b16 a[232:233], v224 offset:6144
    s_lshr_b32 s40, s28, 1
    v_mfma_f32_16x16x32_bf16 a[80:83], a[244:247], a[208:211], a[80:83]
    s_lshl_b32 s41, s13, 1
    v_mfma_f32_16x16x32_bf16 a[84:87], a[240:243], a[196:199], a[84:87]
    ds_read_b64_tr_b16 a[234:235], v224 offset:6528
    s_add_u32 s41, s41, s40
    v_mfma_f32_16x16x32_bf16 a[84:87], a[244:247], a[212:215], a[84:87]
    s_mul_i32 s41, s41, 983040
    v_mfma_f32_16x16x32_bf16 a[88:91], a[240:243], a[200:203], a[88:91]
    ds_read_b64_tr_b16 a[236:237], v224 offset:9216
    s_and_b32 s42, s28, 1
    v_mfma_f32_16x16x32_bf16 a[88:91], a[244:247], a[216:219], a[88:91]
    s_lshl_b32 s43, s42, 11
    v_mfma_f32_16x16x32_bf16 a[92:95], a[240:243], a[204:207], a[92:95]
    ds_read_b64_tr_b16 a[238:239], v224 offset:9600
    s_add_u32 s41, s41, s43
    v_mfma_f32_16x16x32_bf16 a[92:95], a[244:247], a[220:223], a[92:95]
    s_waitcnt lgkmcnt(4)
    s_add_u32 s41, s41, 0x00400000
    v_mfma_f32_16x16x32_bf16 a[0:3], a[224:227], a[96:99], a[0:3]
    ds_read_b64_tr_b16 a[240:241], v224 offset:32
    s_mul_i32 s50, s12, 48
    v_mfma_f32_16x16x32_bf16 a[0:3], a[228:231], a[112:115], a[0:3]
    s_add_u32 s50, s50, 96
    v_mfma_f32_16x16x32_bf16 a[4:7], a[224:227], a[100:103], a[4:7]
    ds_read_b64_tr_b16 a[242:243], v224 offset:416
    s_lshl_b32 s51, s50, 12
    v_mfma_f32_16x16x32_bf16 a[4:7], a[228:231], a[116:119], a[4:7]
    s_sub_u32 s51, s51, s43
    v_mfma_f32_16x16x32_bf16 a[8:11], a[224:227], a[104:107], a[8:11]
    ds_read_b64_tr_b16 a[244:245], v224 offset:3104
    v_mfma_f32_16x16x32_bf16 a[8:11], a[228:231], a[120:123], a[8:11]
    s_add_u32 s4, s56, s41
    s_addc_u32 s5, s57, 0
    v_mfma_f32_16x16x32_bf16 a[12:15], a[224:227], a[108:111], a[12:15]
    ds_read_b64_tr_b16 a[246:247], v224 offset:3488
    s_mov_b32 s6, s51
    v_mfma_f32_16x16x32_bf16 a[12:15], a[228:231], a[124:127], a[12:15]
    s_waitcnt lgkmcnt(4)
    s_mov_b32 s7, 0x20000
    v_mfma_f32_16x16x32_bf16 a[48:51], a[232:235], a[96:99], a[48:51]
    ds_read_b64_tr_b16 a[224:225], v224 offset:6176
    s_mul_i32 s41, s14, 10240
    v_mfma_f32_16x16x32_bf16 a[48:51], a[236:239], a[112:115], a[48:51]
    s_mul_i32 s43, s42, 5120
    v_mfma_f32_16x16x32_bf16 a[52:55], a[232:235], a[100:103], a[52:55]
    ds_read_b64_tr_b16 a[226:227], v224 offset:6560
    s_add_u32 s41, s41, s43
    v_mfma_f32_16x16x32_bf16 a[52:55], a[236:239], a[116:119], a[52:55]
    s_mul_i32 s43, s40, 40960
    v_mfma_f32_16x16x32_bf16 a[56:59], a[232:235], a[104:107], a[56:59]
    ds_read_b64_tr_b16 a[228:229], v224 offset:9248
    s_add_u32 s41, s41, s43
    v_mfma_f32_16x16x32_bf16 a[56:59], a[236:239], a[120:123], a[56:59]
    s_mul_i32 s51, s50, 40960
    v_mfma_f32_16x16x32_bf16 a[60:63], a[232:235], a[108:111], a[60:63]
    ds_read_b64_tr_b16 a[230:231], v224 offset:9632
    s_sub_u32 s51, s51, s41
    v_mfma_f32_16x16x32_bf16 a[60:63], a[236:239], a[124:127], a[60:63]
    s_waitcnt lgkmcnt(4)
    s_add_u32 s41, s41, 0x02800000
    v_mfma_f32_16x16x32_bf16 a[16:19], a[240:243], a[96:99], a[16:19]
    ds_read_b64_tr_b16 a[232:233], v224 offset:64
    v_mfma_f32_16x16x32_bf16 a[16:19], a[244:247], a[112:115], a[16:19]
    s_add_u32 s8, s56, s41
    s_addc_u32 s9, s57, 0
    v_mfma_f32_16x16x32_bf16 a[20:23], a[240:243], a[100:103], a[20:23]
    ds_read_b64_tr_b16 a[234:235], v224 offset:448
    s_mov_b32 s10, s51
    v_mfma_f32_16x16x32_bf16 a[20:23], a[244:247], a[116:119], a[20:23]
    s_mov_b32 s11, 0x20000
    v_mfma_f32_16x16x32_bf16 a[24:27], a[240:243], a[104:107], a[24:27]
    ds_read_b64_tr_b16 a[236:237], v224 offset:3136
    s_lshr_b32 s40, s13, 1
    v_mfma_f32_16x16x32_bf16 a[24:27], a[244:247], a[120:123], a[24:27]
    s_lshl_b32 s40, s40, 2
    v_mfma_f32_16x16x32_bf16 a[28:31], a[240:243], a[108:111], a[28:31]
    ds_read_b64_tr_b16 a[238:239], v224 offset:3520
    s_add_u32 s40, s40, s12
    v_mfma_f32_16x16x32_bf16 a[28:31], a[244:247], a[124:127], a[28:31]
    s_waitcnt lgkmcnt(4)
    s_lshl_b32 s15, s40, 7
    v_mfma_f32_16x16x32_bf16 a[64:67], a[224:227], a[96:99], a[64:67]
    ds_read_b64_tr_b16 a[240:241], v224 offset:6208
    s_lshl_b32 s40, s13, 2
    v_mfma_f32_16x16x32_bf16 a[64:67], a[228:231], a[112:115], a[64:67]
    s_add_u32 s40, s40, s14
    v_mfma_f32_16x16x32_bf16 a[68:71], a[224:227], a[100:103], a[68:71]
    ds_read_b64_tr_b16 a[242:243], v224 offset:6592
    s_lshl_b32 s40, s40, 7
    v_mfma_f32_16x16x32_bf16 a[68:71], a[228:231], a[116:119], a[68:71]
    s_add_u32 s78, s40, 4096
    v_mfma_f32_16x16x32_bf16 a[72:75], a[224:227], a[104:107], a[72:75]
    ds_read_b64_tr_b16 a[244:245], v224 offset:9280
    s_lshl_b32 s40, s12, 2
    v_mfma_f32_16x16x32_bf16 a[72:75], a[228:231], a[120:123], a[72:75]
    s_add_u32 s79, s78, s40
    v_mfma_f32_16x16x32_bf16 a[76:79], a[224:227], a[108:111], a[76:79]
    ds_read_b64_tr_b16 a[246:247], v224 offset:9664
    v_lshrrev_b32 v218, 2, v212
    v_mfma_f32_16x16x32_bf16 a[76:79], a[228:231], a[124:127], a[76:79]
    s_waitcnt lgkmcnt(4)
    v_and_b32 v218, 28, v218
    v_mfma_f32_16x16x32_bf16 a[32:35], a[232:235], a[96:99], a[32:35]
    ds_read_b64_tr_b16 a[224:225], v224 offset:36864
    v_add_u32 v213, 4096, v212
    v_mfma_f32_16x16x32_bf16 a[32:35], a[236:239], a[112:115], a[32:35]
    v_add_u32 v214, 8192, v212
    v_mfma_f32_16x16x32_bf16 a[36:39], a[232:235], a[100:103], a[36:39]
    ds_read_b64_tr_b16 a[226:227], v224 offset:37248
    v_add_u32 v215, 98304, v212
    v_mfma_f32_16x16x32_bf16 a[36:39], a[236:239], a[116:119], a[36:39]
    v_mov_b32 v217, s58
    v_mfma_f32_16x16x32_bf16 a[40:43], a[232:235], a[104:107], a[40:43]
    ds_read_b64_tr_b16 a[228:229], v224 offset:39936
    s_add_u32 s81, s49, 16384
    v_mfma_f32_16x16x32_bf16 a[40:43], a[236:239], a[120:123], a[40:43]
    v_mfma_f32_16x16x32_bf16 a[44:47], a[232:235], a[108:111], a[44:47]
    ds_read_b64_tr_b16 a[230:231], v224 offset:40320
    v_mfma_f32_16x16x32_bf16 a[44:47], a[236:239], a[124:127], a[44:47]
    s_waitcnt lgkmcnt(4)
    v_mfma_f32_16x16x32_bf16 a[80:83], a[240:243], a[96:99], a[80:83]
    ds_read_b64_tr_b16 a[232:233], v224 offset:43008
    v_mfma_f32_16x16x32_bf16 a[80:83], a[244:247], a[112:115], a[80:83]
    v_mfma_f32_16x16x32_bf16 a[84:87], a[240:243], a[100:103], a[84:87]
    ds_read_b64_tr_b16 a[234:235], v224 offset:43392
    v_mfma_f32_16x16x32_bf16 a[84:87], a[244:247], a[116:119], a[84:87]
    v_mfma_f32_16x16x32_bf16 a[88:91], a[240:243], a[104:107], a[88:91]
    ds_read_b64_tr_b16 a[236:237], v224 offset:46080
    v_mfma_f32_16x16x32_bf16 a[88:91], a[244:247], a[120:123], a[88:91]
    v_mfma_f32_16x16x32_bf16 a[92:95], a[240:243], a[108:111], a[92:95]
    ds_read_b64_tr_b16 a[238:239], v224 offset:46464
    v_mfma_f32_16x16x32_bf16 a[92:95], a[244:247], a[124:127], a[92:95]
    s_waitcnt vmcnt(18) lgkmcnt(4)
    v_mfma_f32_16x16x32_bf16 a[0:3], a[224:227], a[128:131], a[0:3]
    ds_read_b64_tr_b16 a[240:241], v224 offset:36896
    v_mfma_f32_16x16x32_bf16 a[0:3], a[228:231], a[144:147], a[0:3]
    v_mfma_f32_16x16x32_bf16 a[4:7], a[224:227], a[132:135], a[4:7]
    ds_read_b64_tr_b16 a[242:243], v224 offset:37280
    v_mfma_f32_16x16x32_bf16 a[4:7], a[228:231], a[148:151], a[4:7]
    v_mfma_f32_16x16x32_bf16 a[8:11], a[224:227], a[136:139], a[8:11]
    ds_read_b64_tr_b16 a[244:245], v224 offset:39968
    v_mfma_f32_16x16x32_bf16 a[8:11], a[228:231], a[152:155], a[8:11]
    v_mfma_f32_16x16x32_bf16 a[12:15], a[224:227], a[140:143], a[12:15]
    ds_read_b64_tr_b16 a[246:247], v224 offset:40352
    v_mfma_f32_16x16x32_bf16 a[12:15], a[228:231], a[156:159], a[12:15]
    s_waitcnt lgkmcnt(4)
    v_mfma_f32_16x16x32_bf16 a[48:51], a[232:235], a[128:131], a[48:51]
    ds_read_b64_tr_b16 a[224:225], v224 offset:43040
    v_mfma_f32_16x16x32_bf16 a[48:51], a[236:239], a[144:147], a[48:51]
    v_mfma_f32_16x16x32_bf16 a[52:55], a[232:235], a[132:135], a[52:55]
    ds_read_b64_tr_b16 a[226:227], v224 offset:43424
    v_mfma_f32_16x16x32_bf16 a[52:55], a[236:239], a[148:151], a[52:55]
    v_mfma_f32_16x16x32_bf16 a[56:59], a[232:235], a[136:139], a[56:59]
    ds_read_b64_tr_b16 a[228:229], v224 offset:46112
    v_mfma_f32_16x16x32_bf16 a[56:59], a[236:239], a[152:155], a[56:59]
    v_mfma_f32_16x16x32_bf16 a[60:63], a[232:235], a[140:143], a[60:63]
    ds_read_b64_tr_b16 a[230:231], v224 offset:46496
    v_mfma_f32_16x16x32_bf16 a[60:63], a[236:239], a[156:159], a[60:63]
    s_waitcnt lgkmcnt(4)
    v_mfma_f32_16x16x32_bf16 a[16:19], a[240:243], a[128:131], a[16:19]
    ds_read_b64_tr_b16 a[232:233], v224 offset:36928
    v_mfma_f32_16x16x32_bf16 a[16:19], a[244:247], a[144:147], a[16:19]
    v_mfma_f32_16x16x32_bf16 a[20:23], a[240:243], a[132:135], a[20:23]
    ds_read_b64_tr_b16 a[234:235], v224 offset:37312
    v_mfma_f32_16x16x32_bf16 a[20:23], a[244:247], a[148:151], a[20:23]
    v_mfma_f32_16x16x32_bf16 a[24:27], a[240:243], a[136:139], a[24:27]
    ds_read_b64_tr_b16 a[236:237], v224 offset:40000
    v_accvgpr_read_b32 v192, a0
    v_mfma_f32_16x16x32_bf16 a[24:27], a[244:247], a[152:155], a[24:27]
    v_accvgpr_read_b32 v193, a1
    v_accvgpr_read_b32 v194, a2
    v_mfma_f32_16x16x32_bf16 a[28:31], a[240:243], a[140:143], a[28:31]
    ds_read_b64_tr_b16 a[238:239], v224 offset:40384
    v_accvgpr_read_b32 v195, a3
    v_mfma_f32_16x16x32_bf16 a[28:31], a[244:247], a[156:159], a[28:31]
    s_waitcnt lgkmcnt(4)
    v_mul_f32 v228, s95, v192
    v_mul_f32 v229, s95, v193
    v_mfma_f32_16x16x32_bf16 a[64:67], a[224:227], a[128:131], a[64:67]
    ds_read_b64_tr_b16 a[240:241], v224 offset:43072
    v_mul_f32 v230, s95, v194
    v_mfma_f32_16x16x32_bf16 a[64:67], a[228:231], a[144:147], a[64:67]
    v_exp_f32 v228, v228
    v_mfma_f32_16x16x32_bf16 a[68:71], a[224:227], a[132:135], a[68:71]
    ds_read_b64_tr_b16 a[242:243], v224 offset:43456
    v_mul_f32 v231, s95, v195
    v_mfma_f32_16x16x32_bf16 a[68:71], a[228:231], a[148:151], a[68:71]
    v_exp_f32 v229, v229
    v_mfma_f32_16x16x32_bf16 a[72:75], a[224:227], a[136:139], a[72:75]
    ds_read_b64_tr_b16 a[244:245], v224 offset:46144
    v_accvgpr_read_b32 v196, a48
    v_mfma_f32_16x16x32_bf16 a[72:75], a[228:231], a[152:155], a[72:75]
    v_exp_f32 v230, v230
    v_mfma_f32_16x16x32_bf16 a[76:79], a[224:227], a[140:143], a[76:79]
    ds_read_b64_tr_b16 a[246:247], v224 offset:46528
    v_accvgpr_read_b32 v197, a49
    v_mfma_f32_16x16x32_bf16 a[76:79], a[228:231], a[156:159], a[76:79]
    s_waitcnt lgkmcnt(4)
    s_waitcnt vmcnt(6)
    s_barrier
    v_mfma_f32_16x16x32_bf16 a[32:35], a[232:235], a[128:131], a[32:35]
    ds_read_b64_tr_b16 a[224:225], v219 offset:36864
    v_accvgpr_read_b32 v198, a50
    v_mfma_f32_16x16x32_bf16 a[32:35], a[236:239], a[144:147], a[32:35]
    v_exp_f32 v231, v231
    v_mfma_f32_16x16x32_bf16 a[36:39], a[232:235], a[132:135], a[36:39]
    ds_read_b64_tr_b16 a[226:227], v219 offset:38400
    v_accvgpr_read_b32 v199, a51
    v_mfma_f32_16x16x32_bf16 a[36:39], a[236:239], a[148:151], a[36:39]
    v_mul_f32 v192, v192, v196
    v_mul_f32 v193, v193, v197
    v_mfma_f32_16x16x32_bf16 a[40:43], a[232:235], a[136:139], a[40:43]
    ds_read_b64_tr_b16 a[228:229], v219 offset:49152
    v_mul_f32 v194, v194, v198
    v_mfma_f32_16x16x32_bf16 a[40:43], a[236:239], a[152:155], a[40:43]
    v_mul_f32 v195, v195, v199
    v_add_f32 v228, 1.0, v228
    v_mfma_f32_16x16x32_bf16 a[44:47], a[232:235], a[140:143], a[44:47]
    ds_read_b64_tr_b16 a[230:231], v219 offset:50688
    v_add_f32 v229, 1.0, v229
    v_mfma_f32_16x16x32_bf16 a[44:47], a[236:239], a[156:159], a[44:47]
    s_waitcnt lgkmcnt(4)
    v_rcp_f32 v228, v228
    v_mfma_f32_16x16x32_bf16 a[80:83], a[240:243], a[128:131], a[80:83]
    ds_read_b64_tr_b16 a[232:233], v219 offset:36872
    v_add_f32 v230, 1.0, v230
    v_mfma_f32_16x16x32_bf16 a[80:83], a[244:247], a[144:147], a[80:83]
    v_rcp_f32 v229, v229
    v_mfma_f32_16x16x32_bf16 a[84:87], a[240:243], a[132:135], a[84:87]
    ds_read_b64_tr_b16 a[234:235], v219 offset:38408
    v_add_f32 v231, 1.0, v231
    v_mfma_f32_16x16x32_bf16 a[84:87], a[244:247], a[148:151], a[84:87]
    v_rcp_f32 v230, v230
    v_mfma_f32_16x16x32_bf16 a[88:91], a[240:243], a[136:139], a[88:91]
    ds_read_b64_tr_b16 a[236:237], v219 offset:49160
    v_mul_f32 v192, v192, v228
    v_mfma_f32_16x16x32_bf16 a[88:91], a[244:247], a[152:155], a[88:91]
    v_rcp_f32 v231, v231
    v_mfma_f32_16x16x32_bf16 a[92:95], a[240:243], a[140:143], a[92:95]
    ds_read_b64_tr_b16 a[238:239], v219 offset:50696
    s_mov_b32 s33, 0
    v_mfma_f32_16x16x32_bf16 a[92:95], a[244:247], a[156:159], a[92:95]
    s_waitcnt lgkmcnt(4)
    v_mul_f32 v193, v193, v229
    v_mul_f32 v194, v194, v230
    v_mfma_f32_16x16x32_bf16 v[0:3], a[224:227], a[192:195], v[0:3]
    ds_read_b64_tr_b16 a[240:241], v220 offset:36864
    s_add_u32 m0, s31, 0
    v_mfma_f32_16x16x32_bf16 v[0:3], a[228:231], a[208:211], v[0:3]
    buffer_load_dwordx4 v200, s[16:19], s33 offen lds
    v_mfma_f32_16x16x32_bf16 v[48:51], a[224:227], a[196:199], v[48:51]
    ds_read_b64_tr_b16 a[242:243], v220 offset:38400
    v_mul_f32 v195, v195, v231
    v_mfma_f32_16x16x32_bf16 v[48:51], a[228:231], a[212:215], v[48:51]
    v_cvt_pk_bf16_f32 v232, v192, v193
    v_cvt_pk_bf16_f32 v233, v194, v195
    v_mfma_f32_16x16x32_bf16 v[96:99], a[224:227], a[200:203], v[96:99]
    ds_read_b64_tr_b16 a[244:245], v220 offset:49152
    v_accvgpr_read_b32 v236, a4
    v_mfma_f32_16x16x32_bf16 v[96:99], a[228:231], a[216:219], v[96:99]
    v_accvgpr_read_b32 v237, a5
    v_accvgpr_read_b32 v238, a6
    v_mfma_f32_16x16x32_bf16 v[144:147], a[224:227], a[204:207], v[144:147]
    ds_read_b64_tr_b16 a[246:247], v220 offset:50688
    v_accvgpr_read_b32 v239, a7
    v_mfma_f32_16x16x32_bf16 v[144:147], a[228:231], a[220:223], v[144:147]
    s_waitcnt lgkmcnt(4)
    v_mul_f32 v244, s95, v236
    v_mul_f32 v245, s95, v237
    v_mfma_f32_16x16x32_bf16 v[4:7], a[232:235], a[192:195], v[4:7]
    ds_read_b64_tr_b16 a[224:225], v220 offset:36872
    s_add_u32 m0, s31, 1024
    v_mfma_f32_16x16x32_bf16 v[4:7], a[236:239], a[208:211], v[4:7]
    buffer_load_dwordx4 v201, s[16:19], s33 offen lds
    v_mfma_f32_16x16x32_bf16 v[52:55], a[232:235], a[196:199], v[52:55]
    ds_read_b64_tr_b16 a[226:227], v220 offset:38408
    v_mul_f32 v246, s95, v238
    v_mfma_f32_16x16x32_bf16 v[52:55], a[236:239], a[212:215], v[52:55]
    v_exp_f32 v244, v244
    v_mfma_f32_16x16x32_bf16 v[100:103], a[232:235], a[200:203], v[100:103]
    ds_read_b64_tr_b16 a[228:229], v220 offset:49160
    v_mul_f32 v247, s95, v239
    v_mfma_f32_16x16x32_bf16 v[100:103], a[236:239], a[216:219], v[100:103]
    v_exp_f32 v245, v245
    v_mfma_f32_16x16x32_bf16 v[148:151], a[232:235], a[204:207], v[148:151]
    ds_read_b64_tr_b16 a[230:231], v220 offset:50696
    v_accvgpr_read_b32 v240, a52
    v_mfma_f32_16x16x32_bf16 v[148:151], a[236:239], a[220:223], v[148:151]
    s_waitcnt lgkmcnt(4)
    v_exp_f32 v246, v246
    v_mfma_f32_16x16x32_bf16 v[8:11], a[240:243], a[192:195], v[8:11]
    ds_read_b64_tr_b16 a[232:233], v219 offset:36992
    s_add_u32 m0, s31, 2048
    v_mfma_f32_16x16x32_bf16 v[8:11], a[244:247], a[208:211], v[8:11]
    buffer_load_dwordx4 v202, s[16:19], s33 offen lds
    v_mfma_f32_16x16x32_bf16 v[56:59], a[240:243], a[196:199], v[56:59]
    ds_read_b64_tr_b16 a[234:235], v219 offset:38528
    v_accvgpr_read_b32 v241, a53
    v_mfma_f32_16x16x32_bf16 v[56:59], a[244:247], a[212:215], v[56:59]
    v_exp_f32 v247, v247
    v_mfma_f32_16x16x32_bf16 v[104:107], a[240:243], a[200:203], v[104:107]
    ds_read_b64_tr_b16 a[236:237], v219 offset:49280
    v_accvgpr_read_b32 v242, a54
    v_mfma_f32_16x16x32_bf16 v[104:107], a[244:247], a[216:219], v[104:107]
    v_accvgpr_read_b32 v243, a55
    v_mul_f32 v236, v236, v240
    v_mfma_f32_16x16x32_bf16 v[152:155], a[240:243], a[204:207], v[152:155]
    ds_read_b64_tr_b16 a[238:239], v219 offset:50816
    s_mov_b32 s33, 12288
    v_mfma_f32_16x16x32_bf16 v[152:155], a[244:247], a[220:223], v[152:155]
    s_waitcnt lgkmcnt(4)
    v_mul_f32 v237, v237, v241
    v_mul_f32 v238, v238, v242
    v_mfma_f32_16x16x32_bf16 v[12:15], a[224:227], a[192:195], v[12:15]
    ds_read_b64_tr_b16 a[240:241], v219 offset:37000
    s_add_u32 m0, s31, 12288
    v_mfma_f32_16x16x32_bf16 v[12:15], a[228:231], a[208:211], v[12:15]
    buffer_load_dwordx4 v200, s[16:19], s33 offen lds
    v_mfma_f32_16x16x32_bf16 v[60:63], a[224:227], a[196:199], v[60:63]
    ds_read_b64_tr_b16 a[242:243], v219 offset:38536
    v_mul_f32 v239, v239, v243
    v_mfma_f32_16x16x32_bf16 v[60:63], a[228:231], a[212:215], v[60:63]
    v_add_f32 v244, 1.0, v244
    v_add_f32 v245, 1.0, v245
    v_mfma_f32_16x16x32_bf16 v[108:111], a[224:227], a[200:203], v[108:111]
    ds_read_b64_tr_b16 a[244:245], v219 offset:49288
    v_add_f32 v246, 1.0, v246
    v_mfma_f32_16x16x32_bf16 v[108:111], a[228:231], a[216:219], v[108:111]
    v_rcp_f32 v244, v244
    v_mfma_f32_16x16x32_bf16 v[156:159], a[224:227], a[204:207], v[156:159]
    ds_read_b64_tr_b16 a[246:247], v219 offset:50824
    v_add_f32 v247, 1.0, v247
    v_mfma_f32_16x16x32_bf16 v[156:159], a[228:231], a[220:223], v[156:159]
    s_waitcnt lgkmcnt(4)
    v_rcp_f32 v245, v245
    v_mfma_f32_16x16x32_bf16 v[16:19], a[232:235], a[192:195], v[16:19]
    ds_read_b64_tr_b16 a[224:225], v220 offset:36992
    s_add_u32 m0, s31, 13312
    v_mfma_f32_16x16x32_bf16 v[16:19], a[236:239], a[208:211], v[16:19]
    buffer_load_dwordx4 v201, s[16:19], s33 offen lds
    v_mfma_f32_16x16x32_bf16 v[64:67], a[232:235], a[196:199], v[64:67]
    ds_read_b64_tr_b16 a[226:227], v220 offset:38528
    v_mul_f32 v236, v236, v244
    v_mfma_f32_16x16x32_bf16 v[64:67], a[236:239], a[212:215], v[64:67]
    v_rcp_f32 v246, v246
    v_mfma_f32_16x16x32_bf16 v[112:115], a[232:235], a[200:203], v[112:115]
    ds_read_b64_tr_b16 a[228:229], v220 offset:49280
    v_mul_f32 v237, v237, v245
    v_mfma_f32_16x16x32_bf16 v[112:115], a[236:239], a[216:219], v[112:115]
    v_rcp_f32 v247, v247
    v_mfma_f32_16x16x32_bf16 v[160:163], a[232:235], a[204:207], v[160:163]
    ds_read_b64_tr_b16 a[230:231], v220 offset:50816
    v_mul_f32 v238, v238, v246
    v_mfma_f32_16x16x32_bf16 v[160:163], a[236:239], a[220:223], v[160:163]
    s_waitcnt lgkmcnt(4)
    v_mul_f32 v239, v239, v247
    v_cvt_pk_bf16_f32 v234, v236, v237
    v_mfma_f32_16x16x32_bf16 v[20:23], a[240:243], a[192:195], v[20:23]
    ds_read_b64_tr_b16 a[232:233], v220 offset:37000
    s_add_u32 m0, s31, 14336
    v_mfma_f32_16x16x32_bf16 v[20:23], a[244:247], a[208:211], v[20:23]
    buffer_load_dwordx4 v202, s[16:19], s33 offen lds
    v_mfma_f32_16x16x32_bf16 v[68:71], a[240:243], a[196:199], v[68:71]
    ds_read_b64_tr_b16 a[234:235], v220 offset:38536
    v_cvt_pk_bf16_f32 v235, v238, v239
    v_mfma_f32_16x16x32_bf16 v[68:71], a[244:247], a[212:215], v[68:71]
    v_accvgpr_read_b32 v192, a8
    v_accvgpr_read_b32 v193, a9
    v_mfma_f32_16x16x32_bf16 v[116:119], a[240:243], a[200:203], v[116:119]
    ds_read_b64_tr_b16 a[236:237], v220 offset:49288
    v_permlane32_swap_b32 v232, v234
    v_mfma_f32_16x16x32_bf16 v[116:119], a[244:247], a[216:219], v[116:119]
    v_permlane32_swap_b32 v233, v235
    v_accvgpr_read_b32 v194, a10
    v_mfma_f32_16x16x32_bf16 v[164:167], a[240:243], a[204:207], v[164:167]
    ds_read_b64_tr_b16 a[238:239], v220 offset:50824
    s_mov_b32 s33, 24576
    v_mfma_f32_16x16x32_bf16 v[164:167], a[244:247], a[220:223], v[164:167]
    s_waitcnt lgkmcnt(4)
    v_permlane16_swap_b32 v232, v234
    v_permlane16_swap_b32 v233, v235
    v_mfma_f32_16x16x32_bf16 v[24:27], a[224:227], a[192:195], v[24:27]
    ds_read_b64_tr_b16 a[240:241], v219 offset:37120
    s_add_u32 m0, s31, 24576
    v_mfma_f32_16x16x32_bf16 v[24:27], a[228:231], a[208:211], v[24:27]
    buffer_load_dwordx4 v200, s[16:19], s33 offen lds
    v_mfma_f32_16x16x32_bf16 v[72:75], a[224:227], a[196:199], v[72:75]
    ds_read_b64_tr_b16 a[242:243], v219 offset:38656
    v_accvgpr_read_b32 v195, a11
    v_mfma_f32_16x16x32_bf16 v[72:75], a[228:231], a[212:215], v[72:75]
    buffer_store_dwordx4 v[232:235], v255, s[24:27], s92 offen offset:0 sc1
    v_mfma_f32_16x16x32_bf16 v[120:123], a[224:227], a[200:203], v[120:123]
    ds_read_b64_tr_b16 a[244:245], v219 offset:49408
    v_mul_f32 v228, s95, v192
    v_mfma_f32_16x16x32_bf16 v[120:123], a[228:231], a[216:219], v[120:123]
    v_exp_f32 v228, v228
    v_mfma_f32_16x16x32_bf16 v[168:171], a[224:227], a[204:207], v[168:171]
    ds_read_b64_tr_b16 a[246:247], v219 offset:50944
    v_mul_f32 v229, s95, v193
    v_mfma_f32_16x16x32_bf16 v[168:171], a[228:231], a[220:223], v[168:171]
    s_waitcnt lgkmcnt(4)
    v_exp_f32 v229, v229
    v_mfma_f32_16x16x32_bf16 v[28:31], a[232:235], a[192:195], v[28:31]
    ds_read_b64_tr_b16 a[224:225], v219 offset:37128
    s_add_u32 m0, s31, 25600
    v_mfma_f32_16x16x32_bf16 v[28:31], a[236:239], a[208:211], v[28:31]
    buffer_load_dwordx4 v201, s[16:19], s33 offen lds
    v_mfma_f32_16x16x32_bf16 v[76:79], a[232:235], a[196:199], v[76:79]
    ds_read_b64_tr_b16 a[226:227], v219 offset:38664
    v_mul_f32 v230, s95, v194
    v_mfma_f32_16x16x32_bf16 v[76:79], a[236:239], a[212:215], v[76:79]
    v_exp_f32 v230, v230
    v_mfma_f32_16x16x32_bf16 v[124:127], a[232:235], a[200:203], v[124:127]
    ds_read_b64_tr_b16 a[228:229], v219 offset:49416
    v_mul_f32 v231, s95, v195
    v_mfma_f32_16x16x32_bf16 v[124:127], a[236:239], a[216:219], v[124:127]
    v_exp_f32 v231, v231
    v_mfma_f32_16x16x32_bf16 v[172:175], a[232:235], a[204:207], v[172:175]
    ds_read_b64_tr_b16 a[230:231], v219 offset:50952
    v_accvgpr_read_b32 v196, a56
    v_mfma_f32_16x16x32_bf16 v[172:175], a[236:239], a[220:223], v[172:175]
    s_waitcnt lgkmcnt(4)
    v_accvgpr_read_b32 v197, a57
    v_accvgpr_read_b32 v198, a58
    v_mfma_f32_16x16x32_bf16 v[32:35], a[240:243], a[192:195], v[32:35]
    ds_read_b64_tr_b16 a[232:233], v220 offset:37120
    s_add_u32 m0, s31, 26624
    v_mfma_f32_16x16x32_bf16 v[32:35], a[244:247], a[208:211], v[32:35]
    buffer_load_dwordx4 v202, s[16:19], s33 offen lds
    v_mfma_f32_16x16x32_bf16 v[80:83], a[240:243], a[196:199], v[80:83]
    ds_read_b64_tr_b16 a[234:235], v220 offset:38656
    v_accvgpr_read_b32 v199, a59
    v_mfma_f32_16x16x32_bf16 v[80:83], a[244:247], a[212:215], v[80:83]
    v_mul_f32 v192, v192, v196
    v_mul_f32 v193, v193, v197
    v_mfma_f32_16x16x32_bf16 v[128:131], a[240:243], a[200:203], v[128:131]
    ds_read_b64_tr_b16 a[236:237], v220 offset:49408
    v_mul_f32 v194, v194, v198
    v_mfma_f32_16x16x32_bf16 v[128:131], a[244:247], a[216:219], v[128:131]
    v_mul_f32 v195, v195, v199
    v_add_f32 v228, 1.0, v228
    v_mfma_f32_16x16x32_bf16 v[176:179], a[240:243], a[204:207], v[176:179]
    ds_read_b64_tr_b16 a[238:239], v220 offset:50944
    v_add_f32 v229, 1.0, v229
    v_mfma_f32_16x16x32_bf16 v[176:179], a[244:247], a[220:223], v[176:179]
    s_waitcnt lgkmcnt(4)
    v_rcp_f32 v228, v228
    v_mfma_f32_16x16x32_bf16 v[36:39], a[224:227], a[192:195], v[36:39]
    ds_read_b64_tr_b16 a[240:241], v220 offset:37128
    v_add_f32 v230, 1.0, v230
    v_mfma_f32_16x16x32_bf16 v[36:39], a[228:231], a[208:211], v[36:39]
    v_rcp_f32 v229, v229
    v_mfma_f32_16x16x32_bf16 v[84:87], a[224:227], a[196:199], v[84:87]
    ds_read_b64_tr_b16 a[242:243], v220 offset:38664
    v_add_f32 v231, 1.0, v231
    v_mfma_f32_16x16x32_bf16 v[84:87], a[228:231], a[212:215], v[84:87]
    v_rcp_f32 v230, v230
    v_mfma_f32_16x16x32_bf16 v[132:135], a[224:227], a[200:203], v[132:135]
    ds_read_b64_tr_b16 a[244:245], v220 offset:49416
    v_mul_f32 v192, v192, v228
    v_mfma_f32_16x16x32_bf16 v[132:135], a[228:231], a[216:219], v[132:135]
    v_rcp_f32 v231, v231
    v_mfma_f32_16x16x32_bf16 v[180:183], a[224:227], a[204:207], v[180:183]
    ds_read_b64_tr_b16 a[246:247], v220 offset:50952
    v_mul_f32 v193, v193, v229
    v_mfma_f32_16x16x32_bf16 v[180:183], a[228:231], a[220:223], v[180:183]
    s_waitcnt lgkmcnt(4)
    v_mul_f32 v194, v194, v230
    v_mul_f32 v195, v195, v231
    v_mfma_f32_16x16x32_bf16 v[40:43], a[232:235], a[192:195], v[40:43]
    ds_read_b64_tr_b16 a[224:225], v221 offset:0
    v_cvt_pk_bf16_f32 v232, v192, v193
    v_mfma_f32_16x16x32_bf16 v[40:43], a[236:239], a[208:211], v[40:43]
    v_cvt_pk_bf16_f32 v233, v194, v195
    v_accvgpr_read_b32 v236, a12
    v_mfma_f32_16x16x32_bf16 v[88:91], a[232:235], a[196:199], v[88:91]
    ds_read_b64_tr_b16 a[226:227], v221 offset:1536
    v_accvgpr_read_b32 v237, a13
    v_mfma_f32_16x16x32_bf16 v[88:91], a[236:239], a[212:215], v[88:91]
    v_accvgpr_read_b32 v238, a14
    v_accvgpr_read_b32 v239, a15
    v_mfma_f32_16x16x32_bf16 v[136:139], a[232:235], a[200:203], v[136:139]
    ds_read_b64_tr_b16 a[228:229], v221 offset:12288
    v_mul_f32 v244, s95, v236
    v_mfma_f32_16x16x32_bf16 v[136:139], a[236:239], a[216:219], v[136:139]
    v_exp_f32 v244, v244
    v_mfma_f32_16x16x32_bf16 v[184:187], a[232:235], a[204:207], v[184:187]
    ds_read_b64_tr_b16 a[230:231], v221 offset:13824
    v_mul_f32 v245, s95, v237
    v_mfma_f32_16x16x32_bf16 v[184:187], a[236:239], a[220:223], v[184:187]
    s_waitcnt lgkmcnt(4)
    v_exp_f32 v245, v245
    v_mfma_f32_16x16x32_bf16 v[44:47], a[240:243], a[192:195], v[44:47]
    ds_read_b64_tr_b16 a[232:233], v221 offset:8
    v_mul_f32 v246, s95, v238
    v_mfma_f32_16x16x32_bf16 v[44:47], a[244:247], a[208:211], v[44:47]
    v_exp_f32 v246, v246
    v_mfma_f32_16x16x32_bf16 v[92:95], a[240:243], a[196:199], v[92:95]
    ds_read_b64_tr_b16 a[234:235], v221 offset:1544
    v_mul_f32 v247, s95, v239
    v_mfma_f32_16x16x32_bf16 v[92:95], a[244:247], a[212:215], v[92:95]
    v_exp_f32 v247, v247
    v_mfma_f32_16x16x32_bf16 v[140:143], a[240:243], a[200:203], v[140:143]
    ds_read_b64_tr_b16 a[236:237], v221 offset:12296
    v_accvgpr_read_b32 v240, a60
    v_mfma_f32_16x16x32_bf16 v[140:143], a[244:247], a[216:219], v[140:143]
    v_accvgpr_read_b32 v241, a61
    v_accvgpr_read_b32 v242, a62
    v_mfma_f32_16x16x32_bf16 v[188:191], a[240:243], a[204:207], v[188:191]
    ds_read_b64_tr_b16 a[238:239], v221 offset:13832
    v_accvgpr_read_b32 v243, a63
    v_mfma_f32_16x16x32_bf16 v[188:191], a[244:247], a[220:223], v[188:191]
    s_waitcnt lgkmcnt(4)
    v_mul_f32 v236, v236, v240
    v_mul_f32 v237, v237, v241
    v_mfma_f32_16x16x32_bf16 v[0:3], a[224:227], a[96:99], v[0:3]
    ds_read_b64_tr_b16 a[240:241], v222 offset:0
    v_mul_f32 v238, v238, v242
    v_mfma_f32_16x16x32_bf16 v[0:3], a[228:231], a[112:115], v[0:3]
    v_mul_f32 v239, v239, v243
    v_add_f32 v244, 1.0, v244
    v_mfma_f32_16x16x32_bf16 v[48:51], a[224:227], a[100:103], v[48:51]
    ds_read_b64_tr_b16 a[242:243], v222 offset:1536
    v_add_f32 v245, 1.0, v245
    v_mfma_f32_16x16x32_bf16 v[48:51], a[228:231], a[116:119], v[48:51]
    v_rcp_f32 v244, v244
    v_mfma_f32_16x16x32_bf16 v[96:99], a[224:227], a[104:107], v[96:99]
    ds_read_b64_tr_b16 a[244:245], v222 offset:12288
    v_add_f32 v246, 1.0, v246
    v_mfma_f32_16x16x32_bf16 v[96:99], a[228:231], a[120:123], v[96:99]
    v_rcp_f32 v245, v245
    v_mfma_f32_16x16x32_bf16 v[144:147], a[224:227], a[108:111], v[144:147]
    ds_read_b64_tr_b16 a[246:247], v222 offset:13824
    v_add_f32 v247, 1.0, v247
    v_mfma_f32_16x16x32_bf16 v[144:147], a[228:231], a[124:127], v[144:147]
    s_waitcnt lgkmcnt(4)
    v_rcp_f32 v246, v246
    v_mfma_f32_16x16x32_bf16 v[4:7], a[232:235], a[96:99], v[4:7]
    ds_read_b64_tr_b16 a[224:225], v222 offset:8
    v_mul_f32 v236, v236, v244
    v_mfma_f32_16x16x32_bf16 v[4:7], a[236:239], a[112:115], v[4:7]
    v_rcp_f32 v247, v247
    v_mfma_f32_16x16x32_bf16 v[52:55], a[232:235], a[100:103], v[52:55]
    ds_read_b64_tr_b16 a[226:227], v222 offset:1544
    v_mul_f32 v237, v237, v245
    v_mfma_f32_16x16x32_bf16 v[52:55], a[236:239], a[116:119], v[52:55]
    v_mul_f32 v238, v238, v246
    v_mul_f32 v239, v239, v247
    v_mfma_f32_16x16x32_bf16 v[100:103], a[232:235], a[104:107], v[100:103]
    ds_read_b64_tr_b16 a[228:229], v222 offset:12296
    v_cvt_pk_bf16_f32 v234, v236, v237
    v_mfma_f32_16x16x32_bf16 v[100:103], a[236:239], a[120:123], v[100:103]
    v_cvt_pk_bf16_f32 v235, v238, v239
    v_accvgpr_read_b32 v192, a16
    v_mfma_f32_16x16x32_bf16 v[148:151], a[232:235], a[108:111], v[148:151]
    ds_read_b64_tr_b16 a[230:231], v222 offset:13832
    v_accvgpr_read_b32 v193, a17
    v_mfma_f32_16x16x32_bf16 v[148:151], a[236:239], a[124:127], v[148:151]
    s_waitcnt lgkmcnt(4)
    v_permlane32_swap_b32 v232, v234
    v_permlane32_swap_b32 v233, v235
    v_mfma_f32_16x16x32_bf16 v[8:11], a[240:243], a[96:99], v[8:11]
    ds_read_b64_tr_b16 a[232:233], v221 offset:128
    v_accvgpr_read_b32 v194, a18
    v_mfma_f32_16x16x32_bf16 v[8:11], a[244:247], a[112:115], v[8:11]
    v_permlane16_swap_b32 v232, v234
    v_permlane16_swap_b32 v233, v235
    v_mfma_f32_16x16x32_bf16 v[56:59], a[240:243], a[100:103], v[56:59]
    ds_read_b64_tr_b16 a[234:235], v221 offset:1664
    v_accvgpr_read_b32 v195, a19
    v_mfma_f32_16x16x32_bf16 v[56:59], a[244:247], a[116:119], v[56:59]
    buffer_store_dwordx4 v[232:235], v255, s[24:27], s92 offen offset:2048 sc1
    v_mfma_f32_16x16x32_bf16 v[104:107], a[240:243], a[104:107], v[104:107]
    ds_read_b64_tr_b16 a[236:237], v221 offset:12416
    v_mul_f32 v228, s95, v192
    v_mfma_f32_16x16x32_bf16 v[104:107], a[244:247], a[120:123], v[104:107]
    v_exp_f32 v228, v228
    v_mfma_f32_16x16x32_bf16 v[152:155], a[240:243], a[108:111], v[152:155]
    ds_read_b64_tr_b16 a[238:239], v221 offset:13952
    v_mul_f32 v229, s95, v193
    v_mfma_f32_16x16x32_bf16 v[152:155], a[244:247], a[124:127], v[152:155]
    s_waitcnt lgkmcnt(4)
    v_exp_f32 v229, v229
    v_mfma_f32_16x16x32_bf16 v[12:15], a[224:227], a[96:99], v[12:15]
    ds_read_b64_tr_b16 a[240:241], v221 offset:136
    v_mul_f32 v230, s95, v194
    v_mfma_f32_16x16x32_bf16 v[12:15], a[228:231], a[112:115], v[12:15]
    v_exp_f32 v230, v230
    v_mfma_f32_16x16x32_bf16 v[60:63], a[224:227], a[100:103], v[60:63]
    ds_read_b64_tr_b16 a[242:243], v221 offset:1672
    v_mul_f32 v231, s95, v195
    v_mfma_f32_16x16x32_bf16 v[60:63], a[228:231], a[116:119], v[60:63]
    v_exp_f32 v231, v231
    v_mfma_f32_16x16x32_bf16 v[108:111], a[224:227], a[104:107], v[108:111]
    ds_read_b64_tr_b16 a[244:245], v221 offset:12424
    v_accvgpr_read_b32 v196, a64
    v_mfma_f32_16x16x32_bf16 v[108:111], a[228:231], a[120:123], v[108:111]
    v_accvgpr_read_b32 v197, a65
    v_accvgpr_read_b32 v198, a66
    v_mfma_f32_16x16x32_bf16 v[156:159], a[224:227], a[108:111], v[156:159]
    ds_read_b64_tr_b16 a[246:247], v221 offset:13960
    v_accvgpr_read_b32 v199, a67
    v_mfma_f32_16x16x32_bf16 v[156:159], a[228:231], a[124:127], v[156:159]
    s_waitcnt lgkmcnt(4)
    v_mul_f32 v192, v192, v196
    v_mul_f32 v193, v193, v197
    v_mfma_f32_16x16x32_bf16 v[16:19], a[232:235], a[96:99], v[16:19]
    ds_read_b64_tr_b16 a[224:225], v222 offset:128
    v_mul_f32 v194, v194, v198
    v_mfma_f32_16x16x32_bf16 v[16:19], a[236:239], a[112:115], v[16:19]
    v_mul_f32 v195, v195, v199
    v_add_f32 v228, 1.0, v228
    v_mfma_f32_16x16x32_bf16 v[64:67], a[232:235], a[100:103], v[64:67]
    ds_read_b64_tr_b16 a[226:227], v222 offset:1664
    v_add_f32 v229, 1.0, v229
    v_mfma_f32_16x16x32_bf16 v[64:67], a[236:239], a[116:119], v[64:67]
    v_rcp_f32 v228, v228
    v_mfma_f32_16x16x32_bf16 v[112:115], a[232:235], a[104:107], v[112:115]
    ds_read_b64_tr_b16 a[228:229], v222 offset:12416
    v_add_f32 v230, 1.0, v230
    v_mfma_f32_16x16x32_bf16 v[112:115], a[236:239], a[120:123], v[112:115]
    v_rcp_f32 v229, v229
    v_mfma_f32_16x16x32_bf16 v[160:163], a[232:235], a[108:111], v[160:163]
    ds_read_b64_tr_b16 a[230:231], v222 offset:13952
    v_add_f32 v231, 1.0, v231
    v_mfma_f32_16x16x32_bf16 v[160:163], a[236:239], a[124:127], v[160:163]
    s_waitcnt lgkmcnt(4)
    v_rcp_f32 v230, v230
    v_mfma_f32_16x16x32_bf16 v[20:23], a[240:243], a[96:99], v[20:23]
    ds_read_b64_tr_b16 a[232:233], v222 offset:136
    v_mul_f32 v192, v192, v228
    v_mfma_f32_16x16x32_bf16 v[20:23], a[244:247], a[112:115], v[20:23]
    v_rcp_f32 v231, v231
    v_mfma_f32_16x16x32_bf16 v[68:71], a[240:243], a[100:103], v[68:71]
    ds_read_b64_tr_b16 a[234:235], v222 offset:1672
    v_mul_f32 v193, v193, v229
    v_mfma_f32_16x16x32_bf16 v[68:71], a[244:247], a[116:119], v[68:71]
    v_mul_f32 v194, v194, v230
    v_mul_f32 v195, v195, v231
    v_mfma_f32_16x16x32_bf16 v[116:119], a[240:243], a[104:107], v[116:119]
    ds_read_b64_tr_b16 a[236:237], v222 offset:12424
    v_cvt_pk_bf16_f32 v232, v192, v193
    v_mfma_f32_16x16x32_bf16 v[116:119], a[244:247], a[120:123], v[116:119]
    v_cvt_pk_bf16_f32 v233, v194, v195
    v_accvgpr_read_b32 v236, a20
    v_mfma_f32_16x16x32_bf16 v[164:167], a[240:243], a[108:111], v[164:167]
    ds_read_b64_tr_b16 a[238:239], v222 offset:13960
    v_accvgpr_read_b32 v237, a21
    v_mfma_f32_16x16x32_bf16 v[164:167], a[244:247], a[124:127], v[164:167]
    s_waitcnt lgkmcnt(4)
    v_accvgpr_read_b32 v238, a22
    v_accvgpr_read_b32 v239, a23
    v_mfma_f32_16x16x32_bf16 v[24:27], a[224:227], a[96:99], v[24:27]
    ds_read_b64_tr_b16 a[240:241], v221 offset:256
    v_mul_f32 v244, s95, v236
    v_mfma_f32_16x16x32_bf16 v[24:27], a[228:231], a[112:115], v[24:27]
    v_exp_f32 v244, v244
    v_mfma_f32_16x16x32_bf16 v[72:75], a[224:227], a[100:103], v[72:75]
    ds_read_b64_tr_b16 a[242:243], v221 offset:1792
    v_mul_f32 v245, s95, v237
    v_mfma_f32_16x16x32_bf16 v[72:75], a[228:231], a[116:119], v[72:75]
    v_exp_f32 v245, v245
    v_mfma_f32_16x16x32_bf16 v[120:123], a[224:227], a[104:107], v[120:123]
    ds_read_b64_tr_b16 a[244:245], v221 offset:12544
    v_mul_f32 v246, s95, v238
    v_mfma_f32_16x16x32_bf16 v[120:123], a[228:231], a[120:123], v[120:123]
    v_exp_f32 v246, v246
    v_mfma_f32_16x16x32_bf16 v[168:171], a[224:227], a[108:111], v[168:171]
    ds_read_b64_tr_b16 a[246:247], v221 offset:14080
    v_mul_f32 v247, s95, v239
    v_mfma_f32_16x16x32_bf16 v[168:171], a[228:231], a[124:127], v[168:171]
    s_waitcnt lgkmcnt(4)
    v_exp_f32 v247, v247
    v_mfma_f32_16x16x32_bf16 v[28:31], a[232:235], a[96:99], v[28:31]
    ds_read_b64_tr_b16 a[224:225], v221 offset:264
    v_accvgpr_read_b32 v240, a68
    v_mfma_f32_16x16x32_bf16 v[28:31], a[236:239], a[112:115], v[28:31]
    v_accvgpr_read_b32 v241, a69
    v_accvgpr_read_b32 v242, a70
    v_mfma_f32_16x16x32_bf16 v[76:79], a[232:235], a[100:103], v[76:79]
    ds_read_b64_tr_b16 a[226:227], v221 offset:1800
    v_accvgpr_read_b32 v243, a71
    v_mfma_f32_16x16x32_bf16 v[76:79], a[236:239], a[116:119], v[76:79]
    v_mul_f32 v236, v236, v240
    v_mul_f32 v237, v237, v241
    v_mfma_f32_16x16x32_bf16 v[124:127], a[232:235], a[104:107], v[124:127]
    ds_read_b64_tr_b16 a[228:229], v221 offset:12552
    v_mul_f32 v238, v238, v242
    v_mfma_f32_16x16x32_bf16 v[124:127], a[236:239], a[120:123], v[124:127]
    v_mul_f32 v239, v239, v243
    v_add_f32 v244, 1.0, v244
    v_mfma_f32_16x16x32_bf16 v[172:175], a[232:235], a[108:111], v[172:175]
    ds_read_b64_tr_b16 a[230:231], v221 offset:14088
    v_add_f32 v245, 1.0, v245
    v_mfma_f32_16x16x32_bf16 v[172:175], a[236:239], a[124:127], v[172:175]
    s_waitcnt lgkmcnt(4)
    v_rcp_f32 v244, v244
    v_mfma_f32_16x16x32_bf16 v[32:35], a[240:243], a[96:99], v[32:35]
    ds_read_b64_tr_b16 a[232:233], v222 offset:256
    v_add_f32 v246, 1.0, v246
    v_mfma_f32_16x16x32_bf16 v[32:35], a[244:247], a[112:115], v[32:35]
    v_rcp_f32 v245, v245
    v_mfma_f32_16x16x32_bf16 v[80:83], a[240:243], a[100:103], v[80:83]
    ds_read_b64_tr_b16 a[234:235], v222 offset:1792
    v_add_f32 v247, 1.0, v247
    v_mfma_f32_16x16x32_bf16 v[80:83], a[244:247], a[116:119], v[80:83]
    v_rcp_f32 v246, v246
    v_mfma_f32_16x16x32_bf16 v[128:131], a[240:243], a[104:107], v[128:131]
    ds_read_b64_tr_b16 a[236:237], v222 offset:12544
    v_mul_f32 v236, v236, v244
    v_mfma_f32_16x16x32_bf16 v[128:131], a[244:247], a[120:123], v[128:131]
    v_rcp_f32 v247, v247
    v_mfma_f32_16x16x32_bf16 v[176:179], a[240:243], a[108:111], v[176:179]
    ds_read_b64_tr_b16 a[238:239], v222 offset:14080
    v_mul_f32 v237, v237, v245
    v_mfma_f32_16x16x32_bf16 v[176:179], a[244:247], a[124:127], v[176:179]
    s_waitcnt lgkmcnt(4)
    v_mul_f32 v238, v238, v246
    v_mul_f32 v239, v239, v247
    v_mfma_f32_16x16x32_bf16 v[36:39], a[224:227], a[96:99], v[36:39]
    ds_read_b64_tr_b16 a[240:241], v222 offset:264
    v_cvt_pk_bf16_f32 v234, v236, v237
    v_mfma_f32_16x16x32_bf16 v[36:39], a[228:231], a[112:115], v[36:39]
    v_cvt_pk_bf16_f32 v235, v238, v239
    v_accvgpr_read_b32 v192, a24
    v_mfma_f32_16x16x32_bf16 v[84:87], a[224:227], a[100:103], v[84:87]
    ds_read_b64_tr_b16 a[242:243], v222 offset:1800
    v_accvgpr_read_b32 v193, a25
    v_mfma_f32_16x16x32_bf16 v[84:87], a[228:231], a[116:119], v[84:87]
    v_permlane32_swap_b32 v232, v234
    v_permlane32_swap_b32 v233, v235
    v_mfma_f32_16x16x32_bf16 v[132:135], a[224:227], a[104:107], v[132:135]
    ds_read_b64_tr_b16 a[244:245], v222 offset:12552
    v_accvgpr_read_b32 v194, a26
    v_mfma_f32_16x16x32_bf16 v[132:135], a[228:231], a[120:123], v[132:135]
    v_permlane16_swap_b32 v232, v234
    v_permlane16_swap_b32 v233, v235
    v_mfma_f32_16x16x32_bf16 v[180:183], a[224:227], a[108:111], v[180:183]
    ds_read_b64_tr_b16 a[246:247], v222 offset:14088
    v_accvgpr_read_b32 v195, a27
    v_mfma_f32_16x16x32_bf16 v[180:183], a[228:231], a[124:127], v[180:183]
    s_waitcnt lgkmcnt(4)
    s_waitcnt vmcnt(11)
    s_barrier
    v_mfma_f32_16x16x32_bf16 v[40:43], a[232:235], a[96:99], v[40:43]
    ds_read_b64_tr_b16 a[224:225], v221 offset:36864
    v_mul_f32 v228, s95, v192
    v_mfma_f32_16x16x32_bf16 v[40:43], a[236:239], a[112:115], v[40:43]
    buffer_store_dwordx4 v[232:235], v255, s[24:27], s93 offen offset:0 sc1
    v_mfma_f32_16x16x32_bf16 v[88:91], a[232:235], a[100:103], v[88:91]
    ds_read_b64_tr_b16 a[226:227], v221 offset:38400
    v_mul_f32 v229, s95, v193
    v_mfma_f32_16x16x32_bf16 v[88:91], a[236:239], a[116:119], v[88:91]
    v_exp_f32 v228, v228
    v_mfma_f32_16x16x32_bf16 v[136:139], a[232:235], a[104:107], v[136:139]
    ds_read_b64_tr_b16 a[228:229], v221 offset:49152
    v_mul_f32 v230, s95, v194
    v_mfma_f32_16x16x32_bf16 v[136:139], a[236:239], a[120:123], v[136:139]
    v_exp_f32 v229, v229
    v_mfma_f32_16x16x32_bf16 v[184:187], a[232:235], a[108:111], v[184:187]
    ds_read_b64_tr_b16 a[230:231], v221 offset:50688
    v_mul_f32 v231, s95, v195
    v_mfma_f32_16x16x32_bf16 v[184:187], a[236:239], a[124:127], v[184:187]
    s_waitcnt lgkmcnt(4)
    v_exp_f32 v230, v230
    v_mfma_f32_16x16x32_bf16 v[44:47], a[240:243], a[96:99], v[44:47]
    ds_read_b64_tr_b16 a[232:233], v221 offset:36872
    v_accvgpr_read_b32 v196, a72
    v_mfma_f32_16x16x32_bf16 v[44:47], a[244:247], a[112:115], v[44:47]
    v_exp_f32 v231, v231
    v_mfma_f32_16x16x32_bf16 v[92:95], a[240:243], a[100:103], v[92:95]
    ds_read_b64_tr_b16 a[234:235], v221 offset:38408
    v_accvgpr_read_b32 v197, a73
    v_mfma_f32_16x16x32_bf16 v[92:95], a[244:247], a[116:119], v[92:95]
    v_accvgpr_read_b32 v198, a74
    v_accvgpr_read_b32 v199, a75
    v_mfma_f32_16x16x32_bf16 v[140:143], a[240:243], a[104:107], v[140:143]
    ds_read_b64_tr_b16 a[236:237], v221 offset:49160
    v_mul_f32 v192, v192, v196
    v_mfma_f32_16x16x32_bf16 v[140:143], a[244:247], a[120:123], v[140:143]
    v_mul_f32 v193, v193, v197
    v_mul_f32 v194, v194, v198
    v_mfma_f32_16x16x32_bf16 v[188:191], a[240:243], a[108:111], v[188:191]
    ds_read_b64_tr_b16 a[238:239], v221 offset:50696
    s_mov_b32 s33, 36864
    v_mfma_f32_16x16x32_bf16 v[188:191], a[244:247], a[124:127], v[188:191]
    s_waitcnt lgkmcnt(4)
    v_mul_f32 v195, v195, v199
    v_add_f32 v228, 1.0, v228
    v_mfma_f32_16x16x32_bf16 v[0:3], a[224:227], a[128:131], v[0:3]
    ds_read_b64_tr_b16 a[240:241], v222 offset:36864
    s_add_u32 m0, s31, 36864
    v_mfma_f32_16x16x32_bf16 v[0:3], a[228:231], a[144:147], v[0:3]
    buffer_load_dwordx4 v200, s[16:19], s33 offen lds
    v_mfma_f32_16x16x32_bf16 v[48:51], a[224:227], a[132:135], v[48:51]
    ds_read_b64_tr_b16 a[242:243], v222 offset:38400
    v_add_f32 v229, 1.0, v229
    v_mfma_f32_16x16x32_bf16 v[48:51], a[228:231], a[148:151], v[48:51]
    v_rcp_f32 v228, v228
    v_mfma_f32_16x16x32_bf16 v[96:99], a[224:227], a[136:139], v[96:99]
    ds_read_b64_tr_b16 a[244:245], v222 offset:49152
    v_add_f32 v230, 1.0, v230
    v_mfma_f32_16x16x32_bf16 v[96:99], a[228:231], a[152:155], v[96:99]
    v_rcp_f32 v229, v229
    v_mfma_f32_16x16x32_bf16 v[144:147], a[224:227], a[140:143], v[144:147]
    ds_read_b64_tr_b16 a[246:247], v222 offset:50688
    v_add_f32 v231, 1.0, v231
    v_mfma_f32_16x16x32_bf16 v[144:147], a[228:231], a[156:159], v[144:147]
    s_waitcnt lgkmcnt(4)
    v_rcp_f32 v230, v230
    v_mfma_f32_16x16x32_bf16 v[4:7], a[232:235], a[128:131], v[4:7]
    ds_read_b64_tr_b16 a[224:225], v222 offset:36872
    s_add_u32 m0, s31, 37888
    v_mfma_f32_16x16x32_bf16 v[4:7], a[236:239], a[144:147], v[4:7]
    buffer_load_dwordx4 v201, s[16:19], s33 offen lds
    v_mfma_f32_16x16x32_bf16 v[52:55], a[232:235], a[132:135], v[52:55]
    ds_read_b64_tr_b16 a[226:227], v222 offset:38408
    v_mul_f32 v192, v192, v228
    v_mfma_f32_16x16x32_bf16 v[52:55], a[236:239], a[148:151], v[52:55]
    v_rcp_f32 v231, v231
    v_mfma_f32_16x16x32_bf16 v[100:103], a[232:235], a[136:139], v[100:103]
    ds_read_b64_tr_b16 a[228:229], v222 offset:49160
    v_mul_f32 v193, v193, v229
    v_mfma_f32_16x16x32_bf16 v[100:103], a[236:239], a[152:155], v[100:103]
    v_mul_f32 v194, v194, v230
    v_mul_f32 v195, v195, v231
    v_mfma_f32_16x16x32_bf16 v[148:151], a[232:235], a[140:143], v[148:151]
    ds_read_b64_tr_b16 a[230:231], v222 offset:50696
    v_cvt_pk_bf16_f32 v232, v192, v193
    v_mfma_f32_16x16x32_bf16 v[148:151], a[236:239], a[156:159], v[148:151]
    s_waitcnt lgkmcnt(4)
    v_cvt_pk_bf16_f32 v233, v194, v195
    v_accvgpr_read_b32 v236, a28
    v_mfma_f32_16x16x32_bf16 v[8:11], a[240:243], a[128:131], v[8:11]
    ds_read_b64_tr_b16 a[232:233], v221 offset:36992
    s_add_u32 m0, s31, 38912
    v_mfma_f32_16x16x32_bf16 v[8:11], a[244:247], a[144:147], v[8:11]
    buffer_load_dwordx4 v202, s[16:19], s33 offen lds
    v_mfma_f32_16x16x32_bf16 v[56:59], a[240:243], a[132:135], v[56:59]
    ds_read_b64_tr_b16 a[234:235], v221 offset:38528
    v_accvgpr_read_b32 v237, a29
    v_mfma_f32_16x16x32_bf16 v[56:59], a[244:247], a[148:151], v[56:59]
    v_accvgpr_read_b32 v238, a30
    v_accvgpr_read_b32 v239, a31
    v_mfma_f32_16x16x32_bf16 v[104:107], a[240:243], a[136:139], v[104:107]
    ds_read_b64_tr_b16 a[236:237], v221 offset:49280
    v_mul_f32 v244, s95, v236
    v_mfma_f32_16x16x32_bf16 v[104:107], a[244:247], a[152:155], v[104:107]
    v_exp_f32 v244, v244
    v_mfma_f32_16x16x32_bf16 v[152:155], a[240:243], a[140:143], v[152:155]
    ds_read_b64_tr_b16 a[238:239], v221 offset:50816
    s_mov_b32 s33, 0
    v_mfma_f32_16x16x32_bf16 v[152:155], a[244:247], a[156:159], v[152:155]
    s_waitcnt lgkmcnt(4)
    v_mul_f32 v245, s95, v237
    v_mul_f32 v246, s95, v238
    v_mfma_f32_16x16x32_bf16 v[12:15], a[224:227], a[128:131], v[12:15]
    ds_read_b64_tr_b16 a[240:241], v221 offset:37000
    s_add_u32 m0, s31, 49152
    v_mfma_f32_16x16x32_bf16 v[12:15], a[228:231], a[144:147], v[12:15]
    buffer_load_dwordx4 v203, s[20:23], s33 offen lds
    v_mfma_f32_16x16x32_bf16 v[60:63], a[224:227], a[132:135], v[60:63]
    ds_read_b64_tr_b16 a[242:243], v221 offset:38536
    v_mul_f32 v247, s95, v239
    v_mfma_f32_16x16x32_bf16 v[60:63], a[228:231], a[148:151], v[60:63]
    v_exp_f32 v245, v245
    v_mfma_f32_16x16x32_bf16 v[108:111], a[224:227], a[136:139], v[108:111]
    ds_read_b64_tr_b16 a[244:245], v221 offset:49288
    v_accvgpr_read_b32 v240, a76
    v_mfma_f32_16x16x32_bf16 v[108:111], a[228:231], a[152:155], v[108:111]
    v_exp_f32 v246, v246
    v_mfma_f32_16x16x32_bf16 v[156:159], a[224:227], a[140:143], v[156:159]
    ds_read_b64_tr_b16 a[246:247], v221 offset:50824
    v_accvgpr_read_b32 v241, a77
    v_mfma_f32_16x16x32_bf16 v[156:159], a[228:231], a[156:159], v[156:159]
    s_waitcnt lgkmcnt(4)
    v_exp_f32 v247, v247
    v_mfma_f32_16x16x32_bf16 v[16:19], a[232:235], a[128:131], v[16:19]
    ds_read_b64_tr_b16 a[224:225], v222 offset:36992
    s_add_u32 m0, s31, 50176
    v_mfma_f32_16x16x32_bf16 v[16:19], a[236:239], a[144:147], v[16:19]
    buffer_load_dwordx4 v204, s[20:23], s33 offen lds
    v_mfma_f32_16x16x32_bf16 v[64:67], a[232:235], a[132:135], v[64:67]
    ds_read_b64_tr_b16 a[226:227], v222 offset:38528
    v_accvgpr_read_b32 v242, a78
    v_mfma_f32_16x16x32_bf16 v[64:67], a[236:239], a[148:151], v[64:67]
    v_accvgpr_read_b32 v243, a79
    v_mul_f32 v236, v236, v240
    v_mfma_f32_16x16x32_bf16 v[112:115], a[232:235], a[136:139], v[112:115]
    ds_read_b64_tr_b16 a[228:229], v222 offset:49280
    v_mul_f32 v237, v237, v241
    v_mfma_f32_16x16x32_bf16 v[112:115], a[236:239], a[152:155], v[112:115]
    v_mul_f32 v238, v238, v242
    v_mul_f32 v239, v239, v243
    v_mfma_f32_16x16x32_bf16 v[160:163], a[232:235], a[140:143], v[160:163]
    ds_read_b64_tr_b16 a[230:231], v222 offset:50816
    v_add_f32 v244, 1.0, v244
    v_mfma_f32_16x16x32_bf16 v[160:163], a[236:239], a[156:159], v[160:163]
    s_waitcnt lgkmcnt(4)
    v_rcp_f32 v244, v244
    v_mfma_f32_16x16x32_bf16 v[20:23], a[240:243], a[128:131], v[20:23]
    ds_read_b64_tr_b16 a[232:233], v222 offset:37000
    s_add_u32 m0, s31, 51200
    v_mfma_f32_16x16x32_bf16 v[20:23], a[244:247], a[144:147], v[20:23]
    buffer_load_dwordx4 v205, s[20:23], s33 offen lds
    v_mfma_f32_16x16x32_bf16 v[68:71], a[240:243], a[132:135], v[68:71]
    ds_read_b64_tr_b16 a[234:235], v222 offset:38536
    v_add_f32 v245, 1.0, v245
    v_mfma_f32_16x16x32_bf16 v[68:71], a[244:247], a[148:151], v[68:71]
    v_rcp_f32 v245, v245
    v_mfma_f32_16x16x32_bf16 v[116:119], a[240:243], a[136:139], v[116:119]
    ds_read_b64_tr_b16 a[236:237], v222 offset:49288
    v_add_f32 v246, 1.0, v246
    v_mfma_f32_16x16x32_bf16 v[116:119], a[244:247], a[152:155], v[116:119]
    v_rcp_f32 v246, v246
    v_mfma_f32_16x16x32_bf16 v[164:167], a[240:243], a[140:143], v[164:167]
    ds_read_b64_tr_b16 a[238:239], v222 offset:50824
    s_mov_b32 s33, 12288
    v_mfma_f32_16x16x32_bf16 v[164:167], a[244:247], a[156:159], v[164:167]
    s_waitcnt lgkmcnt(4)
    v_add_f32 v247, 1.0, v247
    v_mul_f32 v236, v236, v244
    v_mfma_f32_16x16x32_bf16 v[24:27], a[224:227], a[128:131], v[24:27]
    ds_read_b64_tr_b16 a[240:241], v221 offset:37120
    s_add_u32 m0, s31, 61440
    v_mfma_f32_16x16x32_bf16 v[24:27], a[228:231], a[144:147], v[24:27]
    buffer_load_dwordx4 v203, s[20:23], s33 offen lds
    v_mfma_f32_16x16x32_bf16 v[72:75], a[224:227], a[132:135], v[72:75]
    ds_read_b64_tr_b16 a[242:243], v221 offset:38656
    v_mul_f32 v237, v237, v245
    v_mfma_f32_16x16x32_bf16 v[72:75], a[228:231], a[148:151], v[72:75]
    v_rcp_f32 v247, v247
    v_mfma_f32_16x16x32_bf16 v[120:123], a[224:227], a[136:139], v[120:123]
    ds_read_b64_tr_b16 a[244:245], v221 offset:49408
    v_mul_f32 v238, v238, v246
    v_mfma_f32_16x16x32_bf16 v[120:123], a[228:231], a[152:155], v[120:123]
    v_mul_f32 v239, v239, v247
    v_cvt_pk_bf16_f32 v234, v236, v237
    v_mfma_f32_16x16x32_bf16 v[168:171], a[224:227], a[140:143], v[168:171]
    ds_read_b64_tr_b16 a[246:247], v221 offset:50944
    v_cvt_pk_bf16_f32 v235, v238, v239
    v_mfma_f32_16x16x32_bf16 v[168:171], a[228:231], a[156:159], v[168:171]
    s_waitcnt lgkmcnt(4)
    v_accvgpr_read_b32 v192, a32
    v_accvgpr_read_b32 v193, a33
    v_mfma_f32_16x16x32_bf16 v[28:31], a[232:235], a[128:131], v[28:31]
    ds_read_b64_tr_b16 a[224:225], v221 offset:37128
    s_add_u32 m0, s31, 62464
    v_mfma_f32_16x16x32_bf16 v[28:31], a[236:239], a[144:147], v[28:31]
    buffer_load_dwordx4 v204, s[20:23], s33 offen lds
    v_mfma_f32_16x16x32_bf16 v[76:79], a[232:235], a[132:135], v[76:79]
    ds_read_b64_tr_b16 a[226:227], v221 offset:38664
    v_permlane32_swap_b32 v232, v234
    v_mfma_f32_16x16x32_bf16 v[76:79], a[236:239], a[148:151], v[76:79]
    v_permlane32_swap_b32 v233, v235
    v_accvgpr_read_b32 v194, a34
    v_mfma_f32_16x16x32_bf16 v[124:127], a[232:235], a[136:139], v[124:127]
    ds_read_b64_tr_b16 a[228:229], v221 offset:49416
    v_accvgpr_read_b32 v195, a35
    v_mfma_f32_16x16x32_bf16 v[124:127], a[236:239], a[152:155], v[124:127]
    v_permlane16_swap_b32 v232, v234
    v_permlane16_swap_b32 v233, v235
    v_mfma_f32_16x16x32_bf16 v[172:175], a[232:235], a[140:143], v[172:175]
    ds_read_b64_tr_b16 a[230:231], v221 offset:50952
    v_mul_f32 v228, s95, v192
    v_mfma_f32_16x16x32_bf16 v[172:175], a[236:239], a[156:159], v[172:175]
    s_waitcnt lgkmcnt(4)
    v_exp_f32 v228, v228
    v_mfma_f32_16x16x32_bf16 v[32:35], a[240:243], a[128:131], v[32:35]
    ds_read_b64_tr_b16 a[232:233], v222 offset:37120
    s_add_u32 m0, s31, 63488
    v_mfma_f32_16x16x32_bf16 v[32:35], a[244:247], a[144:147], v[32:35]
    buffer_load_dwordx4 v205, s[20:23], s33 offen lds
    v_mfma_f32_16x16x32_bf16 v[80:83], a[240:243], a[132:135], v[80:83]
    ds_read_b64_tr_b16 a[234:235], v222 offset:38656
    v_mul_f32 v229, s95, v193
    v_mfma_f32_16x16x32_bf16 v[80:83], a[244:247], a[148:151], v[80:83]
    buffer_store_dwordx4 v[232:235], v255, s[24:27], s93 offen offset:2048 sc1
    v_mfma_f32_16x16x32_bf16 v[128:131], a[240:243], a[136:139], v[128:131]
    ds_read_b64_tr_b16 a[236:237], v222 offset:49408
    v_mul_f32 v230, s95, v194
    v_mfma_f32_16x16x32_bf16 v[128:131], a[244:247], a[152:155], v[128:131]
    v_exp_f32 v229, v229
    v_mfma_f32_16x16x32_bf16 v[176:179], a[240:243], a[140:143], v[176:179]
    ds_read_b64_tr_b16 a[238:239], v222 offset:50944
    v_mul_f32 v231, s95, v195
    v_mfma_f32_16x16x32_bf16 v[176:179], a[244:247], a[156:159], v[176:179]
    s_waitcnt lgkmcnt(4)
    v_exp_f32 v230, v230
    v_mfma_f32_16x16x32_bf16 v[36:39], a[224:227], a[128:131], v[36:39]
    ds_read_b64_tr_b16 a[240:241], v222 offset:37128
    v_accvgpr_read_b32 v196, a80
    v_mfma_f32_16x16x32_bf16 v[36:39], a[228:231], a[144:147], v[36:39]
    v_exp_f32 v231, v231
    v_mfma_f32_16x16x32_bf16 v[84:87], a[224:227], a[132:135], v[84:87]
    ds_read_b64_tr_b16 a[242:243], v222 offset:38664
    v_accvgpr_read_b32 v197, a81
    v_mfma_f32_16x16x32_bf16 v[84:87], a[228:231], a[148:151], v[84:87]
    v_accvgpr_read_b32 v198, a82
    v_accvgpr_read_b32 v199, a83
    v_mfma_f32_16x16x32_bf16 v[132:135], a[224:227], a[136:139], v[132:135]
    ds_read_b64_tr_b16 a[244:245], v222 offset:49416
    v_mul_f32 v192, v192, v196
    v_mfma_f32_16x16x32_bf16 v[132:135], a[228:231], a[152:155], v[132:135]
    v_mul_f32 v193, v193, v197
    v_mul_f32 v194, v194, v198
    v_mfma_f32_16x16x32_bf16 v[180:183], a[224:227], a[140:143], v[180:183]
    ds_read_b64_tr_b16 a[246:247], v222 offset:50952
    v_mul_f32 v195, v195, v199
    v_mfma_f32_16x16x32_bf16 v[180:183], a[228:231], a[156:159], v[180:183]
    s_waitcnt lgkmcnt(4)
    v_add_f32 v228, 1.0, v228
    v_add_f32 v229, 1.0, v229
    v_mfma_f32_16x16x32_bf16 v[40:43], a[232:235], a[128:131], v[40:43]
    v_rcp_f32 v228, v228
    v_mfma_f32_16x16x32_bf16 v[40:43], a[236:239], a[144:147], v[40:43]
    v_rcp_f32 v229, v229
    v_mfma_f32_16x16x32_bf16 v[88:91], a[232:235], a[132:135], v[88:91]
    v_add_f32 v230, 1.0, v230
    v_add_f32 v231, 1.0, v231
    v_mfma_f32_16x16x32_bf16 v[88:91], a[236:239], a[148:151], v[88:91]
    v_rcp_f32 v230, v230
    v_mfma_f32_16x16x32_bf16 v[136:139], a[232:235], a[136:139], v[136:139]
    v_rcp_f32 v231, v231
    v_mfma_f32_16x16x32_bf16 v[136:139], a[236:239], a[152:155], v[136:139]
    v_mul_f32 v192, v192, v228
    v_mul_f32 v193, v193, v229
    v_mfma_f32_16x16x32_bf16 v[184:187], a[232:235], a[140:143], v[184:187]
    v_mul_f32 v194, v194, v230
    v_mul_f32 v195, v195, v231
    v_mfma_f32_16x16x32_bf16 v[184:187], a[236:239], a[156:159], v[184:187]
    s_waitcnt lgkmcnt(0)
    v_cvt_pk_bf16_f32 v232, v192, v193
    v_cvt_pk_bf16_f32 v233, v194, v195
    v_mfma_f32_16x16x32_bf16 v[44:47], a[240:243], a[128:131], v[44:47]
    v_accvgpr_read_b32 v236, a36
    v_accvgpr_read_b32 v237, a37
    v_mfma_f32_16x16x32_bf16 v[44:47], a[244:247], a[144:147], v[44:47]
    v_accvgpr_read_b32 v238, a38
    v_accvgpr_read_b32 v239, a39
    v_mfma_f32_16x16x32_bf16 v[92:95], a[240:243], a[132:135], v[92:95]
    v_mul_f32 v244, s95, v236
    v_mul_f32 v245, s95, v237
    v_mfma_f32_16x16x32_bf16 v[92:95], a[244:247], a[148:151], v[92:95]
    v_exp_f32 v244, v244
    v_mfma_f32_16x16x32_bf16 v[140:143], a[240:243], a[136:139], v[140:143]
    v_exp_f32 v245, v245
    v_mfma_f32_16x16x32_bf16 v[140:143], a[244:247], a[152:155], v[140:143]
    v_mul_f32 v246, s95, v238
    v_mul_f32 v247, s95, v239
    v_mfma_f32_16x16x32_bf16 v[188:191], a[240:243], a[140:143], v[188:191]
    v_exp_f32 v246, v246
    v_mfma_f32_16x16x32_bf16 v[188:191], a[244:247], a[156:159], v[188:191]
    v_exp_f32 v247, v247
    s_waitcnt vmcnt(16)
    s_barrier
    ds_read_b128 a[192:195], v206 offset:0
    ds_read_b128 a[196:199], v207 offset:0
    ds_read_b128 a[200:203], v206 offset:128
    ds_read_b128 a[204:207], v207 offset:128
    ds_read_b128 a[208:211], v206 offset:256
    ds_read_b128 a[212:215], v207 offset:256
    ds_read_b128 a[216:219], v206 offset:6144
    ds_read_b128 a[220:223], v207 offset:6144
    ds_read_b128 a[224:227], v206 offset:6272
    ds_read_b128 a[228:231], v207 offset:6272
    ds_read_b128 a[232:235], v206 offset:6400
    ds_read_b128 a[236:239], v207 offset:6400
    v_accvgpr_read_b32 v240, a84
    v_accvgpr_read_b32 v241, a85
    v_accvgpr_read_b32 v242, a86
    v_accvgpr_read_b32 v243, a87
    v_mul_f32 v236, v236, v240
    v_mul_f32 v237, v237, v241
    v_mul_f32 v238, v238, v242
    v_mul_f32 v239, v239, v243
    v_add_f32 v244, 1.0, v244
    v_add_f32 v245, 1.0, v245
    v_add_f32 v246, 1.0, v246
    v_add_f32 v247, 1.0, v247
    v_rcp_f32 v244, v244
    v_rcp_f32 v245, v245
    v_rcp_f32 v246, v246
    v_rcp_f32 v247, v247
    s_nop 0
    v_mul_f32 v236, v236, v244
    v_mul_f32 v237, v237, v245
    v_mul_f32 v238, v238, v246
    v_mul_f32 v239, v239, v247
    v_cvt_pk_bf16_f32 v234, v236, v237
    v_cvt_pk_bf16_f32 v235, v238, v239
    s_nop 1
    v_permlane32_swap_b32 v232, v234
    v_permlane32_swap_b32 v233, v235
    s_nop 1
    v_permlane16_swap_b32 v232, v234
    v_permlane16_swap_b32 v233, v235
    buffer_store_dwordx4 v[232:235], v255, s[24:27], s94 offen offset:0 sc1
    v_accvgpr_read_b32 v192, a40
    v_accvgpr_read_b32 v193, a41
    v_accvgpr_read_b32 v194, a42
    v_accvgpr_read_b32 v195, a43
    v_mul_f32 v228, s95, v192
    v_mul_f32 v229, s95, v193
    v_mul_f32 v230, s95, v194
    v_mul_f32 v231, s95, v195
    v_exp_f32 v228, v228
    v_exp_f32 v229, v229
    v_exp_f32 v230, v230
    v_exp_f32 v231, v231
    s_nop 0
    v_accvgpr_read_b32 v196, a88
    v_accvgpr_read_b32 v197, a89
    v_accvgpr_read_b32 v198, a90
    v_accvgpr_read_b32 v199, a91
    v_mul_f32 v192, v192, v196
    v_mul_f32 v193, v193, v197
    v_mul_f32 v194, v194, v198
    v_mul_f32 v195, v195, v199
    v_add_f32 v228, 1.0, v228
    v_add_f32 v229, 1.0, v229
    v_add_f32 v230, 1.0, v230
    v_add_f32 v231, 1.0, v231
    v_rcp_f32 v228, v228
    v_rcp_f32 v229, v229
    v_rcp_f32 v230, v230
    v_rcp_f32 v231, v231
    s_nop 0
    v_mul_f32 v192, v192, v228
    v_mul_f32 v193, v193, v229
    v_mul_f32 v194, v194, v230
    v_mul_f32 v195, v195, v231
    v_cvt_pk_bf16_f32 v232, v192, v193
    v_cvt_pk_bf16_f32 v233, v194, v195
    v_accvgpr_read_b32 v236, a44
    v_accvgpr_read_b32 v237, a45
    v_accvgpr_read_b32 v238, a46
    v_accvgpr_read_b32 v239, a47
    v_mul_f32 v244, s95, v236
    v_mul_f32 v245, s95, v237
    v_mul_f32 v246, s95, v238
    v_mul_f32 v247, s95, v239
    v_exp_f32 v244, v244
    v_exp_f32 v245, v245
    v_exp_f32 v246, v246
    v_exp_f32 v247, v247
    s_nop 0
    v_accvgpr_read_b32 v240, a92
    v_accvgpr_read_b32 v241, a93
    v_accvgpr_read_b32 v242, a94
    v_accvgpr_read_b32 v243, a95
    v_mul_f32 v236, v236, v240
    v_mul_f32 v237, v237, v241
    v_mul_f32 v238, v238, v242
    v_mul_f32 v239, v239, v243
    v_add_f32 v244, 1.0, v244
    v_add_f32 v245, 1.0, v245
    v_add_f32 v246, 1.0, v246
    v_add_f32 v247, 1.0, v247
    v_rcp_f32 v244, v244
    v_rcp_f32 v245, v245
    v_rcp_f32 v246, v246
    v_rcp_f32 v247, v247
    s_nop 0
    v_mul_f32 v236, v236, v244
    v_mul_f32 v237, v237, v245
    v_mul_f32 v238, v238, v246
    v_mul_f32 v239, v239, v247
    v_cvt_pk_bf16_f32 v234, v236, v237
    v_cvt_pk_bf16_f32 v235, v238, v239
    s_nop 1
    v_permlane32_swap_b32 v232, v234
    v_permlane32_swap_b32 v233, v235
    s_nop 1
    v_permlane16_swap_b32 v232, v234
    v_permlane16_swap_b32 v233, v235
    buffer_store_dwordx4 v[232:235], v255, s[24:27], s94 offen offset:2048 sc1
    s_mov_b32 s42, 0x3dd53b95
    s_mov_b32 s43, s42
    v_pk_mul_f32 v[0:1], v[0:1], s[42:43]
    v_pk_mul_f32 v[2:3], v[2:3], s[42:43]
    v_pk_mul_f32 v[4:5], v[4:5], s[42:43]
    v_pk_mul_f32 v[6:7], v[6:7], s[42:43]
    v_cvt_pk_bf16_f32 v0, v0, v1
    v_cvt_pk_bf16_f32 v1, v2, v3
    v_cvt_pk_bf16_f32 v2, v4, v5
    v_cvt_pk_bf16_f32 v3, v6, v7
    v_pk_mul_f32 v[8:9], v[8:9], s[42:43]
    v_pk_mul_f32 v[10:11], v[10:11], s[42:43]
    v_pk_mul_f32 v[12:13], v[12:13], s[42:43]
    v_pk_mul_f32 v[14:15], v[14:15], s[42:43]
    v_cvt_pk_bf16_f32 v4, v8, v9
    v_cvt_pk_bf16_f32 v5, v10, v11
    v_cvt_pk_bf16_f32 v6, v12, v13
    v_cvt_pk_bf16_f32 v7, v14, v15
    v_pk_mul_f32 v[16:17], v[16:17], s[42:43]
    v_pk_mul_f32 v[18:19], v[18:19], s[42:43]
    v_pk_mul_f32 v[20:21], v[20:21], s[42:43]
    v_pk_mul_f32 v[22:23], v[22:23], s[42:43]
    v_cvt_pk_bf16_f32 v8, v16, v17
    v_cvt_pk_bf16_f32 v9, v18, v19
    v_cvt_pk_bf16_f32 v10, v20, v21
    v_cvt_pk_bf16_f32 v11, v22, v23
    v_pk_mul_f32 v[24:25], v[24:25], s[42:43]
    v_pk_mul_f32 v[26:27], v[26:27], s[42:43]
    v_pk_mul_f32 v[28:29], v[28:29], s[42:43]
    v_pk_mul_f32 v[30:31], v[30:31], s[42:43]
    v_cvt_pk_bf16_f32 v12, v24, v25
    v_cvt_pk_bf16_f32 v13, v26, v27
    v_cvt_pk_bf16_f32 v14, v28, v29
    v_cvt_pk_bf16_f32 v15, v30, v31
    v_pk_mul_f32 v[32:33], v[32:33], s[42:43]
    v_pk_mul_f32 v[34:35], v[34:35], s[42:43]
    v_pk_mul_f32 v[36:37], v[36:37], s[42:43]
    v_pk_mul_f32 v[38:39], v[38:39], s[42:43]
    v_cvt_pk_bf16_f32 v16, v32, v33
    v_cvt_pk_bf16_f32 v17, v34, v35
    v_cvt_pk_bf16_f32 v18, v36, v37
    v_cvt_pk_bf16_f32 v19, v38, v39
    v_pk_mul_f32 v[40:41], v[40:41], s[42:43]
    v_pk_mul_f32 v[42:43], v[42:43], s[42:43]
    v_pk_mul_f32 v[44:45], v[44:45], s[42:43]
    v_pk_mul_f32 v[46:47], v[46:47], s[42:43]
    v_cvt_pk_bf16_f32 v20, v40, v41
    v_cvt_pk_bf16_f32 v21, v42, v43
    v_cvt_pk_bf16_f32 v22, v44, v45
    v_cvt_pk_bf16_f32 v23, v46, v47
    v_pk_mul_f32 v[48:49], v[48:49], s[42:43]
    v_pk_mul_f32 v[50:51], v[50:51], s[42:43]
    v_pk_mul_f32 v[52:53], v[52:53], s[42:43]
    v_pk_mul_f32 v[54:55], v[54:55], s[42:43]
    v_cvt_pk_bf16_f32 v24, v48, v49
    v_cvt_pk_bf16_f32 v25, v50, v51
    v_cvt_pk_bf16_f32 v26, v52, v53
    v_cvt_pk_bf16_f32 v27, v54, v55
    v_pk_mul_f32 v[56:57], v[56:57], s[42:43]
    v_pk_mul_f32 v[58:59], v[58:59], s[42:43]
    v_pk_mul_f32 v[60:61], v[60:61], s[42:43]
    v_pk_mul_f32 v[62:63], v[62:63], s[42:43]
    v_cvt_pk_bf16_f32 v28, v56, v57
    v_cvt_pk_bf16_f32 v29, v58, v59
    v_cvt_pk_bf16_f32 v30, v60, v61
    v_cvt_pk_bf16_f32 v31, v62, v63
    v_pk_mul_f32 v[64:65], v[64:65], s[42:43]
    v_pk_mul_f32 v[66:67], v[66:67], s[42:43]
    v_pk_mul_f32 v[68:69], v[68:69], s[42:43]
    v_pk_mul_f32 v[70:71], v[70:71], s[42:43]
    v_cvt_pk_bf16_f32 v32, v64, v65
    v_cvt_pk_bf16_f32 v33, v66, v67
    v_cvt_pk_bf16_f32 v34, v68, v69
    v_cvt_pk_bf16_f32 v35, v70, v71
    v_pk_mul_f32 v[72:73], v[72:73], s[42:43]
    v_pk_mul_f32 v[74:75], v[74:75], s[42:43]
    v_pk_mul_f32 v[76:77], v[76:77], s[42:43]
    v_pk_mul_f32 v[78:79], v[78:79], s[42:43]
    v_cvt_pk_bf16_f32 v36, v72, v73
    v_cvt_pk_bf16_f32 v37, v74, v75
    v_cvt_pk_bf16_f32 v38, v76, v77
    v_cvt_pk_bf16_f32 v39, v78, v79
    v_pk_mul_f32 v[80:81], v[80:81], s[42:43]
    v_pk_mul_f32 v[82:83], v[82:83], s[42:43]
    v_pk_mul_f32 v[84:85], v[84:85], s[42:43]
    v_pk_mul_f32 v[86:87], v[86:87], s[42:43]
    v_cvt_pk_bf16_f32 v40, v80, v81
    v_cvt_pk_bf16_f32 v41, v82, v83
    v_cvt_pk_bf16_f32 v42, v84, v85
    v_cvt_pk_bf16_f32 v43, v86, v87
    v_pk_mul_f32 v[88:89], v[88:89], s[42:43]
    v_pk_mul_f32 v[90:91], v[90:91], s[42:43]
    v_pk_mul_f32 v[92:93], v[92:93], s[42:43]
    v_pk_mul_f32 v[94:95], v[94:95], s[42:43]
    v_cvt_pk_bf16_f32 v44, v88, v89
    v_cvt_pk_bf16_f32 v45, v90, v91
    v_cvt_pk_bf16_f32 v46, v92, v93
    v_cvt_pk_bf16_f32 v47, v94, v95
    v_pk_mul_f32 v[96:97], v[96:97], s[42:43]
    v_pk_mul_f32 v[98:99], v[98:99], s[42:43]
    v_pk_mul_f32 v[100:101], v[100:101], s[42:43]
    v_pk_mul_f32 v[102:103], v[102:103], s[42:43]
    v_cvt_pk_bf16_f32 v48, v96, v97
    v_cvt_pk_bf16_f32 v49, v98, v99
    v_cvt_pk_bf16_f32 v50, v100, v101
    v_cvt_pk_bf16_f32 v51, v102, v103
    v_pk_mul_f32 v[104:105], v[104:105], s[42:43]
    v_pk_mul_f32 v[106:107], v[106:107], s[42:43]
    v_pk_mul_f32 v[108:109], v[108:109], s[42:43]
    v_pk_mul_f32 v[110:111], v[110:111], s[42:43]
    v_cvt_pk_bf16_f32 v52, v104, v105
    v_cvt_pk_bf16_f32 v53, v106, v107
    v_cvt_pk_bf16_f32 v54, v108, v109
    v_cvt_pk_bf16_f32 v55, v110, v111
    v_pk_mul_f32 v[112:113], v[112:113], s[42:43]
    v_pk_mul_f32 v[114:115], v[114:115], s[42:43]
    v_pk_mul_f32 v[116:117], v[116:117], s[42:43]
    v_pk_mul_f32 v[118:119], v[118:119], s[42:43]
    v_cvt_pk_bf16_f32 v56, v112, v113
    v_cvt_pk_bf16_f32 v57, v114, v115
    v_cvt_pk_bf16_f32 v58, v116, v117
    v_cvt_pk_bf16_f32 v59, v118, v119
    v_pk_mul_f32 v[120:121], v[120:121], s[42:43]
    v_pk_mul_f32 v[122:123], v[122:123], s[42:43]
    v_pk_mul_f32 v[124:125], v[124:125], s[42:43]
    v_pk_mul_f32 v[126:127], v[126:127], s[42:43]
    v_cvt_pk_bf16_f32 v60, v120, v121
    v_cvt_pk_bf16_f32 v61, v122, v123
    v_cvt_pk_bf16_f32 v62, v124, v125
    v_cvt_pk_bf16_f32 v63, v126, v127
    v_pk_mul_f32 v[128:129], v[128:129], s[42:43]
    v_pk_mul_f32 v[130:131], v[130:131], s[42:43]
    v_pk_mul_f32 v[132:133], v[132:133], s[42:43]
    v_pk_mul_f32 v[134:135], v[134:135], s[42:43]
    v_cvt_pk_bf16_f32 v64, v128, v129
    v_cvt_pk_bf16_f32 v65, v130, v131
    v_cvt_pk_bf16_f32 v66, v132, v133
    v_cvt_pk_bf16_f32 v67, v134, v135
    v_pk_mul_f32 v[136:137], v[136:137], s[42:43]
    v_pk_mul_f32 v[138:139], v[138:139], s[42:43]
    v_pk_mul_f32 v[140:141], v[140:141], s[42:43]
    v_pk_mul_f32 v[142:143], v[142:143], s[42:43]
    v_cvt_pk_bf16_f32 v68, v136, v137
    v_cvt_pk_bf16_f32 v69, v138, v139
    v_cvt_pk_bf16_f32 v70, v140, v141
    v_cvt_pk_bf16_f32 v71, v142, v143
    v_pk_mul_f32 v[144:145], v[144:145], s[42:43]
    v_pk_mul_f32 v[146:147], v[146:147], s[42:43]
    v_pk_mul_f32 v[148:149], v[148:149], s[42:43]
    v_pk_mul_f32 v[150:151], v[150:151], s[42:43]
    v_cvt_pk_bf16_f32 v72, v144, v145
    v_cvt_pk_bf16_f32 v73, v146, v147
    v_cvt_pk_bf16_f32 v74, v148, v149
    v_cvt_pk_bf16_f32 v75, v150, v151
    v_pk_mul_f32 v[152:153], v[152:153], s[42:43]
    v_pk_mul_f32 v[154:155], v[154:155], s[42:43]
    v_pk_mul_f32 v[156:157], v[156:157], s[42:43]
    v_pk_mul_f32 v[158:159], v[158:159], s[42:43]
    v_cvt_pk_bf16_f32 v76, v152, v153
    v_cvt_pk_bf16_f32 v77, v154, v155
    v_cvt_pk_bf16_f32 v78, v156, v157
    v_cvt_pk_bf16_f32 v79, v158, v159
    v_pk_mul_f32 v[160:161], v[160:161], s[42:43]
    v_pk_mul_f32 v[162:163], v[162:163], s[42:43]
    v_pk_mul_f32 v[164:165], v[164:165], s[42:43]
    v_pk_mul_f32 v[166:167], v[166:167], s[42:43]
    v_cvt_pk_bf16_f32 v80, v160, v161
    v_cvt_pk_bf16_f32 v81, v162, v163
    v_cvt_pk_bf16_f32 v82, v164, v165
    v_cvt_pk_bf16_f32 v83, v166, v167
    v_pk_mul_f32 v[168:169], v[168:169], s[42:43]
    v_pk_mul_f32 v[170:171], v[170:171], s[42:43]
    v_pk_mul_f32 v[172:173], v[172:173], s[42:43]
    v_pk_mul_f32 v[174:175], v[174:175], s[42:43]
    v_cvt_pk_bf16_f32 v84, v168, v169
    v_cvt_pk_bf16_f32 v85, v170, v171
    v_cvt_pk_bf16_f32 v86, v172, v173
    v_cvt_pk_bf16_f32 v87, v174, v175
    v_pk_mul_f32 v[176:177], v[176:177], s[42:43]
    v_pk_mul_f32 v[178:179], v[178:179], s[42:43]
    v_pk_mul_f32 v[180:181], v[180:181], s[42:43]
    v_pk_mul_f32 v[182:183], v[182:183], s[42:43]
    v_cvt_pk_bf16_f32 v88, v176, v177
    v_cvt_pk_bf16_f32 v89, v178, v179
    v_cvt_pk_bf16_f32 v90, v180, v181
    v_cvt_pk_bf16_f32 v91, v182, v183
    v_pk_mul_f32 v[184:185], v[184:185], s[42:43]
    v_pk_mul_f32 v[186:187], v[186:187], s[42:43]
    v_pk_mul_f32 v[188:189], v[188:189], s[42:43]
    v_pk_mul_f32 v[190:191], v[190:191], s[42:43]
    v_cvt_pk_bf16_f32 v92, v184, v185
    v_cvt_pk_bf16_f32 v93, v186, v187
    v_cvt_pk_bf16_f32 v94, v188, v189
    v_cvt_pk_bf16_f32 v95, v190, v191
    v_mov_b32 v228, -1
    v_mov_b32 v229, -1
    v_mov_b32 v230, -1
    v_mov_b32 v231, -1
    s_waitcnt lgkmcnt(0)
    v_mfma_f32_16x16x32_bf16 v[96:99], a[192:195], v[0:3], 0
    v_mfma_f32_16x16x32_bf16 v[96:99], a[196:199], v[4:7], v[96:99]
    s_mov_b32 s33, 24576
    s_add_u32 m0, s31, 73728
    v_mfma_f32_16x16x32_bf16 v[96:99], a[200:203], v[8:11], v[96:99]
    buffer_load_dwordx4 v203, s[20:23], s33 offen lds
    v_mfma_f32_16x16x32_bf16 v[96:99], a[204:207], v[12:15], v[96:99]
    v_mfma_f32_16x16x32_bf16 v[96:99], a[208:211], v[16:19], v[96:99]
    s_add_u32 m0, s31, 74752
    v_mfma_f32_16x16x32_bf16 v[96:99], a[212:215], v[20:23], v[96:99]
    buffer_load_dwordx4 v204, s[20:23], s33 offen lds
    v_mfma_f32_16x16x32_bf16 v[104:107], a[192:195], v[24:27], 0
    v_mfma_f32_16x16x32_bf16 v[104:107], a[196:199], v[28:31], v[104:107]
    s_add_u32 m0, s31, 75776
    v_mfma_f32_16x16x32_bf16 v[104:107], a[200:203], v[32:35], v[104:107]
    buffer_load_dwordx4 v205, s[20:23], s33 offen lds
    v_mfma_f32_16x16x32_bf16 v[104:107], a[204:207], v[36:39], v[104:107]
    v_mfma_f32_16x16x32_bf16 v[104:107], a[208:211], v[40:43], v[104:107]
    v_mfma_f32_16x16x32_bf16 v[104:107], a[212:215], v[44:47], v[104:107]
    v_mfma_f32_16x16x32_bf16 v[112:115], a[192:195], v[48:51], 0
    v_mfma_f32_16x16x32_bf16 v[112:115], a[196:199], v[52:55], v[112:115]
    v_mfma_f32_16x16x32_bf16 v[112:115], a[200:203], v[56:59], v[112:115]
    v_mfma_f32_16x16x32_bf16 v[112:115], a[204:207], v[60:63], v[112:115]
    v_mfma_f32_16x16x32_bf16 v[112:115], a[208:211], v[64:67], v[112:115]
    v_mfma_f32_16x16x32_bf16 v[112:115], a[212:215], v[68:71], v[112:115]
    v_mfma_f32_16x16x32_bf16 v[120:123], a[192:195], v[72:75], 0
    v_mfma_f32_16x16x32_bf16 v[120:123], a[196:199], v[76:79], v[120:123]
    v_mfma_f32_16x16x32_bf16 v[120:123], a[200:203], v[80:83], v[120:123]
    v_mfma_f32_16x16x32_bf16 v[120:123], a[204:207], v[84:87], v[120:123]
    v_mfma_f32_16x16x32_bf16 v[120:123], a[208:211], v[88:91], v[120:123]
    v_mfma_f32_16x16x32_bf16 v[120:123], a[212:215], v[92:95], v[120:123]
    v_mfma_f32_16x16x32_bf16 v[100:103], a[216:219], v[0:3], 0
    v_mfma_f32_16x16x32_bf16 v[100:103], a[220:223], v[4:7], v[100:103]
    v_mfma_f32_16x16x32_bf16 v[100:103], a[224:227], v[8:11], v[100:103]
    ds_read_b128 a[192:195], v206 offset:12288
    v_mfma_f32_16x16x32_bf16 v[100:103], a[228:231], v[12:15], v[100:103]
    v_mfma_f32_16x16x32_bf16 v[100:103], a[232:235], v[16:19], v[100:103]
    ds_read_b128 a[196:199], v207 offset:12288
    v_mfma_f32_16x16x32_bf16 v[100:103], a[236:239], v[20:23], v[100:103]
    v_mfma_f32_16x16x32_bf16 v[108:111], a[216:219], v[24:27], 0
    ds_read_b128 a[200:203], v206 offset:12416
    v_mfma_f32_16x16x32_bf16 v[108:111], a[220:223], v[28:31], v[108:111]
    v_mfma_f32_16x16x32_bf16 v[108:111], a[224:227], v[32:35], v[108:111]
    ds_read_b128 a[204:207], v207 offset:12416
    v_mfma_f32_16x16x32_bf16 v[108:111], a[228:231], v[36:39], v[108:111]
    v_mfma_f32_16x16x32_bf16 v[108:111], a[232:235], v[40:43], v[108:111]
    ds_read_b128 a[208:211], v206 offset:12544
    v_mfma_f32_16x16x32_bf16 v[108:111], a[236:239], v[44:47], v[108:111]
    v_mfma_f32_16x16x32_bf16 v[116:119], a[216:219], v[48:51], 0
    ds_read_b128 a[212:215], v207 offset:12544
    v_mfma_f32_16x16x32_bf16 v[116:119], a[220:223], v[52:55], v[116:119]
    v_mfma_f32_16x16x32_bf16 v[116:119], a[224:227], v[56:59], v[116:119]
    v_mfma_f32_16x16x32_bf16 v[116:119], a[228:231], v[60:63], v[116:119]
    v_mfma_f32_16x16x32_bf16 v[116:119], a[232:235], v[64:67], v[116:119]
    s_mov_b32 s34, 49152
    v_mfma_f32_16x16x32_bf16 v[116:119], a[236:239], v[68:71], v[116:119]
    s_mov_b32 s33, 36864
    v_mfma_f32_16x16x32_bf16 v[124:127], a[216:219], v[72:75], 0
    v_mfma_f32_16x16x32_bf16 v[124:127], a[220:223], v[76:79], v[124:127]
    v_mfma_f32_16x16x32_bf16 v[124:127], a[224:227], v[80:83], v[124:127]
    v_mfma_f32_16x16x32_bf16 v[124:127], a[228:231], v[84:87], v[124:127]
    v_mfma_f32_16x16x32_bf16 v[124:127], a[232:235], v[88:91], v[124:127]
    v_mfma_f32_16x16x32_bf16 v[124:127], a[236:239], v[92:95], v[124:127]
    s_nop 7
    v_max3_f32 v236, v96, v97, v98
    v_max3_f32 v236, v236, v99, v100
    v_max3_f32 v236, v236, v101, v102
    v_max_f32 v236, v236, v103
    v_mov_b32 v240, v236
    s_nop 1
    v_permlane32_swap_b32 v240, v236
    v_max_f32 v236, v236, v240
    v_mov_b32 v240, v236
    s_nop 1
    v_permlane16_swap_b32 v240, v236
    v_max_f32 v236, v236, v240
    v_sub_f32 v160, 0, v236
    v_sub_f32 v161, 0, v236
    v_sub_f32 v162, 0, v236
    v_sub_f32 v163, 0, v236
    v_sub_f32 v176, v96, v236
    v_sub_f32 v177, v97, v236
    v_sub_f32 v178, v98, v236
    v_sub_f32 v179, v99, v236
    v_sub_f32 v180, v100, v236
    v_sub_f32 v181, v101, v236
    v_sub_f32 v182, v102, v236
    v_sub_f32 v183, v103, v236
    v_exp_f32 v176, v176
    v_exp_f32 v177, v177
    v_exp_f32 v178, v178
    v_exp_f32 v179, v179
    v_exp_f32 v180, v180
    v_exp_f32 v181, v181
    v_exp_f32 v182, v182
    v_exp_f32 v183, v183
    v_add_f32 v192, v176, v177
    v_add_f32 v192, v192, v178
    v_add_f32 v192, v192, v179
    v_add_f32 v192, v192, v180
    v_add_f32 v192, v192, v181
    v_add_f32 v192, v192, v182
    v_add_f32 v192, v192, v183
    v_cvt_pk_bf16_f32 v128, v176, v177
    v_cvt_pk_bf16_f32 v129, v178, v179
    v_cvt_pk_bf16_f32 v130, v180, v181
    v_cvt_pk_bf16_f32 v131, v182, v183
    v_mov_b32 v196, 0
    v_max3_f32 v237, v104, v105, v106
    v_max3_f32 v237, v237, v107, v108
    v_max3_f32 v237, v237, v109, v110
    v_max_f32 v237, v237, v111
    v_mov_b32 v240, v237
    s_nop 1
    v_permlane32_swap_b32 v240, v237
    v_max_f32 v237, v237, v240
    v_mov_b32 v240, v237
    s_nop 1
    v_permlane16_swap_b32 v240, v237
    v_max_f32 v237, v237, v240
    v_sub_f32 v164, 0, v237
    v_sub_f32 v165, 0, v237
    v_sub_f32 v166, 0, v237
    v_sub_f32 v167, 0, v237
    v_sub_f32 v176, v104, v237
    v_sub_f32 v177, v105, v237
    v_sub_f32 v178, v106, v237
    v_sub_f32 v179, v107, v237
    v_sub_f32 v180, v108, v237
    v_sub_f32 v181, v109, v237
    v_sub_f32 v182, v110, v237
    v_sub_f32 v183, v111, v237
    v_exp_f32 v176, v176
    v_exp_f32 v177, v177
    v_exp_f32 v178, v178
    v_exp_f32 v179, v179
    v_exp_f32 v180, v180
    v_exp_f32 v181, v181
    v_exp_f32 v182, v182
    v_exp_f32 v183, v183
    v_add_f32 v193, v176, v177
    v_add_f32 v193, v193, v178
    v_add_f32 v193, v193, v179
    v_add_f32 v193, v193, v180
    v_add_f32 v193, v193, v181
    v_add_f32 v193, v193, v182
    v_add_f32 v193, v193, v183
    v_cvt_pk_bf16_f32 v132, v176, v177
    v_cvt_pk_bf16_f32 v133, v178, v179
    v_cvt_pk_bf16_f32 v134, v180, v181
    v_cvt_pk_bf16_f32 v135, v182, v183
    v_mov_b32 v197, 0
    v_max3_f32 v238, v112, v113, v114
    v_max3_f32 v238, v238, v115, v116
    v_max3_f32 v238, v238, v117, v118
    v_max_f32 v238, v238, v119
    v_mov_b32 v240, v238
    s_nop 1
    v_permlane32_swap_b32 v240, v238
    v_max_f32 v238, v238, v240
    v_mov_b32 v240, v238
    s_nop 1
    v_permlane16_swap_b32 v240, v238
    v_max_f32 v238, v238, v240
    v_sub_f32 v168, 0, v238
    v_sub_f32 v169, 0, v238
    v_sub_f32 v170, 0, v238
    v_sub_f32 v171, 0, v238
    v_sub_f32 v176, v112, v238
    v_sub_f32 v177, v113, v238
    v_sub_f32 v178, v114, v238
    v_sub_f32 v179, v115, v238
    v_sub_f32 v180, v116, v238
    v_sub_f32 v181, v117, v238
    v_sub_f32 v182, v118, v238
    v_sub_f32 v183, v119, v238
    v_exp_f32 v176, v176
    v_exp_f32 v177, v177
    v_exp_f32 v178, v178
    v_exp_f32 v179, v179
    v_exp_f32 v180, v180
    v_exp_f32 v181, v181
    v_exp_f32 v182, v182
    v_exp_f32 v183, v183
    v_add_f32 v194, v176, v177
    v_add_f32 v194, v194, v178
    v_add_f32 v194, v194, v179
    v_add_f32 v194, v194, v180
    v_add_f32 v194, v194, v181
    v_add_f32 v194, v194, v182
    v_add_f32 v194, v194, v183
    v_cvt_pk_bf16_f32 v136, v176, v177
    v_cvt_pk_bf16_f32 v137, v178, v179
    v_cvt_pk_bf16_f32 v138, v180, v181
    v_cvt_pk_bf16_f32 v139, v182, v183
    v_mov_b32 v198, 0
    v_max3_f32 v239, v120, v121, v122
    v_max3_f32 v239, v239, v123, v124
    v_max3_f32 v239, v239, v125, v126
    v_max_f32 v239, v239, v127
    v_mov_b32 v240, v239
    s_nop 1
    v_permlane32_swap_b32 v240, v239
    v_max_f32 v239, v239, v240
    v_mov_b32 v240, v239
    s_nop 1
    v_permlane16_swap_b32 v240, v239
    v_max_f32 v239, v239, v240
    v_sub_f32 v172, 0, v239
    v_sub_f32 v173, 0, v239
    v_sub_f32 v174, 0, v239
    v_sub_f32 v175, 0, v239
    v_sub_f32 v176, v120, v239
    v_sub_f32 v177, v121, v239
    v_sub_f32 v178, v122, v239
    v_sub_f32 v179, v123, v239
    v_sub_f32 v180, v124, v239
    v_sub_f32 v181, v125, v239
    v_sub_f32 v182, v126, v239
    v_sub_f32 v183, v127, v239
    v_exp_f32 v176, v176
    v_exp_f32 v177, v177
    v_exp_f32 v178, v178
    v_exp_f32 v179, v179
    v_exp_f32 v180, v180
    v_exp_f32 v181, v181
    v_exp_f32 v182, v182
    v_exp_f32 v183, v183
    v_add_f32 v195, v176, v177
    v_add_f32 v195, v195, v178
    v_add_f32 v195, v195, v179
    v_add_f32 v195, v195, v180
    v_add_f32 v195, v195, v181
    v_add_f32 v195, v195, v182
    v_add_f32 v195, v195, v183
    v_cvt_pk_bf16_f32 v140, v176, v177
    v_cvt_pk_bf16_f32 v141, v178, v179
    v_cvt_pk_bf16_f32 v142, v180, v181
    v_cvt_pk_bf16_f32 v143, v182, v183
    v_mov_b32 v199, 0
    s_nop 1
    s_waitcnt vmcnt(9)
    v_mfma_f32_16x16x32_bf16 v[96:99], a[192:195], v[0:3], v[160:163]
    s_barrier
    v_add_f32 v196, v196, v192
    v_add_f32 v197, v197, v193
    v_mfma_f32_16x16x32_bf16 v[96:99], a[196:199], v[4:7], v[96:99]
    ds_read_b128 a[216:219], v206 offset:18432
    s_add_u32 m0, s31, 0
    v_mfma_f32_16x16x32_bf16 v[96:99], a[200:203], v[8:11], v[96:99]
    buffer_load_dwordx4 v200, s[16:19], s34 offen lds
    v_mfma_f32_16x16x32_bf16 v[96:99], a[204:207], v[12:15], v[96:99]
    ds_read_b128 a[220:223], v207 offset:18432
    s_add_u32 m0, s31, 1024
    v_mfma_f32_16x16x32_bf16 v[96:99], a[208:211], v[16:19], v[96:99]
    buffer_load_dwordx4 v201, s[16:19], s34 offen lds
    v_mfma_f32_16x16x32_bf16 v[96:99], a[212:215], v[20:23], v[96:99]
    ds_read_b128 a[224:227], v206 offset:18560
    s_add_u32 m0, s31, 2048
    v_mfma_f32_16x16x32_bf16 v[104:107], a[192:195], v[24:27], v[164:167]
    buffer_load_dwordx4 v202, s[16:19], s34 offen lds
    v_mfma_f32_16x16x32_bf16 v[104:107], a[196:199], v[28:31], v[104:107]
    ds_read_b128 a[228:231], v207 offset:18560
    s_add_u32 m0, s31, 86016
    v_mfma_f32_16x16x32_bf16 v[104:107], a[200:203], v[32:35], v[104:107]
    buffer_load_dwordx4 v203, s[20:23], s33 offen lds
    v_mfma_f32_16x16x32_bf16 v[104:107], a[204:207], v[36:39], v[104:107]
    ds_read_b128 a[232:235], v206 offset:18688
    v_add_f32 v198, v198, v194
    v_mfma_f32_16x16x32_bf16 v[104:107], a[208:211], v[40:43], v[104:107]
    v_exp_f32 v176, v96
    v_mfma_f32_16x16x32_bf16 v[104:107], a[212:215], v[44:47], v[104:107]
    v_exp_f32 v177, v97
    v_mfma_f32_16x16x32_bf16 v[112:115], a[192:195], v[48:51], v[168:171]
    v_exp_f32 v178, v98
    v_mfma_f32_16x16x32_bf16 v[112:115], a[196:199], v[52:55], v[112:115]
    v_exp_f32 v179, v99
    v_mfma_f32_16x16x32_bf16 v[112:115], a[200:203], v[56:59], v[112:115]
    ds_read_b128 a[236:239], v207 offset:18688
    s_add_u32 m0, s31, 87040
    v_mfma_f32_16x16x32_bf16 v[112:115], a[204:207], v[60:63], v[112:115]
    buffer_load_dwordx4 v204, s[20:23], s33 offen lds
    v_mfma_f32_16x16x32_bf16 v[112:115], a[208:211], v[64:67], v[112:115]
    v_exp_f32 v180, v104
    v_mfma_f32_16x16x32_bf16 v[112:115], a[212:215], v[68:71], v[112:115]
    v_exp_f32 v181, v105
    v_mfma_f32_16x16x32_bf16 v[120:123], a[192:195], v[72:75], v[172:175]
    v_exp_f32 v182, v106
    v_mfma_f32_16x16x32_bf16 v[120:123], a[196:199], v[76:79], v[120:123]
    v_exp_f32 v183, v107
    v_mfma_f32_16x16x32_bf16 v[120:123], a[200:203], v[80:83], v[120:123]
    s_add_u32 m0, s31, 88064
    v_add_f32 v199, v199, v195
    v_add_f32 v192, v176, v177
    v_mfma_f32_16x16x32_bf16 v[120:123], a[204:207], v[84:87], v[120:123]
    buffer_load_dwordx4 v205, s[20:23], s33 offen lds
    v_mfma_f32_16x16x32_bf16 v[120:123], a[208:211], v[88:91], v[120:123]
    s_add_u32 s34, s34, 12288
    v_exp_f32 v184, v112
    v_mfma_f32_16x16x32_bf16 v[120:123], a[212:215], v[92:95], v[120:123]
    s_waitcnt lgkmcnt(0)
    v_exp_f32 v185, v113
    v_mfma_f32_16x16x32_bf16 v[100:103], a[216:219], v[0:3], v[160:163]
    s_add_u32 s33, s33, 12288
    v_exp_f32 v186, v114
    v_mfma_f32_16x16x32_bf16 v[100:103], a[220:223], v[4:7], v[100:103]
    v_exp_f32 v187, v115
    v_mfma_f32_16x16x32_bf16 v[100:103], a[224:227], v[8:11], v[100:103]
    ds_read_b128 a[192:195], v206 offset:24576
    v_cvt_pk_bf16_f32 v144, v176, v177
    v_mfma_f32_16x16x32_bf16 v[100:103], a[228:231], v[12:15], v[100:103]
    ds_read_b128 a[196:199], v207 offset:24576
    v_add_f32 v192, v192, v178
    v_mfma_f32_16x16x32_bf16 v[100:103], a[232:235], v[16:19], v[100:103]
    v_exp_f32 v188, v120
    v_mfma_f32_16x16x32_bf16 v[100:103], a[236:239], v[20:23], v[100:103]
    v_exp_f32 v189, v121
    v_mfma_f32_16x16x32_bf16 v[108:111], a[216:219], v[24:27], v[164:167]
    v_exp_f32 v190, v122
    v_mfma_f32_16x16x32_bf16 v[108:111], a[220:223], v[28:31], v[108:111]
    v_exp_f32 v191, v123
    v_mfma_f32_16x16x32_bf16 v[108:111], a[224:227], v[32:35], v[108:111]
    ds_read_b128 a[200:203], v206 offset:24704
    v_add_f32 v192, v192, v179
    v_mfma_f32_16x16x32_bf16 v[108:111], a[228:231], v[36:39], v[108:111]
    ds_read_b128 a[204:207], v207 offset:24704
    v_cvt_pk_bf16_f32 v145, v178, v179
    v_mfma_f32_16x16x32_bf16 v[108:111], a[232:235], v[40:43], v[108:111]
    v_exp_f32 v176, v100
    v_mfma_f32_16x16x32_bf16 v[108:111], a[236:239], v[44:47], v[108:111]
    v_exp_f32 v177, v101
    v_mfma_f32_16x16x32_bf16 v[116:119], a[216:219], v[48:51], v[168:171]
    ds_read_b64_tr_b16 a[240:241], v208 offset:0
    v_add_f32 v193, v180, v181
    v_mfma_f32_16x16x32_bf16 v[116:119], a[220:223], v[52:55], v[116:119]
    ds_read_b64_tr_b16 a[242:243], v208 offset:6144
    v_cvt_pk_bf16_f32 v148, v180, v181
    v_mfma_f32_16x16x32_bf16 v[116:119], a[224:227], v[56:59], v[116:119]
    ds_read_b128 a[208:211], v206 offset:24832
    v_add_f32 v193, v193, v182
    v_mfma_f32_16x16x32_bf16 v[116:119], a[228:231], v[60:63], v[116:119]
    ds_read_b128 a[212:215], v207 offset:24832
    v_add_f32 v193, v193, v183
    v_mfma_f32_16x16x32_bf16 v[116:119], a[232:235], v[64:67], v[116:119]
    ds_read_b64_tr_b16 a[244:245], v209 offset:0
    v_cvt_pk_bf16_f32 v149, v182, v183
    v_mfma_f32_16x16x32_bf16 v[116:119], a[236:239], v[68:71], v[116:119]
    ds_read_b64_tr_b16 a[246:247], v209 offset:6144
    v_add_f32 v194, v184, v185
    v_mfma_f32_16x16x32_bf16 v[124:127], a[216:219], v[72:75], v[172:175]
    v_exp_f32 v178, v102
    v_mfma_f32_16x16x32_bf16 v[124:127], a[220:223], v[76:79], v[124:127]
    v_exp_f32 v179, v103
    v_mfma_f32_16x16x32_bf16 v[124:127], a[224:227], v[80:83], v[124:127]
    ds_read_b64_tr_b16 a[248:249], v210 offset:0
    v_cvt_pk_bf16_f32 v152, v184, v185
    v_mfma_f32_16x16x32_bf16 v[124:127], a[228:231], v[84:87], v[124:127]
    ds_read_b64_tr_b16 a[250:251], v210 offset:6144
    v_add_f32 v194, v194, v186
    v_mfma_f32_16x16x32_bf16 v[124:127], a[232:235], v[88:91], v[124:127]
    v_exp_f32 v180, v108
    v_mfma_f32_16x16x32_bf16 v[124:127], a[236:239], v[92:95], v[124:127]
    s_waitcnt lgkmcnt(6)
    v_exp_f32 v181, v109
    v_mfma_f32_16x16x32_bf16 a[0:3], a[240:243], v[128:131], 0
    ds_read_b64_tr_b16 a[252:253], v211 offset:0
    v_add_f32 v194, v194, v187
    v_mfma_f32_16x16x32_bf16 a[4:7], a[240:243], v[132:135], 0
    ds_read_b64_tr_b16 a[254:255], v211 offset:6144
    v_cvt_pk_bf16_f32 v153, v186, v187
    v_mfma_f32_16x16x32_bf16 a[8:11], a[240:243], v[136:139], 0
    v_exp_f32 v182, v110
    v_mfma_f32_16x16x32_bf16 a[12:15], a[240:243], v[140:143], 0
    s_waitcnt lgkmcnt(4)
    v_exp_f32 v183, v111
    v_mfma_f32_16x16x32_bf16 a[16:19], a[244:247], v[128:131], 0
    ds_read_b64_tr_b16 a[240:241], v208 offset:128
    v_add_f32 v195, v188, v189
    v_mfma_f32_16x16x32_bf16 a[20:23], a[244:247], v[132:135], 0
    ds_read_b64_tr_b16 a[242:243], v208 offset:6272
    v_cvt_pk_bf16_f32 v156, v188, v189
    v_mfma_f32_16x16x32_bf16 a[24:27], a[244:247], v[136:139], 0
    v_exp_f32 v184, v116
    v_mfma_f32_16x16x32_bf16 a[28:31], a[244:247], v[140:143], 0
    s_waitcnt lgkmcnt(4)
    v_exp_f32 v185, v117
    v_mfma_f32_16x16x32_bf16 a[32:35], a[248:251], v[128:131], 0
    ds_read_b64_tr_b16 a[244:245], v209 offset:128
    v_add_f32 v195, v195, v190
    v_mfma_f32_16x16x32_bf16 a[36:39], a[248:251], v[132:135], 0
    ds_read_b64_tr_b16 a[246:247], v209 offset:6272
    v_add_f32 v195, v195, v191
    v_mfma_f32_16x16x32_bf16 a[40:43], a[248:251], v[136:139], 0
    v_exp_f32 v186, v118
    v_mfma_f32_16x16x32_bf16 a[44:47], a[248:251], v[140:143], 0
    s_waitcnt lgkmcnt(4)
    v_exp_f32 v187, v119
    v_mfma_f32_16x16x32_bf16 a[48:51], a[252:255], v[128:131], 0
    ds_read_b64_tr_b16 a[248:249], v210 offset:128
    v_cvt_pk_bf16_f32 v157, v190, v191
    v_mfma_f32_16x16x32_bf16 a[52:55], a[252:255], v[132:135], 0
    ds_read_b64_tr_b16 a[250:251], v210 offset:6272
    v_add_f32 v192, v192, v176
    v_mfma_f32_16x16x32_bf16 a[56:59], a[252:255], v[136:139], 0
    v_exp_f32 v188, v124
    v_mfma_f32_16x16x32_bf16 a[60:63], a[252:255], v[140:143], 0
    s_waitcnt lgkmcnt(4)
    v_exp_f32 v189, v125
    v_mfma_f32_16x16x32_bf16 a[64:67], a[240:243], v[128:131], 0
    ds_read_b64_tr_b16 a[252:253], v211 offset:128
    v_add_f32 v192, v192, v177
    v_mfma_f32_16x16x32_bf16 a[68:71], a[240:243], v[132:135], 0
    ds_read_b64_tr_b16 a[254:255], v211 offset:6272
    v_cvt_pk_bf16_f32 v146, v176, v177
    v_mfma_f32_16x16x32_bf16 a[72:75], a[240:243], v[136:139], 0
    v_exp_f32 v190, v126
    v_mfma_f32_16x16x32_bf16 a[76:79], a[240:243], v[140:143], 0
    s_waitcnt lgkmcnt(4)
    v_exp_f32 v191, v127
    v_mfma_f32_16x16x32_bf16 a[80:83], a[244:247], v[128:131], 0
    ds_read_b64_tr_b16 a[240:241], v208 offset:256
    v_add_f32 v192, v192, v178
    v_mfma_f32_16x16x32_bf16 a[84:87], a[244:247], v[132:135], 0
    ds_read_b64_tr_b16 a[242:243], v208 offset:6400
    v_add_f32 v192, v192, v179
    v_mfma_f32_16x16x32_bf16 a[88:91], a[244:247], v[136:139], 0
    v_cvt_pk_bf16_f32 v147, v178, v179
    v_add_f32 v193, v193, v180
    v_mfma_f32_16x16x32_bf16 a[92:95], a[244:247], v[140:143], 0
    s_waitcnt lgkmcnt(4)
    v_add_f32 v193, v193, v181
    v_cvt_pk_bf16_f32 v150, v180, v181
    v_mfma_f32_16x16x32_bf16 a[96:99], a[248:251], v[128:131], 0
    ds_read_b64_tr_b16 a[244:245], v209 offset:256
    v_add_f32 v193, v193, v182
    v_mfma_f32_16x16x32_bf16 a[100:103], a[248:251], v[132:135], 0
    ds_read_b64_tr_b16 a[246:247], v209 offset:6400
    v_add_f32 v193, v193, v183
    v_mfma_f32_16x16x32_bf16 a[104:107], a[248:251], v[136:139], 0
    v_cvt_pk_bf16_f32 v151, v182, v183
    v_add_f32 v194, v194, v184
    v_mfma_f32_16x16x32_bf16 a[108:111], a[248:251], v[140:143], 0
    s_waitcnt lgkmcnt(4)
    v_add_f32 v194, v194, v185
    v_cvt_pk_bf16_f32 v154, v184, v185
    v_mfma_f32_16x16x32_bf16 a[112:115], a[252:255], v[128:131], 0
    ds_read_b64_tr_b16 a[248:249], v210 offset:256
    v_add_f32 v194, v194, v186
    v_mfma_f32_16x16x32_bf16 a[116:119], a[252:255], v[132:135], 0
    ds_read_b64_tr_b16 a[250:251], v210 offset:6400
    v_add_f32 v194, v194, v187
    v_mfma_f32_16x16x32_bf16 a[120:123], a[252:255], v[136:139], 0
    v_cvt_pk_bf16_f32 v155, v186, v187
    v_add_f32 v195, v195, v188
    v_mfma_f32_16x16x32_bf16 a[124:127], a[252:255], v[140:143], 0
    s_waitcnt lgkmcnt(4)
    v_add_f32 v195, v195, v189
    v_cvt_pk_bf16_f32 v158, v188, v189
    v_mfma_f32_16x16x32_bf16 a[128:131], a[240:243], v[128:131], 0
    ds_read_b64_tr_b16 a[252:253], v211 offset:256
    v_add_f32 v195, v195, v190
    v_mfma_f32_16x16x32_bf16 a[132:135], a[240:243], v[132:135], 0
    ds_read_b64_tr_b16 a[254:255], v211 offset:6400
    v_add_f32 v195, v195, v191
    v_mfma_f32_16x16x32_bf16 a[136:139], a[240:243], v[136:139], 0
    v_cvt_pk_bf16_f32 v159, v190, v191
    v_max3_f32 v236, v192, v193, v194
    v_mfma_f32_16x16x32_bf16 a[140:143], a[240:243], v[140:143], 0
    s_waitcnt lgkmcnt(4)
    v_max_f32 v236, v236, v195
    v_cmp_nge_f32 vcc, s37, v236
    v_mfma_f32_16x16x32_bf16 a[144:147], a[244:247], v[128:131], 0
    v_mfma_f32_16x16x32_bf16 a[148:151], a[244:247], v[132:135], 0
    s_mov_b32 m0, s59
    v_mfma_f32_16x16x32_bf16 a[152:155], a[244:247], v[136:139], 0
    buffer_load_dwordx4 v225, s[64:67], s90 offen lds
    v_mfma_f32_16x16x32_bf16 a[156:159], a[244:247], v[140:143], 0
    s_waitcnt lgkmcnt(2)
    v_mfma_f32_16x16x32_bf16 a[160:163], a[248:251], v[128:131], 0
    s_add_u32 s90, s90, 32
    v_mfma_f32_16x16x32_bf16 a[164:167], a[248:251], v[132:135], 0
    s_cmp_eq_u32 s90, 320
    s_cselect_b32 s90, 0x40000000, s90
    v_mfma_f32_16x16x32_bf16 a[168:171], a[248:251], v[136:139], 0
    v_mfma_f32_16x16x32_bf16 a[172:175], a[248:251], v[140:143], 0
    s_waitcnt lgkmcnt(0)
    v_mfma_f32_16x16x32_bf16 a[176:179], a[252:255], v[128:131], 0
    v_mfma_f32_16x16x32_bf16 a[180:183], a[252:255], v[132:135], 0
    v_mfma_f32_16x16x32_bf16 a[184:187], a[252:255], v[136:139], 0
    v_mfma_f32_16x16x32_bf16 a[188:191], a[252:255], v[140:143], 0
    s_waitcnt vmcnt(10)
    s_cbranch_vccnz K2_rare_P0
K2_ret_P0:
    s_mov_b32 s35, 15
    .p2align 6
K2_loop:
    v_mfma_f32_16x16x32_bf16 v[96:99], a[192:195], v[0:3], v[160:163]
    s_barrier
    v_add_f32 v196, v196, v192
    v_add_f32 v197, v197, v193
    v_mfma_f32_16x16x32_bf16 v[96:99], a[196:199], v[4:7], v[96:99]
    ds_read_b128 a[216:219], v206 offset:30720
    s_add_u32 m0, s31, 12288
    v_mfma_f32_16x16x32_bf16 v[96:99], a[200:203], v[8:11], v[96:99]
    buffer_load_dwordx4 v200, s[16:19], s34 offen lds
    v_mfma_f32_16x16x32_bf16 v[96:99], a[204:207], v[12:15], v[96:99]
    ds_read_b128 a[220:223], v207 offset:30720
    s_add_u32 m0, s31, 13312
    v_mfma_f32_16x16x32_bf16 v[96:99], a[208:211], v[16:19], v[96:99]
    buffer_load_dwordx4 v201, s[16:19], s34 offen lds
    v_mfma_f32_16x16x32_bf16 v[96:99], a[212:215], v[20:23], v[96:99]
    ds_read_b128 a[224:227], v206 offset:30848
    s_add_u32 m0, s31, 14336
    v_mfma_f32_16x16x32_bf16 v[104:107], a[192:195], v[24:27], v[164:167]
    buffer_load_dwordx4 v202, s[16:19], s34 offen lds
    v_mfma_f32_16x16x32_bf16 v[104:107], a[196:199], v[28:31], v[104:107]
    ds_read_b128 a[228:231], v207 offset:30848
    s_add_u32 m0, s31, 49152
    v_mfma_f32_16x16x32_bf16 v[104:107], a[200:203], v[32:35], v[104:107]
    buffer_load_dwordx4 v203, s[20:23], s33 offen lds
    v_mfma_f32_16x16x32_bf16 v[104:107], a[204:207], v[36:39], v[104:107]
    ds_read_b128 a[232:235], v206 offset:30976
    v_add_f32 v198, v198, v194
    v_mfma_f32_16x16x32_bf16 v[104:107], a[208:211], v[40:43], v[104:107]
    v_exp_f32 v176, v96
    v_mfma_f32_16x16x32_bf16 v[104:107], a[212:215], v[44:47], v[104:107]
    v_exp_f32 v177, v97
    v_mfma_f32_16x16x32_bf16 v[112:115], a[192:195], v[48:51], v[168:171]
    v_exp_f32 v178, v98
    v_mfma_f32_16x16x32_bf16 v[112:115], a[196:199], v[52:55], v[112:115]
    v_exp_f32 v179, v99
    v_mfma_f32_16x16x32_bf16 v[112:115], a[200:203], v[56:59], v[112:115]
    ds_read_b128 a[236:239], v207 offset:30976
    s_add_u32 m0, s31, 50176
    v_mfma_f32_16x16x32_bf16 v[112:115], a[204:207], v[60:63], v[112:115]
    buffer_load_dwordx4 v204, s[20:23], s33 offen lds
    v_mfma_f32_16x16x32_bf16 v[112:115], a[208:211], v[64:67], v[112:115]
    v_exp_f32 v180, v104
    v_mfma_f32_16x16x32_bf16 v[112:115], a[212:215], v[68:71], v[112:115]
    v_exp_f32 v181, v105
    v_mfma_f32_16x16x32_bf16 v[120:123], a[192:195], v[72:75], v[172:175]
    v_exp_f32 v182, v106
    v_mfma_f32_16x16x32_bf16 v[120:123], a[196:199], v[76:79], v[120:123]
    v_exp_f32 v183, v107
    v_mfma_f32_16x16x32_bf16 v[120:123], a[200:203], v[80:83], v[120:123]
    s_add_u32 m0, s31, 51200
    v_add_f32 v199, v199, v195
    v_add_f32 v192, v176, v177
    v_mfma_f32_16x16x32_bf16 v[120:123], a[204:207], v[84:87], v[120:123]
    buffer_load_dwordx4 v205, s[20:23], s33 offen lds
    v_mfma_f32_16x16x32_bf16 v[120:123], a[208:211], v[88:91], v[120:123]
    s_add_u32 s34, s34, 12288
    v_exp_f32 v184, v112
    v_mfma_f32_16x16x32_bf16 v[120:123], a[212:215], v[92:95], v[120:123]
    s_waitcnt lgkmcnt(0)
    v_exp_f32 v185, v113
    v_mfma_f32_16x16x32_bf16 v[100:103], a[216:219], v[0:3], v[160:163]
    s_add_u32 s33, s33, 12288
    v_exp_f32 v186, v114
    v_mfma_f32_16x16x32_bf16 v[100:103], a[220:223], v[4:7], v[100:103]
    v_exp_f32 v187, v115
    v_mfma_f32_16x16x32_bf16 v[100:103], a[224:227], v[8:11], v[100:103]
    ds_read_b128 a[192:195], v206 offset:36864
    v_cvt_pk_bf16_f32 v128, v176, v177
    v_mfma_f32_16x16x32_bf16 v[100:103], a[228:231], v[12:15], v[100:103]
    ds_read_b128 a[196:199], v207 offset:36864
    v_add_f32 v192, v192, v178
    v_mfma_f32_16x16x32_bf16 v[100:103], a[232:235], v[16:19], v[100:103]
    v_exp_f32 v188, v120
    v_mfma_f32_16x16x32_bf16 v[100:103], a[236:239], v[20:23], v[100:103]
    v_exp_f32 v189, v121
    v_mfma_f32_16x16x32_bf16 v[108:111], a[216:219], v[24:27], v[164:167]
    v_exp_f32 v190, v122
    v_mfma_f32_16x16x32_bf16 v[108:111], a[220:223], v[28:31], v[108:111]
    v_exp_f32 v191, v123
    v_mfma_f32_16x16x32_bf16 v[108:111], a[224:227], v[32:35], v[108:111]
    ds_read_b128 a[200:203], v206 offset:36992
    v_add_f32 v192, v192, v179
    v_mfma_f32_16x16x32_bf16 v[108:111], a[228:231], v[36:39], v[108:111]
    ds_read_b128 a[204:207], v207 offset:36992
    v_cvt_pk_bf16_f32 v129, v178, v179
    v_mfma_f32_16x16x32_bf16 v[108:111], a[232:235], v[40:43], v[108:111]
    v_exp_f32 v176, v100
    v_mfma_f32_16x16x32_bf16 v[108:111], a[236:239], v[44:47], v[108:111]
    v_exp_f32 v177, v101
    v_mfma_f32_16x16x32_bf16 v[116:119], a[216:219], v[48:51], v[168:171]
    ds_read_b64_tr_b16 a[240:241], v208 offset:12288
    v_add_f32 v193, v180, v181
    v_mfma_f32_16x16x32_bf16 v[116:119], a[220:223], v[52:55], v[116:119]
    ds_read_b64_tr_b16 a[242:243], v208 offset:18432
    v_cvt_pk_bf16_f32 v132, v180, v181
    v_mfma_f32_16x16x32_bf16 v[116:119], a[224:227], v[56:59], v[116:119]
    ds_read_b128 a[208:211], v206 offset:37120
    v_add_f32 v193, v193, v182
    v_mfma_f32_16x16x32_bf16 v[116:119], a[228:231], v[60:63], v[116:119]
    ds_read_b128 a[212:215], v207 offset:37120
    v_add_f32 v193, v193, v183
    v_mfma_f32_16x16x32_bf16 v[116:119], a[232:235], v[64:67], v[116:119]
    ds_read_b64_tr_b16 a[244:245], v209 offset:12288
    v_cvt_pk_bf16_f32 v133, v182, v183
    v_mfma_f32_16x16x32_bf16 v[116:119], a[236:239], v[68:71], v[116:119]
    ds_read_b64_tr_b16 a[246:247], v209 offset:18432
    v_add_f32 v194, v184, v185
    v_mfma_f32_16x16x32_bf16 v[124:127], a[216:219], v[72:75], v[172:175]
    v_exp_f32 v178, v102
    v_mfma_f32_16x16x32_bf16 v[124:127], a[220:223], v[76:79], v[124:127]
    v_exp_f32 v179, v103
    v_mfma_f32_16x16x32_bf16 v[124:127], a[224:227], v[80:83], v[124:127]
    ds_read_b64_tr_b16 a[248:249], v210 offset:12288
    v_cvt_pk_bf16_f32 v136, v184, v185
    v_mfma_f32_16x16x32_bf16 v[124:127], a[228:231], v[84:87], v[124:127]
    ds_read_b64_tr_b16 a[250:251], v210 offset:18432
    v_add_f32 v194, v194, v186
    v_mfma_f32_16x16x32_bf16 v[124:127], a[232:235], v[88:91], v[124:127]
    v_exp_f32 v180, v108
    v_mfma_f32_16x16x32_bf16 v[124:127], a[236:239], v[92:95], v[124:127]
    s_waitcnt lgkmcnt(6)
    v_exp_f32 v181, v109
    v_mfma_f32_16x16x32_bf16 a[0:3], a[240:243], v[144:147], a[0:3]
    ds_read_b64_tr_b16 a[252:253], v211 offset:12288
    v_add_f32 v194, v194, v187
    v_mfma_f32_16x16x32_bf16 a[4:7], a[240:243], v[148:151], a[4:7]
    ds_read_b64_tr_b16 a[254:255], v211 offset:18432
    v_cvt_pk_bf16_f32 v137, v186, v187
    v_mfma_f32_16x16x32_bf16 a[8:11], a[240:243], v[152:155], a[8:11]
    v_exp_f32 v182, v110
    v_mfma_f32_16x16x32_bf16 a[12:15], a[240:243], v[156:159], a[12:15]
    s_waitcnt lgkmcnt(4)
    v_exp_f32 v183, v111
    v_mfma_f32_16x16x32_bf16 a[16:19], a[244:247], v[144:147], a[16:19]
    ds_read_b64_tr_b16 a[240:241], v208 offset:12416
    v_add_f32 v195, v188, v189
    v_mfma_f32_16x16x32_bf16 a[20:23], a[244:247], v[148:151], a[20:23]
    ds_read_b64_tr_b16 a[242:243], v208 offset:18560
    v_cvt_pk_bf16_f32 v140, v188, v189
    v_mfma_f32_16x16x32_bf16 a[24:27], a[244:247], v[152:155], a[24:27]
    v_exp_f32 v184, v116
    v_mfma_f32_16x16x32_bf16 a[28:31], a[244:247], v[156:159], a[28:31]
    s_waitcnt lgkmcnt(4)
    v_exp_f32 v185, v117
    v_mfma_f32_16x16x32_bf16 a[32:35], a[248:251], v[144:147], a[32:35]
    ds_read_b64_tr_b16 a[244:245], v209 offset:12416
    v_add_f32 v195, v195, v190
    v_mfma_f32_16x16x32_bf16 a[36:39], a[248:251], v[148:151], a[36:39]
    ds_read_b64_tr_b16 a[246:247], v209 offset:18560
    v_add_f32 v195, v195, v191
    v_mfma_f32_16x16x32_bf16 a[40:43], a[248:251], v[152:155], a[40:43]
    v_exp_f32 v186, v118
    v_mfma_f32_16x16x32_bf16 a[44:47], a[248:251], v[156:159], a[44:47]
    s_waitcnt lgkmcnt(4)
    v_exp_f32 v187, v119
    v_mfma_f32_16x16x32_bf16 a[48:51], a[252:255], v[144:147], a[48:51]
    ds_read_b64_tr_b16 a[248:249], v210 offset:12416
    v_cvt_pk_bf16_f32 v141, v190, v191
    v_mfma_f32_16x16x32_bf16 a[52:55], a[252:255], v[148:151], a[52:55]
    ds_read_b64_tr_b16 a[250:251], v210 offset:18560
    v_add_f32 v192, v192, v176
    v_mfma_f32_16x16x32_bf16 a[56:59], a[252:255], v[152:155], a[56:59]
    v_exp_f32 v188, v124
    v_mfma_f32_16x16x32_bf16 a[60:63], a[252:255], v[156:159], a[60:63]
    s_waitcnt lgkmcnt(4)
    v_exp_f32 v189, v125
    v_mfma_f32_16x16x32_bf16 a[64:67], a[240:243], v[144:147], a[64:67]
    ds_read_b64_tr_b16 a[252:253], v211 offset:12416
    v_add_f32 v192, v192, v177
    v_mfma_f32_16x16x32_bf16 a[68:71], a[240:243], v[148:151], a[68:71]
    ds_read_b64_tr_b16 a[254:255], v211 offset:18560
    v_cvt_pk_bf16_f32 v130, v176, v177
    v_mfma_f32_16x16x32_bf16 a[72:75], a[240:243], v[152:155], a[72:75]
    v_exp_f32 v190, v126
    v_mfma_f32_16x16x32_bf16 a[76:79], a[240:243], v[156:159], a[76:79]
    s_waitcnt lgkmcnt(4)
    v_exp_f32 v191, v127
    v_mfma_f32_16x16x32_bf16 a[80:83], a[244:247], v[144:147], a[80:83]
    ds_read_b64_tr_b16 a[240:241], v208 offset:12544
    v_add_f32 v192, v192, v178
    v_mfma_f32_16x16x32_bf16 a[84:87], a[244:247], v[148:151], a[84:87]
    ds_read_b64_tr_b16 a[242:243], v208 offset:18688
    v_add_f32 v192, v192, v179
    v_mfma_f32_16x16x32_bf16 a[88:91], a[244:247], v[152:155], a[88:91]
    v_cvt_pk_bf16_f32 v131, v178, v179
    v_add_f32 v193, v193, v180
    v_mfma_f32_16x16x32_bf16 a[92:95], a[244:247], v[156:159], a[92:95]
    s_waitcnt lgkmcnt(4)
    v_add_f32 v193, v193, v181
    v_cvt_pk_bf16_f32 v134, v180, v181
    v_mfma_f32_16x16x32_bf16 a[96:99], a[248:251], v[144:147], a[96:99]
    ds_read_b64_tr_b16 a[244:245], v209 offset:12544
    v_add_f32 v193, v193, v182
    v_mfma_f32_16x16x32_bf16 a[100:103], a[248:251], v[148:151], a[100:103]
    ds_read_b64_tr_b16 a[246:247], v209 offset:18688
    v_add_f32 v193, v193, v183
    v_mfma_f32_16x16x32_bf16 a[104:107], a[248:251], v[152:155], a[104:107]
    v_cvt_pk_bf16_f32 v135, v182, v183
    v_add_f32 v194, v194, v184
    v_mfma_f32_16x16x32_bf16 a[108:111], a[248:251], v[156:159], a[108:111]
    s_waitcnt lgkmcnt(4)
    v_add_f32 v194, v194, v185
    v_cvt_pk_bf16_f32 v138, v184, v185
    v_mfma_f32_16x16x32_bf16 a[112:115], a[252:255], v[144:147], a[112:115]
    ds_read_b64_tr_b16 a[248:249], v210 offset:12544
    v_add_f32 v194, v194, v186
    v_mfma_f32_16x16x32_bf16 a[116:119], a[252:255], v[148:151], a[116:119]
    ds_read_b64_tr_b16 a[250:251], v210 offset:18688
    v_add_f32 v194, v194, v187
    v_mfma_f32_16x16x32_bf16 a[120:123], a[252:255], v[152:155], a[120:123]
    v_cvt_pk_bf16_f32 v139, v186, v187
    v_add_f32 v195, v195, v188
    v_mfma_f32_16x16x32_bf16 a[124:127], a[252:255], v[156:159], a[124:127]
    s_waitcnt lgkmcnt(4)
    v_add_f32 v195, v195, v189
    v_cvt_pk_bf16_f32 v142, v188, v189
    v_mfma_f32_16x16x32_bf16 a[128:131], a[240:243], v[144:147], a[128:131]
    ds_read_b64_tr_b16 a[252:253], v211 offset:12544
    v_add_f32 v195, v195, v190
    v_mfma_f32_16x16x32_bf16 a[132:135], a[240:243], v[148:151], a[132:135]
    ds_read_b64_tr_b16 a[254:255], v211 offset:18688
    v_add_f32 v195, v195, v191
    v_mfma_f32_16x16x32_bf16 a[136:139], a[240:243], v[152:155], a[136:139]
    v_cvt_pk_bf16_f32 v143, v190, v191
    v_max3_f32 v236, v192, v193, v194
    v_mfma_f32_16x16x32_bf16 a[140:143], a[240:243], v[156:159], a[140:143]
    s_waitcnt lgkmcnt(4)
    v_max_f32 v236, v236, v195
    v_cmp_nge_f32 vcc, s37, v236
    v_mfma_f32_16x16x32_bf16 a[144:147], a[244:247], v[144:147], a[144:147]
    v_mfma_f32_16x16x32_bf16 a[148:151], a[244:247], v[148:151], a[148:151]
    v_mfma_f32_16x16x32_bf16 a[152:155], a[244:247], v[152:155], a[152:155]
    buffer_store_dwordx4 v[228:231], v212, s[44:47], s48 offen sc1
    v_mfma_f32_16x16x32_bf16 a[156:159], a[244:247], v[156:159], a[156:159]
    s_waitcnt lgkmcnt(2)
    v_mfma_f32_16x16x32_bf16 a[160:163], a[248:251], v[144:147], a[160:163]
    s_add_u32 s48, s48, 1024
    v_mfma_f32_16x16x32_bf16 a[164:167], a[248:251], v[148:151], a[164:167]
    v_mfma_f32_16x16x32_bf16 a[168:171], a[248:251], v[152:155], a[168:171]
    v_mfma_f32_16x16x32_bf16 a[172:175], a[248:251], v[156:159], a[172:175]
    s_waitcnt lgkmcnt(0)
    v_mfma_f32_16x16x32_bf16 a[176:179], a[252:255], v[144:147], a[176:179]
    v_mfma_f32_16x16x32_bf16 a[180:183], a[252:255], v[148:151], a[180:183]
    v_mfma_f32_16x16x32_bf16 a[184:187], a[252:255], v[152:155], a[184:187]
    v_mfma_f32_16x16x32_bf16 a[188:191], a[252:255], v[156:159], a[188:191]
    s_waitcnt vmcnt(10)
    s_cbranch_vccnz K2_rare_L0
K2_ret_L0:
    v_mfma_f32_16x16x32_bf16 v[96:99], a[192:195], v[0:3], v[160:163]
    s_barrier
    v_add_f32 v196, v196, v192
    v_add_f32 v197, v197, v193
    v_mfma_f32_16x16x32_bf16 v[96:99], a[196:199], v[4:7], v[96:99]
    ds_read_b128 a[216:219], v206 offset:43008
    s_add_u32 m0, s31, 24576
    v_mfma_f32_16x16x32_bf16 v[96:99], a[200:203], v[8:11], v[96:99]
    buffer_load_dwordx4 v200, s[16:19], s34 offen lds
    v_mfma_f32_16x16x32_bf16 v[96:99], a[204:207], v[12:15], v[96:99]
    ds_read_b128 a[220:223], v207 offset:43008
    s_add_u32 m0, s31, 25600
    v_mfma_f32_16x16x32_bf16 v[96:99], a[208:211], v[16:19], v[96:99]
    buffer_load_dwordx4 v201, s[16:19], s34 offen lds
    v_mfma_f32_16x16x32_bf16 v[96:99], a[212:215], v[20:23], v[96:99]
    ds_read_b128 a[224:227], v206 offset:43136
    s_add_u32 m0, s31, 26624
    v_mfma_f32_16x16x32_bf16 v[104:107], a[192:195], v[24:27], v[164:167]
    buffer_load_dwordx4 v202, s[16:19], s34 offen lds
    v_mfma_f32_16x16x32_bf16 v[104:107], a[196:199], v[28:31], v[104:107]
    ds_read_b128 a[228:231], v207 offset:43136
    s_add_u32 m0, s31, 61440
    v_mfma_f32_16x16x32_bf16 v[104:107], a[200:203], v[32:35], v[104:107]
    buffer_load_dwordx4 v203, s[20:23], s33 offen lds
    v_mfma_f32_16x16x32_bf16 v[104:107], a[204:207], v[36:39], v[104:107]
    ds_read_b128 a[232:235], v206 offset:43264
    v_add_f32 v198, v198, v194
    v_mfma_f32_16x16x32_bf16 v[104:107], a[208:211], v[40:43], v[104:107]
    v_exp_f32 v176, v96
    v_mfma_f32_16x16x32_bf16 v[104:107], a[212:215], v[44:47], v[104:107]
    v_exp_f32 v177, v97
    v_mfma_f32_16x16x32_bf16 v[112:115], a[192:195], v[48:51], v[168:171]
    v_exp_f32 v178, v98
    v_mfma_f32_16x16x32_bf16 v[112:115], a[196:199], v[52:55], v[112:115]
    v_exp_f32 v179, v99
    v_mfma_f32_16x16x32_bf16 v[112:115], a[200:203], v[56:59], v[112:115]
    ds_read_b128 a[236:239], v207 offset:43264
    s_add_u32 m0, s31, 62464
    v_mfma_f32_16x16x32_bf16 v[112:115], a[204:207], v[60:63], v[112:115]
    buffer_load_dwordx4 v204, s[20:23], s33 offen lds
    v_mfma_f32_16x16x32_bf16 v[112:115], a[208:211], v[64:67], v[112:115]
    v_exp_f32 v180, v104
    v_mfma_f32_16x16x32_bf16 v[112:115], a[212:215], v[68:71], v[112:115]
    v_exp_f32 v181, v105
    v_mfma_f32_16x16x32_bf16 v[120:123], a[192:195], v[72:75], v[172:175]
    v_exp_f32 v182, v106
    v_mfma_f32_16x16x32_bf16 v[120:123], a[196:199], v[76:79], v[120:123]
    v_exp_f32 v183, v107
    v_mfma_f32_16x16x32_bf16 v[120:123], a[200:203], v[80:83], v[120:123]
    s_add_u32 m0, s31, 63488
    v_add_f32 v199, v199, v195
    v_add_f32 v192, v176, v177
    v_mfma_f32_16x16x32_bf16 v[120:123], a[204:207], v[84:87], v[120:123]
    buffer_load_dwordx4 v205, s[20:23], s33 offen lds
    v_mfma_f32_16x16x32_bf16 v[120:123], a[208:211], v[88:91], v[120:123]
    s_add_u32 s34, s34, 12288
    v_exp_f32 v184, v112
    v_mfma_f32_16x16x32_bf16 v[120:123], a[212:215], v[92:95], v[120:123]
    s_waitcnt lgkmcnt(0)
    v_exp_f32 v185, v113
    v_mfma_f32_16x16x32_bf16 v[100:103], a[216:219], v[0:3], v[160:163]
    s_add_u32 s33, s33, 12288
    v_exp_f32 v186, v114
    v_mfma_f32_16x16x32_bf16 v[100:103], a[220:223], v[4:7], v[100:103]
    v_exp_f32 v187, v115
    v_mfma_f32_16x16x32_bf16 v[100:103], a[224:227], v[8:11], v[100:103]
    ds_read_b128 a[192:195], v206 offset:0
    v_cvt_pk_bf16_f32 v144, v176, v177
    v_mfma_f32_16x16x32_bf16 v[100:103], a[228:231], v[12:15], v[100:103]
    ds_read_b128 a[196:199], v207 offset:0
    v_add_f32 v192, v192, v178
    v_mfma_f32_16x16x32_bf16 v[100:103], a[232:235], v[16:19], v[100:103]
    v_exp_f32 v188, v120
    v_mfma_f32_16x16x32_bf16 v[100:103], a[236:239], v[20:23], v[100:103]
    v_exp_f32 v189, v121
    v_mfma_f32_16x16x32_bf16 v[108:111], a[216:219], v[24:27], v[164:167]
    v_exp_f32 v190, v122
    v_mfma_f32_16x16x32_bf16 v[108:111], a[220:223], v[28:31], v[108:111]
    v_exp_f32 v191, v123
    v_mfma_f32_16x16x32_bf16 v[108:111], a[224:227], v[32:35], v[108:111]
    ds_read_b128 a[200:203], v206 offset:128
    v_add_f32 v192, v192, v179
    v_mfma_f32_16x16x32_bf16 v[108:111], a[228:231], v[36:39], v[108:111]
    ds_read_b128 a[204:207], v207 offset:128
    v_cvt_pk_bf16_f32 v145, v178, v179
    v_mfma_f32_16x16x32_bf16 v[108:111], a[232:235], v[40:43], v[108:111]
    v_exp_f32 v176, v100
    v_mfma_f32_16x16x32_bf16 v[108:111], a[236:239], v[44:47], v[108:111]
    v_exp_f32 v177, v101
    v_mfma_f32_16x16x32_bf16 v[116:119], a[216:219], v[48:51], v[168:171]
    ds_read_b64_tr_b16 a[240:241], v208 offset:24576
    v_add_f32 v193, v180, v181
    v_mfma_f32_16x16x32_bf16 v[116:119], a[220:223], v[52:55], v[116:119]
    ds_read_b64_tr_b16 a[242:243], v208 offset:30720
    v_cvt_pk_bf16_f32 v148, v180, v181
    v_mfma_f32_16x16x32_bf16 v[116:119], a[224:227], v[56:59], v[116:119]
    ds_read_b128 a[208:211], v206 offset:256
    v_add_f32 v193, v193, v182
    v_mfma_f32_16x16x32_bf16 v[116:119], a[228:231], v[60:63], v[116:119]
    ds_read_b128 a[212:215], v207 offset:256
    v_add_f32 v193, v193, v183
    v_mfma_f32_16x16x32_bf16 v[116:119], a[232:235], v[64:67], v[116:119]
    ds_read_b64_tr_b16 a[244:245], v209 offset:24576
    v_cvt_pk_bf16_f32 v149, v182, v183
    v_mfma_f32_16x16x32_bf16 v[116:119], a[236:239], v[68:71], v[116:119]
    ds_read_b64_tr_b16 a[246:247], v209 offset:30720
    v_add_f32 v194, v184, v185
    v_mfma_f32_16x16x32_bf16 v[124:127], a[216:219], v[72:75], v[172:175]
    v_exp_f32 v178, v102
    v_mfma_f32_16x16x32_bf16 v[124:127], a[220:223], v[76:79], v[124:127]
    v_exp_f32 v179, v103
    v_mfma_f32_16x16x32_bf16 v[124:127], a[224:227], v[80:83], v[124:127]
    ds_read_b64_tr_b16 a[248:249], v210 offset:24576
    v_cvt_pk_bf16_f32 v152, v184, v185
    v_mfma_f32_16x16x32_bf16 v[124:127], a[228:231], v[84:87], v[124:127]
    ds_read_b64_tr_b16 a[250:251], v210 offset:30720
    v_add_f32 v194, v194, v186
    v_mfma_f32_16x16x32_bf16 v[124:127], a[232:235], v[88:91], v[124:127]
    v_exp_f32 v180, v108
    v_mfma_f32_16x16x32_bf16 v[124:127], a[236:239], v[92:95], v[124:127]
    s_waitcnt lgkmcnt(6)
    v_exp_f32 v181, v109
    v_mfma_f32_16x16x32_bf16 a[0:3], a[240:243], v[128:131], a[0:3]
    ds_read_b64_tr_b16 a[252:253], v211 offset:24576
    v_add_f32 v194, v194, v187
    v_mfma_f32_16x16x32_bf16 a[4:7], a[240:243], v[132:135], a[4:7]
    ds_read_b64_tr_b16 a[254:255], v211 offset:30720
    v_cvt_pk_bf16_f32 v153, v186, v187
    v_mfma_f32_16x16x32_bf16 a[8:11], a[240:243], v[136:139], a[8:11]
    v_exp_f32 v182, v110
    v_mfma_f32_16x16x32_bf16 a[12:15], a[240:243], v[140:143], a[12:15]
    s_waitcnt lgkmcnt(4)
    v_exp_f32 v183, v111
    v_mfma_f32_16x16x32_bf16 a[16:19], a[244:247], v[128:131], a[16:19]
    ds_read_b64_tr_b16 a[240:241], v208 offset:24704
    v_add_f32 v195, v188, v189
    v_mfma_f32_16x16x32_bf16 a[20:23], a[244:247], v[132:135], a[20:23]
    ds_read_b64_tr_b16 a[242:243], v208 offset:30848
    v_cvt_pk_bf16_f32 v156, v188, v189
    v_mfma_f32_16x16x32_bf16 a[24:27], a[244:247], v[136:139], a[24:27]
    v_exp_f32 v184, v116
    v_mfma_f32_16x16x32_bf16 a[28:31], a[244:247], v[140:143], a[28:31]
    s_waitcnt lgkmcnt(4)
    v_exp_f32 v185, v117
    v_mfma_f32_16x16x32_bf16 a[32:35], a[248:251], v[128:131], a[32:35]
    ds_read_b64_tr_b16 a[244:245], v209 offset:24704
    v_add_f32 v195, v195, v190
    v_mfma_f32_16x16x32_bf16 a[36:39], a[248:251], v[132:135], a[36:39]
    ds_read_b64_tr_b16 a[246:247], v209 offset:30848
    v_add_f32 v195, v195, v191
    v_mfma_f32_16x16x32_bf16 a[40:43], a[248:251], v[136:139], a[40:43]
    v_exp_f32 v186, v118
    v_mfma_f32_16x16x32_bf16 a[44:47], a[248:251], v[140:143], a[44:47]
    s_waitcnt lgkmcnt(4)
    v_exp_f32 v187, v119
    v_mfma_f32_16x16x32_bf16 a[48:51], a[252:255], v[128:131], a[48:51]
    ds_read_b64_tr_b16 a[248:249], v210 offset:24704
    v_cvt_pk_bf16_f32 v157, v190, v191
    v_mfma_f32_16x16x32_bf16 a[52:55], a[252:255], v[132:135], a[52:55]
    ds_read_b64_tr_b16 a[250:251], v210 offset:30848
    v_add_f32 v192, v192, v176
    v_mfma_f32_16x16x32_bf16 a[56:59], a[252:255], v[136:139], a[56:59]
    v_exp_f32 v188, v124
    v_mfma_f32_16x16x32_bf16 a[60:63], a[252:255], v[140:143], a[60:63]
    s_waitcnt lgkmcnt(4)
    v_exp_f32 v189, v125
    v_mfma_f32_16x16x32_bf16 a[64:67], a[240:243], v[128:131], a[64:67]
    ds_read_b64_tr_b16 a[252:253], v211 offset:24704
    v_add_f32 v192, v192, v177
    v_mfma_f32_16x16x32_bf16 a[68:71], a[240:243], v[132:135], a[68:71]
    ds_read_b64_tr_b16 a[254:255], v211 offset:30848
    v_cvt_pk_bf16_f32 v146, v176, v177
    v_mfma_f32_16x16x32_bf16 a[72:75], a[240:243], v[136:139], a[72:75]
    v_exp_f32 v190, v126
    v_mfma_f32_16x16x32_bf16 a[76:79], a[240:243], v[140:143], a[76:79]
    s_waitcnt lgkmcnt(4)
    v_exp_f32 v191, v127
    v_mfma_f32_16x16x32_bf16 a[80:83], a[244:247], v[128:131], a[80:83]
    ds_read_b64_tr_b16 a[240:241], v208 offset:24832
    v_add_f32 v192, v192, v178
    v_mfma_f32_16x16x32_bf16 a[84:87], a[244:247], v[132:135], a[84:87]
    ds_read_b64_tr_b16 a[242:243], v208 offset:30976
    v_add_f32 v192, v192, v179
    v_mfma_f32_16x16x32_bf16 a[88:91], a[244:247], v[136:139], a[88:91]
    v_cvt_pk_bf16_f32 v147, v178, v179
    v_add_f32 v193, v193, v180
    v_mfma_f32_16x16x32_bf16 a[92:95], a[244:247], v[140:143], a[92:95]
    s_waitcnt lgkmcnt(4)
    v_add_f32 v193, v193, v181
    v_cvt_pk_bf16_f32 v150, v180, v181
    v_mfma_f32_16x16x32_bf16 a[96:99], a[248:251], v[128:131], a[96:99]
    ds_read_b64_tr_b16 a[244:245], v209 offset:24832
    v_add_f32 v193, v193, v182
    v_mfma_f32_16x16x32_bf16 a[100:103], a[248:251], v[132:135], a[100:103]
    ds_read_b64_tr_b16 a[246:247], v209 offset:30976
    v_add_f32 v193, v193, v183
    v_mfma_f32_16x16x32_bf16 a[104:107], a[248:251], v[136:139], a[104:107]
    v_cvt_pk_bf16_f32 v151, v182, v183
    v_add_f32 v194, v194, v184
    v_mfma_f32_16x16x32_bf16 a[108:111], a[248:251], v[140:143], a[108:111]
    s_waitcnt lgkmcnt(4)
    v_add_f32 v194, v194, v185
    v_cvt_pk_bf16_f32 v154, v184, v185
    v_mfma_f32_16x16x32_bf16 a[112:115], a[252:255], v[128:131], a[112:115]
    ds_read_b64_tr_b16 a[248:249], v210 offset:24832
    v_add_f32 v194, v194, v186
    v_mfma_f32_16x16x32_bf16 a[116:119], a[252:255], v[132:135], a[116:119]
    ds_read_b64_tr_b16 a[250:251], v210 offset:30976
    v_add_f32 v194, v194, v187
    v_mfma_f32_16x16x32_bf16 a[120:123], a[252:255], v[136:139], a[120:123]
    v_cvt_pk_bf16_f32 v155, v186, v187
    v_add_f32 v195, v195, v188
    v_mfma_f32_16x16x32_bf16 a[124:127], a[252:255], v[140:143], a[124:127]
    s_waitcnt lgkmcnt(4)
    v_add_f32 v195, v195, v189
    v_cvt_pk_bf16_f32 v158, v188, v189
    v_mfma_f32_16x16x32_bf16 a[128:131], a[240:243], v[128:131], a[128:131]
    ds_read_b64_tr_b16 a[252:253], v211 offset:24832
    v_add_f32 v195, v195, v190
    v_mfma_f32_16x16x32_bf16 a[132:135], a[240:243], v[132:135], a[132:135]
    ds_read_b64_tr_b16 a[254:255], v211 offset:30976
    v_add_f32 v195, v195, v191
    v_mfma_f32_16x16x32_bf16 a[136:139], a[240:243], v[136:139], a[136:139]
    v_cvt_pk_bf16_f32 v159, v190, v191
    v_max3_f32 v236, v192, v193, v194
    v_mfma_f32_16x16x32_bf16 a[140:143], a[240:243], v[140:143], a[140:143]
    s_waitcnt lgkmcnt(4)
    v_max_f32 v236, v236, v195
    v_cmp_nge_f32 vcc, s37, v236
    v_mfma_f32_16x16x32_bf16 a[144:147], a[244:247], v[128:131], a[144:147]
    s_sub_u32 s40, s35, 3
    v_mfma_f32_16x16x32_bf16 a[148:151], a[244:247], v[132:135], a[148:151]
    s_lshl_b32 s40, s40, 16
    s_add_u32 s40, s40, s81
    v_mfma_f32_16x16x32_bf16 a[152:155], a[244:247], v[136:139], a[152:155]
    buffer_store_dword v217, v249, s[72:75], s40 offen sc1
    v_mfma_f32_16x16x32_bf16 a[156:159], a[244:247], v[140:143], a[156:159]
    s_waitcnt vmcnt(13)
    s_waitcnt lgkmcnt(2)
    v_mfma_f32_16x16x32_bf16 a[160:163], a[248:251], v[128:131], a[160:163]
    ds_read_b64_tr_b16 v[232:233], v226
    v_mfma_f32_16x16x32_bf16 a[164:167], a[248:251], v[132:135], a[164:167]
    ds_read_b64_tr_b16 v[234:235], v253
    v_mfma_f32_16x16x32_bf16 a[168:171], a[248:251], v[136:139], a[168:171]
    v_mfma_f32_16x16x32_bf16 a[172:175], a[248:251], v[140:143], a[172:175]
    s_waitcnt lgkmcnt(2)
    v_mfma_f32_16x16x32_bf16 a[176:179], a[252:255], v[128:131], a[176:179]
    v_mfma_f32_16x16x32_bf16 a[180:183], a[252:255], v[132:135], a[180:183]
    v_mfma_f32_16x16x32_bf16 a[184:187], a[252:255], v[136:139], a[184:187]
    v_mfma_f32_16x16x32_bf16 a[188:191], a[252:255], v[140:143], a[188:191]
    s_waitcnt vmcnt(10)
    s_cbranch_vccnz K2_rare_L1
K2_ret_L1:
    v_mfma_f32_16x16x32_bf16 v[96:99], a[192:195], v[0:3], v[160:163]
    s_barrier
    v_add_f32 v196, v196, v192
    v_add_f32 v197, v197, v193
    v_mfma_f32_16x16x32_bf16 v[96:99], a[196:199], v[4:7], v[96:99]
    ds_read_b128 a[216:219], v206 offset:6144
    s_add_u32 m0, s31, 36864
    v_mfma_f32_16x16x32_bf16 v[96:99], a[200:203], v[8:11], v[96:99]
    buffer_load_dwordx4 v200, s[16:19], s34 offen lds
    v_mfma_f32_16x16x32_bf16 v[96:99], a[204:207], v[12:15], v[96:99]
    ds_read_b128 a[220:223], v207 offset:6144
    s_add_u32 m0, s31, 37888
    v_mfma_f32_16x16x32_bf16 v[96:99], a[208:211], v[16:19], v[96:99]
    buffer_load_dwordx4 v201, s[16:19], s34 offen lds
    v_mfma_f32_16x16x32_bf16 v[96:99], a[212:215], v[20:23], v[96:99]
    ds_read_b128 a[224:227], v206 offset:6272
    s_add_u32 m0, s31, 38912
    v_mfma_f32_16x16x32_bf16 v[104:107], a[192:195], v[24:27], v[164:167]
    buffer_load_dwordx4 v202, s[16:19], s34 offen lds
    v_mfma_f32_16x16x32_bf16 v[104:107], a[196:199], v[28:31], v[104:107]
    ds_read_b128 a[228:231], v207 offset:6272
    s_add_u32 m0, s31, 73728
    v_mfma_f32_16x16x32_bf16 v[104:107], a[200:203], v[32:35], v[104:107]
    buffer_load_dwordx4 v203, s[20:23], s33 offen lds
    v_mfma_f32_16x16x32_bf16 v[104:107], a[204:207], v[36:39], v[104:107]
    ds_read_b128 a[232:235], v206 offset:6400
    v_add_f32 v198, v198, v194
    v_mfma_f32_16x16x32_bf16 v[104:107], a[208:211], v[40:43], v[104:107]
    v_exp_f32 v176, v96
    v_mfma_f32_16x16x32_bf16 v[104:107], a[212:215], v[44:47], v[104:107]
    v_exp_f32 v177, v97
    v_mfma_f32_16x16x32_bf16 v[112:115], a[192:195], v[48:51], v[168:171]
    v_exp_f32 v178, v98
    v_mfma_f32_16x16x32_bf16 v[112:115], a[196:199], v[52:55], v[112:115]
    v_exp_f32 v179, v99
    v_mfma_f32_16x16x32_bf16 v[112:115], a[200:203], v[56:59], v[112:115]
    ds_read_b128 a[236:239], v207 offset:6400
    s_add_u32 m0, s31, 74752
    v_mfma_f32_16x16x32_bf16 v[112:115], a[204:207], v[60:63], v[112:115]
    buffer_load_dwordx4 v204, s[20:23], s33 offen lds
    v_mfma_f32_16x16x32_bf16 v[112:115], a[208:211], v[64:67], v[112:115]
    v_exp_f32 v180, v104
    v_mfma_f32_16x16x32_bf16 v[112:115], a[212:215], v[68:71], v[112:115]
    v_exp_f32 v181, v105
    v_mfma_f32_16x16x32_bf16 v[120:123], a[192:195], v[72:75], v[172:175]
    v_exp_f32 v182, v106
    v_mfma_f32_16x16x32_bf16 v[120:123], a[196:199], v[76:79], v[120:123]
    v_exp_f32 v183, v107
    v_mfma_f32_16x16x32_bf16 v[120:123], a[200:203], v[80:83], v[120:123]
    s_add_u32 m0, s31, 75776
    v_add_f32 v199, v199, v195
    v_add_f32 v192, v176, v177
    v_mfma_f32_16x16x32_bf16 v[120:123], a[204:207], v[84:87], v[120:123]
    buffer_load_dwordx4 v205, s[20:23], s33 offen lds
    v_mfma_f32_16x16x32_bf16 v[120:123], a[208:211], v[88:91], v[120:123]
    s_add_u32 s34, s34, 12288
    v_exp_f32 v184, v112
    v_mfma_f32_16x16x32_bf16 v[120:123], a[212:215], v[92:95], v[120:123]
    s_waitcnt lgkmcnt(0)
    v_exp_f32 v185, v113
    v_mfma_f32_16x16x32_bf16 v[100:103], a[216:219], v[0:3], v[160:163]
    s_add_u32 s33, s33, 12288
    v_exp_f32 v186, v114
    v_mfma_f32_16x16x32_bf16 v[100:103], a[220:223], v[4:7], v[100:103]
    v_exp_f32 v187, v115
    v_mfma_f32_16x16x32_bf16 v[100:103], a[224:227], v[8:11], v[100:103]
    ds_read_b128 a[192:195], v206 offset:12288
    v_cvt_pk_bf16_f32 v128, v176, v177
    v_mfma_f32_16x16x32_bf16 v[100:103], a[228:231], v[12:15], v[100:103]
    ds_read_b128 a[196:199], v207 offset:12288
    v_add_f32 v192, v192, v178
    v_mfma_f32_16x16x32_bf16 v[100:103], a[232:235], v[16:19], v[100:103]
    v_exp_f32 v188, v120
    v_mfma_f32_16x16x32_bf16 v[100:103], a[236:239], v[20:23], v[100:103]
    v_exp_f32 v189, v121
    v_mfma_f32_16x16x32_bf16 v[108:111], a[216:219], v[24:27], v[164:167]
    v_exp_f32 v190, v122
    v_mfma_f32_16x16x32_bf16 v[108:111], a[220:223], v[28:31], v[108:111]
    v_exp_f32 v191, v123
    v_mfma_f32_16x16x32_bf16 v[108:111], a[224:227], v[32:35], v[108:111]
    ds_read_b128 a[200:203], v206 offset:12416
    v_add_f32 v192, v192, v179
    v_mfma_f32_16x16x32_bf16 v[108:111], a[228:231], v[36:39], v[108:111]
    ds_read_b128 a[204:207], v207 offset:12416
    v_cvt_pk_bf16_f32 v129, v178, v179
    v_mfma_f32_16x16x32_bf16 v[108:111], a[232:235], v[40:43], v[108:111]
    v_exp_f32 v176, v100
    v_mfma_f32_16x16x32_bf16 v[108:111], a[236:239], v[44:47], v[108:111]
    v_exp_f32 v177, v101
    v_mfma_f32_16x16x32_bf16 v[116:119], a[216:219], v[48:51], v[168:171]
    ds_read_b64_tr_b16 a[240:241], v208 offset:36864
    v_add_f32 v193, v180, v181
    v_mfma_f32_16x16x32_bf16 v[116:119], a[220:223], v[52:55], v[116:119]
    ds_read_b64_tr_b16 a[242:243], v208 offset:43008
    v_cvt_pk_bf16_f32 v132, v180, v181
    v_mfma_f32_16x16x32_bf16 v[116:119], a[224:227], v[56:59], v[116:119]
    ds_read_b128 a[208:211], v206 offset:12544
    v_add_f32 v193, v193, v182
    v_mfma_f32_16x16x32_bf16 v[116:119], a[228:231], v[60:63], v[116:119]
    ds_read_b128 a[212:215], v207 offset:12544
    v_add_f32 v193, v193, v183
    v_mfma_f32_16x16x32_bf16 v[116:119], a[232:235], v[64:67], v[116:119]
    ds_read_b64_tr_b16 a[244:245], v209 offset:36864
    v_cvt_pk_bf16_f32 v133, v182, v183
    v_mfma_f32_16x16x32_bf16 v[116:119], a[236:239], v[68:71], v[116:119]
    ds_read_b64_tr_b16 a[246:247], v209 offset:43008
    v_add_f32 v194, v184, v185
    v_mfma_f32_16x16x32_bf16 v[124:127], a[216:219], v[72:75], v[172:175]
    v_exp_f32 v178, v102
    v_mfma_f32_16x16x32_bf16 v[124:127], a[220:223], v[76:79], v[124:127]
    v_exp_f32 v179, v103
    v_mfma_f32_16x16x32_bf16 v[124:127], a[224:227], v[80:83], v[124:127]
    ds_read_b64_tr_b16 a[248:249], v210 offset:36864
    v_cvt_pk_bf16_f32 v136, v184, v185
    v_mfma_f32_16x16x32_bf16 v[124:127], a[228:231], v[84:87], v[124:127]
    ds_read_b64_tr_b16 a[250:251], v210 offset:43008
    v_add_f32 v194, v194, v186
    v_mfma_f32_16x16x32_bf16 v[124:127], a[232:235], v[88:91], v[124:127]
    v_exp_f32 v180, v108
    v_mfma_f32_16x16x32_bf16 v[124:127], a[236:239], v[92:95], v[124:127]
    s_waitcnt lgkmcnt(6)
    v_exp_f32 v181, v109
    v_mfma_f32_16x16x32_bf16 a[0:3], a[240:243], v[144:147], a[0:3]
    ds_read_b64_tr_b16 a[252:253], v211 offset:36864
    v_add_f32 v194, v194, v187
    v_mfma_f32_16x16x32_bf16 a[4:7], a[240:243], v[148:151], a[4:7]
    ds_read_b64_tr_b16 a[254:255], v211 offset:43008
    v_cvt_pk_bf16_f32 v137, v186, v187
    v_mfma_f32_16x16x32_bf16 a[8:11], a[240:243], v[152:155], a[8:11]
    v_exp_f32 v182, v110
    v_mfma_f32_16x16x32_bf16 a[12:15], a[240:243], v[156:159], a[12:15]
    s_waitcnt lgkmcnt(4)
    v_exp_f32 v183, v111
    v_mfma_f32_16x16x32_bf16 a[16:19], a[244:247], v[144:147], a[16:19]
    ds_read_b64_tr_b16 a[240:241], v208 offset:36992
    v_add_f32 v195, v188, v189
    v_mfma_f32_16x16x32_bf16 a[20:23], a[244:247], v[148:151], a[20:23]
    ds_read_b64_tr_b16 a[242:243], v208 offset:43136
    v_cvt_pk_bf16_f32 v140, v188, v189
    v_mfma_f32_16x16x32_bf16 a[24:27], a[244:247], v[152:155], a[24:27]
    v_exp_f32 v184, v116
    v_mfma_f32_16x16x32_bf16 a[28:31], a[244:247], v[156:159], a[28:31]
    s_waitcnt lgkmcnt(4)
    v_exp_f32 v185, v117
    v_mfma_f32_16x16x32_bf16 a[32:35], a[248:251], v[144:147], a[32:35]
    ds_read_b64_tr_b16 a[244:245], v209 offset:36992
    v_add_f32 v195, v195, v190
    v_mfma_f32_16x16x32_bf16 a[36:39], a[248:251], v[148:151], a[36:39]
    ds_read_b64_tr_b16 a[246:247], v209 offset:43136
    v_add_f32 v195, v195, v191
    v_mfma_f32_16x16x32_bf16 a[40:43], a[248:251], v[152:155], a[40:43]
    v_exp_f32 v186, v118
    v_mfma_f32_16x16x32_bf16 a[44:47], a[248:251], v[156:159], a[44:47]
    s_waitcnt lgkmcnt(4)
    v_exp_f32 v187, v119
    v_mfma_f32_16x16x32_bf16 a[48:51], a[252:255], v[144:147], a[48:51]
    ds_read_b64_tr_b16 a[248:249], v210 offset:36992
    v_cvt_pk_bf16_f32 v141, v190, v191
    v_mfma_f32_16x16x32_bf16 a[52:55], a[252:255], v[148:151], a[52:55]
    ds_read_b64_tr_b16 a[250:251], v210 offset:43136
    v_add_f32 v192, v192, v176
    v_mfma_f32_16x16x32_bf16 a[56:59], a[252:255], v[152:155], a[56:59]
    v_exp_f32 v188, v124
    v_mfma_f32_16x16x32_bf16 a[60:63], a[252:255], v[156:159], a[60:63]
    s_waitcnt lgkmcnt(4)
    v_exp_f32 v189, v125
    v_mfma_f32_16x16x32_bf16 a[64:67], a[240:243], v[144:147], a[64:67]
    ds_read_b64_tr_b16 a[252:253], v211 offset:36992
    v_add_f32 v192, v192, v177
    v_mfma_f32_16x16x32_bf16 a[68:71], a[240:243], v[148:151], a[68:71]
    ds_read_b64_tr_b16 a[254:255], v211 offset:43136
    v_cvt_pk_bf16_f32 v130, v176, v177
    v_mfma_f32_16x16x32_bf16 a[72:75], a[240:243], v[152:155], a[72:75]
    v_exp_f32 v190, v126
    v_mfma_f32_16x16x32_bf16 a[76:79], a[240:243], v[156:159], a[76:79]
    s_waitcnt lgkmcnt(4)
    v_exp_f32 v191, v127
    v_mfma_f32_16x16x32_bf16 a[80:83], a[244:247], v[144:147], a[80:83]
    ds_read_b64_tr_b16 a[240:241], v208 offset:37120
    v_add_f32 v192, v192, v178
    v_mfma_f32_16x16x32_bf16 a[84:87], a[244:247], v[148:151], a[84:87]
    ds_read_b64_tr_b16 a[242:243], v208 offset:43264
    v_add_f32 v192, v192, v179
    v_mfma_f32_16x16x32_bf16 a[88:91], a[244:247], v[152:155], a[88:91]
    v_cvt_pk_bf16_f32 v131, v178, v179
    v_add_f32 v193, v193, v180
    v_mfma_f32_16x16x32_bf16 a[92:95], a[244:247], v[156:159], a[92:95]
    s_waitcnt lgkmcnt(4)
    v_add_f32 v193, v193, v181
    v_cvt_pk_bf16_f32 v134, v180, v181
    v_mfma_f32_16x16x32_bf16 a[96:99], a[248:251], v[144:147], a[96:99]
    ds_read_b64_tr_b16 a[244:245], v209 offset:37120
    v_add_f32 v193, v193, v182
    v_mfma_f32_16x16x32_bf16 a[100:103], a[248:251], v[148:151], a[100:103]
    ds_read_b64_tr_b16 a[246:247], v209 offset:43264
    v_add_f32 v193, v193, v183
    v_mfma_f32_16x16x32_bf16 a[104:107], a[248:251], v[152:155], a[104:107]
    v_cvt_pk_bf16_f32 v135, v182, v183
    v_add_f32 v194, v194, v184
    v_mfma_f32_16x16x32_bf16 a[108:111], a[248:251], v[156:159], a[108:111]
    s_waitcnt lgkmcnt(4)
    v_add_f32 v194, v194, v185
    v_cvt_pk_bf16_f32 v138, v184, v185
    v_mfma_f32_16x16x32_bf16 a[112:115], a[252:255], v[144:147], a[112:115]
    ds_read_b64_tr_b16 a[248:249], v210 offset:37120
    v_add_f32 v194, v194, v186
    v_mfma_f32_16x16x32_bf16 a[116:119], a[252:255], v[148:151], a[116:119]
    ds_read_b64_tr_b16 a[250:251], v210 offset:43264
    v_add_f32 v194, v194, v187
    v_mfma_f32_16x16x32_bf16 a[120:123], a[252:255], v[152:155], a[120:123]
    v_cvt_pk_bf16_f32 v139, v186, v187
    v_add_f32 v195, v195, v188
    v_mfma_f32_16x16x32_bf16 a[124:127], a[252:255], v[156:159], a[124:127]
    s_waitcnt lgkmcnt(4)
    v_add_f32 v195, v195, v189
    v_cvt_pk_bf16_f32 v142, v188, v189
    v_mfma_f32_16x16x32_bf16 a[128:131], a[240:243], v[144:147], a[128:131]
    ds_read_b64_tr_b16 a[252:253], v211 offset:37120
    v_add_f32 v195, v195, v190
    v_mfma_f32_16x16x32_bf16 a[132:135], a[240:243], v[148:151], a[132:135]
    ds_read_b64_tr_b16 a[254:255], v211 offset:43264
    v_add_f32 v195, v195, v191
    v_mfma_f32_16x16x32_bf16 a[136:139], a[240:243], v[152:155], a[136:139]
    v_cvt_pk_bf16_f32 v143, v190, v191
    v_max3_f32 v236, v192, v193, v194
    v_mfma_f32_16x16x32_bf16 a[140:143], a[240:243], v[156:159], a[140:143]
    s_waitcnt lgkmcnt(4)
    v_max_f32 v236, v236, v195
    v_cmp_nge_f32 vcc, s37, v236
    v_mfma_f32_16x16x32_bf16 a[144:147], a[244:247], v[144:147], a[144:147]
    v_mfma_f32_16x16x32_bf16 a[148:151], a[244:247], v[148:151], a[148:151]
    v_mfma_f32_16x16x32_bf16 a[152:155], a[244:247], v[152:155], a[152:155]
    v_mfma_f32_16x16x32_bf16 a[156:159], a[244:247], v[156:159], a[156:159]
    s_waitcnt lgkmcnt(2)
    v_mfma_f32_16x16x32_bf16 a[160:163], a[248:251], v[144:147], a[160:163]
    v_mfma_f32_16x16x32_bf16 a[164:167], a[248:251], v[148:151], a[164:167]
    v_mfma_f32_16x16x32_bf16 a[168:171], a[248:251], v[152:155], a[168:171]
    buffer_store_dwordx4 v[232:235], v212, s[68:71], s91 offen sc1
    v_mfma_f32_16x16x32_bf16 a[172:175], a[248:251], v[156:159], a[172:175]
    s_waitcnt lgkmcnt(0)
    v_mfma_f32_16x16x32_bf16 a[176:179], a[252:255], v[144:147], a[176:179]
    s_add_u32 s91, s91, 1024
    v_mfma_f32_16x16x32_bf16 a[180:183], a[252:255], v[148:151], a[180:183]
    v_mfma_f32_16x16x32_bf16 a[184:187], a[252:255], v[152:155], a[184:187]
    v_mfma_f32_16x16x32_bf16 a[188:191], a[252:255], v[156:159], a[188:191]
    s_waitcnt vmcnt(10)
    s_cbranch_vccnz K2_rare_L2
K2_ret_L2:
    v_mfma_f32_16x16x32_bf16 v[96:99], a[192:195], v[0:3], v[160:163]
    s_barrier
    v_add_f32 v196, v196, v192
    v_add_f32 v197, v197, v193
    v_mfma_f32_16x16x32_bf16 v[96:99], a[196:199], v[4:7], v[96:99]
    ds_read_b128 a[216:219], v206 offset:18432
    s_add_u32 m0, s31, 0
    v_mfma_f32_16x16x32_bf16 v[96:99], a[200:203], v[8:11], v[96:99]
    buffer_load_dwordx4 v200, s[16:19], s34 offen lds
    v_mfma_f32_16x16x32_bf16 v[96:99], a[204:207], v[12:15], v[96:99]
    ds_read_b128 a[220:223], v207 offset:18432
    s_add_u32 m0, s31, 1024
    v_mfma_f32_16x16x32_bf16 v[96:99], a[208:211], v[16:19], v[96:99]
    buffer_load_dwordx4 v201, s[16:19], s34 offen lds
    v_mfma_f32_16x16x32_bf16 v[96:99], a[212:215], v[20:23], v[96:99]
    ds_read_b128 a[224:227], v206 offset:18560
    s_add_u32 m0, s31, 2048
    v_mfma_f32_16x16x32_bf16 v[104:107], a[192:195], v[24:27], v[164:167]
    buffer_load_dwordx4 v202, s[16:19], s34 offen lds
    v_mfma_f32_16x16x32_bf16 v[104:107], a[196:199], v[28:31], v[104:107]
    ds_read_b128 a[228:231], v207 offset:18560
    s_add_u32 m0, s31, 86016
    v_mfma_f32_16x16x32_bf16 v[104:107], a[200:203], v[32:35], v[104:107]
    buffer_load_dwordx4 v203, s[20:23], s33 offen lds
    v_mfma_f32_16x16x32_bf16 v[104:107], a[204:207], v[36:39], v[104:107]
    ds_read_b128 a[232:235], v206 offset:18688
    v_add_f32 v198, v198, v194
    v_mfma_f32_16x16x32_bf16 v[104:107], a[208:211], v[40:43], v[104:107]
    v_exp_f32 v176, v96
    v_mfma_f32_16x16x32_bf16 v[104:107], a[212:215], v[44:47], v[104:107]
    v_exp_f32 v177, v97
    v_mfma_f32_16x16x32_bf16 v[112:115], a[192:195], v[48:51], v[168:171]
    v_exp_f32 v178, v98
    v_mfma_f32_16x16x32_bf16 v[112:115], a[196:199], v[52:55], v[112:115]
    v_exp_f32 v179, v99
    v_mfma_f32_16x16x32_bf16 v[112:115], a[200:203], v[56:59], v[112:115]
    ds_read_b128 a[236:239], v207 offset:18688
    s_add_u32 m0, s31, 87040
    v_mfma_f32_16x16x32_bf16 v[112:115], a[204:207], v[60:63], v[112:115]
    buffer_load_dwordx4 v204, s[20:23], s33 offen lds
    v_mfma_f32_16x16x32_bf16 v[112:115], a[208:211], v[64:67], v[112:115]
    v_exp_f32 v180, v104
    v_mfma_f32_16x16x32_bf16 v[112:115], a[212:215], v[68:71], v[112:115]
    v_exp_f32 v181, v105
    v_mfma_f32_16x16x32_bf16 v[120:123], a[192:195], v[72:75], v[172:175]
    v_exp_f32 v182, v106
    v_mfma_f32_16x16x32_bf16 v[120:123], a[196:199], v[76:79], v[120:123]
    v_exp_f32 v183, v107
    v_mfma_f32_16x16x32_bf16 v[120:123], a[200:203], v[80:83], v[120:123]
    s_add_u32 m0, s31, 88064
    v_add_f32 v199, v199, v195
    v_add_f32 v192, v176, v177
    v_mfma_f32_16x16x32_bf16 v[120:123], a[204:207], v[84:87], v[120:123]
    buffer_load_dwordx4 v205, s[20:23], s33 offen lds
    v_mfma_f32_16x16x32_bf16 v[120:123], a[208:211], v[88:91], v[120:123]
    s_add_u32 s34, s34, 12288
    v_exp_f32 v184, v112
    v_mfma_f32_16x16x32_bf16 v[120:123], a[212:215], v[92:95], v[120:123]
    s_waitcnt lgkmcnt(0)
    v_exp_f32 v185, v113
    v_mfma_f32_16x16x32_bf16 v[100:103], a[216:219], v[0:3], v[160:163]
    s_add_u32 s33, s33, 12288
    v_exp_f32 v186, v114
    v_mfma_f32_16x16x32_bf16 v[100:103], a[220:223], v[4:7], v[100:103]
    v_exp_f32 v187, v115
    v_mfma_f32_16x16x32_bf16 v[100:103], a[224:227], v[8:11], v[100:103]
    ds_read_b128 a[192:195], v206 offset:24576
    v_cvt_pk_bf16_f32 v144, v176, v177
    v_mfma_f32_16x16x32_bf16 v[100:103], a[228:231], v[12:15], v[100:103]
    ds_read_b128 a[196:199], v207 offset:24576
    v_add_f32 v192, v192, v178
    v_mfma_f32_16x16x32_bf16 v[100:103], a[232:235], v[16:19], v[100:103]
    v_exp_f32 v188, v120
    v_mfma_f32_16x16x32_bf16 v[100:103], a[236:239], v[20:23], v[100:103]
    v_exp_f32 v189, v121
    v_mfma_f32_16x16x32_bf16 v[108:111], a[216:219], v[24:27], v[164:167]
    v_exp_f32 v190, v122
    v_mfma_f32_16x16x32_bf16 v[108:111], a[220:223], v[28:31], v[108:111]
    v_exp_f32 v191, v123
    v_mfma_f32_16x16x32_bf16 v[108:111], a[224:227], v[32:35], v[108:111]
    ds_read_b128 a[200:203], v206 offset:24704
    v_add_f32 v192, v192, v179
    v_mfma_f32_16x16x32_bf16 v[108:111], a[228:231], v[36:39], v[108:111]
    ds_read_b128 a[204:207], v207 offset:24704
    v_cvt_pk_bf16_f32 v145, v178, v179
    v_mfma_f32_16x16x32_bf16 v[108:111], a[232:235], v[40:43], v[108:111]
    v_exp_f32 v176, v100
    v_mfma_f32_16x16x32_bf16 v[108:111], a[236:239], v[44:47], v[108:111]
    v_exp_f32 v177, v101
    v_mfma_f32_16x16x32_bf16 v[116:119], a[216:219], v[48:51], v[168:171]
    ds_read_b64_tr_b16 a[240:241], v208 offset:0
    v_add_f32 v193, v180, v181
    v_mfma_f32_16x16x32_bf16 v[116:119], a[220:223], v[52:55], v[116:119]
    ds_read_b64_tr_b16 a[242:243], v208 offset:6144
    v_cvt_pk_bf16_f32 v148, v180, v181
    v_mfma_f32_16x16x32_bf16 v[116:119], a[224:227], v[56:59], v[116:119]
    ds_read_b128 a[208:211], v206 offset:24832
    v_add_f32 v193, v193, v182
    v_mfma_f32_16x16x32_bf16 v[116:119], a[228:231], v[60:63], v[116:119]
    ds_read_b128 a[212:215], v207 offset:24832
    v_add_f32 v193, v193, v183
    v_mfma_f32_16x16x32_bf16 v[116:119], a[232:235], v[64:67], v[116:119]
    ds_read_b64_tr_b16 a[244:245], v209 offset:0
    v_cvt_pk_bf16_f32 v149, v182, v183
    v_mfma_f32_16x16x32_bf16 v[116:119], a[236:239], v[68:71], v[116:119]
    ds_read_b64_tr_b16 a[246:247], v209 offset:6144
    v_add_f32 v194, v184, v185
    v_mfma_f32_16x16x32_bf16 v[124:127], a[216:219], v[72:75], v[172:175]
    v_exp_f32 v178, v102
    v_mfma_f32_16x16x32_bf16 v[124:127], a[220:223], v[76:79], v[124:127]
    v_exp_f32 v179, v103
    v_mfma_f32_16x16x32_bf16 v[124:127], a[224:227], v[80:83], v[124:127]
    ds_read_b64_tr_b16 a[248:249], v210 offset:0
    v_cvt_pk_bf16_f32 v152, v184, v185
    v_mfma_f32_16x16x32_bf16 v[124:127], a[228:231], v[84:87], v[124:127]
    ds_read_b64_tr_b16 a[250:251], v210 offset:6144
    v_add_f32 v194, v194, v186
    v_mfma_f32_16x16x32_bf16 v[124:127], a[232:235], v[88:91], v[124:127]
    v_exp_f32 v180, v108
    v_mfma_f32_16x16x32_bf16 v[124:127], a[236:239], v[92:95], v[124:127]
    s_waitcnt lgkmcnt(6)
    v_exp_f32 v181, v109
    v_mfma_f32_16x16x32_bf16 a[0:3], a[240:243], v[128:131], a[0:3]
    ds_read_b64_tr_b16 a[252:253], v211 offset:0
    v_add_f32 v194, v194, v187
    v_mfma_f32_16x16x32_bf16 a[4:7], a[240:243], v[132:135], a[4:7]
    ds_read_b64_tr_b16 a[254:255], v211 offset:6144
    v_cvt_pk_bf16_f32 v153, v186, v187
    v_mfma_f32_16x16x32_bf16 a[8:11], a[240:243], v[136:139], a[8:11]
    v_exp_f32 v182, v110
    v_mfma_f32_16x16x32_bf16 a[12:15], a[240:243], v[140:143], a[12:15]
    s_waitcnt lgkmcnt(4)
    v_exp_f32 v183, v111
    v_mfma_f32_16x16x32_bf16 a[16:19], a[244:247], v[128:131], a[16:19]
    ds_read_b64_tr_b16 a[240:241], v208 offset:128
    v_add_f32 v195, v188, v189
    v_mfma_f32_16x16x32_bf16 a[20:23], a[244:247], v[132:135], a[20:23]
    ds_read_b64_tr_b16 a[242:243], v208 offset:6272
    v_cvt_pk_bf16_f32 v156, v188, v189
    v_mfma_f32_16x16x32_bf16 a[24:27], a[244:247], v[136:139], a[24:27]
    v_exp_f32 v184, v116
    v_mfma_f32_16x16x32_bf16 a[28:31], a[244:247], v[140:143], a[28:31]
    s_waitcnt lgkmcnt(4)
    v_exp_f32 v185, v117
    v_mfma_f32_16x16x32_bf16 a[32:35], a[248:251], v[128:131], a[32:35]
    ds_read_b64_tr_b16 a[244:245], v209 offset:128
    v_add_f32 v195, v195, v190
    v_mfma_f32_16x16x32_bf16 a[36:39], a[248:251], v[132:135], a[36:39]
    ds_read_b64_tr_b16 a[246:247], v209 offset:6272
    v_add_f32 v195, v195, v191
    v_mfma_f32_16x16x32_bf16 a[40:43], a[248:251], v[136:139], a[40:43]
    v_exp_f32 v186, v118
    v_mfma_f32_16x16x32_bf16 a[44:47], a[248:251], v[140:143], a[44:47]
    s_waitcnt lgkmcnt(4)
    v_exp_f32 v187, v119
    v_mfma_f32_16x16x32_bf16 a[48:51], a[252:255], v[128:131], a[48:51]
    ds_read_b64_tr_b16 a[248:249], v210 offset:128
    v_cvt_pk_bf16_f32 v157, v190, v191
    v_mfma_f32_16x16x32_bf16 a[52:55], a[252:255], v[132:135], a[52:55]
    ds_read_b64_tr_b16 a[250:251], v210 offset:6272
    v_add_f32 v192, v192, v176
    v_mfma_f32_16x16x32_bf16 a[56:59], a[252:255], v[136:139], a[56:59]
    v_exp_f32 v188, v124
    v_mfma_f32_16x16x32_bf16 a[60:63], a[252:255], v[140:143], a[60:63]
    s_waitcnt lgkmcnt(4)
    v_exp_f32 v189, v125
    v_mfma_f32_16x16x32_bf16 a[64:67], a[240:243], v[128:131], a[64:67]
    ds_read_b64_tr_b16 a[252:253], v211 offset:128
    v_add_f32 v192, v192, v177
    v_mfma_f32_16x16x32_bf16 a[68:71], a[240:243], v[132:135], a[68:71]
    ds_read_b64_tr_b16 a[254:255], v211 offset:6272
    v_cvt_pk_bf16_f32 v146, v176, v177
    v_mfma_f32_16x16x32_bf16 a[72:75], a[240:243], v[136:139], a[72:75]
    v_exp_f32 v190, v126
    v_mfma_f32_16x16x32_bf16 a[76:79], a[240:243], v[140:143], a[76:79]
    s_waitcnt lgkmcnt(4)
    v_exp_f32 v191, v127
    v_mfma_f32_16x16x32_bf16 a[80:83], a[244:247], v[128:131], a[80:83]
    ds_read_b64_tr_b16 a[240:241], v208 offset:256
    v_add_f32 v192, v192, v178
    v_mfma_f32_16x16x32_bf16 a[84:87], a[244:247], v[132:135], a[84:87]
    ds_read_b64_tr_b16 a[242:243], v208 offset:6400
    v_add_f32 v192, v192, v179
    v_mfma_f32_16x16x32_bf16 a[88:91], a[244:247], v[136:139], a[88:91]
    v_cvt_pk_bf16_f32 v147, v178, v179
    v_add_f32 v193, v193, v180
    v_mfma_f32_16x16x32_bf16 a[92:95], a[244:247], v[140:143], a[92:95]
    s_waitcnt lgkmcnt(4)
    v_add_f32 v193, v193, v181
    v_cvt_pk_bf16_f32 v150, v180, v181
    v_mfma_f32_16x16x32_bf16 a[96:99], a[248:251], v[128:131], a[96:99]
    ds_read_b64_tr_b16 a[244:245], v209 offset:256
    v_add_f32 v193, v193, v182
    v_mfma_f32_16x16x32_bf16 a[100:103], a[248:251], v[132:135], a[100:103]
    ds_read_b64_tr_b16 a[246:247], v209 offset:6400
    v_add_f32 v193, v193, v183
    v_mfma_f32_16x16x32_bf16 a[104:107], a[248:251], v[136:139], a[104:107]
    v_cvt_pk_bf16_f32 v151, v182, v183
    v_add_f32 v194, v194, v184
    v_mfma_f32_16x16x32_bf16 a[108:111], a[248:251], v[140:143], a[108:111]
    s_waitcnt lgkmcnt(4)
    v_add_f32 v194, v194, v185
    v_cvt_pk_bf16_f32 v154, v184, v185
    v_mfma_f32_16x16x32_bf16 a[112:115], a[252:255], v[128:131], a[112:115]
    ds_read_b64_tr_b16 a[248:249], v210 offset:256
    v_add_f32 v194, v194, v186
    v_mfma_f32_16x16x32_bf16 a[116:119], a[252:255], v[132:135], a[116:119]
    ds_read_b64_tr_b16 a[250:251], v210 offset:6400
    v_add_f32 v194, v194, v187
    v_mfma_f32_16x16x32_bf16 a[120:123], a[252:255], v[136:139], a[120:123]
    v_cvt_pk_bf16_f32 v155, v186, v187
    v_add_f32 v195, v195, v188
    v_mfma_f32_16x16x32_bf16 a[124:127], a[252:255], v[140:143], a[124:127]
    s_waitcnt lgkmcnt(4)
    v_add_f32 v195, v195, v189
    v_cvt_pk_bf16_f32 v158, v188, v189
    v_mfma_f32_16x16x32_bf16 a[128:131], a[240:243], v[128:131], a[128:131]
    ds_read_b64_tr_b16 a[252:253], v211 offset:256
    v_add_f32 v195, v195, v190
    v_mfma_f32_16x16x32_bf16 a[132:135], a[240:243], v[132:135], a[132:135]
    ds_read_b64_tr_b16 a[254:255], v211 offset:6400
    v_add_f32 v195, v195, v191
    v_mfma_f32_16x16x32_bf16 a[136:139], a[240:243], v[136:139], a[136:139]
    v_cvt_pk_bf16_f32 v159, v190, v191
    v_max3_f32 v236, v192, v193, v194
    v_mfma_f32_16x16x32_bf16 a[140:143], a[240:243], v[140:143], a[140:143]
    s_waitcnt lgkmcnt(4)
    v_max_f32 v236, v236, v195
    v_cmp_nge_f32 vcc, s37, v236
    v_mfma_f32_16x16x32_bf16 a[144:147], a[244:247], v[128:131], a[144:147]
    v_mfma_f32_16x16x32_bf16 a[148:151], a[244:247], v[132:135], a[148:151]
    s_mov_b32 m0, s59
    v_mfma_f32_16x16x32_bf16 a[152:155], a[244:247], v[136:139], a[152:155]
    buffer_load_dwordx4 v225, s[64:67], s90 offen lds
    v_mfma_f32_16x16x32_bf16 a[156:159], a[244:247], v[140:143], a[156:159]
    s_waitcnt lgkmcnt(2)
    v_mfma_f32_16x16x32_bf16 a[160:163], a[248:251], v[128:131], a[160:163]
    s_add_u32 s90, s90, 32
    v_mfma_f32_16x16x32_bf16 a[164:167], a[248:251], v[132:135], a[164:167]
    s_cmp_eq_u32 s90, 320
    s_cselect_b32 s90, 0x40000000, s90
    v_mfma_f32_16x16x32_bf16 a[168:171], a[248:251], v[136:139], a[168:171]
    v_mfma_f32_16x16x32_bf16 a[172:175], a[248:251], v[140:143], a[172:175]
    s_waitcnt lgkmcnt(0)
    v_mfma_f32_16x16x32_bf16 a[176:179], a[252:255], v[128:131], a[176:179]
    v_mfma_f32_16x16x32_bf16 a[180:183], a[252:255], v[132:135], a[180:183]
    v_mfma_f32_16x16x32_bf16 a[184:187], a[252:255], v[136:139], a[184:187]
    v_mfma_f32_16x16x32_bf16 a[188:191], a[252:255], v[140:143], a[188:191]
    s_waitcnt vmcnt(10)
    s_cbranch_vccnz K2_rare_L3
K2_ret_L3:
    s_sub_u32 s35, s35, 1
    s_cmp_lg_u32 s35, 0
    s_cbranch_scc1 K2_loop
    v_mfma_f32_16x16x32_bf16 v[96:99], a[192:195], v[0:3], v[160:163]
    s_barrier
    v_add_f32 v196, v196, v192
    v_add_f32 v197, v197, v193
    v_mfma_f32_16x16x32_bf16 v[96:99], a[196:199], v[4:7], v[96:99]
    ds_read_b128 a[216:219], v206 offset:30720
    s_mul_i32 s31, s28, 5120
    v_mfma_f32_16x16x32_bf16 v[96:99], a[200:203], v[8:11], v[96:99]
    v_and_b32 v225, 0x3e0, v212
    v_lshlrev_b32 v225, 2, v225
    v_mfma_f32_16x16x32_bf16 v[96:99], a[204:207], v[12:15], v[96:99]
    s_mov_b32 s48, 16384
    ds_read_b128 a[220:223], v207 offset:30720
    s_mul_i32 s34, s12, 491520
    v_mfma_f32_16x16x32_bf16 v[96:99], a[208:211], v[16:19], v[96:99]
    v_and_b32 v226, 16, v212
    v_add3_u32 v225, v225, v226, s48
    v_mfma_f32_16x16x32_bf16 v[96:99], a[212:215], v[20:23], v[96:99]
    ds_read_b128 a[224:227], v206 offset:30848
    s_mul_i32 s33, s12, 49152
    v_mfma_f32_16x16x32_bf16 v[104:107], a[192:195], v[24:27], v[164:167]
    buffer_load_dwordx4 v[228:231], v225, s[72:75], 0 offen sc1
    v_mfma_f32_16x16x32_bf16 v[104:107], a[196:199], v[28:31], v[104:107]
    ds_read_b128 a[228:231], v207 offset:30848
    v_add_f32 v198, v198, v194
    v_mfma_f32_16x16x32_bf16 v[104:107], a[200:203], v[32:35], v[104:107]
    s_getpc_b64 s[86:87]
    v_add_f32 v199, v199, v195
    v_mfma_f32_16x16x32_bf16 v[104:107], a[204:207], v[36:39], v[104:107]
    ds_read_b128 a[232:235], v206 offset:30976
    v_mfma_f32_16x16x32_bf16 v[104:107], a[208:211], v[40:43], v[104:107]
    v_lshlrev_b32 v244, 3, v212
    v_mfma_f32_16x16x32_bf16 v[104:107], a[212:215], v[44:47], v[104:107]
    v_exp_f32 v176, v96
    v_mfma_f32_16x16x32_bf16 v[112:115], a[192:195], v[48:51], v[168:171]
    s_lshl_b32 s40, s28, 13
    v_exp_f32 v177, v97
    v_mfma_f32_16x16x32_bf16 v[112:115], a[196:199], v[52:55], v[112:115]
    v_exp_f32 v178, v98
    v_mfma_f32_16x16x32_bf16 v[112:115], a[200:203], v[56:59], v[112:115]
    ds_read_b128 a[236:239], v207 offset:30976
    v_add_u32 v244, s40, v244
    v_mfma_f32_16x16x32_bf16 v[112:115], a[204:207], v[60:63], v[112:115]
    v_exp_f32 v179, v99
    v_mfma_f32_16x16x32_bf16 v[112:115], a[208:211], v[64:67], v[112:115]
    v_exp_f32 v180, v104
    v_mfma_f32_16x16x32_bf16 v[112:115], a[212:215], v[68:71], v[112:115]
    v_exp_f32 v181, v105
    v_mfma_f32_16x16x32_bf16 v[120:123], a[192:195], v[72:75], v[172:175]
    v_exp_f32 v182, v106
    v_mfma_f32_16x16x32_bf16 v[120:123], a[196:199], v[76:79], v[120:123]
    v_exp_f32 v183, v107
    v_mfma_f32_16x16x32_bf16 v[120:123], a[200:203], v[80:83], v[120:123]
    v_min_u32 v244, K2_end-K2_f1ok-4, v244
    v_add_f32 v192, v176, v177
    v_mfma_f32_16x16x32_bf16 v[120:123], a[204:207], v[84:87], v[120:123]
    global_load_dword v245, v244, s[86:87]
    v_mfma_f32_16x16x32_bf16 v[120:123], a[208:211], v[88:91], v[120:123]
    v_exp_f32 v184, v112
    v_mfma_f32_16x16x32_bf16 v[120:123], a[212:215], v[92:95], v[120:123]
    s_waitcnt lgkmcnt(0)
    v_exp_f32 v185, v113
    v_mfma_f32_16x16x32_bf16 v[100:103], a[216:219], v[0:3], v[160:163]
    v_exp_f32 v186, v114
    v_mfma_f32_16x16x32_bf16 v[100:103], a[220:223], v[4:7], v[100:103]
    v_exp_f32 v187, v115
    v_mfma_f32_16x16x32_bf16 v[100:103], a[224:227], v[8:11], v[100:103]
    ds_read_b128 a[192:195], v206 offset:36864
    v_cvt_pk_bf16_f32 v128, v176, v177
    v_mfma_f32_16x16x32_bf16 v[100:103], a[228:231], v[12:15], v[100:103]
    ds_read_b128 a[196:199], v207 offset:36864
    v_add_f32 v192, v192, v178
    v_mfma_f32_16x16x32_bf16 v[100:103], a[232:235], v[16:19], v[100:103]
    v_exp_f32 v188, v120
    v_mfma_f32_16x16x32_bf16 v[100:103], a[236:239], v[20:23], v[100:103]
    v_exp_f32 v189, v121
    v_mfma_f32_16x16x32_bf16 v[108:111], a[216:219], v[24:27], v[164:167]
    v_exp_f32 v190, v122
    v_mfma_f32_16x16x32_bf16 v[108:111], a[220:223], v[28:31], v[108:111]
    v_exp_f32 v191, v123
    v_mfma_f32_16x16x32_bf16 v[108:111], a[224:227], v[32:35], v[108:111]
    ds_read_b128 a[200:203], v206 offset:36992
    v_add_f32 v192, v192, v179
    v_mfma_f32_16x16x32_bf16 v[108:111], a[228:231], v[36:39], v[108:111]
    ds_read_b128 a[204:207], v207 offset:36992
    v_cvt_pk_bf16_f32 v129, v178, v179
    v_mfma_f32_16x16x32_bf16 v[108:111], a[232:235], v[40:43], v[108:111]
    v_exp_f32 v176, v100
    v_mfma_f32_16x16x32_bf16 v[108:111], a[236:239], v[44:47], v[108:111]
    v_exp_f32 v177, v101
    v_mfma_f32_16x16x32_bf16 v[116:119], a[216:219], v[48:51], v[168:171]
    ds_read_b64_tr_b16 a[240:241], v208 offset:12288
    v_add_f32 v193, v180, v181
    v_mfma_f32_16x16x32_bf16 v[116:119], a[220:223], v[52:55], v[116:119]
    ds_read_b64_tr_b16 a[242:243], v208 offset:18432
    v_cvt_pk_bf16_f32 v132, v180, v181
    v_mfma_f32_16x16x32_bf16 v[116:119], a[224:227], v[56:59], v[116:119]
    ds_read_b128 a[208:211], v206 offset:37120
    v_add_f32 v193, v193, v182
    v_mfma_f32_16x16x32_bf16 v[116:119], a[228:231], v[60:63], v[116:119]
    ds_read_b128 a[212:215], v207 offset:37120
    v_add_f32 v193, v193, v183
    v_mfma_f32_16x16x32_bf16 v[116:119], a[232:235], v[64:67], v[116:119]
    ds_read_b64_tr_b16 a[244:245], v209 offset:12288
    v_cvt_pk_bf16_f32 v133, v182, v183
    v_mfma_f32_16x16x32_bf16 v[116:119], a[236:239], v[68:71], v[116:119]
    ds_read_b64_tr_b16 a[246:247], v209 offset:18432
    v_add_f32 v194, v184, v185
    v_mfma_f32_16x16x32_bf16 v[124:127], a[216:219], v[72:75], v[172:175]
    v_exp_f32 v178, v102
    v_mfma_f32_16x16x32_bf16 v[124:127], a[220:223], v[76:79], v[124:127]
    v_exp_f32 v179, v103
    v_mfma_f32_16x16x32_bf16 v[124:127], a[224:227], v[80:83], v[124:127]
    ds_read_b64_tr_b16 a[248:249], v210 offset:12288
    v_cvt_pk_bf16_f32 v136, v184, v185
    v_mfma_f32_16x16x32_bf16 v[124:127], a[228:231], v[84:87], v[124:127]
    ds_read_b64_tr_b16 a[250:251], v210 offset:18432
    v_add_f32 v194, v194, v186
    v_mfma_f32_16x16x32_bf16 v[124:127], a[232:235], v[88:91], v[124:127]
    v_exp_f32 v180, v108
    v_mfma_f32_16x16x32_bf16 v[124:127], a[236:239], v[92:95], v[124:127]
    s_waitcnt lgkmcnt(6)
    v_exp_f32 v181, v109
    v_mfma_f32_16x16x32_bf16 a[0:3], a[240:243], v[144:147], a[0:3]
    ds_read_b64_tr_b16 a[252:253], v211 offset:12288
    v_add_f32 v194, v194, v187
    v_mfma_f32_16x16x32_bf16 a[4:7], a[240:243], v[148:151], a[4:7]
    ds_read_b64_tr_b16 a[254:255], v211 offset:18432
    v_cvt_pk_bf16_f32 v137, v186, v187
    v_mfma_f32_16x16x32_bf16 a[8:11], a[240:243], v[152:155], a[8:11]
    v_exp_f32 v182, v110
    v_mfma_f32_16x16x32_bf16 a[12:15], a[240:243], v[156:159], a[12:15]
    s_waitcnt lgkmcnt(4)
    v_exp_f32 v183, v111
    v_mfma_f32_16x16x32_bf16 a[16:19], a[244:247], v[144:147], a[16:19]
    ds_read_b64_tr_b16 a[240:241], v208 offset:12416
    v_add_f32 v195, v188, v189
    v_mfma_f32_16x16x32_bf16 a[20:23], a[244:247], v[148:151], a[20:23]
    ds_read_b64_tr_b16 a[242:243], v208 offset:18560
    v_cvt_pk_bf16_f32 v140, v188, v189
    v_mfma_f32_16x16x32_bf16 a[24:27], a[244:247], v[152:155], a[24:27]
    v_exp_f32 v184, v116
    v_mfma_f32_16x16x32_bf16 a[28:31], a[244:247], v[156:159], a[28:31]
    s_waitcnt lgkmcnt(4)
    v_exp_f32 v185, v117
    v_mfma_f32_16x16x32_bf16 a[32:35], a[248:251], v[144:147], a[32:35]
    ds_read_b64_tr_b16 a[244:245], v209 offset:12416
    v_add_f32 v195, v195, v190
    v_mfma_f32_16x16x32_bf16 a[36:39], a[248:251], v[148:151], a[36:39]
    ds_read_b64_tr_b16 a[246:247], v209 offset:18560
    v_add_f32 v195, v195, v191
    v_mfma_f32_16x16x32_bf16 a[40:43], a[248:251], v[152:155], a[40:43]
    v_exp_f32 v186, v118
    v_mfma_f32_16x16x32_bf16 a[44:47], a[248:251], v[156:159], a[44:47]
    s_waitcnt lgkmcnt(4)
    v_exp_f32 v187, v119
    v_mfma_f32_16x16x32_bf16 a[48:51], a[252:255], v[144:147], a[48:51]
    ds_read_b64_tr_b16 a[248:249], v210 offset:12416
    v_cvt_pk_bf16_f32 v141, v190, v191
    v_mfma_f32_16x16x32_bf16 a[52:55], a[252:255], v[148:151], a[52:55]
    ds_read_b64_tr_b16 a[250:251], v210 offset:18560
    v_add_f32 v192, v192, v176
    v_mfma_f32_16x16x32_bf16 a[56:59], a[252:255], v[152:155], a[56:59]
    v_exp_f32 v188, v124
    v_mfma_f32_16x16x32_bf16 a[60:63], a[252:255], v[156:159], a[60:63]
    s_waitcnt lgkmcnt(4)
    v_exp_f32 v189, v125
    v_mfma_f32_16x16x32_bf16 a[64:67], a[240:243], v[144:147], a[64:67]
    ds_read_b64_tr_b16 a[252:253], v211 offset:12416
    v_add_f32 v192, v192, v177
    v_mfma_f32_16x16x32_bf16 a[68:71], a[240:243], v[148:151], a[68:71]
    ds_read_b64_tr_b16 a[254:255], v211 offset:18560
    v_cvt_pk_bf16_f32 v130, v176, v177
    v_mfma_f32_16x16x32_bf16 a[72:75], a[240:243], v[152:155], a[72:75]
    v_exp_f32 v190, v126
    v_mfma_f32_16x16x32_bf16 a[76:79], a[240:243], v[156:159], a[76:79]
    s_waitcnt lgkmcnt(4)
    v_exp_f32 v191, v127
    v_mfma_f32_16x16x32_bf16 a[80:83], a[244:247], v[144:147], a[80:83]
    ds_read_b64_tr_b16 a[240:241], v208 offset:12544
    v_add_f32 v192, v192, v178
    v_mfma_f32_16x16x32_bf16 a[84:87], a[244:247], v[148:151], a[84:87]
    ds_read_b64_tr_b16 a[242:243], v208 offset:18688
    v_add_f32 v192, v192, v179
    v_mfma_f32_16x16x32_bf16 a[88:91], a[244:247], v[152:155], a[88:91]
    v_cvt_pk_bf16_f32 v131, v178, v179
    v_add_f32 v193, v193, v180
    v_mfma_f32_16x16x32_bf16 a[92:95], a[244:247], v[156:159], a[92:95]
    s_waitcnt lgkmcnt(4)
    v_add_f32 v193, v193, v181
    v_cvt_pk_bf16_f32 v134, v180, v181
    v_mfma_f32_16x16x32_bf16 a[96:99], a[248:251], v[144:147], a[96:99]
    ds_read_b64_tr_b16 a[244:245], v209 offset:12544
    v_add_f32 v193, v193, v182
    v_mfma_f32_16x16x32_bf16 a[100:103], a[248:251], v[148:151], a[100:103]
    ds_read_b64_tr_b16 a[246:247], v209 offset:18688
    v_add_f32 v193, v193, v183
    v_mfma_f32_16x16x32_bf16 a[104:107], a[248:251], v[152:155], a[104:107]
    v_cvt_pk_bf16_f32 v135, v182, v183
    v_add_f32 v194, v194, v184
    v_mfma_f32_16x16x32_bf16 a[108:111], a[248:251], v[156:159], a[108:111]
    s_waitcnt lgkmcnt(4)
    v_add_f32 v194, v194, v185
    v_cvt_pk_bf16_f32 v138, v184, v185
    v_mfma_f32_16x16x32_bf16 a[112:115], a[252:255], v[144:147], a[112:115]
    ds_read_b64_tr_b16 a[248:249], v210 offset:12544
    v_add_f32 v194, v194, v186
    v_mfma_f32_16x16x32_bf16 a[116:119], a[252:255], v[148:151], a[116:119]
    ds_read_b64_tr_b16 a[250:251], v210 offset:18688
    v_add_f32 v194, v194, v187
    v_mfma_f32_16x16x32_bf16 a[120:123], a[252:255], v[152:155], a[120:123]
    v_cvt_pk_bf16_f32 v139, v186, v187
    v_add_f32 v195, v195, v188
    v_mfma_f32_16x16x32_bf16 a[124:127], a[252:255], v[156:159], a[124:127]
    s_waitcnt lgkmcnt(4)
    v_add_f32 v195, v195, v189
    v_cvt_pk_bf16_f32 v142, v188, v189
    v_mfma_f32_16x16x32_bf16 a[128:131], a[240:243], v[144:147], a[128:131]
    ds_read_b64_tr_b16 a[252:253], v211 offset:12544
    v_add_f32 v195, v195, v190
    v_mfma_f32_16x16x32_bf16 a[132:135], a[240:243], v[148:151], a[132:135]
    ds_read_b64_tr_b16 a[254:255], v211 offset:18688
    v_add_f32 v195, v195, v191
    v_mfma_f32_16x16x32_bf16 a[136:139], a[240:243], v[152:155], a[136:139]
    v_cvt_pk_bf16_f32 v143, v190, v191
    v_max3_f32 v236, v192, v193, v194
    v_mfma_f32_16x16x32_bf16 a[140:143], a[240:243], v[156:159], a[140:143]
    s_waitcnt lgkmcnt(4)
    v_max_f32 v236, v236, v195
    v_cmp_nge_f32 vcc, s37, v236
    v_mfma_f32_16x16x32_bf16 a[144:147], a[244:247], v[144:147], a[144:147]
    s_mov_b32 s64, s76
    s_mov_b32 s65, s77
    v_mfma_f32_16x16x32_bf16 a[148:151], a[244:247], v[148:151], a[148:151]
    s_mov_b32 s66, 0x00280000
    s_mov_b32 s67, 0x20000
    v_mfma_f32_16x16x32_bf16 a[152:155], a[244:247], v[152:155], a[152:155]
    s_lshl_b32 s40, s13, 7
    s_lshl_b32 s43, s12, 5
    v_mfma_f32_16x16x32_bf16 a[156:159], a[244:247], v[156:159], a[156:159]
    s_waitcnt lgkmcnt(2)
    s_add_u32 s40, s40, s43
    v_lshrrev_b32 v219, 4, v212
    v_mfma_f32_16x16x32_bf16 a[160:163], a[248:251], v[144:147], a[160:163]
    v_and_b32 v216, 15, v219
    v_add_u32 v216, s40, v216
    v_mfma_f32_16x16x32_bf16 a[164:167], a[248:251], v[148:151], a[164:167]
    v_mul_u32_u24 v216, 1280, v216
    v_lshrrev_b32 v219, 4, v219
    v_mfma_f32_16x16x32_bf16 a[168:171], a[248:251], v[152:155], a[168:171]
    v_lshl_add_u32 v216, v219, 3, v216
    s_mul_i32 s40, s14, 320
    v_mfma_f32_16x16x32_bf16 a[172:175], a[248:251], v[156:159], a[172:175]
    s_lshl_b32 s43, s28, 5
    s_add_u32 s40, s40, s43
    s_waitcnt lgkmcnt(0)
    v_mfma_f32_16x16x32_bf16 a[176:179], a[252:255], v[144:147], a[176:179]
    v_add_u32 v216, s40, v216
    v_add_u32 v219, 20480, v216
    v_mfma_f32_16x16x32_bf16 a[180:183], a[252:255], v[148:151], a[180:183]
    s_cmp_lt_u32 s28, 2
    s_cselect_b32 s50, 0, 0x40000000
    v_mfma_f32_16x16x32_bf16 a[184:187], a[252:255], v[152:155], a[184:187]
    v_mfma_f32_16x16x32_bf16 a[188:191], a[252:255], v[156:159], a[188:191]
    s_waitcnt vmcnt(1)
    s_cbranch_vccnz K2_rare_P61
K2_ret_P61:
K2_f1chk:
    v_min3_u32 v226, v228, v229, v230
    v_max3_u32 v228, v228, v229, v230
    v_min_u32 v226, v226, v231
    v_max_u32 v228, v228, v231
    v_xor_b32 v226, s58, v226
    v_xor_b32 v228, s58, v228
    v_or_b32 v228, v228, v226
    v_cmp_ne_u32 vcc, 0, v228
    s_cbranch_vccnz K2_f1slow
K2_f1ok:
    v_mfma_f32_16x16x32_bf16 v[96:99], a[192:195], v[0:3], v[160:163]
    s_barrier
    v_add_f32 v196, v196, v192
    v_add_f32 v197, v197, v193
    v_mfma_f32_16x16x32_bf16 v[96:99], a[196:199], v[4:7], v[96:99]
    ds_read_b128 a[216:219], v206 offset:43008
    s_add_u32 m0, s31, 98304
    v_mfma_f32_16x16x32_bf16 v[96:99], a[200:203], v[8:11], v[96:99]
    buffer_load_dwordx4 v212, s[8:11], s34 offen offset:0 lds
    v_mfma_f32_16x16x32_bf16 v[96:99], a[204:207], v[12:15], v[96:99]
    ds_read_b128 a[220:223], v207 offset:43008
    v_add_f32 v198, v198, v194
    v_mfma_f32_16x16x32_bf16 v[96:99], a[208:211], v[16:19], v[96:99]
    buffer_load_dwordx4 v212, s[8:11], s34 offen offset:1024 lds
    v_mfma_f32_16x16x32_bf16 v[96:99], a[212:215], v[20:23], v[96:99]
    ds_read_b128 a[224:227], v206 offset:43136
    v_add_f32 v199, v199, v195
    v_mfma_f32_16x16x32_bf16 v[104:107], a[192:195], v[24:27], v[164:167]
    buffer_load_dwordx4 v212, s[8:11], s34 offen offset:2048 lds
    v_mfma_f32_16x16x32_bf16 v[104:107], a[196:199], v[28:31], v[104:107]
    ds_read_b128 a[228:231], v207 offset:43136
    v_mfma_f32_16x16x32_bf16 v[104:107], a[200:203], v[32:35], v[104:107]
    buffer_load_dwordx4 v212, s[8:11], s34 offen offset:3072 lds
    v_mfma_f32_16x16x32_bf16 v[104:107], a[204:207], v[36:39], v[104:107]
    ds_read_b128 a[232:235], v206 offset:43264
    v_mfma_f32_16x16x32_bf16 v[104:107], a[208:211], v[40:43], v[104:107]
    s_cmp_eq_u32 s2, 0
    s_cselect_b32 s40, 20480, s37
    v_mfma_f32_16x16x32_bf16 v[104:107], a[212:215], v[44:47], v[104:107]
    v_exp_f32 v176, v96
    v_mfma_f32_16x16x32_bf16 v[112:115], a[192:195], v[48:51], v[168:171]
    buffer_store_dword v217, v249, s[72:75], s40 offen sc1
    v_mfma_f32_16x16x32_bf16 v[112:115], a[196:199], v[52:55], v[112:115]
    v_exp_f32 v177, v97
    v_mfma_f32_16x16x32_bf16 v[112:115], a[200:203], v[56:59], v[112:115]
    ds_read_b128 a[236:239], v207 offset:43264
    s_add_u32 m0, s31, 102400
    v_mfma_f32_16x16x32_bf16 v[112:115], a[204:207], v[60:63], v[112:115]
    buffer_load_dwordx4 v213, s[8:11], s34 offen offset:0 lds
    v_mfma_f32_16x16x32_bf16 v[112:115], a[208:211], v[64:67], v[112:115]
    s_add_u32 s34, s34, 81920
    v_exp_f32 v178, v98
    v_mfma_f32_16x16x32_bf16 v[112:115], a[212:215], v[68:71], v[112:115]
    v_exp_f32 v179, v99
    v_mfma_f32_16x16x32_bf16 v[120:123], a[192:195], v[72:75], v[172:175]
    v_exp_f32 v180, v104
    v_mfma_f32_16x16x32_bf16 v[120:123], a[196:199], v[76:79], v[120:123]
    v_exp_f32 v181, v105
    v_mfma_f32_16x16x32_bf16 v[120:123], a[200:203], v[80:83], v[120:123]
    s_add_u32 m0, s31, 118784
    v_exp_f32 v182, v106
    v_mfma_f32_16x16x32_bf16 v[120:123], a[204:207], v[84:87], v[120:123]
    buffer_load_dwordx4 v212, s[8:11], s34 offen offset:0 lds
    v_mfma_f32_16x16x32_bf16 v[120:123], a[208:211], v[88:91], v[120:123]
    v_exp_f32 v183, v107
    v_mfma_f32_16x16x32_bf16 v[120:123], a[212:215], v[92:95], v[120:123]
    s_waitcnt lgkmcnt(0)
    v_exp_f32 v184, v112
    v_mfma_f32_16x16x32_bf16 v[100:103], a[216:219], v[0:3], v[160:163]
    v_exp_f32 v185, v113
    v_mfma_f32_16x16x32_bf16 v[100:103], a[220:223], v[4:7], v[100:103]
    v_exp_f32 v186, v114
    v_mfma_f32_16x16x32_bf16 v[100:103], a[224:227], v[8:11], v[100:103]
    buffer_load_dwordx4 v212, s[8:11], s34 offen offset:1024 lds
    v_mfma_f32_16x16x32_bf16 v[100:103], a[228:231], v[12:15], v[100:103]
    buffer_load_dwordx4 v212, s[8:11], s34 offen offset:2048 lds
    v_mfma_f32_16x16x32_bf16 v[100:103], a[232:235], v[16:19], v[100:103]
    v_exp_f32 v187, v115
    v_mfma_f32_16x16x32_bf16 v[100:103], a[236:239], v[20:23], v[100:103]
    v_exp_f32 v188, v120
    v_mfma_f32_16x16x32_bf16 v[108:111], a[216:219], v[24:27], v[164:167]
    v_exp_f32 v189, v121
    v_mfma_f32_16x16x32_bf16 v[108:111], a[220:223], v[28:31], v[108:111]
    v_exp_f32 v190, v122
    v_mfma_f32_16x16x32_bf16 v[108:111], a[224:227], v[32:35], v[108:111]
    buffer_load_dwordx4 v212, s[8:11], s34 offen offset:3072 lds
    s_add_u32 m0, s31, 122880
    v_mfma_f32_16x16x32_bf16 v[108:111], a[228:231], v[36:39], v[108:111]
    buffer_load_dwordx4 v213, s[8:11], s34 offen offset:0 lds
    v_mfma_f32_16x16x32_bf16 v[108:111], a[232:235], v[40:43], v[108:111]
    s_add_u32 s34, s34, 81920
    v_exp_f32 v191, v123
    v_mfma_f32_16x16x32_bf16 v[108:111], a[236:239], v[44:47], v[108:111]
    v_add_f32 v192, v176, v177
    v_cvt_pk_bf16_f32 v144, v176, v177
    v_mfma_f32_16x16x32_bf16 v[116:119], a[216:219], v[48:51], v[168:171]
    ds_read_b64_tr_b16 a[240:241], v208 offset:24576
    v_add_f32 v192, v192, v178
    v_mfma_f32_16x16x32_bf16 v[116:119], a[220:223], v[52:55], v[116:119]
    s_add_u32 m0, s31, 139264
    ds_read_b64_tr_b16 a[242:243], v208 offset:30720
    v_mfma_f32_16x16x32_bf16 v[116:119], a[224:227], v[56:59], v[116:119]
    buffer_load_dwordx4 v212, s[8:11], s34 offen offset:0 lds
    v_mfma_f32_16x16x32_bf16 v[116:119], a[228:231], v[60:63], v[116:119]
    buffer_load_dwordx4 v212, s[8:11], s34 offen offset:1024 lds
    v_mfma_f32_16x16x32_bf16 v[116:119], a[232:235], v[64:67], v[116:119]
    ds_read_b64_tr_b16 a[244:245], v209 offset:24576
    v_add_f32 v192, v192, v179
    v_mfma_f32_16x16x32_bf16 v[116:119], a[236:239], v[68:71], v[116:119]
    ds_read_b64_tr_b16 a[246:247], v209 offset:30720
    v_cvt_pk_bf16_f32 v145, v178, v179
    v_mfma_f32_16x16x32_bf16 v[124:127], a[216:219], v[72:75], v[172:175]
    v_exp_f32 v176, v100
    v_mfma_f32_16x16x32_bf16 v[124:127], a[220:223], v[76:79], v[124:127]
    v_exp_f32 v177, v101
    v_mfma_f32_16x16x32_bf16 v[124:127], a[224:227], v[80:83], v[124:127]
    ds_read_b64_tr_b16 a[248:249], v210 offset:24576
    v_add_f32 v193, v180, v181
    v_mfma_f32_16x16x32_bf16 v[124:127], a[228:231], v[84:87], v[124:127]
    ds_read_b64_tr_b16 a[250:251], v210 offset:30720
    v_cvt_pk_bf16_f32 v148, v180, v181
    v_mfma_f32_16x16x32_bf16 v[124:127], a[232:235], v[88:91], v[124:127]
    v_exp_f32 v178, v102
    v_mfma_f32_16x16x32_bf16 v[124:127], a[236:239], v[92:95], v[124:127]
    s_waitcnt lgkmcnt(4)
    v_exp_f32 v179, v103
    v_mfma_f32_16x16x32_bf16 a[0:3], a[240:243], v[128:131], a[0:3]
    ds_read_b64_tr_b16 a[252:253], v211 offset:24576
    v_add_f32 v193, v193, v182
    v_mfma_f32_16x16x32_bf16 a[4:7], a[240:243], v[132:135], a[4:7]
    ds_read_b64_tr_b16 a[254:255], v211 offset:30720
    v_add_f32 v193, v193, v183
    v_mfma_f32_16x16x32_bf16 a[8:11], a[240:243], v[136:139], a[8:11]
    buffer_load_dwordx4 v[0:3], v212, s[4:7], s33 offen offset:0 sc1
    v_mfma_f32_16x16x32_bf16 a[12:15], a[240:243], v[140:143], a[12:15]
    s_waitcnt lgkmcnt(4)
    v_exp_f32 v180, v108
    v_mfma_f32_16x16x32_bf16 a[16:19], a[244:247], v[128:131], a[16:19]
    ds_read_b64_tr_b16 a[240:241], v208 offset:24704
    v_cvt_pk_bf16_f32 v149, v182, v183
    v_mfma_f32_16x16x32_bf16 a[20:23], a[244:247], v[132:135], a[20:23]
    ds_read_b64_tr_b16 a[242:243], v208 offset:30848
    v_add_f32 v194, v184, v185
    v_mfma_f32_16x16x32_bf16 a[24:27], a[244:247], v[136:139], a[24:27]
    buffer_load_dwordx4 v[4:7], v212, s[4:7], s33 offen offset:1024 sc1
    v_mfma_f32_16x16x32_bf16 a[28:31], a[244:247], v[140:143], a[28:31]
    s_waitcnt lgkmcnt(4)
    v_exp_f32 v181, v109
    v_mfma_f32_16x16x32_bf16 a[32:35], a[248:251], v[128:131], a[32:35]
    ds_read_b64_tr_b16 a[244:245], v209 offset:24704
    v_cvt_pk_bf16_f32 v152, v184, v185
    v_mfma_f32_16x16x32_bf16 a[36:39], a[248:251], v[132:135], a[36:39]
    ds_read_b64_tr_b16 a[246:247], v209 offset:30848
    v_add_f32 v194, v194, v186
    v_mfma_f32_16x16x32_bf16 a[40:43], a[248:251], v[136:139], a[40:43]
    buffer_load_dwordx4 v[8:11], v213, s[4:7], s33 offen offset:0 sc1
    v_mfma_f32_16x16x32_bf16 a[44:47], a[248:251], v[140:143], a[44:47]
    s_waitcnt lgkmcnt(4)
    v_exp_f32 v182, v110
    v_mfma_f32_16x16x32_bf16 a[48:51], a[252:255], v[128:131], a[48:51]
    ds_read_b64_tr_b16 a[248:249], v210 offset:24704
    v_add_f32 v194, v194, v187
    v_mfma_f32_16x16x32_bf16 a[52:55], a[252:255], v[132:135], a[52:55]
    ds_read_b64_tr_b16 a[250:251], v210 offset:30848
    v_cvt_pk_bf16_f32 v153, v186, v187
    v_mfma_f32_16x16x32_bf16 a[56:59], a[252:255], v[136:139], a[56:59]
    buffer_load_dwordx4 v[12:15], v213, s[4:7], s33 offen offset:1024 sc1
    v_mfma_f32_16x16x32_bf16 a[60:63], a[252:255], v[140:143], a[60:63]
    s_add_u32 s33, s33, 8192
    s_waitcnt lgkmcnt(4)
    v_add_f32 v195, v188, v189
    v_mfma_f32_16x16x32_bf16 a[64:67], a[240:243], v[128:131], a[64:67]
    ds_read_b64_tr_b16 a[252:253], v211 offset:24704
    v_cvt_pk_bf16_f32 v156, v188, v189
    v_mfma_f32_16x16x32_bf16 a[68:71], a[240:243], v[132:135], a[68:71]
    ds_read_b64_tr_b16 a[254:255], v211 offset:30848
    v_add_f32 v195, v195, v190
    v_mfma_f32_16x16x32_bf16 a[72:75], a[240:243], v[136:139], a[72:75]
    buffer_load_dwordx4 v[16:19], v212, s[4:7], s33 offen offset:0 sc1
    v_mfma_f32_16x16x32_bf16 a[76:79], a[240:243], v[140:143], a[76:79]
    s_waitcnt lgkmcnt(4)
    v_exp_f32 v183, v111
    v_mfma_f32_16x16x32_bf16 a[80:83], a[244:247], v[128:131], a[80:83]
    ds_read_b64_tr_b16 a[240:241], v208 offset:24832
    v_add_f32 v195, v195, v191
    v_mfma_f32_16x16x32_bf16 a[84:87], a[244:247], v[132:135], a[84:87]
    ds_read_b64_tr_b16 a[242:243], v208 offset:30976
    v_cvt_pk_bf16_f32 v157, v190, v191
    v_mfma_f32_16x16x32_bf16 a[88:91], a[244:247], v[136:139], a[88:91]
    buffer_load_dwordx4 v[20:23], v212, s[4:7], s33 offen offset:1024 sc1
    v_mfma_f32_16x16x32_bf16 a[92:95], a[244:247], v[140:143], a[92:95]
    s_waitcnt lgkmcnt(4)
    v_exp_f32 v184, v116
    v_mfma_f32_16x16x32_bf16 a[96:99], a[248:251], v[128:131], a[96:99]
    ds_read_b64_tr_b16 a[244:245], v209 offset:24832
    v_add_f32 v192, v192, v176
    v_mfma_f32_16x16x32_bf16 a[100:103], a[248:251], v[132:135], a[100:103]
    ds_read_b64_tr_b16 a[246:247], v209 offset:30976
    v_add_f32 v192, v192, v177
    v_mfma_f32_16x16x32_bf16 a[104:107], a[248:251], v[136:139], a[104:107]
    buffer_load_dwordx4 v[24:27], v213, s[4:7], s33 offen offset:0 sc1
    v_mfma_f32_16x16x32_bf16 a[108:111], a[248:251], v[140:143], a[108:111]
    s_waitcnt lgkmcnt(4)
    v_exp_f32 v185, v117
    v_mfma_f32_16x16x32_bf16 a[112:115], a[252:255], v[128:131], a[112:115]
    ds_read_b64_tr_b16 a[248:249], v210 offset:24832
    v_cvt_pk_bf16_f32 v146, v176, v177
    v_mfma_f32_16x16x32_bf16 a[116:119], a[252:255], v[132:135], a[116:119]
    ds_read_b64_tr_b16 a[250:251], v210 offset:30976
    v_add_f32 v192, v192, v178
    v_mfma_f32_16x16x32_bf16 a[120:123], a[252:255], v[136:139], a[120:123]
    buffer_load_dwordx4 v[28:31], v213, s[4:7], s33 offen offset:1024 sc1
    v_mfma_f32_16x16x32_bf16 a[124:127], a[252:255], v[140:143], a[124:127]
    s_add_u32 s33, s33, 8192
    s_waitcnt lgkmcnt(4)
    v_add_f32 v192, v192, v179
    v_mfma_f32_16x16x32_bf16 a[128:131], a[240:243], v[128:131], a[128:131]
    ds_read_b64_tr_b16 a[252:253], v211 offset:24832
    v_cvt_pk_bf16_f32 v147, v178, v179
    v_mfma_f32_16x16x32_bf16 a[132:135], a[240:243], v[132:135], a[132:135]
    ds_read_b64_tr_b16 a[254:255], v211 offset:30976
    v_add_f32 v193, v193, v180
    v_mfma_f32_16x16x32_bf16 a[136:139], a[240:243], v[136:139], a[136:139]
    buffer_load_dwordx4 v212, s[8:11], s34 offen offset:2048 lds
    v_mfma_f32_16x16x32_bf16 a[140:143], a[240:243], v[140:143], a[140:143]
    s_waitcnt lgkmcnt(4)
    v_exp_f32 v186, v118
    v_mfma_f32_16x16x32_bf16 a[144:147], a[244:247], v[128:131], a[144:147]
    buffer_load_dwordx4 v212, s[8:11], s34 offen offset:3072 lds
    s_add_u32 m0, s31, 143360
    v_mfma_f32_16x16x32_bf16 a[148:151], a[244:247], v[132:135], a[148:151]
    buffer_load_dwordx4 v213, s[8:11], s34 offen offset:0 lds
    v_mfma_f32_16x16x32_bf16 a[152:155], a[244:247], v[136:139], a[152:155]
    s_add_u32 s34, s34, 81920
    v_exp_f32 v187, v119
    v_mfma_f32_16x16x32_bf16 a[156:159], a[244:247], v[140:143], a[156:159]
    s_add_u32 m0, s31, 0
    s_waitcnt lgkmcnt(2)
    v_add_f32 v193, v193, v181
    v_mfma_f32_16x16x32_bf16 a[160:163], a[248:251], v[128:131], a[160:163]
    buffer_load_dwordx4 v212, s[8:11], s34 offen offset:0 lds
    v_mfma_f32_16x16x32_bf16 a[164:167], a[248:251], v[132:135], a[164:167]
    buffer_load_dwordx4 v212, s[8:11], s34 offen offset:1024 lds
    v_mfma_f32_16x16x32_bf16 a[168:171], a[248:251], v[136:139], a[168:171]
    buffer_load_dwordx4 v212, s[8:11], s34 offen offset:2048 lds
    v_mfma_f32_16x16x32_bf16 a[172:175], a[248:251], v[140:143], a[172:175]
    s_waitcnt lgkmcnt(0)
    v_exp_f32 v188, v124
    v_mfma_f32_16x16x32_bf16 a[176:179], a[252:255], v[128:131], a[176:179]
    buffer_load_dwordx4 v212, s[8:11], s34 offen offset:3072 lds
    s_add_u32 m0, s31, 4096
    v_mfma_f32_16x16x32_bf16 a[180:183], a[252:255], v[132:135], a[180:183]
    buffer_load_dwordx4 v213, s[8:11], s34 offen offset:0 lds
    v_mfma_f32_16x16x32_bf16 a[184:187], a[252:255], v[136:139], a[184:187]
    s_add_u32 s34, s34, 81920
    v_exp_f32 v189, v125
    v_mfma_f32_16x16x32_bf16 a[188:191], a[252:255], v[140:143], a[188:191]
    s_waitcnt vmcnt(23)
    v_exp_f32 v190, v126
    s_nop 0
    v_cvt_pk_bf16_f32 v150, v180, v181
    v_add_f32 v193, v193, v182
    v_add_f32 v193, v193, v183
    v_cvt_pk_bf16_f32 v151, v182, v183
    v_add_f32 v194, v194, v184
    v_add_f32 v194, v194, v185
    v_cvt_pk_bf16_f32 v154, v184, v185
    v_add_f32 v194, v194, v186
    v_add_f32 v194, v194, v187
    v_cvt_pk_bf16_f32 v155, v186, v187
    v_exp_f32 v191, v127
    s_nop 0
    v_add_f32 v195, v195, v188
    v_add_f32 v195, v195, v189
    v_cvt_pk_bf16_f32 v158, v188, v189
    v_add_f32 v195, v195, v190
    v_add_f32 v195, v195, v191
    v_cvt_pk_bf16_f32 v159, v190, v191
    v_max3_f32 v236, v192, v193, v194
    v_max_f32 v236, v236, v195
    v_cmp_nge_f32 vcc, s37, v236
    s_nop 0
    s_cbranch_vccnz K2_rare_P62
K2_ret_P62:
    s_barrier
    ds_read_b64_tr_b16 a[240:241], v208 offset:36864
    ds_read_b64_tr_b16 a[242:243], v208 offset:43008
    ds_read_b64_tr_b16 a[244:245], v209 offset:36864
    ds_read_b64_tr_b16 a[246:247], v209 offset:43008
    ds_read_b64_tr_b16 a[248:249], v210 offset:36864
    ds_read_b64_tr_b16 a[250:251], v210 offset:43008
    s_waitcnt lgkmcnt(4)
    v_mfma_f32_16x16x32_bf16 a[0:3], a[240:243], v[144:147], a[0:3]
    ds_read_b64_tr_b16 a[252:253], v211 offset:36864
    v_add_f32 v196, v196, v192
    v_mfma_f32_16x16x32_bf16 a[4:7], a[240:243], v[148:151], a[4:7]
    ds_read_b64_tr_b16 a[254:255], v211 offset:43008
    s_add_u32 m0, s31, 20480
    v_mfma_f32_16x16x32_bf16 a[8:11], a[240:243], v[152:155], a[8:11]
    buffer_load_dwordx4 v212, s[8:11], s34 offen offset:0 lds
    v_mfma_f32_16x16x32_bf16 a[12:15], a[240:243], v[156:159], a[12:15]
    s_waitcnt lgkmcnt(4)
    buffer_load_dwordx4 v212, s[8:11], s34 offen offset:1024 lds
    v_mfma_f32_16x16x32_bf16 a[16:19], a[244:247], v[144:147], a[16:19]
    ds_read_b64_tr_b16 a[240:241], v208 offset:36992
    v_add_f32 v197, v197, v193
    v_mfma_f32_16x16x32_bf16 a[20:23], a[244:247], v[148:151], a[20:23]
    ds_read_b64_tr_b16 a[242:243], v208 offset:43136
    v_add_f32 v198, v198, v194
    v_mfma_f32_16x16x32_bf16 a[24:27], a[244:247], v[152:155], a[24:27]
    buffer_load_dwordx4 v212, s[8:11], s34 offen offset:2048 lds
    v_mfma_f32_16x16x32_bf16 a[28:31], a[244:247], v[156:159], a[28:31]
    s_waitcnt lgkmcnt(4)
    buffer_load_dwordx4 v212, s[8:11], s34 offen offset:3072 lds
    v_mfma_f32_16x16x32_bf16 a[32:35], a[248:251], v[144:147], a[32:35]
    ds_read_b64_tr_b16 a[244:245], v209 offset:36992
    v_add_f32 v199, v199, v195
    v_mfma_f32_16x16x32_bf16 a[36:39], a[248:251], v[148:151], a[36:39]
    ds_read_b64_tr_b16 a[246:247], v209 offset:43136
    s_add_u32 m0, s31, 24576
    v_mfma_f32_16x16x32_bf16 a[40:43], a[248:251], v[152:155], a[40:43]
    buffer_load_dwordx4 v213, s[8:11], s34 offen offset:0 lds
    v_mfma_f32_16x16x32_bf16 a[44:47], a[248:251], v[156:159], a[44:47]
    s_waitcnt lgkmcnt(4)
    s_add_u32 s34, s34, 81920
    buffer_load_dwordx4 v[32:35], v212, s[4:7], s33 offen offset:0 sc1
    v_mfma_f32_16x16x32_bf16 a[48:51], a[252:255], v[144:147], a[48:51]
    ds_read_b64_tr_b16 a[248:249], v210 offset:36992
    v_mov_b32 v236, v196
    v_mfma_f32_16x16x32_bf16 a[52:55], a[252:255], v[148:151], a[52:55]
    ds_read_b64_tr_b16 a[250:251], v210 offset:43136
    s_add_u32 m0, s31, 40960
    v_mfma_f32_16x16x32_bf16 a[56:59], a[252:255], v[152:155], a[56:59]
    buffer_load_dwordx4 v212, s[8:11], s34 offen offset:0 lds
    v_mfma_f32_16x16x32_bf16 a[60:63], a[252:255], v[156:159], a[60:63]
    s_waitcnt lgkmcnt(4)
    buffer_load_dwordx4 v212, s[8:11], s34 offen offset:1024 lds
    v_mfma_f32_16x16x32_bf16 a[64:67], a[240:243], v[144:147], a[64:67]
    ds_read_b64_tr_b16 a[252:253], v211 offset:36992
    v_mov_b32 v237, v197
    v_mfma_f32_16x16x32_bf16 a[68:71], a[240:243], v[148:151], a[68:71]
    ds_read_b64_tr_b16 a[254:255], v211 offset:43136
    v_mov_b32 v238, v198
    v_mfma_f32_16x16x32_bf16 a[72:75], a[240:243], v[152:155], a[72:75]
    buffer_load_dwordx4 v212, s[8:11], s34 offen offset:2048 lds
    v_mfma_f32_16x16x32_bf16 a[76:79], a[240:243], v[156:159], a[76:79]
    s_waitcnt lgkmcnt(4)
    buffer_load_dwordx4 v212, s[8:11], s34 offen offset:3072 lds
    v_mfma_f32_16x16x32_bf16 a[80:83], a[244:247], v[144:147], a[80:83]
    ds_read_b64_tr_b16 a[240:241], v208 offset:37120
    v_mov_b32 v239, v199
    v_mfma_f32_16x16x32_bf16 a[84:87], a[244:247], v[148:151], a[84:87]
    ds_read_b64_tr_b16 a[242:243], v208 offset:43264
    s_add_u32 m0, s31, 45056
    v_mfma_f32_16x16x32_bf16 a[88:91], a[244:247], v[152:155], a[88:91]
    buffer_load_dwordx4 v213, s[8:11], s34 offen offset:0 lds
    v_mfma_f32_16x16x32_bf16 a[92:95], a[244:247], v[156:159], a[92:95]
    s_waitcnt lgkmcnt(4)
    s_mul_i32 s34, s12, 1966080
    s_add_u32 s34, s34, 1966080
    buffer_load_dwordx4 v[36:39], v212, s[4:7], s33 offen offset:1024 sc1
    v_mfma_f32_16x16x32_bf16 a[96:99], a[248:251], v[144:147], a[96:99]
    ds_read_b64_tr_b16 a[244:245], v209 offset:37120
    v_permlane32_swap_b32 v236, v196
    v_mfma_f32_16x16x32_bf16 a[100:103], a[248:251], v[148:151], a[100:103]
    ds_read_b64_tr_b16 a[246:247], v209 offset:43264
    v_permlane32_swap_b32 v237, v197
    v_mfma_f32_16x16x32_bf16 a[104:107], a[248:251], v[152:155], a[104:107]
    buffer_load_dwordx4 v[40:43], v213, s[4:7], s33 offen offset:0 sc1
    v_mfma_f32_16x16x32_bf16 a[108:111], a[248:251], v[156:159], a[108:111]
    s_waitcnt lgkmcnt(4)
    buffer_load_dwordx4 v[44:47], v213, s[4:7], s33 offen offset:1024 sc1
    s_add_u32 s33, s33, 8192
    v_mfma_f32_16x16x32_bf16 a[112:115], a[252:255], v[144:147], a[112:115]
    ds_read_b64_tr_b16 a[248:249], v210 offset:37120
    v_permlane32_swap_b32 v238, v198
    v_mfma_f32_16x16x32_bf16 a[116:119], a[252:255], v[148:151], a[116:119]
    ds_read_b64_tr_b16 a[250:251], v210 offset:43264
    v_permlane32_swap_b32 v239, v199
    v_mfma_f32_16x16x32_bf16 a[120:123], a[252:255], v[152:155], a[120:123]
    buffer_load_dwordx4 v[48:51], v212, s[4:7], s33 offen offset:0 sc1
    v_mfma_f32_16x16x32_bf16 a[124:127], a[252:255], v[156:159], a[124:127]
    s_waitcnt lgkmcnt(4)
    buffer_load_dwordx4 v[52:55], v212, s[4:7], s33 offen offset:1024 sc1
    v_mfma_f32_16x16x32_bf16 a[128:131], a[240:243], v[144:147], a[128:131]
    ds_read_b64_tr_b16 a[252:253], v211 offset:37120
    v_add_f32 v196, v196, v236
    v_mfma_f32_16x16x32_bf16 a[132:135], a[240:243], v[148:151], a[132:135]
    ds_read_b64_tr_b16 a[254:255], v211 offset:43264
    v_add_f32 v197, v197, v237
    v_mfma_f32_16x16x32_bf16 a[136:139], a[240:243], v[152:155], a[136:139]
    buffer_load_dwordx4 v[56:59], v213, s[4:7], s33 offen offset:0 sc1
    v_mfma_f32_16x16x32_bf16 a[140:143], a[240:243], v[156:159], a[140:143]
    s_waitcnt lgkmcnt(4)
    buffer_load_dwordx4 v[60:63], v213, s[4:7], s33 offen offset:1024 sc1
    s_add_u32 s33, s33, 8192
    v_mfma_f32_16x16x32_bf16 a[144:147], a[244:247], v[144:147], a[144:147]
    ds_read_b128 a[192:195], v215 offset:0
    buffer_load_dwordx4 v[64:67], v212, s[4:7], s33 offen offset:0 sc1
    v_mfma_f32_16x16x32_bf16 a[148:151], a[244:247], v[148:151], a[148:151]
    ds_read_b128 a[196:199], v215 offset:10240
    v_add_f32 v198, v198, v238
    v_mfma_f32_16x16x32_bf16 a[152:155], a[244:247], v[152:155], a[152:155]
    buffer_load_dwordx4 v[68:71], v212, s[4:7], s33 offen offset:1024 sc1
    v_mfma_f32_16x16x32_bf16 a[156:159], a[244:247], v[156:159], a[156:159]
    s_waitcnt lgkmcnt(4)
    buffer_load_dwordx4 v[72:75], v213, s[4:7], s33 offen offset:0 sc1
    v_mfma_f32_16x16x32_bf16 a[160:163], a[248:251], v[144:147], a[160:163]
    ds_read_b128 a[200:203], v215 offset:1024
    buffer_load_dwordx4 v[76:79], v213, s[4:7], s33 offen offset:1024 sc1
    s_add_u32 s33, s33, 8192
    v_mfma_f32_16x16x32_bf16 a[164:167], a[248:251], v[148:151], a[164:167]
    ds_read_b128 a[204:207], v215 offset:11264
    v_add_f32 v199, v199, v239
    v_mfma_f32_16x16x32_bf16 a[168:171], a[248:251], v[152:155], a[168:171]
    buffer_load_dwordx4 v[80:83], v212, s[4:7], s33 offen offset:0 sc1
    v_mfma_f32_16x16x32_bf16 a[172:175], a[248:251], v[156:159], a[172:175]
    s_waitcnt lgkmcnt(4)
    buffer_load_dwordx4 v[84:87], v212, s[4:7], s33 offen offset:1024 sc1
    v_mfma_f32_16x16x32_bf16 a[176:179], a[252:255], v[144:147], a[176:179]
    ds_read_b128 a[208:211], v215 offset:2048
    buffer_load_dwordx4 v[88:91], v213, s[4:7], s33 offen offset:0 sc1
    v_mfma_f32_16x16x32_bf16 a[180:183], a[252:255], v[148:151], a[180:183]
    ds_read_b128 a[212:215], v215 offset:12288
    v_mov_b32 v236, v196
    v_mfma_f32_16x16x32_bf16 a[184:187], a[252:255], v[152:155], a[184:187]
    buffer_load_dwordx4 v[92:95], v213, s[4:7], s33 offen offset:1024 sc1
    s_mul_i32 s33, s12, 196608
    s_add_u32 s33, s33, 196608
    v_mfma_f32_16x16x32_bf16 a[188:191], a[252:255], v[156:159], a[188:191]
    s_waitcnt vmcnt(38) lgkmcnt(4)
    s_mul_i32 s40, s12, 40
    s_add_u32 s40, s40, s29
    s_nop 0
    v_mov_b32 v237, v197
    v_mov_b32 v238, v198
    v_mov_b32 v239, v199
    s_nop 1
    v_permlane16_swap_b32 v236, v196
    v_permlane16_swap_b32 v237, v197
    v_permlane16_swap_b32 v238, v198
    v_permlane16_swap_b32 v239, v199
    v_add_f32 v196, v196, v236
    v_add_f32 v197, v197, v237
    v_add_f32 v198, v198, v238
    v_add_f32 v199, v199, v239
    v_rcp_f32 v196, v196
    v_rcp_f32 v197, v197
    v_rcp_f32 v198, v198
    v_rcp_f32 v199, v199
    s_nop 0
    s_add_u32 s40, s40, 48
    s_lshl_b32 s40, s40, 12
    v_mfma_f32_16x16x32_bf16 v[96:99], a[192:195], v[0:3], 0
    ds_read_b128 a[216:219], v215 offset:3072
    v_accvgpr_read_b32 v176, a0
    v_accvgpr_read_b32 v177, a1
    v_accvgpr_read_b32 v178, a2
    v_mfma_f32_16x16x32_bf16 v[96:99], a[196:199], v[8:11], v[96:99]
    ds_read_b128 a[220:223], v215 offset:13312
    v_accvgpr_read_b32 v179, a3
    v_accvgpr_read_b32 v180, a16
    v_mfma_f32_16x16x32_bf16 v[100:103], a[192:195], v[4:7], 0
    v_accvgpr_read_b32 v181, a17
    v_accvgpr_read_b32 v182, a18
    v_accvgpr_read_b32 v183, a19
    v_mfma_f32_16x16x32_bf16 v[100:103], a[196:199], v[12:15], v[100:103]
    s_waitcnt lgkmcnt(4)
    v_mul_f32 v176, v176, v196
    v_mul_f32 v177, v177, v196
    v_mfma_f32_16x16x32_bf16 v[104:107], a[200:203], v[0:3], 0
    ds_read_b128 a[192:195], v215 offset:4096
    v_mul_f32 v178, v178, v196
    v_mul_f32 v179, v179, v196
    v_mfma_f32_16x16x32_bf16 v[104:107], a[204:207], v[8:11], v[104:107]
    ds_read_b128 a[196:199], v215 offset:14336
    v_mul_f32 v180, v180, v196
    v_mul_f32 v181, v181, v196
    v_mul_f32 v182, v182, v196
    v_mfma_f32_16x16x32_bf16 v[108:111], a[200:203], v[4:7], 0
    v_mul_f32 v183, v183, v196
    v_cvt_pk_bf16_f32 v184, v176, v177
    v_mfma_f32_16x16x32_bf16 v[108:111], a[204:207], v[12:15], v[108:111]
    s_waitcnt lgkmcnt(4)
    v_cvt_pk_bf16_f32 v185, v178, v179
    v_cvt_pk_bf16_f32 v186, v180, v181
    v_mfma_f32_16x16x32_bf16 v[112:115], a[208:211], v[0:3], 0
    ds_read_b128 a[200:203], v215 offset:5120
    v_cvt_pk_bf16_f32 v187, v182, v183
    buffer_store_dwordx4 v[184:187], v212, s[24:27], s40 offen offset:0 sc1
    v_accvgpr_read_b32 v236, a4
    v_mfma_f32_16x16x32_bf16 v[112:115], a[212:215], v[8:11], v[112:115]
    ds_read_b128 a[204:207], v215 offset:15360
    v_accvgpr_read_b32 v237, a5
    v_accvgpr_read_b32 v238, a6
    v_mfma_f32_16x16x32_bf16 v[116:119], a[208:211], v[4:7], 0
    buffer_load_dwordx2 a[224:225], v216, s[64:67], 0 offen offset:0
    v_accvgpr_read_b32 v239, a7
    v_accvgpr_read_b32 v240, a20
    v_mfma_f32_16x16x32_bf16 v[116:119], a[212:215], v[12:15], v[116:119]
    s_waitcnt lgkmcnt(4)
    v_accvgpr_read_b32 v241, a21
    v_accvgpr_read_b32 v242, a22
    v_accvgpr_read_b32 v243, a23
    v_mfma_f32_16x16x32_bf16 v[120:123], a[216:219], v[0:3], 0
    ds_read_b128 a[208:211], v215 offset:6144
    v_mul_f32 v236, v236, v197
    v_mul_f32 v237, v237, v197
    v_mfma_f32_16x16x32_bf16 v[120:123], a[220:223], v[8:11], v[120:123]
    ds_read_b128 a[212:215], v215 offset:16384
    v_mul_f32 v238, v238, v197
    v_mul_f32 v239, v239, v197
    v_mul_f32 v240, v240, v197
    v_mfma_f32_16x16x32_bf16 v[124:127], a[216:219], v[4:7], 0
    v_mul_f32 v241, v241, v197
    v_mul_f32 v242, v242, v197
    v_mfma_f32_16x16x32_bf16 v[124:127], a[220:223], v[12:15], v[124:127]
    s_waitcnt lgkmcnt(4)
    v_mul_f32 v243, v243, v197
    v_cvt_pk_bf16_f32 v188, v236, v237
    v_mfma_f32_16x16x32_bf16 v[128:131], a[192:195], v[0:3], 0
    ds_read_b128 a[216:219], v215 offset:7168
    v_cvt_pk_bf16_f32 v189, v238, v239
    v_cvt_pk_bf16_f32 v190, v240, v241
    v_cvt_pk_bf16_f32 v191, v242, v243
    v_mfma_f32_16x16x32_bf16 v[128:131], a[196:199], v[8:11], v[128:131]
    ds_read_b128 a[220:223], v215 offset:17408
    buffer_store_dwordx4 v[188:191], v212, s[24:27], s40 offen offset:1024 sc1
    v_accvgpr_read_b32 v176, a8
    v_mfma_f32_16x16x32_bf16 v[132:135], a[192:195], v[4:7], 0
    v_accvgpr_read_b32 v177, a9
    v_accvgpr_read_b32 v178, a10
    v_mfma_f32_16x16x32_bf16 v[132:135], a[196:199], v[12:15], v[132:135]
    s_waitcnt lgkmcnt(4)
    v_accvgpr_read_b32 v179, a11
    v_accvgpr_read_b32 v180, a24
    v_accvgpr_read_b32 v181, a25
    v_mfma_f32_16x16x32_bf16 v[136:139], a[200:203], v[0:3], 0
    ds_read_b128 a[192:195], v215 offset:8192
    v_accvgpr_read_b32 v182, a26
    v_accvgpr_read_b32 v183, a27
    v_mfma_f32_16x16x32_bf16 v[136:139], a[204:207], v[8:11], v[136:139]
    ds_read_b128 a[196:199], v215 offset:18432
    v_mul_f32 v176, v176, v198
    v_mul_f32 v177, v177, v198
    v_mfma_f32_16x16x32_bf16 v[140:143], a[200:203], v[4:7], 0
    buffer_load_dwordx2 a[226:227], v219, s[64:67], 0 offen offset:0
    v_mul_f32 v178, v178, v198
    v_mul_f32 v179, v179, v198
    v_mul_f32 v180, v180, v198
    v_mfma_f32_16x16x32_bf16 v[140:143], a[204:207], v[12:15], v[140:143]
    s_waitcnt lgkmcnt(4)
    v_mul_f32 v181, v181, v198
    v_mul_f32 v182, v182, v198
    v_mfma_f32_16x16x32_bf16 v[144:147], a[208:211], v[0:3], 0
    ds_read_b128 a[200:203], v215 offset:9216
    v_mul_f32 v183, v183, v198
    v_cvt_pk_bf16_f32 v184, v176, v177
    v_cvt_pk_bf16_f32 v185, v178, v179
    v_mfma_f32_16x16x32_bf16 v[144:147], a[212:215], v[8:11], v[144:147]
    ds_read_b128 a[204:207], v215 offset:19456
    v_cvt_pk_bf16_f32 v186, v180, v181
    v_cvt_pk_bf16_f32 v187, v182, v183
    v_mfma_f32_16x16x32_bf16 v[148:151], a[208:211], v[4:7], 0
    buffer_store_dwordx4 v[184:187], v212, s[24:27], s40 offen offset:2048 sc1
    v_accvgpr_read_b32 v236, a12
    v_mfma_f32_16x16x32_bf16 v[148:151], a[212:215], v[12:15], v[148:151]
    s_barrier
    s_waitcnt lgkmcnt(4)
    v_accvgpr_read_b32 v237, a13
    v_accvgpr_read_b32 v238, a14
    v_accvgpr_read_b32 v239, a15
    v_mfma_f32_16x16x32_bf16 v[152:155], a[216:219], v[0:3], 0
    ds_read_b128 a[208:211], v215 offset:20480
    v_accvgpr_read_b32 v240, a28
    v_accvgpr_read_b32 v241, a29
    v_mfma_f32_16x16x32_bf16 v[152:155], a[220:223], v[8:11], v[152:155]
    ds_read_b128 a[212:215], v215 offset:30720
    v_accvgpr_read_b32 v242, a30
    v_accvgpr_read_b32 v243, a31
    v_mfma_f32_16x16x32_bf16 v[156:159], a[216:219], v[4:7], 0
    v_mul_f32 v236, v236, v199
    v_mul_f32 v237, v237, v199
    v_mul_f32 v238, v238, v199
    v_mfma_f32_16x16x32_bf16 v[156:159], a[220:223], v[12:15], v[156:159]
    s_waitcnt lgkmcnt(4)
    v_mul_f32 v239, v239, v199
    v_mul_f32 v240, v240, v199
    v_mfma_f32_16x16x32_bf16 v[160:163], a[192:195], v[0:3], 0
    ds_read_b128 a[216:219], v215 offset:21504
    v_mul_f32 v241, v241, v199
    v_mul_f32 v242, v242, v199
    v_mfma_f32_16x16x32_bf16 v[160:163], a[196:199], v[8:11], v[160:163]
    ds_read_b128 a[220:223], v215 offset:31744
    v_mul_f32 v243, v243, v199
    v_cvt_pk_bf16_f32 v188, v236, v237
    v_cvt_pk_bf16_f32 v189, v238, v239
    v_mfma_f32_16x16x32_bf16 v[164:167], a[192:195], v[4:7], 0
    v_cvt_pk_bf16_f32 v190, v240, v241
    v_cvt_pk_bf16_f32 v191, v242, v243
    v_mfma_f32_16x16x32_bf16 v[164:167], a[196:199], v[12:15], v[164:167]
    s_waitcnt lgkmcnt(4)
    buffer_store_dwordx4 v[188:191], v212, s[24:27], s40 offen offset:3072 sc1
    s_add_u32 s40, s40, 32768
    v_mfma_f32_16x16x32_bf16 v[168:171], a[200:203], v[0:3], 0
    ds_read_b128 a[192:195], v215 offset:22528
    v_accvgpr_read_b32 v176, a32
    v_accvgpr_read_b32 v177, a33
    v_accvgpr_read_b32 v178, a34
    v_mfma_f32_16x16x32_bf16 v[168:171], a[204:207], v[8:11], v[168:171]
    ds_read_b128 a[196:199], v215 offset:32768
    v_accvgpr_read_b32 v179, a35
    v_accvgpr_read_b32 v180, a48
    v_mfma_f32_16x16x32_bf16 v[172:175], a[200:203], v[4:7], 0
    v_accvgpr_read_b32 v181, a49
    v_accvgpr_read_b32 v182, a50
    v_accvgpr_read_b32 v183, a51
    v_mfma_f32_16x16x32_bf16 v[172:175], a[204:207], v[12:15], v[172:175]
    s_waitcnt vmcnt(40) lgkmcnt(4)
    v_mul_f32 v176, v176, v196
    v_mul_f32 v177, v177, v196
    v_mfma_f32_16x16x32_bf16 v[96:99], a[208:211], v[16:19], v[96:99]
    ds_read_b128 a[200:203], v215 offset:23552
    v_mul_f32 v178, v178, v196
    v_mul_f32 v179, v179, v196
    v_mfma_f32_16x16x32_bf16 v[96:99], a[212:215], v[24:27], v[96:99]
    ds_read_b128 a[204:207], v215 offset:33792
    v_mul_f32 v180, v180, v196
    v_mul_f32 v181, v181, v196
    v_mul_f32 v182, v182, v196
    v_mfma_f32_16x16x32_bf16 v[100:103], a[208:211], v[20:23], v[100:103]
    v_mul_f32 v183, v183, v196
    v_cvt_pk_bf16_f32 v184, v176, v177
    v_mfma_f32_16x16x32_bf16 v[100:103], a[212:215], v[28:31], v[100:103]
    s_waitcnt lgkmcnt(4)
    v_cvt_pk_bf16_f32 v185, v178, v179
    v_cvt_pk_bf16_f32 v186, v180, v181
    v_mfma_f32_16x16x32_bf16 v[104:107], a[216:219], v[16:19], v[104:107]
    ds_read_b128 a[208:211], v215 offset:24576
    v_cvt_pk_bf16_f32 v187, v182, v183
    buffer_store_dwordx4 v[184:187], v212, s[24:27], s40 offen offset:0 sc1
    v_accvgpr_read_b32 v236, a36
    v_mfma_f32_16x16x32_bf16 v[104:107], a[220:223], v[24:27], v[104:107]
    ds_read_b128 a[212:215], v215 offset:34816
    v_accvgpr_read_b32 v237, a37
    v_accvgpr_read_b32 v238, a38
    v_mfma_f32_16x16x32_bf16 v[108:111], a[216:219], v[20:23], v[108:111]
    v_accvgpr_read_b32 v239, a39
    v_accvgpr_read_b32 v240, a52
    v_mfma_f32_16x16x32_bf16 v[108:111], a[220:223], v[28:31], v[108:111]
    s_waitcnt lgkmcnt(4)
    v_accvgpr_read_b32 v241, a53
    v_accvgpr_read_b32 v242, a54
    v_accvgpr_read_b32 v243, a55
    v_mfma_f32_16x16x32_bf16 v[112:115], a[192:195], v[16:19], v[112:115]
    ds_read_b128 a[216:219], v215 offset:25600
    v_mul_f32 v236, v236, v197
    v_mul_f32 v237, v237, v197
    v_mfma_f32_16x16x32_bf16 v[112:115], a[196:199], v[24:27], v[112:115]
    ds_read_b128 a[220:223], v215 offset:35840
    v_mul_f32 v238, v238, v197
    v_mul_f32 v239, v239, v197
    v_mul_f32 v240, v240, v197
    v_mfma_f32_16x16x32_bf16 v[116:119], a[192:195], v[20:23], v[116:119]
    buffer_load_dwordx2 a[228:229], v216, s[64:67], 0 offen offset:128
    v_mul_f32 v241, v241, v197
    v_mul_f32 v242, v242, v197
    v_mfma_f32_16x16x32_bf16 v[116:119], a[196:199], v[28:31], v[116:119]
    s_waitcnt lgkmcnt(4)
    v_mul_f32 v243, v243, v197
    v_cvt_pk_bf16_f32 v188, v236, v237
    v_mfma_f32_16x16x32_bf16 v[120:123], a[200:203], v[16:19], v[120:123]
    ds_read_b128 a[192:195], v215 offset:26624
    v_cvt_pk_bf16_f32 v189, v238, v239
    v_cvt_pk_bf16_f32 v190, v240, v241
    v_cvt_pk_bf16_f32 v191, v242, v243
    v_mfma_f32_16x16x32_bf16 v[120:123], a[204:207], v[24:27], v[120:123]
    ds_read_b128 a[196:199], v215 offset:36864
    buffer_store_dwordx4 v[188:191], v212, s[24:27], s40 offen offset:1024 sc1
    v_accvgpr_read_b32 v176, a40
    v_mfma_f32_16x16x32_bf16 v[124:127], a[200:203], v[20:23], v[124:127]
    v_accvgpr_read_b32 v177, a41
    v_accvgpr_read_b32 v178, a42
    v_mfma_f32_16x16x32_bf16 v[124:127], a[204:207], v[28:31], v[124:127]
    s_waitcnt lgkmcnt(4)
    v_accvgpr_read_b32 v179, a43
    v_accvgpr_read_b32 v180, a56
    v_accvgpr_read_b32 v181, a57
    v_mfma_f32_16x16x32_bf16 v[128:131], a[208:211], v[16:19], v[128:131]
    ds_read_b128 a[200:203], v215 offset:27648
    v_accvgpr_read_b32 v182, a58
    v_accvgpr_read_b32 v183, a59
    v_mfma_f32_16x16x32_bf16 v[128:131], a[212:215], v[24:27], v[128:131]
    ds_read_b128 a[204:207], v215 offset:37888
    v_mul_f32 v176, v176, v198
    v_mul_f32 v177, v177, v198
    v_mfma_f32_16x16x32_bf16 v[132:135], a[208:211], v[20:23], v[132:135]
    v_mul_f32 v178, v178, v198
    v_mul_f32 v179, v179, v198
    v_mul_f32 v180, v180, v198
    v_mfma_f32_16x16x32_bf16 v[132:135], a[212:215], v[28:31], v[132:135]
    s_waitcnt lgkmcnt(4)
    v_mul_f32 v181, v181, v198
    v_mul_f32 v182, v182, v198
    v_mfma_f32_16x16x32_bf16 v[136:139], a[216:219], v[16:19], v[136:139]
    ds_read_b128 a[208:211], v215 offset:28672
    v_mul_f32 v183, v183, v198
    v_cvt_pk_bf16_f32 v184, v176, v177
    v_cvt_pk_bf16_f32 v185, v178, v179
    v_mfma_f32_16x16x32_bf16 v[136:139], a[220:223], v[24:27], v[136:139]
    ds_read_b128 a[212:215], v215 offset:38912
    v_cvt_pk_bf16_f32 v186, v180, v181
    v_cvt_pk_bf16_f32 v187, v182, v183
    v_mfma_f32_16x16x32_bf16 v[140:143], a[216:219], v[20:23], v[140:143]
    buffer_load_dwordx2 a[230:231], v219, s[64:67], 0 offen offset:128
    buffer_store_dwordx4 v[184:187], v212, s[24:27], s40 offen offset:2048 sc1
    v_accvgpr_read_b32 v236, a44
    v_mfma_f32_16x16x32_bf16 v[140:143], a[220:223], v[28:31], v[140:143]
    s_waitcnt lgkmcnt(4)
    v_accvgpr_read_b32 v237, a45
    v_accvgpr_read_b32 v238, a46
    v_accvgpr_read_b32 v239, a47
    v_mfma_f32_16x16x32_bf16 v[144:147], a[192:195], v[16:19], v[144:147]
    ds_read_b128 a[216:219], v215 offset:29696
    v_accvgpr_read_b32 v240, a60
    v_accvgpr_read_b32 v241, a61
    v_mfma_f32_16x16x32_bf16 v[144:147], a[196:199], v[24:27], v[144:147]
    ds_read_b128 a[220:223], v215 offset:39936
    v_accvgpr_read_b32 v242, a62
    v_accvgpr_read_b32 v243, a63
    v_mfma_f32_16x16x32_bf16 v[148:151], a[192:195], v[20:23], v[148:151]
    s_waitcnt vmcnt(42)
    v_mul_f32 v236, v236, v199
    v_mul_f32 v237, v237, v199
    v_mul_f32 v238, v238, v199
    v_mfma_f32_16x16x32_bf16 v[148:151], a[196:199], v[28:31], v[148:151]
    s_barrier
    s_waitcnt lgkmcnt(4)
    s_add_u32 m0, s31, 98304
    v_mul_f32 v239, v239, v199
    v_mul_f32 v240, v240, v199
    v_mfma_f32_16x16x32_bf16 v[152:155], a[200:203], v[16:19], v[152:155]
    ds_read_b128 a[192:195], v215 offset:40960
    v_mul_f32 v241, v241, v199
    v_mul_f32 v242, v242, v199
    v_mfma_f32_16x16x32_bf16 v[152:155], a[204:207], v[24:27], v[152:155]
    ds_read_b128 a[196:199], v215 offset:51200
    v_mul_f32 v243, v243, v199
    v_cvt_pk_bf16_f32 v188, v236, v237
    v_cvt_pk_bf16_f32 v189, v238, v239
    v_mfma_f32_16x16x32_bf16 v[156:159], a[200:203], v[20:23], v[156:159]
    buffer_load_dwordx4 v212, s[8:11], s34 offen offset:0 lds
    v_cvt_pk_bf16_f32 v190, v240, v241
    v_cvt_pk_bf16_f32 v191, v242, v243
    v_mfma_f32_16x16x32_bf16 v[156:159], a[204:207], v[28:31], v[156:159]
    s_waitcnt lgkmcnt(4)
    buffer_store_dwordx4 v[188:191], v212, s[24:27], s40 offen offset:3072 sc1
    s_add_u32 s40, s40, 32768
    v_mfma_f32_16x16x32_bf16 v[160:163], a[208:211], v[16:19], v[160:163]
    ds_read_b128 a[200:203], v215 offset:41984
    v_accvgpr_read_b32 v176, a64
    v_accvgpr_read_b32 v177, a65
    v_accvgpr_read_b32 v178, a66
    v_mfma_f32_16x16x32_bf16 v[160:163], a[212:215], v[24:27], v[160:163]
    ds_read_b128 a[204:207], v215 offset:52224
    v_accvgpr_read_b32 v179, a67
    v_accvgpr_read_b32 v180, a80
    v_mfma_f32_16x16x32_bf16 v[164:167], a[208:211], v[20:23], v[164:167]
    buffer_load_dwordx4 v212, s[8:11], s34 offen offset:1024 lds
    v_accvgpr_read_b32 v181, a81
    v_accvgpr_read_b32 v182, a82
    v_accvgpr_read_b32 v183, a83
    v_mfma_f32_16x16x32_bf16 v[164:167], a[212:215], v[28:31], v[164:167]
    s_waitcnt lgkmcnt(4)
    v_mul_f32 v176, v176, v196
    v_mul_f32 v177, v177, v196
    v_mfma_f32_16x16x32_bf16 v[168:171], a[216:219], v[16:19], v[168:171]
    ds_read_b128 a[208:211], v215 offset:43008
    v_mul_f32 v178, v178, v196
    v_mul_f32 v179, v179, v196
    v_mfma_f32_16x16x32_bf16 v[168:171], a[220:223], v[24:27], v[168:171]
    ds_read_b128 a[212:215], v215 offset:53248
    v_mul_f32 v180, v180, v196
    v_mul_f32 v181, v181, v196
    v_mul_f32 v182, v182, v196
    v_mfma_f32_16x16x32_bf16 v[172:175], a[216:219], v[20:23], v[172:175]
    buffer_load_dwordx4 v212, s[8:11], s34 offen offset:2048 lds
    v_mul_f32 v183, v183, v196
    v_cvt_pk_bf16_f32 v184, v176, v177
    v_mfma_f32_16x16x32_bf16 v[172:175], a[220:223], v[28:31], v[172:175]
    s_waitcnt vmcnt(27) lgkmcnt(4)
    v_cvt_pk_bf16_f32 v185, v178, v179
    v_cvt_pk_bf16_f32 v186, v180, v181
    v_mfma_f32_16x16x32_bf16 v[96:99], a[192:195], v[32:35], v[96:99]
    ds_read_b128 a[216:219], v215 offset:44032
    v_cvt_pk_bf16_f32 v187, v182, v183
    buffer_store_dwordx4 v[184:187], v212, s[24:27], s40 offen offset:0 sc1
    v_accvgpr_read_b32 v236, a68
    v_mfma_f32_16x16x32_bf16 v[96:99], a[196:199], v[40:43], v[96:99]
    ds_read_b128 a[220:223], v215 offset:54272
    v_accvgpr_read_b32 v237, a69
    v_accvgpr_read_b32 v238, a70
    v_mfma_f32_16x16x32_bf16 v[100:103], a[192:195], v[36:39], v[100:103]
    buffer_load_dwordx4 v212, s[8:11], s34 offen offset:3072 lds
    v_accvgpr_read_b32 v239, a71
    v_accvgpr_read_b32 v240, a84
    v_mfma_f32_16x16x32_bf16 v[100:103], a[196:199], v[44:47], v[100:103]
    s_waitcnt lgkmcnt(4)
    s_add_u32 m0, s31, 102400
    v_accvgpr_read_b32 v241, a85
    v_accvgpr_read_b32 v242, a86
    v_accvgpr_read_b32 v243, a87
    v_mfma_f32_16x16x32_bf16 v[104:107], a[200:203], v[32:35], v[104:107]
    ds_read_b128 a[192:195], v215 offset:45056
    v_mul_f32 v236, v236, v197
    v_mul_f32 v237, v237, v197
    v_mfma_f32_16x16x32_bf16 v[104:107], a[204:207], v[40:43], v[104:107]
    ds_read_b128 a[196:199], v215 offset:55296
    v_mul_f32 v238, v238, v197
    v_mul_f32 v239, v239, v197
    v_mul_f32 v240, v240, v197
    v_mfma_f32_16x16x32_bf16 v[108:111], a[200:203], v[36:39], v[108:111]
    buffer_load_dwordx4 v213, s[8:11], s34 offen offset:0 lds
    v_mul_f32 v241, v241, v197
    v_mul_f32 v242, v242, v197
    v_mfma_f32_16x16x32_bf16 v[108:111], a[204:207], v[44:47], v[108:111]
    s_waitcnt lgkmcnt(4)
    s_add_u32 s34, s34, 81920
    v_mul_f32 v243, v243, v197
    v_cvt_pk_bf16_f32 v188, v236, v237
    v_mfma_f32_16x16x32_bf16 v[112:115], a[208:211], v[32:35], v[112:115]
    ds_read_b128 a[200:203], v215 offset:46080
    v_cvt_pk_bf16_f32 v189, v238, v239
    v_cvt_pk_bf16_f32 v190, v240, v241
    v_cvt_pk_bf16_f32 v191, v242, v243
    v_mfma_f32_16x16x32_bf16 v[112:115], a[212:215], v[40:43], v[112:115]
    ds_read_b128 a[204:207], v215 offset:56320
    buffer_store_dwordx4 v[188:191], v212, s[24:27], s40 offen offset:1024 sc1
    v_accvgpr_read_b32 v176, a72
    v_mfma_f32_16x16x32_bf16 v[116:119], a[208:211], v[36:39], v[116:119]
    buffer_load_dwordx2 a[232:233], v216, s[64:67], s50 offen offset:256
    v_accvgpr_read_b32 v177, a73
    v_accvgpr_read_b32 v178, a74
    v_mfma_f32_16x16x32_bf16 v[116:119], a[212:215], v[44:47], v[116:119]
    s_waitcnt lgkmcnt(4)
    v_accvgpr_read_b32 v179, a75
    v_accvgpr_read_b32 v180, a88
    v_accvgpr_read_b32 v181, a89
    v_mfma_f32_16x16x32_bf16 v[120:123], a[216:219], v[32:35], v[120:123]
    ds_read_b128 a[208:211], v215 offset:47104
    v_accvgpr_read_b32 v182, a90
    v_accvgpr_read_b32 v183, a91
    v_mfma_f32_16x16x32_bf16 v[120:123], a[220:223], v[40:43], v[120:123]
    ds_read_b128 a[212:215], v215 offset:57344
    v_mul_f32 v176, v176, v198
    v_mul_f32 v177, v177, v198
    v_mfma_f32_16x16x32_bf16 v[124:127], a[216:219], v[36:39], v[124:127]
    v_mul_f32 v178, v178, v198
    v_mul_f32 v179, v179, v198
    v_mul_f32 v180, v180, v198
    v_mfma_f32_16x16x32_bf16 v[124:127], a[220:223], v[44:47], v[124:127]
    s_waitcnt lgkmcnt(4)
    v_mul_f32 v181, v181, v198
    v_mul_f32 v182, v182, v198
    v_mfma_f32_16x16x32_bf16 v[128:131], a[192:195], v[32:35], v[128:131]
    ds_read_b128 a[216:219], v215 offset:48128
    v_mul_f32 v183, v183, v198
    v_cvt_pk_bf16_f32 v184, v176, v177
    v_cvt_pk_bf16_f32 v185, v178, v179
    v_mfma_f32_16x16x32_bf16 v[128:131], a[196:199], v[40:43], v[128:131]
    ds_read_b128 a[220:223], v215 offset:58368
    v_cvt_pk_bf16_f32 v186, v180, v181
    v_cvt_pk_bf16_f32 v187, v182, v183
    v_mfma_f32_16x16x32_bf16 v[132:135], a[192:195], v[36:39], v[132:135]
    buffer_store_dwordx4 v[184:187], v212, s[24:27], s40 offen offset:2048 sc1
    v_accvgpr_read_b32 v236, a76
    v_mfma_f32_16x16x32_bf16 v[132:135], a[196:199], v[44:47], v[132:135]
    s_waitcnt lgkmcnt(4)
    v_accvgpr_read_b32 v237, a77
    v_accvgpr_read_b32 v238, a78
    v_accvgpr_read_b32 v239, a79
    v_mfma_f32_16x16x32_bf16 v[136:139], a[200:203], v[32:35], v[136:139]
    ds_read_b128 a[192:195], v215 offset:49152
    v_accvgpr_read_b32 v240, a92
    v_accvgpr_read_b32 v241, a93
    v_mfma_f32_16x16x32_bf16 v[136:139], a[204:207], v[40:43], v[136:139]
    ds_read_b128 a[196:199], v215 offset:59392
    v_accvgpr_read_b32 v242, a94
    v_accvgpr_read_b32 v243, a95
    v_mfma_f32_16x16x32_bf16 v[140:143], a[200:203], v[36:39], v[140:143]
    buffer_load_dwordx2 a[234:235], v219, s[64:67], s50 offen offset:256
    v_mul_f32 v236, v236, v199
    v_mul_f32 v237, v237, v199
    v_mul_f32 v238, v238, v199
    v_mfma_f32_16x16x32_bf16 v[140:143], a[204:207], v[44:47], v[140:143]
    s_waitcnt lgkmcnt(4)
    v_mul_f32 v239, v239, v199
    v_mul_f32 v240, v240, v199
    v_mfma_f32_16x16x32_bf16 v[144:147], a[208:211], v[32:35], v[144:147]
    ds_read_b128 a[200:203], v215 offset:50176
    v_mul_f32 v241, v241, v199
    v_mul_f32 v242, v242, v199
    v_mfma_f32_16x16x32_bf16 v[144:147], a[212:215], v[40:43], v[144:147]
    ds_read_b128 a[204:207], v215 offset:60416
    v_mul_f32 v243, v243, v199
    v_cvt_pk_bf16_f32 v188, v236, v237
    v_cvt_pk_bf16_f32 v189, v238, v239
    v_mfma_f32_16x16x32_bf16 v[148:151], a[208:211], v[36:39], v[148:151]
    v_cvt_pk_bf16_f32 v190, v240, v241
    v_cvt_pk_bf16_f32 v191, v242, v243
    v_mfma_f32_16x16x32_bf16 v[148:151], a[212:215], v[44:47], v[148:151]
    s_barrier
    s_waitcnt lgkmcnt(4)
    s_add_u32 m0, s31, 118784
    buffer_store_dwordx4 v[188:191], v212, s[24:27], s40 offen offset:3072 sc1
    s_add_u32 s40, s40, 32768
    v_mfma_f32_16x16x32_bf16 v[152:155], a[216:219], v[32:35], v[152:155]
    ds_read_b128 a[208:211], v212 offset:0
    v_accvgpr_read_b32 v176, a96
    v_accvgpr_read_b32 v177, a97
    v_accvgpr_read_b32 v178, a98
    v_mfma_f32_16x16x32_bf16 v[152:155], a[220:223], v[40:43], v[152:155]
    ds_read_b128 a[212:215], v212 offset:10240
    v_accvgpr_read_b32 v179, a99
    v_accvgpr_read_b32 v180, a112
    v_mfma_f32_16x16x32_bf16 v[156:159], a[216:219], v[36:39], v[156:159]
    buffer_load_dwordx4 v212, s[8:11], s34 offen offset:0 lds
    v_accvgpr_read_b32 v181, a113
    v_accvgpr_read_b32 v182, a114
    v_accvgpr_read_b32 v183, a115
    v_mfma_f32_16x16x32_bf16 v[156:159], a[220:223], v[44:47], v[156:159]
    s_waitcnt lgkmcnt(4)
    v_mul_f32 v176, v176, v196
    v_mul_f32 v177, v177, v196
    v_mfma_f32_16x16x32_bf16 v[160:163], a[192:195], v[32:35], v[160:163]
    ds_read_b128 a[216:219], v212 offset:1024
    v_mul_f32 v178, v178, v196
    v_mul_f32 v179, v179, v196
    v_mfma_f32_16x16x32_bf16 v[160:163], a[196:199], v[40:43], v[160:163]
    ds_read_b128 a[220:223], v212 offset:11264
    v_mul_f32 v180, v180, v196
    v_mul_f32 v181, v181, v196
    v_mul_f32 v182, v182, v196
    v_mfma_f32_16x16x32_bf16 v[164:167], a[192:195], v[36:39], v[164:167]
    buffer_load_dwordx4 v212, s[8:11], s34 offen offset:1024 lds
    v_mul_f32 v183, v183, v196
    v_cvt_pk_bf16_f32 v184, v176, v177
    v_mfma_f32_16x16x32_bf16 v[164:167], a[196:199], v[44:47], v[164:167]
    s_waitcnt lgkmcnt(4)
    v_cvt_pk_bf16_f32 v185, v178, v179
    v_cvt_pk_bf16_f32 v186, v180, v181
    v_mfma_f32_16x16x32_bf16 v[168:171], a[200:203], v[32:35], v[168:171]
    ds_read_b128 a[192:195], v212 offset:2048
    v_cvt_pk_bf16_f32 v187, v182, v183
    buffer_store_dwordx4 v[184:187], v212, s[24:27], s40 offen offset:0 sc1
    v_accvgpr_read_b32 v236, a100
    v_mfma_f32_16x16x32_bf16 v[168:171], a[204:207], v[40:43], v[168:171]
    ds_read_b128 a[196:199], v212 offset:12288
    v_accvgpr_read_b32 v237, a101
    v_accvgpr_read_b32 v238, a102
    v_mfma_f32_16x16x32_bf16 v[172:175], a[200:203], v[36:39], v[172:175]
    buffer_load_dwordx4 v212, s[8:11], s34 offen offset:2048 lds
    v_accvgpr_read_b32 v239, a103
    v_accvgpr_read_b32 v240, a116
    v_mfma_f32_16x16x32_bf16 v[172:175], a[204:207], v[44:47], v[172:175]
    s_waitcnt vmcnt(35) lgkmcnt(4)
    v_accvgpr_read_b32 v241, a117
    v_accvgpr_read_b32 v242, a118
    v_accvgpr_read_b32 v243, a119
    v_mfma_f32_16x16x32_bf16 v[96:99], a[208:211], v[48:51], v[96:99]
    ds_read_b128 a[200:203], v212 offset:3072
    v_mul_f32 v236, v236, v197
    v_mul_f32 v237, v237, v197
    v_mfma_f32_16x16x32_bf16 v[96:99], a[212:215], v[56:59], v[96:99]
    ds_read_b128 a[204:207], v212 offset:13312
    v_mul_f32 v238, v238, v197
    v_mul_f32 v239, v239, v197
    v_mul_f32 v240, v240, v197
    v_mfma_f32_16x16x32_bf16 v[100:103], a[208:211], v[52:55], v[100:103]
    buffer_load_dwordx4 v212, s[8:11], s34 offen offset:3072 lds
    v_mul_f32 v241, v241, v197
    v_mul_f32 v242, v242, v197
    v_mfma_f32_16x16x32_bf16 v[100:103], a[212:215], v[60:63], v[100:103]
    s_waitcnt lgkmcnt(4)
    s_add_u32 m0, s31, 122880
    v_mul_f32 v243, v243, v197
    v_cvt_pk_bf16_f32 v188, v236, v237
    v_mfma_f32_16x16x32_bf16 v[104:107], a[216:219], v[48:51], v[104:107]
    ds_read_b128 a[208:211], v212 offset:4096
    v_cvt_pk_bf16_f32 v189, v238, v239
    v_cvt_pk_bf16_f32 v190, v240, v241
    v_cvt_pk_bf16_f32 v191, v242, v243
    v_mfma_f32_16x16x32_bf16 v[104:107], a[220:223], v[56:59], v[104:107]
    ds_read_b128 a[212:215], v212 offset:14336
    buffer_store_dwordx4 v[188:191], v212, s[24:27], s40 offen offset:1024 sc1
    v_accvgpr_read_b32 v176, a104
    v_mfma_f32_16x16x32_bf16 v[108:111], a[216:219], v[52:55], v[108:111]
    buffer_load_dwordx4 v213, s[8:11], s34 offen offset:0 lds
    v_accvgpr_read_b32 v177, a105
    v_accvgpr_read_b32 v178, a106
    v_mfma_f32_16x16x32_bf16 v[108:111], a[220:223], v[60:63], v[108:111]
    s_waitcnt lgkmcnt(4)
    s_add_u32 s34, s34, 81920
    v_accvgpr_read_b32 v179, a107
    v_accvgpr_read_b32 v180, a120
    v_accvgpr_read_b32 v181, a121
    v_mfma_f32_16x16x32_bf16 v[112:115], a[192:195], v[48:51], v[112:115]
    ds_read_b128 a[216:219], v212 offset:5120
    v_accvgpr_read_b32 v182, a122
    v_accvgpr_read_b32 v183, a123
    v_mfma_f32_16x16x32_bf16 v[112:115], a[196:199], v[56:59], v[112:115]
    ds_read_b128 a[220:223], v212 offset:15360
    v_mul_f32 v176, v176, v198
    v_mul_f32 v177, v177, v198
    v_mfma_f32_16x16x32_bf16 v[116:119], a[192:195], v[52:55], v[116:119]
    v_mul_f32 v178, v178, v198
    v_mul_f32 v179, v179, v198
    v_mul_f32 v180, v180, v198
    v_mfma_f32_16x16x32_bf16 v[116:119], a[196:199], v[60:63], v[116:119]
    s_waitcnt lgkmcnt(4)
    v_mul_f32 v181, v181, v198
    v_mul_f32 v182, v182, v198
    v_mfma_f32_16x16x32_bf16 v[120:123], a[200:203], v[48:51], v[120:123]
    ds_read_b128 a[192:195], v212 offset:6144
    v_mul_f32 v183, v183, v198
    v_cvt_pk_bf16_f32 v184, v176, v177
    v_cvt_pk_bf16_f32 v185, v178, v179
    v_mfma_f32_16x16x32_bf16 v[120:123], a[204:207], v[56:59], v[120:123]
    ds_read_b128 a[196:199], v212 offset:16384
    v_cvt_pk_bf16_f32 v186, v180, v181
    v_cvt_pk_bf16_f32 v187, v182, v183
    v_mfma_f32_16x16x32_bf16 v[124:127], a[200:203], v[52:55], v[124:127]
    buffer_store_dwordx4 v[184:187], v212, s[24:27], s40 offen offset:2048 sc1
    v_accvgpr_read_b32 v236, a108
    v_mfma_f32_16x16x32_bf16 v[124:127], a[204:207], v[60:63], v[124:127]
    s_waitcnt lgkmcnt(4)
    v_accvgpr_read_b32 v237, a109
    v_accvgpr_read_b32 v238, a110
    v_accvgpr_read_b32 v239, a111
    v_mfma_f32_16x16x32_bf16 v[128:131], a[208:211], v[48:51], v[128:131]
    ds_read_b128 a[200:203], v212 offset:7168
    v_accvgpr_read_b32 v240, a124
    v_accvgpr_read_b32 v241, a125
    v_mfma_f32_16x16x32_bf16 v[128:131], a[212:215], v[56:59], v[128:131]
    ds_read_b128 a[204:207], v212 offset:17408
    v_accvgpr_read_b32 v242, a126
    v_accvgpr_read_b32 v243, a127
    v_mfma_f32_16x16x32_bf16 v[132:135], a[208:211], v[52:55], v[132:135]
    v_mul_f32 v236, v236, v199
    v_mul_f32 v237, v237, v199
    v_mul_f32 v238, v238, v199
    v_mfma_f32_16x16x32_bf16 v[132:135], a[212:215], v[60:63], v[132:135]
    s_waitcnt lgkmcnt(4)
    v_mul_f32 v239, v239, v199
    v_mul_f32 v240, v240, v199
    v_mfma_f32_16x16x32_bf16 v[136:139], a[216:219], v[48:51], v[136:139]
    ds_read_b128 a[208:211], v212 offset:8192
    v_mul_f32 v241, v241, v199
    v_mul_f32 v242, v242, v199
    v_mfma_f32_16x16x32_bf16 v[136:139], a[220:223], v[56:59], v[136:139]
    ds_read_b128 a[212:215], v212 offset:18432
    v_mul_f32 v243, v243, v199
    v_cvt_pk_bf16_f32 v188, v236, v237
    v_cvt_pk_bf16_f32 v189, v238, v239
    v_mfma_f32_16x16x32_bf16 v[140:143], a[216:219], v[52:55], v[140:143]
    v_cvt_pk_bf16_f32 v190, v240, v241
    v_cvt_pk_bf16_f32 v191, v242, v243
    v_mfma_f32_16x16x32_bf16 v[140:143], a[220:223], v[60:63], v[140:143]
    s_waitcnt lgkmcnt(4)
    buffer_store_dwordx4 v[188:191], v212, s[24:27], s40 offen offset:3072 sc1
    s_add_u32 s40, s40, 32768
    v_mfma_f32_16x16x32_bf16 v[144:147], a[192:195], v[48:51], v[144:147]
    ds_read_b128 a[216:219], v212 offset:9216
    v_mov_b32 v217, s58
    v_add_u32 v217, 2, v217
    v_accvgpr_read_b32 v176, a128
    v_accvgpr_read_b32 v177, a129
    v_accvgpr_read_b32 v178, a130
    v_mfma_f32_16x16x32_bf16 v[144:147], a[196:199], v[56:59], v[144:147]
    ds_read_b128 a[220:223], v212 offset:19456
    v_accvgpr_read_b32 v179, a131
    v_accvgpr_read_b32 v180, a144
    v_mfma_f32_16x16x32_bf16 v[148:151], a[192:195], v[52:55], v[148:151]
    s_waitcnt vmcnt(19)
    v_accvgpr_read_b32 v181, a145
    v_accvgpr_read_b32 v182, a146
    v_accvgpr_read_b32 v183, a147
    v_mfma_f32_16x16x32_bf16 v[148:151], a[196:199], v[60:63], v[148:151]
    s_barrier
    s_waitcnt lgkmcnt(4)
    s_add_u32 m0, s31, 139264
    v_mul_f32 v176, v176, v196
    v_mul_f32 v177, v177, v196
    v_mfma_f32_16x16x32_bf16 v[152:155], a[200:203], v[48:51], v[152:155]
    ds_read_b128 a[192:195], v212 offset:20480
    v_mul_f32 v178, v178, v196
    v_mul_f32 v179, v179, v196
    v_mfma_f32_16x16x32_bf16 v[152:155], a[204:207], v[56:59], v[152:155]
    ds_read_b128 a[196:199], v212 offset:30720
    buffer_store_dword v217, v249, s[72:75], s49 offen sc1
    v_mul_f32 v180, v180, v196
    v_mul_f32 v181, v181, v196
    v_mul_f32 v182, v182, v196
    v_mfma_f32_16x16x32_bf16 v[156:159], a[200:203], v[52:55], v[156:159]
    buffer_load_dwordx4 v212, s[8:11], s34 offen offset:0 lds
    v_mul_f32 v183, v183, v196
    v_cvt_pk_bf16_f32 v184, v176, v177
    v_mfma_f32_16x16x32_bf16 v[156:159], a[204:207], v[60:63], v[156:159]
    s_waitcnt lgkmcnt(4)
    v_cvt_pk_bf16_f32 v185, v178, v179
    v_cvt_pk_bf16_f32 v186, v180, v181
    v_mfma_f32_16x16x32_bf16 v[160:163], a[208:211], v[48:51], v[160:163]
    ds_read_b128 a[200:203], v212 offset:21504
    v_cvt_pk_bf16_f32 v187, v182, v183
    buffer_store_dwordx4 v[184:187], v212, s[24:27], s40 offen offset:0 sc1
    v_accvgpr_read_b32 v236, a132
    v_mfma_f32_16x16x32_bf16 v[160:163], a[212:215], v[56:59], v[160:163]
    ds_read_b128 a[204:207], v212 offset:31744
    v_accvgpr_read_b32 v237, a133
    v_accvgpr_read_b32 v238, a134
    v_mfma_f32_16x16x32_bf16 v[164:167], a[208:211], v[52:55], v[164:167]
    buffer_load_dwordx4 v212, s[8:11], s34 offen offset:1024 lds
    v_accvgpr_read_b32 v239, a135
    v_accvgpr_read_b32 v240, a148
    v_mfma_f32_16x16x32_bf16 v[164:167], a[212:215], v[60:63], v[164:167]
    s_waitcnt lgkmcnt(4)
    v_accvgpr_read_b32 v241, a149
    v_accvgpr_read_b32 v242, a150
    v_accvgpr_read_b32 v243, a151
    v_mfma_f32_16x16x32_bf16 v[168:171], a[216:219], v[48:51], v[168:171]
    ds_read_b128 a[208:211], v212 offset:22528
    v_mul_f32 v236, v236, v197
    v_mul_f32 v237, v237, v197
    v_mfma_f32_16x16x32_bf16 v[168:171], a[220:223], v[56:59], v[168:171]
    ds_read_b128 a[212:215], v212 offset:32768
    v_mul_f32 v238, v238, v197
    v_mul_f32 v239, v239, v197
    v_mul_f32 v240, v240, v197
    v_mfma_f32_16x16x32_bf16 v[172:175], a[216:219], v[52:55], v[172:175]
    buffer_load_dwordx4 v212, s[8:11], s34 offen offset:2048 lds
    v_mul_f32 v241, v241, v197
    v_mul_f32 v242, v242, v197
    v_mfma_f32_16x16x32_bf16 v[172:175], a[220:223], v[60:63], v[172:175]
    s_waitcnt lgkmcnt(4)
    v_mul_f32 v243, v243, v197
    v_cvt_pk_bf16_f32 v188, v236, v237
    v_mfma_f32_16x16x32_bf16 v[96:99], a[192:195], v[64:67], v[96:99]
    ds_read_b128 a[216:219], v212 offset:23552
    v_cvt_pk_bf16_f32 v189, v238, v239
    v_cvt_pk_bf16_f32 v190, v240, v241
    v_cvt_pk_bf16_f32 v191, v242, v243
    v_mfma_f32_16x16x32_bf16 v[96:99], a[196:199], v[72:75], v[96:99]
    ds_read_b128 a[220:223], v212 offset:33792
    buffer_store_dwordx4 v[188:191], v212, s[24:27], s40 offen offset:1024 sc1
    v_accvgpr_read_b32 v176, a136
    v_mfma_f32_16x16x32_bf16 v[100:103], a[192:195], v[68:71], v[100:103]
    buffer_load_dwordx4 v212, s[8:11], s34 offen offset:3072 lds
    v_accvgpr_read_b32 v177, a137
    v_accvgpr_read_b32 v178, a138
    v_mfma_f32_16x16x32_bf16 v[100:103], a[196:199], v[76:79], v[100:103]
    s_waitcnt lgkmcnt(4)
    s_add_u32 m0, s31, 143360
    v_accvgpr_read_b32 v179, a139
    v_accvgpr_read_b32 v180, a152
    v_accvgpr_read_b32 v181, a153
    v_mfma_f32_16x16x32_bf16 v[104:107], a[200:203], v[64:67], v[104:107]
    ds_read_b128 a[192:195], v212 offset:24576
    v_accvgpr_read_b32 v182, a154
    v_accvgpr_read_b32 v183, a155
    v_mfma_f32_16x16x32_bf16 v[104:107], a[204:207], v[72:75], v[104:107]
    ds_read_b128 a[196:199], v212 offset:34816
    v_mul_f32 v176, v176, v198
    v_mul_f32 v177, v177, v198
    v_mfma_f32_16x16x32_bf16 v[108:111], a[200:203], v[68:71], v[108:111]
    buffer_load_dwordx4 v213, s[8:11], s34 offen offset:0 lds
    v_mul_f32 v178, v178, v198
    v_mul_f32 v179, v179, v198
    v_mul_f32 v180, v180, v198
    v_mfma_f32_16x16x32_bf16 v[108:111], a[204:207], v[76:79], v[108:111]
    s_waitcnt lgkmcnt(4)
    s_add_u32 s34, s34, 81920
    v_mul_f32 v181, v181, v198
    v_mul_f32 v182, v182, v198
    v_mfma_f32_16x16x32_bf16 v[112:115], a[208:211], v[64:67], v[112:115]
    ds_read_b128 a[200:203], v212 offset:25600
    v_mul_f32 v183, v183, v198
    v_cvt_pk_bf16_f32 v184, v176, v177
    v_cvt_pk_bf16_f32 v185, v178, v179
    v_mfma_f32_16x16x32_bf16 v[112:115], a[212:215], v[72:75], v[112:115]
    ds_read_b128 a[204:207], v212 offset:35840
    v_cvt_pk_bf16_f32 v186, v180, v181
    v_cvt_pk_bf16_f32 v187, v182, v183
    v_mfma_f32_16x16x32_bf16 v[116:119], a[208:211], v[68:71], v[116:119]
    buffer_store_dwordx4 v[184:187], v212, s[24:27], s40 offen offset:2048 sc1
    v_accvgpr_read_b32 v236, a140
    v_mfma_f32_16x16x32_bf16 v[116:119], a[212:215], v[76:79], v[116:119]
    s_waitcnt lgkmcnt(4)
    v_accvgpr_read_b32 v237, a141
    v_accvgpr_read_b32 v238, a142
    v_accvgpr_read_b32 v239, a143
    v_mfma_f32_16x16x32_bf16 v[120:123], a[216:219], v[64:67], v[120:123]
    ds_read_b128 a[208:211], v212 offset:26624
    v_accvgpr_read_b32 v240, a156
    v_accvgpr_read_b32 v241, a157
    v_mfma_f32_16x16x32_bf16 v[120:123], a[220:223], v[72:75], v[120:123]
    ds_read_b128 a[212:215], v212 offset:36864
    v_accvgpr_read_b32 v242, a158
    v_accvgpr_read_b32 v243, a159
    v_mfma_f32_16x16x32_bf16 v[124:127], a[216:219], v[68:71], v[124:127]
    v_mul_f32 v236, v236, v199
    v_mul_f32 v237, v237, v199
    v_mul_f32 v238, v238, v199
    v_mfma_f32_16x16x32_bf16 v[124:127], a[220:223], v[76:79], v[124:127]
    s_waitcnt lgkmcnt(4)
    v_mul_f32 v239, v239, v199
    v_mul_f32 v240, v240, v199
    v_mfma_f32_16x16x32_bf16 v[128:131], a[192:195], v[64:67], v[128:131]
    ds_read_b128 a[216:219], v212 offset:27648
    v_mul_f32 v241, v241, v199
    v_mul_f32 v242, v242, v199
    v_mfma_f32_16x16x32_bf16 v[128:131], a[196:199], v[72:75], v[128:131]
    ds_read_b128 a[220:223], v212 offset:37888
    v_mul_f32 v243, v243, v199
    v_cvt_pk_bf16_f32 v188, v236, v237
    v_cvt_pk_bf16_f32 v189, v238, v239
    v_mfma_f32_16x16x32_bf16 v[132:135], a[192:195], v[68:71], v[132:135]
    v_cvt_pk_bf16_f32 v190, v240, v241
    v_cvt_pk_bf16_f32 v191, v242, v243
    v_mfma_f32_16x16x32_bf16 v[132:135], a[196:199], v[76:79], v[132:135]
    s_waitcnt lgkmcnt(4)
    buffer_store_dwordx4 v[188:191], v212, s[24:27], s40 offen offset:3072 sc1
    s_add_u32 s40, s40, 32768
    v_mfma_f32_16x16x32_bf16 v[136:139], a[200:203], v[64:67], v[136:139]
    ds_read_b128 a[192:195], v212 offset:28672
    v_accvgpr_read_b32 v176, a160
    v_accvgpr_read_b32 v177, a161
    v_accvgpr_read_b32 v178, a162
    v_mfma_f32_16x16x32_bf16 v[136:139], a[204:207], v[72:75], v[136:139]
    ds_read_b128 a[196:199], v212 offset:38912
    v_accvgpr_read_b32 v179, a163
    v_accvgpr_read_b32 v180, a176
    v_mfma_f32_16x16x32_bf16 v[140:143], a[200:203], v[68:71], v[140:143]
    v_accvgpr_read_b32 v181, a177
    v_accvgpr_read_b32 v182, a178
    v_accvgpr_read_b32 v183, a179
    v_mfma_f32_16x16x32_bf16 v[140:143], a[204:207], v[76:79], v[140:143]
    s_waitcnt lgkmcnt(4)
    v_mul_f32 v176, v176, v196
    v_mul_f32 v177, v177, v196
    v_mfma_f32_16x16x32_bf16 v[144:147], a[208:211], v[64:67], v[144:147]
    ds_read_b128 a[200:203], v212 offset:29696
    v_mul_f32 v178, v178, v196
    v_mul_f32 v179, v179, v196
    v_mfma_f32_16x16x32_bf16 v[144:147], a[212:215], v[72:75], v[144:147]
    ds_read_b128 a[204:207], v212 offset:39936
    v_mul_f32 v180, v180, v196
    v_mul_f32 v181, v181, v196
    v_mul_f32 v182, v182, v196
    v_mfma_f32_16x16x32_bf16 v[148:151], a[208:211], v[68:71], v[148:151]
    v_mul_f32 v183, v183, v196
    v_cvt_pk_bf16_f32 v184, v176, v177
    v_mfma_f32_16x16x32_bf16 v[148:151], a[212:215], v[76:79], v[148:151]
    s_barrier
    s_waitcnt lgkmcnt(4)
    s_add_u32 m0, s31, 0
    v_cvt_pk_bf16_f32 v185, v178, v179
    v_cvt_pk_bf16_f32 v186, v180, v181
    v_mfma_f32_16x16x32_bf16 v[152:155], a[216:219], v[64:67], v[152:155]
    ds_read_b128 a[208:211], v212 offset:40960
    v_cvt_pk_bf16_f32 v187, v182, v183
    buffer_store_dwordx4 v[184:187], v212, s[24:27], s40 offen offset:0 sc1
    v_accvgpr_read_b32 v236, a164
    v_mfma_f32_16x16x32_bf16 v[152:155], a[220:223], v[72:75], v[152:155]
    ds_read_b128 a[212:215], v212 offset:51200
    v_accvgpr_read_b32 v237, a165
    v_accvgpr_read_b32 v238, a166
    v_mfma_f32_16x16x32_bf16 v[156:159], a[216:219], v[68:71], v[156:159]
    buffer_load_dwordx4 v212, s[8:11], s34 offen offset:0 lds
    v_accvgpr_read_b32 v239, a167
    v_accvgpr_read_b32 v240, a180
    v_mfma_f32_16x16x32_bf16 v[156:159], a[220:223], v[76:79], v[156:159]
    s_waitcnt lgkmcnt(4)
    v_accvgpr_read_b32 v241, a181
    v_accvgpr_read_b32 v242, a182
    v_accvgpr_read_b32 v243, a183
    v_mfma_f32_16x16x32_bf16 v[160:163], a[192:195], v[64:67], v[160:163]
    ds_read_b128 a[216:219], v212 offset:41984
    v_mul_f32 v236, v236, v197
    v_mul_f32 v237, v237, v197
    v_mfma_f32_16x16x32_bf16 v[160:163], a[196:199], v[72:75], v[160:163]
    ds_read_b128 a[220:223], v212 offset:52224
    v_mul_f32 v238, v238, v197
    v_mul_f32 v239, v239, v197
    v_mul_f32 v240, v240, v197
    v_mfma_f32_16x16x32_bf16 v[164:167], a[192:195], v[68:71], v[164:167]
    buffer_load_dwordx4 v212, s[8:11], s34 offen offset:1024 lds
    v_mul_f32 v241, v241, v197
    v_mul_f32 v242, v242, v197
    v_mfma_f32_16x16x32_bf16 v[164:167], a[196:199], v[76:79], v[164:167]
    s_waitcnt lgkmcnt(4)
    v_mul_f32 v243, v243, v197
    v_cvt_pk_bf16_f32 v188, v236, v237
    v_mfma_f32_16x16x32_bf16 v[168:171], a[200:203], v[64:67], v[168:171]
    ds_read_b128 a[192:195], v212 offset:43008
    v_cvt_pk_bf16_f32 v189, v238, v239
    v_cvt_pk_bf16_f32 v190, v240, v241
    v_cvt_pk_bf16_f32 v191, v242, v243
    v_mfma_f32_16x16x32_bf16 v[168:171], a[204:207], v[72:75], v[168:171]
    ds_read_b128 a[196:199], v212 offset:53248
    buffer_store_dwordx4 v[188:191], v212, s[24:27], s40 offen offset:1024 sc1
    v_accvgpr_read_b32 v176, a168
    v_mfma_f32_16x16x32_bf16 v[172:175], a[200:203], v[68:71], v[172:175]
    buffer_load_dwordx4 v212, s[8:11], s34 offen offset:2048 lds
    v_accvgpr_read_b32 v177, a169
    v_accvgpr_read_b32 v178, a170
    v_mfma_f32_16x16x32_bf16 v[172:175], a[204:207], v[76:79], v[172:175]
    s_waitcnt lgkmcnt(4)
    v_accvgpr_read_b32 v179, a171
    v_accvgpr_read_b32 v180, a184
    v_accvgpr_read_b32 v181, a185
    v_mfma_f32_16x16x32_bf16 v[96:99], a[208:211], v[80:83], v[96:99]
    ds_read_b128 a[200:203], v212 offset:44032
    v_accvgpr_read_b32 v182, a186
    v_accvgpr_read_b32 v183, a187
    v_mfma_f32_16x16x32_bf16 v[96:99], a[212:215], v[88:91], v[96:99]
    ds_read_b128 a[204:207], v212 offset:54272
    v_mul_f32 v176, v176, v198
    v_mul_f32 v177, v177, v198
    v_mfma_f32_16x16x32_bf16 v[100:103], a[208:211], v[84:87], v[100:103]
    buffer_load_dwordx4 v212, s[8:11], s34 offen offset:3072 lds
    v_mul_f32 v178, v178, v198
    v_mul_f32 v179, v179, v198
    v_mul_f32 v180, v180, v198
    v_mfma_f32_16x16x32_bf16 v[100:103], a[212:215], v[92:95], v[100:103]
    s_waitcnt lgkmcnt(4)
    buffer_load_dword v248, v218, s[72:75], s15 offen sc1
    s_add_u32 m0, s31, 4096
    v_mul_f32 v181, v181, v198
    v_mul_f32 v182, v182, v198
    v_mfma_f32_16x16x32_bf16 v[104:107], a[216:219], v[80:83], v[104:107]
    ds_read_b128 a[208:211], v212 offset:45056
    v_mul_f32 v183, v183, v198
    v_cvt_pk_bf16_f32 v184, v176, v177
    v_cvt_pk_bf16_f32 v185, v178, v179
    v_mfma_f32_16x16x32_bf16 v[104:107], a[220:223], v[88:91], v[104:107]
    ds_read_b128 a[212:215], v212 offset:55296
    v_cvt_pk_bf16_f32 v186, v180, v181
    v_cvt_pk_bf16_f32 v187, v182, v183
    v_mfma_f32_16x16x32_bf16 v[108:111], a[216:219], v[84:87], v[108:111]
    buffer_load_dwordx4 v213, s[8:11], s34 offen offset:0 lds
    buffer_store_dwordx4 v[184:187], v212, s[24:27], s40 offen offset:2048 sc1
    v_accvgpr_read_b32 v236, a172
    v_mfma_f32_16x16x32_bf16 v[108:111], a[220:223], v[92:95], v[108:111]
    s_waitcnt lgkmcnt(4)
    s_add_u32 s34, s34, 81920
    v_accvgpr_read_b32 v237, a173
    v_accvgpr_read_b32 v238, a174
    v_accvgpr_read_b32 v239, a175
    v_mfma_f32_16x16x32_bf16 v[112:115], a[192:195], v[80:83], v[112:115]
    ds_read_b128 a[216:219], v212 offset:46080
    v_accvgpr_read_b32 v240, a188
    v_accvgpr_read_b32 v241, a189
    v_mfma_f32_16x16x32_bf16 v[112:115], a[196:199], v[88:91], v[112:115]
    ds_read_b128 a[220:223], v212 offset:56320
    v_accvgpr_read_b32 v242, a190
    v_accvgpr_read_b32 v243, a191
    v_cvt_pk_bf16_f32 v192, v96, v97
    v_mfma_f32_16x16x32_bf16 v[116:119], a[192:195], v[84:87], v[116:119]
    v_mul_f32 v236, v236, v199
    v_mul_f32 v237, v237, v199
    v_mul_f32 v238, v238, v199
    v_cvt_pk_bf16_f32 v193, v98, v99
    v_mfma_f32_16x16x32_bf16 v[116:119], a[196:199], v[92:95], v[116:119]
    s_waitcnt lgkmcnt(4)
    v_mul_f32 v239, v239, v199
    v_mul_f32 v240, v240, v199
    v_cvt_pk_bf16_f32 v194, v100, v101
    v_mfma_f32_16x16x32_bf16 v[120:123], a[200:203], v[80:83], v[120:123]
    ds_read_b128 a[192:195], v212 offset:47104
    v_mul_f32 v241, v241, v199
    v_mul_f32 v242, v242, v199
    v_cvt_pk_bf16_f32 v195, v102, v103
    v_mfma_f32_16x16x32_bf16 v[120:123], a[204:207], v[88:91], v[120:123]
    ds_read_b128 a[196:199], v212 offset:57344
    v_mul_f32 v243, v243, v199
    v_cvt_pk_bf16_f32 v188, v236, v237
    v_cvt_pk_bf16_f32 v189, v238, v239
    v_cvt_pk_bf16_f32 v200, v104, v105
    v_mfma_f32_16x16x32_bf16 v[124:127], a[200:203], v[84:87], v[124:127]
    v_cvt_pk_bf16_f32 v190, v240, v241
    v_cvt_pk_bf16_f32 v191, v242, v243
    v_cvt_pk_bf16_f32 v201, v106, v107
    v_mfma_f32_16x16x32_bf16 v[124:127], a[204:207], v[92:95], v[124:127]
    s_waitcnt lgkmcnt(4)
    buffer_store_dwordx4 v[188:191], v212, s[24:27], s40 offen offset:3072 sc1
    s_add_u32 s40, s40, 32768
    v_cvt_pk_bf16_f32 v202, v108, v109
    v_mfma_f32_16x16x32_bf16 v[128:131], a[208:211], v[80:83], v[128:131]
    ds_read_b128 a[200:203], v212 offset:48128
    v_cvt_pk_bf16_f32 v203, v110, v111
    v_mfma_f32_16x16x32_bf16 v[128:131], a[212:215], v[88:91], v[128:131]
    ds_read_b128 a[204:207], v212 offset:58368
    v_cvt_pk_bf16_f32 v204, v112, v113
    v_mfma_f32_16x16x32_bf16 v[132:135], a[208:211], v[84:87], v[132:135]
    v_cvt_pk_bf16_f32 v205, v114, v115
    v_mfma_f32_16x16x32_bf16 v[132:135], a[212:215], v[92:95], v[132:135]
    s_waitcnt lgkmcnt(4)
    v_cvt_pk_bf16_f32 v206, v116, v117
    v_mfma_f32_16x16x32_bf16 v[136:139], a[216:219], v[80:83], v[136:139]
    ds_read_b128 a[208:211], v212 offset:49152
    v_cvt_pk_bf16_f32 v207, v118, v119
    v_mfma_f32_16x16x32_bf16 v[136:139], a[220:223], v[88:91], v[136:139]
    ds_read_b128 a[212:215], v212 offset:59392
    v_cvt_pk_bf16_f32 v208, v120, v121
    v_mfma_f32_16x16x32_bf16 v[140:143], a[216:219], v[84:87], v[140:143]
    v_cvt_pk_bf16_f32 v209, v122, v123
    v_mfma_f32_16x16x32_bf16 v[140:143], a[220:223], v[92:95], v[140:143]
    s_waitcnt lgkmcnt(4)
    v_cvt_pk_bf16_f32 v210, v124, v125
    v_mfma_f32_16x16x32_bf16 v[144:147], a[192:195], v[80:83], v[144:147]
    ds_read_b128 a[216:219], v212 offset:50176
    v_cvt_pk_bf16_f32 v211, v126, v127
    v_mfma_f32_16x16x32_bf16 v[144:147], a[196:199], v[88:91], v[144:147]
    ds_read_b128 a[220:223], v212 offset:60416
    v_cvt_pk_bf16_f32 v220, v128, v129
    v_mfma_f32_16x16x32_bf16 v[148:151], a[192:195], v[84:87], v[148:151]
    s_waitcnt vmcnt(34)
    v_cvt_pk_bf16_f32 v221, v130, v131
    v_mfma_f32_16x16x32_bf16 v[148:151], a[196:199], v[92:95], v[148:151]
    s_barrier
    s_waitcnt lgkmcnt(4)
    s_add_u32 m0, s31, 20480
    v_cvt_pk_bf16_f32 v222, v132, v133
    v_mfma_f32_16x16x32_bf16 v[152:155], a[200:203], v[80:83], v[152:155]
    ds_read_b128 a[192:195], v215 offset:0
    v_cvt_pk_bf16_f32 v223, v134, v135
    v_mfma_f32_16x16x32_bf16 v[152:155], a[204:207], v[88:91], v[152:155]
    ds_read_b128 a[196:199], v215 offset:10240
    v_cvt_pk_bf16_f32 v224, v136, v137
    v_mfma_f32_16x16x32_bf16 v[156:159], a[200:203], v[84:87], v[156:159]
    buffer_load_dwordx4 v212, s[8:11], s34 offen offset:0 lds
    v_cvt_pk_bf16_f32 v225, v138, v139
    v_mfma_f32_16x16x32_bf16 v[156:159], a[204:207], v[92:95], v[156:159]
    s_waitcnt lgkmcnt(4)
    v_cvt_pk_bf16_f32 v226, v140, v141
    v_mfma_f32_16x16x32_bf16 v[160:163], a[208:211], v[80:83], v[160:163]
    ds_read_b128 a[200:203], v215 offset:1024
    v_cvt_pk_bf16_f32 v227, v142, v143
    v_mfma_f32_16x16x32_bf16 v[160:163], a[212:215], v[88:91], v[160:163]
    ds_read_b128 a[204:207], v215 offset:11264
    v_cvt_pk_bf16_f32 v228, v144, v145
    v_mfma_f32_16x16x32_bf16 v[164:167], a[208:211], v[84:87], v[164:167]
    buffer_load_dwordx4 v212, s[8:11], s34 offen offset:1024 lds
    v_cvt_pk_bf16_f32 v229, v146, v147
    v_mfma_f32_16x16x32_bf16 v[164:167], a[212:215], v[92:95], v[164:167]
    s_waitcnt lgkmcnt(4)
    v_cvt_pk_bf16_f32 v230, v148, v149
    v_mfma_f32_16x16x32_bf16 v[168:171], a[216:219], v[80:83], v[168:171]
    ds_read_b128 a[208:211], v215 offset:2048
    v_cvt_pk_bf16_f32 v231, v150, v151
    v_mfma_f32_16x16x32_bf16 v[168:171], a[220:223], v[88:91], v[168:171]
    ds_read_b128 a[212:215], v215 offset:12288
    v_cvt_pk_bf16_f32 v232, v152, v153
    v_mfma_f32_16x16x32_bf16 v[172:175], a[216:219], v[84:87], v[172:175]
    buffer_load_dwordx4 v212, s[8:11], s34 offen offset:2048 lds
    v_cvt_pk_bf16_f32 v233, v154, v155
    v_mfma_f32_16x16x32_bf16 v[172:175], a[220:223], v[92:95], v[172:175]
    s_waitcnt lgkmcnt(4)
    v_cvt_pk_bf16_f32 v234, v156, v157
    s_waitcnt vmcnt(6)
K2_pchk0:
    s_add_u32 s42, s58, 2
    v_subrev_u32 v248, s42, v248
    v_cmp_lt_u32 vcc, 4, v248
    s_cbranch_vccnz K2_pslow0
K2_pok0:
    buffer_load_dwordx4 v[0:3], v212, s[4:7], s33 offen offset:0 sc1
    buffer_load_dwordx4 v[4:7], v212, s[4:7], s33 offen offset:1024 sc1
    buffer_load_dwordx4 v[8:11], v213, s[4:7], s33 offen offset:0 sc1
    buffer_load_dwordx4 v[12:15], v213, s[4:7], s33 offen offset:1024 sc1
    s_add_u32 s33, s33, 8192
    buffer_load_dwordx4 v[16:19], v212, s[4:7], s33 offen offset:0 sc1
    buffer_load_dwordx4 v[20:23], v212, s[4:7], s33 offen offset:1024 sc1
    buffer_load_dwordx4 v[24:27], v213, s[4:7], s33 offen offset:0 sc1
    buffer_load_dwordx4 v[28:31], v213, s[4:7], s33 offen offset:1024 sc1
    s_add_u32 s33, s33, 8192
    buffer_load_dwordx4 v[32:35], v212, s[4:7], s33 offen offset:0 sc1
    buffer_load_dwordx4 v[36:39], v212, s[4:7], s33 offen offset:1024 sc1
    buffer_load_dwordx4 v[40:43], v213, s[4:7], s33 offen offset:0 sc1
    buffer_load_dwordx4 v[44:47], v213, s[4:7], s33 offen offset:1024 sc1
    s_add_u32 s33, s33, 8192
    s_waitcnt vmcnt(8)
    v_mfma_f32_16x16x32_bf16 v[96:99], a[192:195], v[0:3], 0
    ds_read_b128 a[216:219], v215 offset:3072
    v_cvt_pk_bf16_f32 v235, v158, v159
    v_mfma_f32_16x16x32_bf16 v[96:99], a[196:199], v[8:11], v[96:99]
    ds_read_b128 a[220:223], v215 offset:13312
    v_cvt_pk_bf16_f32 v244, v160, v161
    v_mfma_f32_16x16x32_bf16 v[100:103], a[192:195], v[4:7], 0
    buffer_load_dwordx4 v212, s[8:11], s34 offen offset:3072 lds
    v_cvt_pk_bf16_f32 v245, v162, v163
    v_mfma_f32_16x16x32_bf16 v[100:103], a[196:199], v[12:15], v[100:103]
    s_waitcnt lgkmcnt(4)
    s_add_u32 m0, s31, 24576
    v_cvt_pk_bf16_f32 v246, v164, v165
    v_mfma_f32_16x16x32_bf16 v[104:107], a[200:203], v[0:3], 0
    ds_read_b128 a[192:195], v215 offset:4096
    v_cvt_pk_bf16_f32 v247, v166, v167
    v_mfma_f32_16x16x32_bf16 v[104:107], a[204:207], v[8:11], v[104:107]
    ds_read_b128 a[196:199], v215 offset:14336
    v_cvt_pk_bf16_f32 v252, v168, v169
    v_mfma_f32_16x16x32_bf16 v[108:111], a[200:203], v[4:7], 0
    buffer_load_dwordx4 v213, s[8:11], s34 offen offset:0 lds
    v_cvt_pk_bf16_f32 v253, v170, v171
    v_mfma_f32_16x16x32_bf16 v[108:111], a[204:207], v[12:15], v[108:111]
    s_waitcnt lgkmcnt(4)
    s_add_u32 s34, s34, 81920
    v_cvt_pk_bf16_f32 v254, v172, v173
    v_mfma_f32_16x16x32_bf16 v[112:115], a[208:211], v[0:3], 0
    ds_read_b128 a[200:203], v215 offset:5120
    v_cvt_pk_bf16_f32 v255, v174, v175
    v_mfma_f32_16x16x32_bf16 v[112:115], a[212:215], v[8:11], v[112:115]
    ds_read_b128 a[204:207], v215 offset:15360
    s_mul_i32 s41, s28, 81920
    v_mfma_f32_16x16x32_bf16 v[116:119], a[208:211], v[4:7], 0
    buffer_load_dwordx4 v[48:51], v212, s[4:7], s33 offen offset:0 sc1
    v_mfma_f32_16x16x32_bf16 v[116:119], a[212:215], v[12:15], v[116:119]
    s_waitcnt lgkmcnt(4)
    s_mul_i32 s42, s12, 10240
    v_mfma_f32_16x16x32_bf16 v[120:123], a[216:219], v[0:3], 0
    ds_read_b128 a[208:211], v215 offset:6144
    s_add_u32 s41, s41, s42
    v_mfma_f32_16x16x32_bf16 v[120:123], a[220:223], v[8:11], v[120:123]
    ds_read_b128 a[212:215], v215 offset:16384
    s_add_u32 s41, s41, 40960
    v_mfma_f32_16x16x32_bf16 v[124:127], a[216:219], v[4:7], 0
    buffer_load_dwordx4 v[52:55], v212, s[4:7], s33 offen offset:1024 sc1
    v_mfma_f32_16x16x32_bf16 v[124:127], a[220:223], v[12:15], v[124:127]
    s_waitcnt lgkmcnt(4)
    s_cmp_eq_u32 s28, s12
    s_cselect_b32 s41, 0x40000000, s41
    v_mfma_f32_16x16x32_bf16 v[128:131], a[192:195], v[0:3], 0
    ds_read_b128 a[216:219], v215 offset:7168
    v_mfma_f32_16x16x32_bf16 v[128:131], a[196:199], v[8:11], v[128:131]
    ds_read_b128 a[220:223], v215 offset:17408
    v_mfma_f32_16x16x32_bf16 v[132:135], a[192:195], v[4:7], 0
    buffer_load_dwordx4 v[56:59], v213, s[4:7], s33 offen offset:0 sc1
    v_mfma_f32_16x16x32_bf16 v[132:135], a[196:199], v[12:15], v[132:135]
    s_waitcnt lgkmcnt(4)
    s_cmp_eq_u32 s28, s12
    s_cselect_b32 s42, 10240, 0
    v_mfma_f32_16x16x32_bf16 v[136:139], a[200:203], v[0:3], 0
    ds_read_b128 a[192:195], v215 offset:8192
    s_add_u32 s42, s42, 71680
    v_mfma_f32_16x16x32_bf16 v[136:139], a[204:207], v[8:11], v[136:139]
    ds_read_b128 a[196:199], v215 offset:18432
    v_add_u32 v243, s42, v212
    v_mfma_f32_16x16x32_bf16 v[140:143], a[200:203], v[4:7], 0
    buffer_load_dwordx4 v[60:63], v213, s[4:7], s33 offen offset:1024 sc1
    v_mfma_f32_16x16x32_bf16 v[140:143], a[204:207], v[12:15], v[140:143]
    s_waitcnt lgkmcnt(4)
    s_add_u32 s33, s33, 8192
    v_mfma_f32_16x16x32_bf16 v[144:147], a[208:211], v[0:3], 0
    ds_read_b128 a[200:203], v215 offset:9216
    v_mfma_f32_16x16x32_bf16 v[144:147], a[212:215], v[8:11], v[144:147]
    ds_read_b128 a[204:207], v215 offset:19456
    v_mfma_f32_16x16x32_bf16 v[148:151], a[208:211], v[4:7], 0
    v_mfma_f32_16x16x32_bf16 v[148:151], a[212:215], v[12:15], v[148:151]
    s_barrier
    s_waitcnt lgkmcnt(4)
    s_add_u32 m0, s31, 40960
    v_mfma_f32_16x16x32_bf16 v[152:155], a[216:219], v[0:3], 0
    ds_read_b128 a[208:211], v215 offset:20480
    v_mfma_f32_16x16x32_bf16 v[152:155], a[220:223], v[8:11], v[152:155]
    ds_read_b128 a[212:215], v215 offset:30720
    v_mfma_f32_16x16x32_bf16 v[156:159], a[216:219], v[4:7], 0
    buffer_load_dwordx4 v212, s[8:11], s34 offen offset:0 lds
    v_mfma_f32_16x16x32_bf16 v[156:159], a[220:223], v[12:15], v[156:159]
    s_waitcnt lgkmcnt(4)
    v_mfma_f32_16x16x32_bf16 v[160:163], a[192:195], v[0:3], 0
    ds_read_b128 a[216:219], v215 offset:21504
    v_mfma_f32_16x16x32_bf16 v[160:163], a[196:199], v[8:11], v[160:163]
    ds_read_b128 a[220:223], v215 offset:31744
    v_mfma_f32_16x16x32_bf16 v[164:167], a[192:195], v[4:7], 0
    buffer_load_dwordx4 v212, s[8:11], s34 offen offset:1024 lds
    v_mfma_f32_16x16x32_bf16 v[164:167], a[196:199], v[12:15], v[164:167]
    s_waitcnt lgkmcnt(4)
    v_mfma_f32_16x16x32_bf16 v[168:171], a[200:203], v[0:3], 0
    ds_read_b128 a[192:195], v215 offset:22528
    v_mfma_f32_16x16x32_bf16 v[168:171], a[204:207], v[8:11], v[168:171]
    ds_read_b128 a[196:199], v215 offset:32768
    v_mfma_f32_16x16x32_bf16 v[172:175], a[200:203], v[4:7], 0
    buffer_load_dwordx4 v212, s[8:11], s34 offen offset:2048 lds
    v_mfma_f32_16x16x32_bf16 v[172:175], a[204:207], v[12:15], v[172:175]
    s_waitcnt vmcnt(13) lgkmcnt(4)
    v_mfma_f32_16x16x32_bf16 v[96:99], a[208:211], v[16:19], v[96:99]
    ds_read_b128 a[200:203], v215 offset:23552
    v_mfma_f32_16x16x32_bf16 v[96:99], a[212:215], v[24:27], v[96:99]
    ds_read_b128 a[204:207], v215 offset:33792
    v_mfma_f32_16x16x32_bf16 v[100:103], a[208:211], v[20:23], v[100:103]
    buffer_load_dwordx4 v212, s[8:11], s34 offen offset:3072 lds
    v_mfma_f32_16x16x32_bf16 v[100:103], a[212:215], v[28:31], v[100:103]
    s_waitcnt lgkmcnt(4)
    s_add_u32 m0, s31, 45056
    buffer_store_dwordx4 v[192:195], v212, s[60:63], s41 offen offset:0 sc1
    v_mfma_f32_16x16x32_bf16 v[104:107], a[216:219], v[16:19], v[104:107]
    ds_read_b128 a[208:211], v215 offset:24576
    v_mfma_f32_16x16x32_bf16 v[104:107], a[220:223], v[24:27], v[104:107]
    ds_read_b128 a[212:215], v215 offset:34816
    v_mfma_f32_16x16x32_bf16 v[108:111], a[216:219], v[20:23], v[108:111]
    buffer_load_dwordx4 v213, s[8:11], s34 offen offset:0 lds
    v_mfma_f32_16x16x32_bf16 v[108:111], a[220:223], v[28:31], v[108:111]
    s_waitcnt lgkmcnt(4)
    s_add_u32 s34, s34, 81920
    ds_write_b128 v243, v[192:195] offset:0
    v_mfma_f32_16x16x32_bf16 v[112:115], a[192:195], v[16:19], v[112:115]
    ds_read_b128 a[216:219], v215 offset:25600
    v_mfma_f32_16x16x32_bf16 v[112:115], a[196:199], v[24:27], v[112:115]
    ds_read_b128 a[220:223], v215 offset:35840
    v_mfma_f32_16x16x32_bf16 v[116:119], a[192:195], v[20:23], v[116:119]
    buffer_load_dwordx4 v[64:67], v212, s[4:7], s33 offen offset:0 sc1
    v_mfma_f32_16x16x32_bf16 v[116:119], a[196:199], v[28:31], v[116:119]
    s_waitcnt lgkmcnt(5)
    v_mfma_f32_16x16x32_bf16 v[120:123], a[200:203], v[16:19], v[120:123]
    ds_read_b128 a[192:195], v215 offset:26624
    v_mfma_f32_16x16x32_bf16 v[120:123], a[204:207], v[24:27], v[120:123]
    ds_read_b128 a[196:199], v215 offset:36864
    v_mfma_f32_16x16x32_bf16 v[124:127], a[200:203], v[20:23], v[124:127]
    buffer_load_dwordx4 v[68:71], v212, s[4:7], s33 offen offset:1024 sc1
    v_mfma_f32_16x16x32_bf16 v[124:127], a[204:207], v[28:31], v[124:127]
    s_waitcnt lgkmcnt(5)
    buffer_store_dwordx4 v[200:203], v212, s[60:63], s41 offen offset:1024 sc1
    v_mfma_f32_16x16x32_bf16 v[128:131], a[208:211], v[16:19], v[128:131]
    ds_read_b128 a[200:203], v215 offset:27648
    v_mfma_f32_16x16x32_bf16 v[128:131], a[212:215], v[24:27], v[128:131]
    ds_read_b128 a[204:207], v215 offset:37888
    v_mfma_f32_16x16x32_bf16 v[132:135], a[208:211], v[20:23], v[132:135]
    buffer_load_dwordx4 v[72:75], v213, s[4:7], s33 offen offset:0 sc1
    v_mfma_f32_16x16x32_bf16 v[132:135], a[212:215], v[28:31], v[132:135]
    s_waitcnt lgkmcnt(4)
    ds_write_b128 v243, v[200:203] offset:1024
    v_mfma_f32_16x16x32_bf16 v[136:139], a[216:219], v[16:19], v[136:139]
    ds_read_b128 a[208:211], v215 offset:28672
    v_mfma_f32_16x16x32_bf16 v[136:139], a[220:223], v[24:27], v[136:139]
    ds_read_b128 a[212:215], v215 offset:38912
    v_mfma_f32_16x16x32_bf16 v[140:143], a[216:219], v[20:23], v[140:143]
    buffer_load_dwordx4 v[76:79], v213, s[4:7], s33 offen offset:1024 sc1
    v_mfma_f32_16x16x32_bf16 v[140:143], a[220:223], v[28:31], v[140:143]
    s_waitcnt lgkmcnt(5)
    s_add_u32 s33, s33, 8192
    v_mfma_f32_16x16x32_bf16 v[144:147], a[192:195], v[16:19], v[144:147]
    ds_read_b128 a[216:219], v215 offset:29696
    v_mov_b32 v217, s58
    v_add_u32 v217, 6, v217
    v_mfma_f32_16x16x32_bf16 v[144:147], a[196:199], v[24:27], v[144:147]
    ds_read_b128 a[220:223], v215 offset:39936
    v_mfma_f32_16x16x32_bf16 v[148:151], a[192:195], v[20:23], v[148:151]
    buffer_store_dwordx4 v[204:207], v212, s[60:63], s41 offen offset:2048 sc1
    v_mfma_f32_16x16x32_bf16 v[148:151], a[196:199], v[28:31], v[148:151]
    s_barrier
    s_waitcnt lgkmcnt(5)
    s_add_u32 m0, s31, 98304
    v_mfma_f32_16x16x32_bf16 v[152:155], a[200:203], v[16:19], v[152:155]
    ds_read_b128 a[192:195], v215 offset:40960
    v_mfma_f32_16x16x32_bf16 v[152:155], a[204:207], v[24:27], v[152:155]
    ds_read_b128 a[196:199], v215 offset:51200
    buffer_store_dword v217, v249, s[72:75], s49 offen sc1
    v_mfma_f32_16x16x32_bf16 v[156:159], a[200:203], v[20:23], v[156:159]
    buffer_load_dwordx4 v212, s[8:11], s34 offen offset:0 lds
    ds_write_b128 v243, v[204:207] offset:2048
    v_mfma_f32_16x16x32_bf16 v[156:159], a[204:207], v[28:31], v[156:159]
    s_waitcnt lgkmcnt(5)
    v_mfma_f32_16x16x32_bf16 v[160:163], a[208:211], v[16:19], v[160:163]
    ds_read_b128 a[200:203], v215 offset:41984
    v_mfma_f32_16x16x32_bf16 v[160:163], a[212:215], v[24:27], v[160:163]
    ds_read_b128 a[204:207], v215 offset:52224
    v_mfma_f32_16x16x32_bf16 v[164:167], a[208:211], v[20:23], v[164:167]
    buffer_load_dwordx4 v212, s[8:11], s34 offen offset:1024 lds
    v_mfma_f32_16x16x32_bf16 v[164:167], a[212:215], v[28:31], v[164:167]
    s_waitcnt lgkmcnt(5)
    v_mfma_f32_16x16x32_bf16 v[168:171], a[216:219], v[16:19], v[168:171]
    ds_read_b128 a[208:211], v215 offset:43008
    v_mfma_f32_16x16x32_bf16 v[168:171], a[220:223], v[24:27], v[168:171]
    ds_read_b128 a[212:215], v215 offset:53248
    v_mfma_f32_16x16x32_bf16 v[172:175], a[216:219], v[20:23], v[172:175]
    buffer_load_dwordx4 v212, s[8:11], s34 offen offset:2048 lds
    v_mfma_f32_16x16x32_bf16 v[172:175], a[220:223], v[28:31], v[172:175]
    s_waitcnt vmcnt(22) lgkmcnt(5)
    v_mfma_f32_16x16x32_bf16 v[96:99], a[192:195], v[32:35], v[96:99]
    ds_read_b128 a[216:219], v215 offset:44032
    v_mfma_f32_16x16x32_bf16 v[96:99], a[196:199], v[40:43], v[96:99]
    ds_read_b128 a[220:223], v215 offset:54272
    v_mfma_f32_16x16x32_bf16 v[100:103], a[192:195], v[36:39], v[100:103]
    buffer_load_dwordx4 v212, s[8:11], s34 offen offset:3072 lds
    v_mfma_f32_16x16x32_bf16 v[100:103], a[196:199], v[44:47], v[100:103]
    s_waitcnt lgkmcnt(4)
    s_add_u32 m0, s31, 102400
    buffer_store_dwordx4 v[208:211], v212, s[60:63], s41 offen offset:3072 sc1
    v_mfma_f32_16x16x32_bf16 v[104:107], a[200:203], v[32:35], v[104:107]
    ds_read_b128 a[192:195], v215 offset:45056
    v_mfma_f32_16x16x32_bf16 v[104:107], a[204:207], v[40:43], v[104:107]
    ds_read_b128 a[196:199], v215 offset:55296
    v_mfma_f32_16x16x32_bf16 v[108:111], a[200:203], v[36:39], v[108:111]
    buffer_load_dwordx4 v213, s[8:11], s34 offen offset:0 lds
    v_mfma_f32_16x16x32_bf16 v[108:111], a[204:207], v[44:47], v[108:111]
    s_waitcnt lgkmcnt(4)
    s_add_u32 s34, s34, 81920
    ds_write_b128 v243, v[208:211] offset:3072
    v_mfma_f32_16x16x32_bf16 v[112:115], a[208:211], v[32:35], v[112:115]
    ds_read_b128 a[200:203], v215 offset:46080
    v_mfma_f32_16x16x32_bf16 v[112:115], a[212:215], v[40:43], v[112:115]
    ds_read_b128 a[204:207], v215 offset:56320
    v_mfma_f32_16x16x32_bf16 v[116:119], a[208:211], v[36:39], v[116:119]
    buffer_load_dwordx4 v[80:83], v212, s[4:7], s33 offen offset:0 sc1
    v_mfma_f32_16x16x32_bf16 v[116:119], a[212:215], v[44:47], v[116:119]
    s_waitcnt lgkmcnt(5)
    v_mfma_f32_16x16x32_bf16 v[120:123], a[216:219], v[32:35], v[120:123]
    ds_read_b128 a[208:211], v215 offset:47104
    v_mfma_f32_16x16x32_bf16 v[120:123], a[220:223], v[40:43], v[120:123]
    ds_read_b128 a[212:215], v215 offset:57344
    v_mfma_f32_16x16x32_bf16 v[124:127], a[216:219], v[36:39], v[124:127]
    buffer_load_dwordx4 v[84:87], v212, s[4:7], s33 offen offset:1024 sc1
    v_mfma_f32_16x16x32_bf16 v[124:127], a[220:223], v[44:47], v[124:127]
    s_waitcnt lgkmcnt(5)
    buffer_store_dwordx4 v[220:223], v213, s[60:63], s41 offen offset:0 sc1
    v_mfma_f32_16x16x32_bf16 v[128:131], a[192:195], v[32:35], v[128:131]
    ds_read_b128 a[216:219], v215 offset:48128
    v_mfma_f32_16x16x32_bf16 v[128:131], a[196:199], v[40:43], v[128:131]
    ds_read_b128 a[220:223], v215 offset:58368
    v_mfma_f32_16x16x32_bf16 v[132:135], a[192:195], v[36:39], v[132:135]
    buffer_load_dwordx4 v[88:91], v213, s[4:7], s33 offen offset:0 sc1
    v_mfma_f32_16x16x32_bf16 v[132:135], a[196:199], v[44:47], v[132:135]
    s_waitcnt lgkmcnt(4)
    ds_write_b128 v243, v[220:223] offset:4096
    v_mfma_f32_16x16x32_bf16 v[136:139], a[200:203], v[32:35], v[136:139]
    ds_read_b128 a[192:195], v215 offset:49152
    v_mfma_f32_16x16x32_bf16 v[136:139], a[204:207], v[40:43], v[136:139]
    ds_read_b128 a[196:199], v215 offset:59392
    v_mfma_f32_16x16x32_bf16 v[140:143], a[200:203], v[36:39], v[140:143]
    buffer_load_dwordx4 v[92:95], v213, s[4:7], s33 offen offset:1024 sc1
    v_mfma_f32_16x16x32_bf16 v[140:143], a[204:207], v[44:47], v[140:143]
    s_waitcnt lgkmcnt(5)
    s_add_u32 s33, s33, 8192
    v_mfma_f32_16x16x32_bf16 v[144:147], a[208:211], v[32:35], v[144:147]
    ds_read_b128 a[200:203], v215 offset:50176
    v_mfma_f32_16x16x32_bf16 v[144:147], a[212:215], v[40:43], v[144:147]
    ds_read_b128 a[204:207], v215 offset:60416
    v_mfma_f32_16x16x32_bf16 v[148:151], a[208:211], v[36:39], v[148:151]
    buffer_store_dwordx4 v[224:227], v213, s[60:63], s41 offen offset:1024 sc1
    v_mfma_f32_16x16x32_bf16 v[148:151], a[212:215], v[44:47], v[148:151]
    s_barrier
    s_waitcnt lgkmcnt(5)
    s_add_u32 m0, s31, 118784
    v_mfma_f32_16x16x32_bf16 v[152:155], a[216:219], v[32:35], v[152:155]
    ds_read_b128 a[208:211], v212 offset:0
    v_mfma_f32_16x16x32_bf16 v[152:155], a[220:223], v[40:43], v[152:155]
    ds_read_b128 a[212:215], v212 offset:10240
    v_mfma_f32_16x16x32_bf16 v[156:159], a[216:219], v[36:39], v[156:159]
    buffer_load_dwordx4 v212, s[8:11], s34 offen offset:0 lds
    ds_write_b128 v243, v[224:227] offset:5120
    v_mfma_f32_16x16x32_bf16 v[156:159], a[220:223], v[44:47], v[156:159]
    s_waitcnt lgkmcnt(5)
    v_mfma_f32_16x16x32_bf16 v[160:163], a[192:195], v[32:35], v[160:163]
    ds_read_b128 a[216:219], v212 offset:1024
    v_mfma_f32_16x16x32_bf16 v[160:163], a[196:199], v[40:43], v[160:163]
    ds_read_b128 a[220:223], v212 offset:11264
    v_mfma_f32_16x16x32_bf16 v[164:167], a[192:195], v[36:39], v[164:167]
    buffer_load_dwordx4 v212, s[8:11], s34 offen offset:1024 lds
    v_mfma_f32_16x16x32_bf16 v[164:167], a[196:199], v[44:47], v[164:167]
    s_waitcnt lgkmcnt(5)
    v_mfma_f32_16x16x32_bf16 v[168:171], a[200:203], v[32:35], v[168:171]
    ds_read_b128 a[192:195], v212 offset:2048
    v_mfma_f32_16x16x32_bf16 v[168:171], a[204:207], v[40:43], v[168:171]
    ds_read_b128 a[196:199], v212 offset:12288
    v_mfma_f32_16x16x32_bf16 v[172:175], a[200:203], v[36:39], v[172:175]
    buffer_load_dwordx4 v212, s[8:11], s34 offen offset:2048 lds
    v_mfma_f32_16x16x32_bf16 v[172:175], a[204:207], v[44:47], v[172:175]
    s_waitcnt vmcnt(28) lgkmcnt(5)
    v_mfma_f32_16x16x32_bf16 v[96:99], a[208:211], v[48:51], v[96:99]
    ds_read_b128 a[200:203], v212 offset:3072
    v_mfma_f32_16x16x32_bf16 v[96:99], a[212:215], v[56:59], v[96:99]
    ds_read_b128 a[204:207], v212 offset:13312
    v_mfma_f32_16x16x32_bf16 v[100:103], a[208:211], v[52:55], v[100:103]
    buffer_load_dwordx4 v212, s[8:11], s34 offen offset:3072 lds
    v_mfma_f32_16x16x32_bf16 v[100:103], a[212:215], v[60:63], v[100:103]
    s_waitcnt lgkmcnt(4)
    s_add_u32 m0, s31, 122880
    buffer_store_dwordx4 v[228:231], v213, s[60:63], s41 offen offset:2048 sc1
    v_mfma_f32_16x16x32_bf16 v[104:107], a[216:219], v[48:51], v[104:107]
    ds_read_b128 a[208:211], v212 offset:4096
    v_mfma_f32_16x16x32_bf16 v[104:107], a[220:223], v[56:59], v[104:107]
    ds_read_b128 a[212:215], v212 offset:14336
    v_mfma_f32_16x16x32_bf16 v[108:111], a[216:219], v[52:55], v[108:111]
    buffer_load_dwordx4 v213, s[8:11], s34 offen offset:0 lds
    v_mfma_f32_16x16x32_bf16 v[108:111], a[220:223], v[60:63], v[108:111]
    s_waitcnt lgkmcnt(4)
    s_add_u32 s34, s34, 81920
    ds_write_b128 v243, v[228:231] offset:6144
    v_mfma_f32_16x16x32_bf16 v[112:115], a[192:195], v[48:51], v[112:115]
    ds_read_b128 a[216:219], v212 offset:5120
    v_mfma_f32_16x16x32_bf16 v[112:115], a[196:199], v[56:59], v[112:115]
    ds_read_b128 a[220:223], v212 offset:15360
    v_mfma_f32_16x16x32_bf16 v[116:119], a[192:195], v[52:55], v[116:119]
    buffer_load_dwordx4 v[0:3], v212, s[4:7], s33 offen offset:0 sc1
    v_mfma_f32_16x16x32_bf16 v[116:119], a[196:199], v[60:63], v[116:119]
    s_waitcnt lgkmcnt(5)
    v_mfma_f32_16x16x32_bf16 v[120:123], a[200:203], v[48:51], v[120:123]
    ds_read_b128 a[192:195], v212 offset:6144
    v_mfma_f32_16x16x32_bf16 v[120:123], a[204:207], v[56:59], v[120:123]
    ds_read_b128 a[196:199], v212 offset:16384
    v_mfma_f32_16x16x32_bf16 v[124:127], a[200:203], v[52:55], v[124:127]
    buffer_load_dwordx4 v[4:7], v212, s[4:7], s33 offen offset:1024 sc1
    v_mfma_f32_16x16x32_bf16 v[124:127], a[204:207], v[60:63], v[124:127]
    s_waitcnt lgkmcnt(5)
    buffer_store_dwordx4 v[232:235], v213, s[60:63], s41 offen offset:3072 sc1
    v_mfma_f32_16x16x32_bf16 v[128:131], a[208:211], v[48:51], v[128:131]
    ds_read_b128 a[200:203], v212 offset:7168
    v_mfma_f32_16x16x32_bf16 v[128:131], a[212:215], v[56:59], v[128:131]
    ds_read_b128 a[204:207], v212 offset:17408
    v_mfma_f32_16x16x32_bf16 v[132:135], a[208:211], v[52:55], v[132:135]
    buffer_load_dwordx4 v[8:11], v213, s[4:7], s33 offen offset:0 sc1
    v_mfma_f32_16x16x32_bf16 v[132:135], a[212:215], v[60:63], v[132:135]
    s_waitcnt lgkmcnt(4)
    ds_write_b128 v243, v[232:235] offset:7168
    v_mfma_f32_16x16x32_bf16 v[136:139], a[216:219], v[48:51], v[136:139]
    ds_read_b128 a[208:211], v212 offset:8192
    v_mfma_f32_16x16x32_bf16 v[136:139], a[220:223], v[56:59], v[136:139]
    ds_read_b128 a[212:215], v212 offset:18432
    v_mfma_f32_16x16x32_bf16 v[140:143], a[216:219], v[52:55], v[140:143]
    buffer_load_dwordx4 v[12:15], v213, s[4:7], s33 offen offset:1024 sc1
    v_mfma_f32_16x16x32_bf16 v[140:143], a[220:223], v[60:63], v[140:143]
    s_waitcnt lgkmcnt(5)
    s_add_u32 s33, s33, 8192
    v_mfma_f32_16x16x32_bf16 v[144:147], a[192:195], v[48:51], v[144:147]
    ds_read_b128 a[216:219], v212 offset:9216
    v_mfma_f32_16x16x32_bf16 v[144:147], a[196:199], v[56:59], v[144:147]
    ds_read_b128 a[220:223], v212 offset:19456
    v_mfma_f32_16x16x32_bf16 v[148:151], a[192:195], v[52:55], v[148:151]
    buffer_load_dword v248, v218, s[72:75], s15 offen sc1
    buffer_store_dwordx4 v[244:247], v214, s[60:63], s41 offen offset:0 sc1
    v_mfma_f32_16x16x32_bf16 v[148:151], a[196:199], v[60:63], v[148:151]
    s_barrier
    s_waitcnt lgkmcnt(5)
    s_add_u32 m0, s31, 139264
    v_mfma_f32_16x16x32_bf16 v[152:155], a[200:203], v[48:51], v[152:155]
    ds_read_b128 a[192:195], v212 offset:20480
    v_mfma_f32_16x16x32_bf16 v[152:155], a[204:207], v[56:59], v[152:155]
    ds_read_b128 a[196:199], v212 offset:30720
    v_mfma_f32_16x16x32_bf16 v[156:159], a[200:203], v[52:55], v[156:159]
    buffer_load_dwordx4 v212, s[8:11], s34 offen offset:0 lds
    ds_write_b128 v243, v[244:247] offset:8192
    v_mfma_f32_16x16x32_bf16 v[156:159], a[204:207], v[60:63], v[156:159]
    s_waitcnt lgkmcnt(5)
    v_mfma_f32_16x16x32_bf16 v[160:163], a[208:211], v[48:51], v[160:163]
    ds_read_b128 a[200:203], v212 offset:21504
    v_mfma_f32_16x16x32_bf16 v[160:163], a[212:215], v[56:59], v[160:163]
    ds_read_b128 a[204:207], v212 offset:31744
    v_mfma_f32_16x16x32_bf16 v[164:167], a[208:211], v[52:55], v[164:167]
    buffer_load_dwordx4 v212, s[8:11], s34 offen offset:1024 lds
    v_mfma_f32_16x16x32_bf16 v[164:167], a[212:215], v[60:63], v[164:167]
    s_waitcnt lgkmcnt(5)
    v_mfma_f32_16x16x32_bf16 v[168:171], a[216:219], v[48:51], v[168:171]
    ds_read_b128 a[208:211], v212 offset:22528
    v_mfma_f32_16x16x32_bf16 v[168:171], a[220:223], v[56:59], v[168:171]
    ds_read_b128 a[212:215], v212 offset:32768
    v_mfma_f32_16x16x32_bf16 v[172:175], a[216:219], v[52:55], v[172:175]
    buffer_load_dwordx4 v212, s[8:11], s34 offen offset:2048 lds
    v_mfma_f32_16x16x32_bf16 v[172:175], a[220:223], v[60:63], v[172:175]
    s_waitcnt vmcnt(30) lgkmcnt(5)
    v_mfma_f32_16x16x32_bf16 v[96:99], a[192:195], v[64:67], v[96:99]
    ds_read_b128 a[216:219], v212 offset:23552
    v_mfma_f32_16x16x32_bf16 v[96:99], a[196:199], v[72:75], v[96:99]
    ds_read_b128 a[220:223], v212 offset:33792
    v_mfma_f32_16x16x32_bf16 v[100:103], a[192:195], v[68:71], v[100:103]
    buffer_load_dwordx4 v212, s[8:11], s34 offen offset:3072 lds
    v_mfma_f32_16x16x32_bf16 v[100:103], a[196:199], v[76:79], v[100:103]
    s_waitcnt lgkmcnt(4)
    s_add_u32 m0, s31, 143360
    buffer_store_dwordx4 v[252:255], v214, s[60:63], s41 offen offset:1024 sc1
    v_mfma_f32_16x16x32_bf16 v[104:107], a[200:203], v[64:67], v[104:107]
    ds_read_b128 a[192:195], v212 offset:24576
    v_mfma_f32_16x16x32_bf16 v[104:107], a[204:207], v[72:75], v[104:107]
    ds_read_b128 a[196:199], v212 offset:34816
    v_mfma_f32_16x16x32_bf16 v[108:111], a[200:203], v[68:71], v[108:111]
    buffer_load_dwordx4 v213, s[8:11], s34 offen offset:0 lds
    v_mfma_f32_16x16x32_bf16 v[108:111], a[204:207], v[76:79], v[108:111]
    s_waitcnt lgkmcnt(4)
    s_add_u32 s34, s34, 81920
    ds_write_b128 v243, v[252:255] offset:9216
    v_mfma_f32_16x16x32_bf16 v[112:115], a[208:211], v[64:67], v[112:115]
    ds_read_b128 a[200:203], v212 offset:25600
    v_mfma_f32_16x16x32_bf16 v[112:115], a[212:215], v[72:75], v[112:115]
    ds_read_b128 a[204:207], v212 offset:35840
    v_mfma_f32_16x16x32_bf16 v[116:119], a[208:211], v[68:71], v[116:119]
    buffer_load_dwordx4 v[16:19], v212, s[4:7], s33 offen offset:0 sc1
    v_mfma_f32_16x16x32_bf16 v[116:119], a[212:215], v[76:79], v[116:119]
    s_waitcnt lgkmcnt(5)
    v_mfma_f32_16x16x32_bf16 v[120:123], a[216:219], v[64:67], v[120:123]
    ds_read_b128 a[208:211], v212 offset:26624
    v_mfma_f32_16x16x32_bf16 v[120:123], a[220:223], v[72:75], v[120:123]
    ds_read_b128 a[212:215], v212 offset:36864
    v_mfma_f32_16x16x32_bf16 v[124:127], a[216:219], v[68:71], v[124:127]
    buffer_load_dwordx4 v[20:23], v212, s[4:7], s33 offen offset:1024 sc1
    v_mfma_f32_16x16x32_bf16 v[124:127], a[220:223], v[76:79], v[124:127]
    s_waitcnt lgkmcnt(5)
    v_mfma_f32_16x16x32_bf16 v[128:131], a[192:195], v[64:67], v[128:131]
    ds_read_b128 a[216:219], v212 offset:27648
    v_mfma_f32_16x16x32_bf16 v[128:131], a[196:199], v[72:75], v[128:131]
    ds_read_b128 a[220:223], v212 offset:37888
    v_mfma_f32_16x16x32_bf16 v[132:135], a[192:195], v[68:71], v[132:135]
    buffer_load_dwordx4 v[24:27], v213, s[4:7], s33 offen offset:0 sc1
    v_mfma_f32_16x16x32_bf16 v[132:135], a[196:199], v[76:79], v[132:135]
    s_waitcnt lgkmcnt(4)
    v_mfma_f32_16x16x32_bf16 v[136:139], a[200:203], v[64:67], v[136:139]
    ds_read_b128 a[192:195], v212 offset:28672
    v_mfma_f32_16x16x32_bf16 v[136:139], a[204:207], v[72:75], v[136:139]
    ds_read_b128 a[196:199], v212 offset:38912
    v_mfma_f32_16x16x32_bf16 v[140:143], a[200:203], v[68:71], v[140:143]
    buffer_load_dwordx4 v[28:31], v213, s[4:7], s33 offen offset:1024 sc1
    v_mfma_f32_16x16x32_bf16 v[140:143], a[204:207], v[76:79], v[140:143]
    s_waitcnt lgkmcnt(4)
    s_add_u32 s33, s33, 8192
    v_mfma_f32_16x16x32_bf16 v[144:147], a[208:211], v[64:67], v[144:147]
    ds_read_b128 a[200:203], v212 offset:29696
    v_mfma_f32_16x16x32_bf16 v[144:147], a[212:215], v[72:75], v[144:147]
    ds_read_b128 a[204:207], v212 offset:39936
    v_mfma_f32_16x16x32_bf16 v[148:151], a[208:211], v[68:71], v[148:151]
    v_mfma_f32_16x16x32_bf16 v[148:151], a[212:215], v[76:79], v[148:151]
    s_barrier
    s_waitcnt lgkmcnt(4)
    s_add_u32 m0, s31, 0
    v_mfma_f32_16x16x32_bf16 v[152:155], a[216:219], v[64:67], v[152:155]
    ds_read_b128 a[208:211], v212 offset:40960
    v_mfma_f32_16x16x32_bf16 v[152:155], a[220:223], v[72:75], v[152:155]
    ds_read_b128 a[212:215], v212 offset:51200
    v_mfma_f32_16x16x32_bf16 v[156:159], a[216:219], v[68:71], v[156:159]
    buffer_load_dwordx4 v212, s[8:11], s34 offen offset:0 lds
    v_mfma_f32_16x16x32_bf16 v[156:159], a[220:223], v[76:79], v[156:159]
    s_waitcnt lgkmcnt(4)
    v_mfma_f32_16x16x32_bf16 v[160:163], a[192:195], v[64:67], v[160:163]
    ds_read_b128 a[216:219], v212 offset:41984
    v_mfma_f32_16x16x32_bf16 v[160:163], a[196:199], v[72:75], v[160:163]
    ds_read_b128 a[220:223], v212 offset:52224
    v_mfma_f32_16x16x32_bf16 v[164:167], a[192:195], v[68:71], v[164:167]
    buffer_load_dwordx4 v212, s[8:11], s34 offen offset:1024 lds
    v_mfma_f32_16x16x32_bf16 v[164:167], a[196:199], v[76:79], v[164:167]
    s_waitcnt lgkmcnt(4)
    v_mfma_f32_16x16x32_bf16 v[168:171], a[200:203], v[64:67], v[168:171]
    ds_read_b128 a[192:195], v212 offset:43008
    v_mfma_f32_16x16x32_bf16 v[168:171], a[204:207], v[72:75], v[168:171]
    ds_read_b128 a[196:199], v212 offset:53248
    v_mfma_f32_16x16x32_bf16 v[172:175], a[200:203], v[68:71], v[172:175]
    buffer_load_dwordx4 v212, s[8:11], s34 offen offset:2048 lds
    v_mfma_f32_16x16x32_bf16 v[172:175], a[204:207], v[76:79], v[172:175]
    s_waitcnt vmcnt(27) lgkmcnt(4)
    s_waitcnt vmcnt(14)
K2_pchk1:
    s_add_u32 s42, s58, 6
    v_subrev_u32 v248, s42, v248
    v_cmp_lt_u32 vcc, 0, v248
    s_cbranch_vccnz K2_pslow1
K2_pok1:
    v_mfma_f32_16x16x32_bf16 v[96:99], a[208:211], v[80:83], v[96:99]
    ds_read_b128 a[200:203], v212 offset:44032
    v_mfma_f32_16x16x32_bf16 v[96:99], a[212:215], v[88:91], v[96:99]
    ds_read_b128 a[204:207], v212 offset:54272
    v_mfma_f32_16x16x32_bf16 v[100:103], a[208:211], v[84:87], v[100:103]
    buffer_load_dwordx4 v212, s[8:11], s34 offen offset:3072 lds
    v_mfma_f32_16x16x32_bf16 v[100:103], a[212:215], v[92:95], v[100:103]
    s_waitcnt lgkmcnt(4)
    s_add_u32 m0, s31, 4096
    v_mfma_f32_16x16x32_bf16 v[104:107], a[216:219], v[80:83], v[104:107]
    ds_read_b128 a[208:211], v212 offset:45056
    v_mfma_f32_16x16x32_bf16 v[104:107], a[220:223], v[88:91], v[104:107]
    ds_read_b128 a[212:215], v212 offset:55296
    v_mfma_f32_16x16x32_bf16 v[108:111], a[216:219], v[84:87], v[108:111]
    buffer_load_dwordx4 v213, s[8:11], s34 offen offset:0 lds
    v_mfma_f32_16x16x32_bf16 v[108:111], a[220:223], v[92:95], v[108:111]
    s_waitcnt lgkmcnt(4)
    s_add_u32 s34, s34, 81920
    v_mfma_f32_16x16x32_bf16 v[112:115], a[192:195], v[80:83], v[112:115]
    ds_read_b128 a[216:219], v212 offset:46080
    v_mfma_f32_16x16x32_bf16 v[112:115], a[196:199], v[88:91], v[112:115]
    ds_read_b128 a[220:223], v212 offset:56320
    v_mfma_f32_16x16x32_bf16 v[116:119], a[192:195], v[84:87], v[116:119]
    buffer_load_dwordx4 v[32:35], v212, s[4:7], s33 offen offset:0 sc1
    v_mfma_f32_16x16x32_bf16 v[116:119], a[196:199], v[92:95], v[116:119]
    s_waitcnt lgkmcnt(4)
    v_mfma_f32_16x16x32_bf16 v[120:123], a[200:203], v[80:83], v[120:123]
    ds_read_b128 a[192:195], v212 offset:47104
    v_mfma_f32_16x16x32_bf16 v[120:123], a[204:207], v[88:91], v[120:123]
    ds_read_b128 a[196:199], v212 offset:57344
    v_mfma_f32_16x16x32_bf16 v[124:127], a[200:203], v[84:87], v[124:127]
    buffer_load_dwordx4 v[36:39], v212, s[4:7], s33 offen offset:1024 sc1
    v_mfma_f32_16x16x32_bf16 v[124:127], a[204:207], v[92:95], v[124:127]
    s_waitcnt lgkmcnt(4)
    v_mfma_f32_16x16x32_bf16 v[128:131], a[208:211], v[80:83], v[128:131]
    ds_read_b128 a[200:203], v212 offset:48128
    v_mfma_f32_16x16x32_bf16 v[128:131], a[212:215], v[88:91], v[128:131]
    ds_read_b128 a[204:207], v212 offset:58368
    v_mfma_f32_16x16x32_bf16 v[132:135], a[208:211], v[84:87], v[132:135]
    buffer_load_dwordx4 v[40:43], v213, s[4:7], s33 offen offset:0 sc1
    v_mfma_f32_16x16x32_bf16 v[132:135], a[212:215], v[92:95], v[132:135]
    s_waitcnt lgkmcnt(4)
    v_mfma_f32_16x16x32_bf16 v[136:139], a[216:219], v[80:83], v[136:139]
    ds_read_b128 a[208:211], v212 offset:49152
    v_mfma_f32_16x16x32_bf16 v[136:139], a[220:223], v[88:91], v[136:139]
    ds_read_b128 a[212:215], v212 offset:59392
    v_mfma_f32_16x16x32_bf16 v[140:143], a[216:219], v[84:87], v[140:143]
    buffer_load_dwordx4 v[44:47], v213, s[4:7], s33 offen offset:1024 sc1
    v_mfma_f32_16x16x32_bf16 v[140:143], a[220:223], v[92:95], v[140:143]
    s_waitcnt lgkmcnt(4)
    s_add_u32 s33, s33, 8192
    v_mfma_f32_16x16x32_bf16 v[144:147], a[192:195], v[80:83], v[144:147]
    ds_read_b128 a[216:219], v212 offset:50176
    v_mfma_f32_16x16x32_bf16 v[144:147], a[196:199], v[88:91], v[144:147]
    ds_read_b128 a[220:223], v212 offset:60416
    v_mfma_f32_16x16x32_bf16 v[148:151], a[192:195], v[84:87], v[148:151]
    v_mfma_f32_16x16x32_bf16 v[148:151], a[196:199], v[92:95], v[148:151]
    s_barrier
    s_waitcnt lgkmcnt(4)
    s_add_u32 m0, s31, 20480
    v_mfma_f32_16x16x32_bf16 v[152:155], a[200:203], v[80:83], v[152:155]
    ds_read_b128 a[192:195], v215 offset:0
    v_mfma_f32_16x16x32_bf16 v[152:155], a[204:207], v[88:91], v[152:155]
    ds_read_b128 a[196:199], v215 offset:10240
    v_mfma_f32_16x16x32_bf16 v[156:159], a[200:203], v[84:87], v[156:159]
    buffer_load_dwordx4 v212, s[8:11], s34 offen offset:0 lds
    v_mfma_f32_16x16x32_bf16 v[156:159], a[204:207], v[92:95], v[156:159]
    s_waitcnt lgkmcnt(4)
    v_mfma_f32_16x16x32_bf16 v[160:163], a[208:211], v[80:83], v[160:163]
    ds_read_b128 a[200:203], v215 offset:1024
    v_mfma_f32_16x16x32_bf16 v[160:163], a[212:215], v[88:91], v[160:163]
    ds_read_b128 a[204:207], v215 offset:11264
    v_mfma_f32_16x16x32_bf16 v[164:167], a[208:211], v[84:87], v[164:167]
    buffer_load_dwordx4 v212, s[8:11], s34 offen offset:1024 lds
    v_mfma_f32_16x16x32_bf16 v[164:167], a[212:215], v[92:95], v[164:167]
    s_waitcnt lgkmcnt(4)
    v_mfma_f32_16x16x32_bf16 v[168:171], a[216:219], v[80:83], v[168:171]
    ds_read_b128 a[208:211], v215 offset:2048
    v_mfma_f32_16x16x32_bf16 v[168:171], a[220:223], v[88:91], v[168:171]
    ds_read_b128 a[212:215], v215 offset:12288
    v_mfma_f32_16x16x32_bf16 v[172:175], a[216:219], v[84:87], v[172:175]
    buffer_load_dwordx4 v212, s[8:11], s34 offen offset:2048 lds
    v_mfma_f32_16x16x32_bf16 v[172:175], a[220:223], v[92:95], v[172:175]
    s_waitcnt lgkmcnt(4)
    v_mfma_f32_16x16x32_bf16 v[96:99], a[192:195], v[0:3], v[96:99]
    ds_read_b128 a[216:219], v215 offset:3072
    v_mfma_f32_16x16x32_bf16 v[96:99], a[196:199], v[8:11], v[96:99]
    ds_read_b128 a[220:223], v215 offset:13312
    v_mfma_f32_16x16x32_bf16 v[100:103], a[192:195], v[4:7], v[100:103]
    buffer_load_dwordx4 v212, s[8:11], s34 offen offset:3072 lds
    v_mfma_f32_16x16x32_bf16 v[100:103], a[196:199], v[12:15], v[100:103]
    s_waitcnt lgkmcnt(4)
    s_add_u32 m0, s31, 24576
    v_mfma_f32_16x16x32_bf16 v[104:107], a[200:203], v[0:3], v[104:107]
    ds_read_b128 a[192:195], v215 offset:4096
    v_mfma_f32_16x16x32_bf16 v[104:107], a[204:207], v[8:11], v[104:107]
    ds_read_b128 a[196:199], v215 offset:14336
    v_mfma_f32_16x16x32_bf16 v[108:111], a[200:203], v[4:7], v[108:111]
    buffer_load_dwordx4 v213, s[8:11], s34 offen offset:0 lds
    v_mfma_f32_16x16x32_bf16 v[108:111], a[204:207], v[12:15], v[108:111]
    s_waitcnt lgkmcnt(4)
    s_add_u32 s34, s34, 81920
    v_mfma_f32_16x16x32_bf16 v[112:115], a[208:211], v[0:3], v[112:115]
    ds_read_b128 a[200:203], v215 offset:5120
    v_mfma_f32_16x16x32_bf16 v[112:115], a[212:215], v[8:11], v[112:115]
    ds_read_b128 a[204:207], v215 offset:15360
    v_mfma_f32_16x16x32_bf16 v[116:119], a[208:211], v[4:7], v[116:119]
    buffer_load_dwordx4 v[48:51], v212, s[4:7], s33 offen offset:0 sc1
    v_mfma_f32_16x16x32_bf16 v[116:119], a[212:215], v[12:15], v[116:119]
    s_waitcnt lgkmcnt(4)
    v_mfma_f32_16x16x32_bf16 v[120:123], a[216:219], v[0:3], v[120:123]
    ds_read_b128 a[208:211], v215 offset:6144
    v_mfma_f32_16x16x32_bf16 v[120:123], a[220:223], v[8:11], v[120:123]
    ds_read_b128 a[212:215], v215 offset:16384
    v_mfma_f32_16x16x32_bf16 v[124:127], a[216:219], v[4:7], v[124:127]
    buffer_load_dwordx4 v[52:55], v212, s[4:7], s33 offen offset:1024 sc1
    v_mfma_f32_16x16x32_bf16 v[124:127], a[220:223], v[12:15], v[124:127]
    s_waitcnt lgkmcnt(4)
    v_mfma_f32_16x16x32_bf16 v[128:131], a[192:195], v[0:3], v[128:131]
    ds_read_b128 a[216:219], v215 offset:7168
    v_mfma_f32_16x16x32_bf16 v[128:131], a[196:199], v[8:11], v[128:131]
    ds_read_b128 a[220:223], v215 offset:17408
    v_mfma_f32_16x16x32_bf16 v[132:135], a[192:195], v[4:7], v[132:135]
    buffer_load_dwordx4 v[56:59], v213, s[4:7], s33 offen offset:0 sc1
    v_mfma_f32_16x16x32_bf16 v[132:135], a[196:199], v[12:15], v[132:135]
    s_waitcnt lgkmcnt(4)
    v_mfma_f32_16x16x32_bf16 v[136:139], a[200:203], v[0:3], v[136:139]
    ds_read_b128 a[192:195], v215 offset:8192
    v_mfma_f32_16x16x32_bf16 v[136:139], a[204:207], v[8:11], v[136:139]
    ds_read_b128 a[196:199], v215 offset:18432
    v_mfma_f32_16x16x32_bf16 v[140:143], a[200:203], v[4:7], v[140:143]
    buffer_load_dwordx4 v[60:63], v213, s[4:7], s33 offen offset:1024 sc1
    v_mfma_f32_16x16x32_bf16 v[140:143], a[204:207], v[12:15], v[140:143]
    s_waitcnt lgkmcnt(4)
    s_add_u32 s33, s33, 8192
    v_mfma_f32_16x16x32_bf16 v[144:147], a[208:211], v[0:3], v[144:147]
    ds_read_b128 a[200:203], v215 offset:9216
    v_mfma_f32_16x16x32_bf16 v[144:147], a[212:215], v[8:11], v[144:147]
    ds_read_b128 a[204:207], v215 offset:19456
    v_mfma_f32_16x16x32_bf16 v[148:151], a[208:211], v[4:7], v[148:151]
    s_waitcnt vmcnt(23)
    v_mfma_f32_16x16x32_bf16 v[148:151], a[212:215], v[12:15], v[148:151]
    s_barrier
    s_waitcnt lgkmcnt(4)
    s_add_u32 m0, s31, 40960
    v_mfma_f32_16x16x32_bf16 v[152:155], a[216:219], v[0:3], v[152:155]
    ds_read_b128 a[208:211], v215 offset:20480
    v_mfma_f32_16x16x32_bf16 v[152:155], a[220:223], v[8:11], v[152:155]
    ds_read_b128 a[212:215], v215 offset:30720
    v_mfma_f32_16x16x32_bf16 v[156:159], a[216:219], v[4:7], v[156:159]
    buffer_load_dwordx4 v212, s[8:11], s34 offen offset:0 lds
    v_mfma_f32_16x16x32_bf16 v[156:159], a[220:223], v[12:15], v[156:159]
    s_waitcnt lgkmcnt(4)
    buffer_store_dword v217, v249, s[72:75], s79 offen sc1
    v_mfma_f32_16x16x32_bf16 v[160:163], a[192:195], v[0:3], v[160:163]
    ds_read_b128 a[216:219], v215 offset:21504
    v_mfma_f32_16x16x32_bf16 v[160:163], a[196:199], v[8:11], v[160:163]
    ds_read_b128 a[220:223], v215 offset:31744
    v_mfma_f32_16x16x32_bf16 v[164:167], a[192:195], v[4:7], v[164:167]
    buffer_load_dwordx4 v212, s[8:11], s34 offen offset:1024 lds
    v_mfma_f32_16x16x32_bf16 v[164:167], a[196:199], v[12:15], v[164:167]
    s_waitcnt lgkmcnt(4)
    v_mfma_f32_16x16x32_bf16 v[168:171], a[200:203], v[0:3], v[168:171]
    ds_read_b128 a[192:195], v215 offset:22528
    v_mfma_f32_16x16x32_bf16 v[168:171], a[204:207], v[8:11], v[168:171]
    ds_read_b128 a[196:199], v215 offset:32768
    v_mfma_f32_16x16x32_bf16 v[172:175], a[200:203], v[4:7], v[172:175]
    buffer_load_dwordx4 v212, s[8:11], s34 offen offset:2048 lds
    v_mfma_f32_16x16x32_bf16 v[172:175], a[204:207], v[12:15], v[172:175]
    s_waitcnt vmcnt(22) lgkmcnt(4)
    v_mfma_f32_16x16x32_bf16 v[96:99], a[208:211], v[16:19], v[96:99]
    ds_read_b128 a[200:203], v215 offset:23552
    v_mfma_f32_16x16x32_bf16 v[96:99], a[212:215], v[24:27], v[96:99]
    ds_read_b128 a[204:207], v215 offset:33792
    v_mfma_f32_16x16x32_bf16 v[100:103], a[208:211], v[20:23], v[100:103]
    buffer_load_dwordx4 v212, s[8:11], s34 offen offset:3072 lds
    v_mfma_f32_16x16x32_bf16 v[100:103], a[212:215], v[28:31], v[100:103]
    s_waitcnt lgkmcnt(4)
    s_add_u32 m0, s31, 45056
    v_mfma_f32_16x16x32_bf16 v[104:107], a[216:219], v[16:19], v[104:107]
    ds_read_b128 a[208:211], v215 offset:24576
    v_mfma_f32_16x16x32_bf16 v[104:107], a[220:223], v[24:27], v[104:107]
    ds_read_b128 a[212:215], v215 offset:34816
    v_mfma_f32_16x16x32_bf16 v[108:111], a[216:219], v[20:23], v[108:111]
    buffer_load_dwordx4 v213, s[8:11], s34 offen offset:0 lds
    v_mfma_f32_16x16x32_bf16 v[108:111], a[220:223], v[28:31], v[108:111]
    s_waitcnt lgkmcnt(4)
    s_add_u32 s34, s34, 81920
    v_mfma_f32_16x16x32_bf16 v[112:115], a[192:195], v[16:19], v[112:115]
    ds_read_b128 a[216:219], v215 offset:25600
    v_mfma_f32_16x16x32_bf16 v[112:115], a[196:199], v[24:27], v[112:115]
    ds_read_b128 a[220:223], v215 offset:35840
    v_mfma_f32_16x16x32_bf16 v[116:119], a[192:195], v[20:23], v[116:119]
    buffer_load_dwordx4 v[64:67], v212, s[4:7], s33 offen offset:0 sc1
    v_mfma_f32_16x16x32_bf16 v[116:119], a[196:199], v[28:31], v[116:119]
    s_waitcnt lgkmcnt(4)
    v_mfma_f32_16x16x32_bf16 v[120:123], a[200:203], v[16:19], v[120:123]
    ds_read_b128 a[192:195], v215 offset:26624
    v_mfma_f32_16x16x32_bf16 v[120:123], a[204:207], v[24:27], v[120:123]
    ds_read_b128 a[196:199], v215 offset:36864
    v_mfma_f32_16x16x32_bf16 v[124:127], a[200:203], v[20:23], v[124:127]
    buffer_load_dwordx4 v[68:71], v212, s[4:7], s33 offen offset:1024 sc1
    v_mfma_f32_16x16x32_bf16 v[124:127], a[204:207], v[28:31], v[124:127]
    s_waitcnt lgkmcnt(4)
    v_mfma_f32_16x16x32_bf16 v[128:131], a[208:211], v[16:19], v[128:131]
    ds_read_b128 a[200:203], v215 offset:27648
    v_mfma_f32_16x16x32_bf16 v[128:131], a[212:215], v[24:27], v[128:131]
    ds_read_b128 a[204:207], v215 offset:37888
    v_mfma_f32_16x16x32_bf16 v[132:135], a[208:211], v[20:23], v[132:135]
    buffer_load_dwordx4 v[72:75], v213, s[4:7], s33 offen offset:0 sc1
    v_mfma_f32_16x16x32_bf16 v[132:135], a[212:215], v[28:31], v[132:135]
    s_waitcnt lgkmcnt(4)
    v_mfma_f32_16x16x32_bf16 v[136:139], a[216:219], v[16:19], v[136:139]
    ds_read_b128 a[208:211], v215 offset:28672
    v_mfma_f32_16x16x32_bf16 v[136:139], a[220:223], v[24:27], v[136:139]
    ds_read_b128 a[212:215], v215 offset:38912
    v_mfma_f32_16x16x32_bf16 v[140:143], a[216:219], v[20:23], v[140:143]
    buffer_load_dwordx4 v[76:79], v213, s[4:7], s33 offen offset:1024 sc1
    v_mfma_f32_16x16x32_bf16 v[140:143], a[220:223], v[28:31], v[140:143]
    s_waitcnt lgkmcnt(4)
    s_add_u32 s33, s33, 8192
    v_mfma_f32_16x16x32_bf16 v[144:147], a[192:195], v[16:19], v[144:147]
    ds_read_b128 a[216:219], v215 offset:29696
    v_mfma_f32_16x16x32_bf16 v[144:147], a[196:199], v[24:27], v[144:147]
    ds_read_b128 a[220:223], v215 offset:39936
    v_mfma_f32_16x16x32_bf16 v[148:151], a[192:195], v[20:23], v[148:151]
    v_mfma_f32_16x16x32_bf16 v[148:151], a[196:199], v[28:31], v[148:151]
    s_barrier
    s_waitcnt lgkmcnt(4)
    s_add_u32 m0, s31, 98304
    v_mfma_f32_16x16x32_bf16 v[152:155], a[200:203], v[16:19], v[152:155]
    ds_read_b128 a[192:195], v215 offset:40960
    v_mfma_f32_16x16x32_bf16 v[152:155], a[204:207], v[24:27], v[152:155]
    ds_read_b128 a[196:199], v215 offset:51200
    v_mfma_f32_16x16x32_bf16 v[156:159], a[200:203], v[20:23], v[156:159]
    buffer_load_dwordx4 v212, s[8:11], s34 offen offset:0 lds
    v_mfma_f32_16x16x32_bf16 v[156:159], a[204:207], v[28:31], v[156:159]
    s_waitcnt lgkmcnt(4)
    v_mfma_f32_16x16x32_bf16 v[160:163], a[208:211], v[16:19], v[160:163]
    ds_read_b128 a[200:203], v215 offset:41984
    v_mfma_f32_16x16x32_bf16 v[160:163], a[212:215], v[24:27], v[160:163]
    ds_read_b128 a[204:207], v215 offset:52224
    v_mfma_f32_16x16x32_bf16 v[164:167], a[208:211], v[20:23], v[164:167]
    buffer_load_dwordx4 v212, s[8:11], s34 offen offset:1024 lds
    v_mfma_f32_16x16x32_bf16 v[164:167], a[212:215], v[28:31], v[164:167]
    s_waitcnt lgkmcnt(4)
    v_mfma_f32_16x16x32_bf16 v[168:171], a[216:219], v[16:19], v[168:171]
    ds_read_b128 a[208:211], v215 offset:43008
    v_mfma_f32_16x16x32_bf16 v[168:171], a[220:223], v[24:27], v[168:171]
    ds_read_b128 a[212:215], v215 offset:53248
    v_mfma_f32_16x16x32_bf16 v[172:175], a[216:219], v[20:23], v[172:175]
    buffer_load_dwordx4 v212, s[8:11], s34 offen offset:2048 lds
    v_mfma_f32_16x16x32_bf16 v[172:175], a[220:223], v[28:31], v[172:175]
    s_waitcnt vmcnt(22) lgkmcnt(4)
    v_mfma_f32_16x16x32_bf16 v[96:99], a[192:195], v[32:35], v[96:99]
    ds_read_b128 a[216:219], v215 offset:44032
    v_mfma_f32_16x16x32_bf16 v[96:99], a[196:199], v[40:43], v[96:99]
    ds_read_b128 a[220:223], v215 offset:54272
    v_mfma_f32_16x16x32_bf16 v[100:103], a[192:195], v[36:39], v[100:103]
    buffer_load_dwordx4 v212, s[8:11], s34 offen offset:3072 lds
    v_mfma_f32_16x16x32_bf16 v[100:103], a[196:199], v[44:47], v[100:103]
    s_waitcnt lgkmcnt(4)
    s_add_u32 m0, s31, 102400
    v_mfma_f32_16x16x32_bf16 v[104:107], a[200:203], v[32:35], v[104:107]
    ds_read_b128 a[192:195], v215 offset:45056
    v_mfma_f32_16x16x32_bf16 v[104:107], a[204:207], v[40:43], v[104:107]
    ds_read_b128 a[196:199], v215 offset:55296
    v_mfma_f32_16x16x32_bf16 v[108:111], a[200:203], v[36:39], v[108:111]
    buffer_load_dwordx4 v213, s[8:11], s34 offen offset:0 lds
    v_mfma_f32_16x16x32_bf16 v[108:111], a[204:207], v[44:47], v[108:111]
    s_waitcnt lgkmcnt(4)
    s_add_u32 s34, s34, 81920
    v_mfma_f32_16x16x32_bf16 v[112:115], a[208:211], v[32:35], v[112:115]
    ds_read_b128 a[200:203], v215 offset:46080
    v_mfma_f32_16x16x32_bf16 v[112:115], a[212:215], v[40:43], v[112:115]
    ds_read_b128 a[204:207], v215 offset:56320
    v_mfma_f32_16x16x32_bf16 v[116:119], a[208:211], v[36:39], v[116:119]
    buffer_load_dwordx4 v[80:83], v212, s[4:7], s33 offen offset:0 sc1
    v_mfma_f32_16x16x32_bf16 v[116:119], a[212:215], v[44:47], v[116:119]
    s_waitcnt lgkmcnt(4)
    v_mfma_f32_16x16x32_bf16 v[120:123], a[216:219], v[32:35], v[120:123]
    ds_read_b128 a[208:211], v215 offset:47104
    v_mfma_f32_16x16x32_bf16 v[120:123], a[220:223], v[40:43], v[120:123]
    ds_read_b128 a[212:215], v215 offset:57344
    v_mfma_f32_16x16x32_bf16 v[124:127], a[216:219], v[36:39], v[124:127]
    buffer_load_dwordx4 v[84:87], v212, s[4:7], s33 offen offset:1024 sc1
    v_mfma_f32_16x16x32_bf16 v[124:127], a[220:223], v[44:47], v[124:127]
    s_waitcnt lgkmcnt(4)
    v_mfma_f32_16x16x32_bf16 v[128:131], a[192:195], v[32:35], v[128:131]
    ds_read_b128 a[216:219], v215 offset:48128
    v_mfma_f32_16x16x32_bf16 v[128:131], a[196:199], v[40:43], v[128:131]
    ds_read_b128 a[220:223], v215 offset:58368
    v_mfma_f32_16x16x32_bf16 v[132:135], a[192:195], v[36:39], v[132:135]
    buffer_load_dwordx4 v[88:91], v213, s[4:7], s33 offen offset:0 sc1
    v_mfma_f32_16x16x32_bf16 v[132:135], a[196:199], v[44:47], v[132:135]
    s_waitcnt lgkmcnt(4)
    v_mfma_f32_16x16x32_bf16 v[136:139], a[200:203], v[32:35], v[136:139]
    ds_read_b128 a[192:195], v215 offset:49152
    v_mfma_f32_16x16x32_bf16 v[136:139], a[204:207], v[40:43], v[136:139]
    ds_read_b128 a[196:199], v215 offset:59392
    v_mfma_f32_16x16x32_bf16 v[140:143], a[200:203], v[36:39], v[140:143]
    buffer_load_dwordx4 v[92:95], v213, s[4:7], s33 offen offset:1024 sc1
    v_mfma_f32_16x16x32_bf16 v[140:143], a[204:207], v[44:47], v[140:143]
    s_waitcnt lgkmcnt(4)
    s_add_u32 s33, s33, 8192
    v_mfma_f32_16x16x32_bf16 v[144:147], a[208:211], v[32:35], v[144:147]
    ds_read_b128 a[200:203], v215 offset:50176
    v_mfma_f32_16x16x32_bf16 v[144:147], a[212:215], v[40:43], v[144:147]
    ds_read_b128 a[204:207], v215 offset:60416
    v_mfma_f32_16x16x32_bf16 v[148:151], a[208:211], v[36:39], v[148:151]
    v_mfma_f32_16x16x32_bf16 v[148:151], a[212:215], v[44:47], v[148:151]
    s_barrier
    s_waitcnt lgkmcnt(4)
    s_add_u32 m0, s31, 118784
    v_mfma_f32_16x16x32_bf16 v[152:155], a[216:219], v[32:35], v[152:155]
    ds_read_b128 a[208:211], v212 offset:0
    v_mfma_f32_16x16x32_bf16 v[152:155], a[220:223], v[40:43], v[152:155]
    ds_read_b128 a[212:215], v212 offset:10240
    v_mfma_f32_16x16x32_bf16 v[156:159], a[216:219], v[36:39], v[156:159]
    buffer_load_dwordx4 v212, s[8:11], s34 offen offset:0 lds
    v_mfma_f32_16x16x32_bf16 v[156:159], a[220:223], v[44:47], v[156:159]
    s_waitcnt lgkmcnt(4)
    v_mfma_f32_16x16x32_bf16 v[160:163], a[192:195], v[32:35], v[160:163]
    ds_read_b128 a[216:219], v212 offset:1024
    v_mfma_f32_16x16x32_bf16 v[160:163], a[196:199], v[40:43], v[160:163]
    ds_read_b128 a[220:223], v212 offset:11264
    v_mfma_f32_16x16x32_bf16 v[164:167], a[192:195], v[36:39], v[164:167]
    buffer_load_dwordx4 v212, s[8:11], s34 offen offset:1024 lds
    v_mfma_f32_16x16x32_bf16 v[164:167], a[196:199], v[44:47], v[164:167]
    s_waitcnt lgkmcnt(4)
    v_mfma_f32_16x16x32_bf16 v[168:171], a[200:203], v[32:35], v[168:171]
    ds_read_b128 a[192:195], v212 offset:2048
    v_mfma_f32_16x16x32_bf16 v[168:171], a[204:207], v[40:43], v[168:171]
    ds_read_b128 a[196:199], v212 offset:12288
    v_mfma_f32_16x16x32_bf16 v[172:175], a[200:203], v[36:39], v[172:175]
    buffer_load_dwordx4 v212, s[8:11], s34 offen offset:2048 lds
    v_mfma_f32_16x16x32_bf16 v[172:175], a[204:207], v[44:47], v[172:175]
    s_waitcnt vmcnt(22) lgkmcnt(4)
    v_mfma_f32_16x16x32_bf16 v[96:99], a[208:211], v[48:51], v[96:99]
    ds_read_b128 a[200:203], v212 offset:3072
    v_mfma_f32_16x16x32_bf16 v[96:99], a[212:215], v[56:59], v[96:99]
    ds_read_b128 a[204:207], v212 offset:13312
    v_mfma_f32_16x16x32_bf16 v[100:103], a[208:211], v[52:55], v[100:103]
    buffer_load_dwordx4 v212, s[8:11], s34 offen offset:3072 lds
    v_mfma_f32_16x16x32_bf16 v[100:103], a[212:215], v[60:63], v[100:103]
    s_waitcnt lgkmcnt(4)
    s_add_u32 m0, s31, 122880
    v_mfma_f32_16x16x32_bf16 v[104:107], a[216:219], v[48:51], v[104:107]
    ds_read_b128 a[208:211], v212 offset:4096
    v_mfma_f32_16x16x32_bf16 v[104:107], a[220:223], v[56:59], v[104:107]
    ds_read_b128 a[212:215], v212 offset:14336
    v_mfma_f32_16x16x32_bf16 v[108:111], a[216:219], v[52:55], v[108:111]
    buffer_load_dwordx4 v213, s[8:11], s34 offen offset:0 lds
    v_mfma_f32_16x16x32_bf16 v[108:111], a[220:223], v[60:63], v[108:111]
    s_waitcnt lgkmcnt(4)
    s_add_u32 s34, s34, 81920
    v_mfma_f32_16x16x32_bf16 v[112:115], a[192:195], v[48:51], v[112:115]
    ds_read_b128 a[216:219], v212 offset:5120
    v_mfma_f32_16x16x32_bf16 v[112:115], a[196:199], v[56:59], v[112:115]
    ds_read_b128 a[220:223], v212 offset:15360
    v_mfma_f32_16x16x32_bf16 v[116:119], a[192:195], v[52:55], v[116:119]
    buffer_load_dwordx4 v[0:3], v212, s[4:7], s33 offen offset:0 sc1
    v_mfma_f32_16x16x32_bf16 v[116:119], a[196:199], v[60:63], v[116:119]
    s_waitcnt lgkmcnt(4)
    v_mfma_f32_16x16x32_bf16 v[120:123], a[200:203], v[48:51], v[120:123]
    ds_read_b128 a[192:195], v212 offset:6144
    v_mfma_f32_16x16x32_bf16 v[120:123], a[204:207], v[56:59], v[120:123]
    ds_read_b128 a[196:199], v212 offset:16384
    v_mfma_f32_16x16x32_bf16 v[124:127], a[200:203], v[52:55], v[124:127]
    buffer_load_dwordx4 v[4:7], v212, s[4:7], s33 offen offset:1024 sc1
    v_mfma_f32_16x16x32_bf16 v[124:127], a[204:207], v[60:63], v[124:127]
    s_waitcnt lgkmcnt(4)
    v_mfma_f32_16x16x32_bf16 v[128:131], a[208:211], v[48:51], v[128:131]
    ds_read_b128 a[200:203], v212 offset:7168
    v_mfma_f32_16x16x32_bf16 v[128:131], a[212:215], v[56:59], v[128:131]
    ds_read_b128 a[204:207], v212 offset:17408
    v_mfma_f32_16x16x32_bf16 v[132:135], a[208:211], v[52:55], v[132:135]
    buffer_load_dwordx4 v[8:11], v213, s[4:7], s33 offen offset:0 sc1
    v_mfma_f32_16x16x32_bf16 v[132:135], a[212:215], v[60:63], v[132:135]
    s_waitcnt lgkmcnt(4)
    v_mfma_f32_16x16x32_bf16 v[136:139], a[216:219], v[48:51], v[136:139]
    ds_read_b128 a[208:211], v212 offset:8192
    v_mfma_f32_16x16x32_bf16 v[136:139], a[220:223], v[56:59], v[136:139]
    ds_read_b128 a[212:215], v212 offset:18432
    v_mfma_f32_16x16x32_bf16 v[140:143], a[216:219], v[52:55], v[140:143]
    buffer_load_dwordx4 v[12:15], v213, s[4:7], s33 offen offset:1024 sc1
    v_mfma_f32_16x16x32_bf16 v[140:143], a[220:223], v[60:63], v[140:143]
    s_waitcnt lgkmcnt(4)
    s_add_u32 s33, s33, 8192
    v_mfma_f32_16x16x32_bf16 v[144:147], a[192:195], v[48:51], v[144:147]
    ds_read_b128 a[216:219], v212 offset:9216
    v_mfma_f32_16x16x32_bf16 v[144:147], a[196:199], v[56:59], v[144:147]
    ds_read_b128 a[220:223], v212 offset:19456
    v_mfma_f32_16x16x32_bf16 v[148:151], a[192:195], v[52:55], v[148:151]
    v_mfma_f32_16x16x32_bf16 v[148:151], a[196:199], v[60:63], v[148:151]
    s_barrier
    s_waitcnt lgkmcnt(4)
    s_add_u32 m0, s31, 139264
    v_mfma_f32_16x16x32_bf16 v[152:155], a[200:203], v[48:51], v[152:155]
    ds_read_b128 a[192:195], v212 offset:20480
    v_mfma_f32_16x16x32_bf16 v[152:155], a[204:207], v[56:59], v[152:155]
    ds_read_b128 a[196:199], v212 offset:30720
    v_mfma_f32_16x16x32_bf16 v[156:159], a[200:203], v[52:55], v[156:159]
    buffer_load_dwordx4 v212, s[8:11], s34 offen offset:0 lds
    v_mfma_f32_16x16x32_bf16 v[156:159], a[204:207], v[60:63], v[156:159]
    s_waitcnt lgkmcnt(4)
    v_mfma_f32_16x16x32_bf16 v[160:163], a[208:211], v[48:51], v[160:163]
    ds_read_b128 a[200:203], v212 offset:21504
    v_mfma_f32_16x16x32_bf16 v[160:163], a[212:215], v[56:59], v[160:163]
    ds_read_b128 a[204:207], v212 offset:31744
    v_mfma_f32_16x16x32_bf16 v[164:167], a[208:211], v[52:55], v[164:167]
    buffer_load_dwordx4 v212, s[8:11], s34 offen offset:1024 lds
    v_mfma_f32_16x16x32_bf16 v[164:167], a[212:215], v[60:63], v[164:167]
    s_waitcnt lgkmcnt(4)
    v_mfma_f32_16x16x32_bf16 v[168:171], a[216:219], v[48:51], v[168:171]
    ds_read_b128 a[208:211], v212 offset:22528
    v_mfma_f32_16x16x32_bf16 v[168:171], a[220:223], v[56:59], v[168:171]
    ds_read_b128 a[212:215], v212 offset:32768
    v_mfma_f32_16x16x32_bf16 v[172:175], a[216:219], v[52:55], v[172:175]
    buffer_load_dwordx4 v212, s[8:11], s34 offen offset:2048 lds
    v_mfma_f32_16x16x32_bf16 v[172:175], a[220:223], v[60:63], v[172:175]
    s_waitcnt vmcnt(21) lgkmcnt(4)
    v_mfma_f32_16x16x32_bf16 v[96:99], a[192:195], v[64:67], v[96:99]
    ds_read_b128 a[216:219], v212 offset:23552
    s_mov_b32 s68, s82
    v_mfma_f32_16x16x32_bf16 v[96:99], a[196:199], v[72:75], v[96:99]
    ds_read_b128 a[220:223], v212 offset:33792
    s_mov_b32 s69, s83
    v_mfma_f32_16x16x32_bf16 v[100:103], a[192:195], v[68:71], v[100:103]
    buffer_load_dwordx4 v212, s[8:11], s34 offen offset:3072 lds
    v_mfma_f32_16x16x32_bf16 v[100:103], a[196:199], v[76:79], v[100:103]
    s_waitcnt lgkmcnt(4)
    s_add_u32 m0, s31, 143360
    s_mov_b32 s70, 0x00280000
    v_mfma_f32_16x16x32_bf16 v[104:107], a[200:203], v[64:67], v[104:107]
    ds_read_b128 a[192:195], v212 offset:24576
    s_mov_b32 s71, 0x20000
    v_mfma_f32_16x16x32_bf16 v[104:107], a[204:207], v[72:75], v[104:107]
    ds_read_b128 a[196:199], v212 offset:34816
    s_mul_i32 s16, s12, 81920
    v_mfma_f32_16x16x32_bf16 v[108:111], a[200:203], v[68:71], v[108:111]
    buffer_load_dwordx4 v213, s[8:11], s34 offen offset:0 lds
    v_mfma_f32_16x16x32_bf16 v[108:111], a[204:207], v[76:79], v[108:111]
    s_waitcnt lgkmcnt(4)
    s_add_u32 s34, s34, 81920
    s_lshl_b32 s59, s28, 10
    v_mfma_f32_16x16x32_bf16 v[112:115], a[208:211], v[64:67], v[112:115]
    ds_read_b128 a[200:203], v212 offset:25600
    s_add_u32 s16, s16, s59
    v_mfma_f32_16x16x32_bf16 v[112:115], a[212:215], v[72:75], v[112:115]
    ds_read_b128 a[204:207], v212 offset:35840
    s_mov_b32 s51, 262144
    v_mfma_f32_16x16x32_bf16 v[116:119], a[208:211], v[68:71], v[116:119]
    buffer_load_dwordx4 v[16:19], v212, s[4:7], s33 offen offset:0 sc1
    v_mfma_f32_16x16x32_bf16 v[116:119], a[212:215], v[76:79], v[116:119]
    s_waitcnt lgkmcnt(4)
    s_add_u32 s40, s12, 1
    v_mfma_f32_16x16x32_bf16 v[120:123], a[216:219], v[64:67], v[120:123]
    ds_read_b128 a[208:211], v212 offset:26624
    s_and_b32 s40, s40, 3
    v_mfma_f32_16x16x32_bf16 v[120:123], a[220:223], v[72:75], v[120:123]
    ds_read_b128 a[212:215], v212 offset:36864
    s_mul_i32 s40, s40, 10240
    v_mfma_f32_16x16x32_bf16 v[124:127], a[216:219], v[68:71], v[124:127]
    buffer_load_dwordx4 v[20:23], v212, s[4:7], s33 offen offset:1024 sc1
    v_mfma_f32_16x16x32_bf16 v[124:127], a[220:223], v[76:79], v[124:127]
    s_waitcnt lgkmcnt(4)
    s_add_u32 s92, s40, s16
    v_mfma_f32_16x16x32_bf16 v[128:131], a[192:195], v[64:67], v[128:131]
    ds_read_b128 a[216:219], v212 offset:27648
    s_add_u32 s40, s12, 2
    v_mfma_f32_16x16x32_bf16 v[128:131], a[196:199], v[72:75], v[128:131]
    ds_read_b128 a[220:223], v212 offset:37888
    s_and_b32 s40, s40, 3
    v_mfma_f32_16x16x32_bf16 v[132:135], a[192:195], v[68:71], v[132:135]
    buffer_load_dwordx4 v[24:27], v213, s[4:7], s33 offen offset:0 sc1
    v_mfma_f32_16x16x32_bf16 v[132:135], a[196:199], v[76:79], v[132:135]
    s_waitcnt lgkmcnt(4)
    s_mul_i32 s40, s40, 10240
    v_mfma_f32_16x16x32_bf16 v[136:139], a[200:203], v[64:67], v[136:139]
    ds_read_b128 a[192:195], v212 offset:28672
    s_add_u32 s93, s40, s16
    v_mfma_f32_16x16x32_bf16 v[136:139], a[204:207], v[72:75], v[136:139]
    ds_read_b128 a[196:199], v212 offset:38912
    s_add_u32 s40, s12, 3
    v_mfma_f32_16x16x32_bf16 v[140:143], a[200:203], v[68:71], v[140:143]
    buffer_load_dwordx4 v[28:31], v213, s[4:7], s33 offen offset:1024 sc1
    v_mfma_f32_16x16x32_bf16 v[140:143], a[204:207], v[76:79], v[140:143]
    s_waitcnt lgkmcnt(4)
    s_add_u32 s33, s33, 8192
    s_and_b32 s40, s40, 3
    v_mfma_f32_16x16x32_bf16 v[144:147], a[208:211], v[64:67], v[144:147]
    ds_read_b128 a[200:203], v212 offset:29696
    s_mul_i32 s40, s40, 10240
    v_mfma_f32_16x16x32_bf16 v[144:147], a[212:215], v[72:75], v[144:147]
    ds_read_b128 a[204:207], v212 offset:39936
    s_add_u32 s94, s40, s16
    v_mfma_f32_16x16x32_bf16 v[148:151], a[208:211], v[68:71], v[148:151]
    v_add_u32 v240, s59, v212
    v_mfma_f32_16x16x32_bf16 v[148:151], a[212:215], v[76:79], v[148:151]
    s_barrier
    s_waitcnt lgkmcnt(4)
    s_add_u32 m0, s31, 0
    v_mfma_f32_16x16x32_bf16 v[152:155], a[216:219], v[64:67], v[152:155]
    ds_read_b128 a[208:211], v212 offset:40960
    v_add_u32 v240, 61440, v240
    v_mfma_f32_16x16x32_bf16 v[152:155], a[220:223], v[72:75], v[152:155]
    ds_read_b128 a[212:215], v212 offset:51200
    v_and_b32 v241, 12, v218
    v_mfma_f32_16x16x32_bf16 v[156:159], a[216:219], v[68:71], v[156:159]
    buffer_load_dwordx4 v212, s[8:11], s34 offen offset:0 lds
    v_mfma_f32_16x16x32_bf16 v[156:159], a[220:223], v[76:79], v[156:159]
    s_waitcnt lgkmcnt(4)
    s_mul_i32 s17, s28, 81920
    v_mfma_f32_16x16x32_bf16 v[160:163], a[192:195], v[64:67], v[160:163]
    ds_read_b128 a[216:219], v212 offset:41984
    s_mul_i32 s40, s12, 10240
    v_mfma_f32_16x16x32_bf16 v[160:163], a[196:199], v[72:75], v[160:163]
    ds_read_b128 a[220:223], v212 offset:52224
    s_add_u32 s17, s17, s40
    v_mfma_f32_16x16x32_bf16 v[164:167], a[192:195], v[68:71], v[164:167]
    buffer_load_dwordx4 v212, s[8:11], s34 offen offset:1024 lds
    v_mfma_f32_16x16x32_bf16 v[164:167], a[196:199], v[76:79], v[164:167]
    s_waitcnt lgkmcnt(4)
    s_cmp_eq_u32 s28, s12
    s_cselect_b32 s17, 0x40000000, s17
    v_mfma_f32_16x16x32_bf16 v[168:171], a[200:203], v[64:67], v[168:171]
    ds_read_b128 a[192:195], v212 offset:43008
    v_mfma_f32_16x16x32_bf16 v[168:171], a[204:207], v[72:75], v[168:171]
    ds_read_b128 a[196:199], v212 offset:53248
    v_mfma_f32_16x16x32_bf16 v[172:175], a[200:203], v[68:71], v[172:175]
    buffer_load_dwordx4 v212, s[8:11], s34 offen offset:2048 lds
    v_mfma_f32_16x16x32_bf16 v[172:175], a[204:207], v[76:79], v[172:175]
    s_waitcnt vmcnt(21) lgkmcnt(4)
    s_cmp_eq_u32 s28, s12
    s_cselect_b32 s40, 0, 10240
    v_mfma_f32_16x16x32_bf16 v[96:99], a[208:211], v[80:83], v[96:99]
    ds_read_b128 a[200:203], v212 offset:44032
    s_add_u32 s40, s40, 61440
    v_mfma_f32_16x16x32_bf16 v[96:99], a[212:215], v[88:91], v[96:99]
    ds_read_b128 a[204:207], v212 offset:54272
    v_add_u32 v242, s40, v212
    v_mfma_f32_16x16x32_bf16 v[100:103], a[208:211], v[84:87], v[100:103]
    buffer_load_dwordx4 v212, s[8:11], s34 offen offset:3072 lds
    v_mfma_f32_16x16x32_bf16 v[100:103], a[212:215], v[92:95], v[100:103]
    s_waitcnt lgkmcnt(4)
    s_add_u32 m0, s31, 4096
    v_mfma_f32_16x16x32_bf16 v[104:107], a[216:219], v[80:83], v[104:107]
    ds_read_b128 a[208:211], v212 offset:45056
    v_mfma_f32_16x16x32_bf16 v[104:107], a[220:223], v[88:91], v[104:107]
    ds_read_b128 a[212:215], v212 offset:55296
    v_mfma_f32_16x16x32_bf16 v[108:111], a[216:219], v[84:87], v[108:111]
    buffer_load_dwordx4 v213, s[8:11], s34 offen offset:0 lds
    v_mfma_f32_16x16x32_bf16 v[108:111], a[220:223], v[92:95], v[108:111]
    s_waitcnt lgkmcnt(4)
    s_add_u32 s34, s34, 81920
    v_mfma_f32_16x16x32_bf16 v[112:115], a[192:195], v[80:83], v[112:115]
    ds_read_b128 a[216:219], v212 offset:46080
    v_mfma_f32_16x16x32_bf16 v[112:115], a[196:199], v[88:91], v[112:115]
    ds_read_b128 a[220:223], v212 offset:56320
    v_mfma_f32_16x16x32_bf16 v[116:119], a[192:195], v[84:87], v[116:119]
    buffer_load_dwordx4 v[32:35], v212, s[4:7], s33 offen offset:0 sc1
    v_mfma_f32_16x16x32_bf16 v[116:119], a[196:199], v[92:95], v[116:119]
    s_waitcnt lgkmcnt(4)
    v_mfma_f32_16x16x32_bf16 v[120:123], a[200:203], v[80:83], v[120:123]
    ds_read_b128 a[192:195], v212 offset:47104
    v_mfma_f32_16x16x32_bf16 v[120:123], a[204:207], v[88:91], v[120:123]
    ds_read_b128 a[196:199], v212 offset:57344
    v_mfma_f32_16x16x32_bf16 v[124:127], a[200:203], v[84:87], v[124:127]
    buffer_load_dwordx4 v[36:39], v212, s[4:7], s33 offen offset:1024 sc1
    v_mfma_f32_16x16x32_bf16 v[124:127], a[204:207], v[92:95], v[124:127]
    s_waitcnt lgkmcnt(4)
    v_mfma_f32_16x16x32_bf16 v[128:131], a[208:211], v[80:83], v[128:131]
    ds_read_b128 a[200:203], v212 offset:48128
    v_mfma_f32_16x16x32_bf16 v[128:131], a[212:215], v[88:91], v[128:131]
    ds_read_b128 a[204:207], v212 offset:58368
    v_mfma_f32_16x16x32_bf16 v[132:135], a[208:211], v[84:87], v[132:135]
    buffer_load_dwordx4 v[40:43], v213, s[4:7], s33 offen offset:0 sc1
    v_mfma_f32_16x16x32_bf16 v[132:135], a[212:215], v[92:95], v[132:135]
    s_waitcnt lgkmcnt(4)
    v_mfma_f32_16x16x32_bf16 v[136:139], a[216:219], v[80:83], v[136:139]
    ds_read_b128 a[208:211], v212 offset:49152
    v_mfma_f32_16x16x32_bf16 v[136:139], a[220:223], v[88:91], v[136:139]
    ds_read_b128 a[212:215], v212 offset:59392
    v_mfma_f32_16x16x32_bf16 v[140:143], a[216:219], v[84:87], v[140:143]
    buffer_load_dwordx4 v[44:47], v213, s[4:7], s33 offen offset:1024 sc1
    v_mfma_f32_16x16x32_bf16 v[140:143], a[220:223], v[92:95], v[140:143]
    s_waitcnt lgkmcnt(4)
    s_add_u32 s33, s33, 8192
    v_mfma_f32_16x16x32_bf16 v[144:147], a[192:195], v[80:83], v[144:147]
    ds_read_b128 a[216:219], v212 offset:50176
    v_mfma_f32_16x16x32_bf16 v[144:147], a[196:199], v[88:91], v[144:147]
    ds_read_b128 a[220:223], v212 offset:60416
    v_mfma_f32_16x16x32_bf16 v[148:151], a[192:195], v[84:87], v[148:151]
    v_mfma_f32_16x16x32_bf16 v[148:151], a[196:199], v[92:95], v[148:151]
    s_barrier
    s_waitcnt lgkmcnt(4)
    s_add_u32 m0, s31, 20480
    v_mfma_f32_16x16x32_bf16 v[152:155], a[200:203], v[80:83], v[152:155]
    ds_read_b128 a[192:195], v215 offset:0
    v_mfma_f32_16x16x32_bf16 v[152:155], a[204:207], v[88:91], v[152:155]
    ds_read_b128 a[196:199], v215 offset:10240
    v_mfma_f32_16x16x32_bf16 v[156:159], a[200:203], v[84:87], v[156:159]
    buffer_load_dwordx4 v212, s[8:11], s34 offen offset:0 lds
    v_mfma_f32_16x16x32_bf16 v[156:159], a[204:207], v[92:95], v[156:159]
    s_waitcnt lgkmcnt(4)
    v_mfma_f32_16x16x32_bf16 v[160:163], a[208:211], v[80:83], v[160:163]
    ds_read_b128 a[200:203], v215 offset:1024
    v_mfma_f32_16x16x32_bf16 v[160:163], a[212:215], v[88:91], v[160:163]
    ds_read_b128 a[204:207], v215 offset:11264
    v_mfma_f32_16x16x32_bf16 v[164:167], a[208:211], v[84:87], v[164:167]
    buffer_load_dwordx4 v212, s[8:11], s34 offen offset:1024 lds
    v_mfma_f32_16x16x32_bf16 v[164:167], a[212:215], v[92:95], v[164:167]
    s_waitcnt lgkmcnt(4)
    v_mfma_f32_16x16x32_bf16 v[168:171], a[216:219], v[80:83], v[168:171]
    ds_read_b128 a[208:211], v215 offset:2048
    v_mfma_f32_16x16x32_bf16 v[168:171], a[220:223], v[88:91], v[168:171]
    ds_read_b128 a[212:215], v215 offset:12288
    v_mfma_f32_16x16x32_bf16 v[172:175], a[216:219], v[84:87], v[172:175]
    buffer_load_dwordx4 v212, s[8:11], s34 offen offset:2048 lds
    v_mfma_f32_16x16x32_bf16 v[172:175], a[220:223], v[92:95], v[172:175]
    s_waitcnt vmcnt(21) lgkmcnt(4)
    v_mfma_f32_16x16x32_bf16 v[96:99], a[192:195], v[0:3], v[96:99]
    ds_read_b128 a[216:219], v215 offset:3072
    v_mfma_f32_16x16x32_bf16 v[96:99], a[196:199], v[8:11], v[96:99]
    ds_read_b128 a[220:223], v215 offset:13312
    v_mfma_f32_16x16x32_bf16 v[100:103], a[192:195], v[4:7], v[100:103]
    buffer_load_dwordx4 v212, s[8:11], s34 offen offset:3072 lds
    v_mfma_f32_16x16x32_bf16 v[100:103], a[196:199], v[12:15], v[100:103]
    s_waitcnt lgkmcnt(4)
    s_add_u32 m0, s31, 24576
    v_mfma_f32_16x16x32_bf16 v[104:107], a[200:203], v[0:3], v[104:107]
    ds_read_b128 a[192:195], v215 offset:4096
    v_mfma_f32_16x16x32_bf16 v[104:107], a[204:207], v[8:11], v[104:107]
    ds_read_b128 a[196:199], v215 offset:14336
    v_mfma_f32_16x16x32_bf16 v[108:111], a[200:203], v[4:7], v[108:111]
    buffer_load_dwordx4 v213, s[8:11], s34 offen offset:0 lds
    v_mfma_f32_16x16x32_bf16 v[108:111], a[204:207], v[12:15], v[108:111]
    s_waitcnt lgkmcnt(4)
    s_add_u32 s34, s34, 81920
    v_mfma_f32_16x16x32_bf16 v[112:115], a[208:211], v[0:3], v[112:115]
    ds_read_b128 a[200:203], v215 offset:5120
    v_mfma_f32_16x16x32_bf16 v[112:115], a[212:215], v[8:11], v[112:115]
    ds_read_b128 a[204:207], v215 offset:15360
    v_mfma_f32_16x16x32_bf16 v[116:119], a[208:211], v[4:7], v[116:119]
    buffer_load_dwordx4 v[48:51], v212, s[4:7], s33 offen offset:0 sc1
    v_mfma_f32_16x16x32_bf16 v[116:119], a[212:215], v[12:15], v[116:119]
    s_waitcnt lgkmcnt(4)
    v_mfma_f32_16x16x32_bf16 v[120:123], a[216:219], v[0:3], v[120:123]
    ds_read_b128 a[208:211], v215 offset:6144
    v_mfma_f32_16x16x32_bf16 v[120:123], a[220:223], v[8:11], v[120:123]
    ds_read_b128 a[212:215], v215 offset:16384
    v_mfma_f32_16x16x32_bf16 v[124:127], a[216:219], v[4:7], v[124:127]
    buffer_load_dwordx4 v[52:55], v212, s[4:7], s33 offen offset:1024 sc1
    v_mfma_f32_16x16x32_bf16 v[124:127], a[220:223], v[12:15], v[124:127]
    s_waitcnt lgkmcnt(4)
    v_mfma_f32_16x16x32_bf16 v[128:131], a[192:195], v[0:3], v[128:131]
    ds_read_b128 a[216:219], v215 offset:7168
    v_mfma_f32_16x16x32_bf16 v[128:131], a[196:199], v[8:11], v[128:131]
    ds_read_b128 a[220:223], v215 offset:17408
    v_mfma_f32_16x16x32_bf16 v[132:135], a[192:195], v[4:7], v[132:135]
    buffer_load_dwordx4 v[56:59], v213, s[4:7], s33 offen offset:0 sc1
    v_mfma_f32_16x16x32_bf16 v[132:135], a[196:199], v[12:15], v[132:135]
    s_waitcnt lgkmcnt(4)
    v_mfma_f32_16x16x32_bf16 v[136:139], a[200:203], v[0:3], v[136:139]
    ds_read_b128 a[192:195], v215 offset:8192
    v_mfma_f32_16x16x32_bf16 v[136:139], a[204:207], v[8:11], v[136:139]
    ds_read_b128 a[196:199], v215 offset:18432
    v_mfma_f32_16x16x32_bf16 v[140:143], a[200:203], v[4:7], v[140:143]
    buffer_load_dwordx4 v[60:63], v213, s[4:7], s33 offen offset:1024 sc1
    v_mfma_f32_16x16x32_bf16 v[140:143], a[204:207], v[12:15], v[140:143]
    s_waitcnt lgkmcnt(4)
    s_add_u32 s33, s33, 8192
    v_mfma_f32_16x16x32_bf16 v[144:147], a[208:211], v[0:3], v[144:147]
    ds_read_b128 a[200:203], v215 offset:9216
    v_mfma_f32_16x16x32_bf16 v[144:147], a[212:215], v[8:11], v[144:147]
    ds_read_b128 a[204:207], v215 offset:19456
    v_mfma_f32_16x16x32_bf16 v[148:151], a[208:211], v[4:7], v[148:151]
    v_mfma_f32_16x16x32_bf16 v[148:151], a[212:215], v[12:15], v[148:151]
    s_barrier
    s_waitcnt lgkmcnt(4)
    s_add_u32 m0, s31, 40960
    v_mfma_f32_16x16x32_bf16 v[152:155], a[216:219], v[0:3], v[152:155]
    ds_read_b128 a[208:211], v215 offset:20480
    v_mfma_f32_16x16x32_bf16 v[152:155], a[220:223], v[8:11], v[152:155]
    ds_read_b128 a[212:215], v215 offset:30720
    v_mfma_f32_16x16x32_bf16 v[156:159], a[216:219], v[4:7], v[156:159]
    buffer_load_dwordx4 v212, s[8:11], s34 offen offset:0 lds
    v_mfma_f32_16x16x32_bf16 v[156:159], a[220:223], v[12:15], v[156:159]
    s_waitcnt lgkmcnt(4)
    v_mfma_f32_16x16x32_bf16 v[160:163], a[192:195], v[0:3], v[160:163]
    ds_read_b128 a[216:219], v215 offset:21504
    v_mfma_f32_16x16x32_bf16 v[160:163], a[196:199], v[8:11], v[160:163]
    ds_read_b128 a[220:223], v215 offset:31744
    v_mfma_f32_16x16x32_bf16 v[164:167], a[192:195], v[4:7], v[164:167]
    buffer_load_dwordx4 v212, s[8:11], s34 offen offset:1024 lds
    v_mfma_f32_16x16x32_bf16 v[164:167], a[196:199], v[12:15], v[164:167]
    s_waitcnt lgkmcnt(4)
    v_mfma_f32_16x16x32_bf16 v[168:171], a[200:203], v[0:3], v[168:171]
    ds_read_b128 a[192:195], v215 offset:22528
    v_mfma_f32_16x16x32_bf16 v[168:171], a[204:207], v[8:11], v[168:171]
    ds_read_b128 a[196:199], v215 offset:32768
    v_mfma_f32_16x16x32_bf16 v[172:175], a[200:203], v[4:7], v[172:175]
    buffer_load_dwordx4 v212, s[8:11], s34 offen offset:2048 lds
    v_mfma_f32_16x16x32_bf16 v[172:175], a[204:207], v[12:15], v[172:175]
    s_waitcnt vmcnt(21) lgkmcnt(4)
    v_mfma_f32_16x16x32_bf16 v[96:99], a[208:211], v[16:19], v[96:99]
    ds_read_b128 a[200:203], v215 offset:23552
    v_mfma_f32_16x16x32_bf16 v[96:99], a[212:215], v[24:27], v[96:99]
    ds_read_b128 a[204:207], v215 offset:33792
    v_mfma_f32_16x16x32_bf16 v[100:103], a[208:211], v[20:23], v[100:103]
    buffer_load_dwordx4 v212, s[8:11], s34 offen offset:3072 lds
    v_mfma_f32_16x16x32_bf16 v[100:103], a[212:215], v[28:31], v[100:103]
    s_waitcnt lgkmcnt(4)
    s_add_u32 m0, s31, 45056
    v_mfma_f32_16x16x32_bf16 v[104:107], a[216:219], v[16:19], v[104:107]
    ds_read_b128 a[208:211], v215 offset:24576
    v_mfma_f32_16x16x32_bf16 v[104:107], a[220:223], v[24:27], v[104:107]
    ds_read_b128 a[212:215], v215 offset:34816
    v_mfma_f32_16x16x32_bf16 v[108:111], a[216:219], v[20:23], v[108:111]
    buffer_load_dwordx4 v213, s[8:11], s34 offen offset:0 lds
    v_mfma_f32_16x16x32_bf16 v[108:111], a[220:223], v[28:31], v[108:111]
    s_waitcnt lgkmcnt(4)
    s_add_u32 s34, s34, 81920
    v_mfma_f32_16x16x32_bf16 v[112:115], a[192:195], v[16:19], v[112:115]
    ds_read_b128 a[216:219], v215 offset:25600
    v_mfma_f32_16x16x32_bf16 v[112:115], a[196:199], v[24:27], v[112:115]
    ds_read_b128 a[220:223], v215 offset:35840
    v_mfma_f32_16x16x32_bf16 v[116:119], a[192:195], v[20:23], v[116:119]
    buffer_load_dwordx4 v[64:67], v212, s[4:7], s33 offen offset:0 sc1
    v_mfma_f32_16x16x32_bf16 v[116:119], a[196:199], v[28:31], v[116:119]
    s_waitcnt lgkmcnt(4)
    v_mfma_f32_16x16x32_bf16 v[120:123], a[200:203], v[16:19], v[120:123]
    ds_read_b128 a[192:195], v215 offset:26624
    v_mfma_f32_16x16x32_bf16 v[120:123], a[204:207], v[24:27], v[120:123]
    ds_read_b128 a[196:199], v215 offset:36864
    v_mfma_f32_16x16x32_bf16 v[124:127], a[200:203], v[20:23], v[124:127]
    buffer_load_dwordx4 v[68:71], v212, s[4:7], s33 offen offset:1024 sc1
    v_mfma_f32_16x16x32_bf16 v[124:127], a[204:207], v[28:31], v[124:127]
    s_waitcnt lgkmcnt(4)
    v_mfma_f32_16x16x32_bf16 v[128:131], a[208:211], v[16:19], v[128:131]
    ds_read_b128 a[200:203], v215 offset:27648
    v_mfma_f32_16x16x32_bf16 v[128:131], a[212:215], v[24:27], v[128:131]
    ds_read_b128 a[204:207], v215 offset:37888
    v_mfma_f32_16x16x32_bf16 v[132:135], a[208:211], v[20:23], v[132:135]
    buffer_load_dwordx4 v[72:75], v213, s[4:7], s33 offen offset:0 sc1
    v_mfma_f32_16x16x32_bf16 v[132:135], a[212:215], v[28:31], v[132:135]
    s_waitcnt lgkmcnt(4)
    v_mfma_f32_16x16x32_bf16 v[136:139], a[216:219], v[16:19], v[136:139]
    ds_read_b128 a[208:211], v215 offset:28672
    v_mfma_f32_16x16x32_bf16 v[136:139], a[220:223], v[24:27], v[136:139]
    ds_read_b128 a[212:215], v215 offset:38912
    v_mfma_f32_16x16x32_bf16 v[140:143], a[216:219], v[20:23], v[140:143]
    buffer_load_dwordx4 v[76:79], v213, s[4:7], s33 offen offset:1024 sc1
    v_mfma_f32_16x16x32_bf16 v[140:143], a[220:223], v[28:31], v[140:143]
    s_waitcnt lgkmcnt(4)
    s_add_u32 s33, s33, 8192
    v_mfma_f32_16x16x32_bf16 v[144:147], a[192:195], v[16:19], v[144:147]
    ds_read_b128 a[216:219], v215 offset:29696
    v_mfma_f32_16x16x32_bf16 v[144:147], a[196:199], v[24:27], v[144:147]
    ds_read_b128 a[220:223], v215 offset:39936
    v_mfma_f32_16x16x32_bf16 v[148:151], a[192:195], v[20:23], v[148:151]
    v_mfma_f32_16x16x32_bf16 v[148:151], a[196:199], v[28:31], v[148:151]
    s_barrier
    s_waitcnt lgkmcnt(4)
    s_add_u32 m0, s31, 98304
    v_mfma_f32_16x16x32_bf16 v[152:155], a[200:203], v[16:19], v[152:155]
    ds_read_b128 a[192:195], v215 offset:40960
    v_mfma_f32_16x16x32_bf16 v[152:155], a[204:207], v[24:27], v[152:155]
    ds_read_b128 a[196:199], v215 offset:51200
    v_mfma_f32_16x16x32_bf16 v[156:159], a[200:203], v[20:23], v[156:159]
    buffer_load_dwordx4 v212, s[8:11], s34 offen offset:0 lds
    v_mfma_f32_16x16x32_bf16 v[156:159], a[204:207], v[28:31], v[156:159]
    s_waitcnt lgkmcnt(4)
    v_mfma_f32_16x16x32_bf16 v[160:163], a[208:211], v[16:19], v[160:163]
    ds_read_b128 a[200:203], v215 offset:41984
    v_mfma_f32_16x16x32_bf16 v[160:163], a[212:215], v[24:27], v[160:163]
    ds_read_b128 a[204:207], v215 offset:52224
    v_mfma_f32_16x16x32_bf16 v[164:167], a[208:211], v[20:23], v[164:167]
    buffer_load_dwordx4 v212, s[8:11], s34 offen offset:1024 lds
    v_mfma_f32_16x16x32_bf16 v[164:167], a[212:215], v[28:31], v[164:167]
    s_waitcnt lgkmcnt(4)
    v_mfma_f32_16x16x32_bf16 v[168:171], a[216:219], v[16:19], v[168:171]
    ds_read_b128 a[208:211], v215 offset:43008
    v_mfma_f32_16x16x32_bf16 v[168:171], a[220:223], v[24:27], v[168:171]
    ds_read_b128 a[212:215], v215 offset:53248
    v_mfma_f32_16x16x32_bf16 v[172:175], a[216:219], v[20:23], v[172:175]
    buffer_load_dwordx4 v212, s[8:11], s34 offen offset:2048 lds
    v_mfma_f32_16x16x32_bf16 v[172:175], a[220:223], v[28:31], v[172:175]
    s_waitcnt vmcnt(21) lgkmcnt(4)
    v_mfma_f32_16x16x32_bf16 v[96:99], a[192:195], v[32:35], v[96:99]
    ds_read_b128 a[216:219], v215 offset:44032
    v_mfma_f32_16x16x32_bf16 v[96:99], a[196:199], v[40:43], v[96:99]
    ds_read_b128 a[220:223], v215 offset:54272
    v_mfma_f32_16x16x32_bf16 v[100:103], a[192:195], v[36:39], v[100:103]
    buffer_load_dwordx4 v212, s[8:11], s34 offen offset:3072 lds
    v_mfma_f32_16x16x32_bf16 v[100:103], a[196:199], v[44:47], v[100:103]
    s_waitcnt lgkmcnt(4)
    s_add_u32 m0, s31, 102400
    v_mfma_f32_16x16x32_bf16 v[104:107], a[200:203], v[32:35], v[104:107]
    ds_read_b128 a[192:195], v215 offset:45056
    v_mfma_f32_16x16x32_bf16 v[104:107], a[204:207], v[40:43], v[104:107]
    ds_read_b128 a[196:199], v215 offset:55296
    v_mfma_f32_16x16x32_bf16 v[108:111], a[200:203], v[36:39], v[108:111]
    buffer_load_dwordx4 v213, s[8:11], s34 offen offset:0 lds
    v_mfma_f32_16x16x32_bf16 v[108:111], a[204:207], v[44:47], v[108:111]
    s_waitcnt lgkmcnt(4)
    s_add_u32 s34, s34, 81920
    v_mfma_f32_16x16x32_bf16 v[112:115], a[208:211], v[32:35], v[112:115]
    ds_read_b128 a[200:203], v215 offset:46080
    v_mfma_f32_16x16x32_bf16 v[112:115], a[212:215], v[40:43], v[112:115]
    ds_read_b128 a[204:207], v215 offset:56320
    v_mfma_f32_16x16x32_bf16 v[116:119], a[208:211], v[36:39], v[116:119]
    buffer_load_dwordx4 v[80:83], v212, s[4:7], s33 offen offset:0 sc1
    v_mfma_f32_16x16x32_bf16 v[116:119], a[212:215], v[44:47], v[116:119]
    s_waitcnt lgkmcnt(4)
    v_mfma_f32_16x16x32_bf16 v[120:123], a[216:219], v[32:35], v[120:123]
    ds_read_b128 a[208:211], v215 offset:47104
    v_mfma_f32_16x16x32_bf16 v[120:123], a[220:223], v[40:43], v[120:123]
    ds_read_b128 a[212:215], v215 offset:57344
    v_mfma_f32_16x16x32_bf16 v[124:127], a[216:219], v[36:39], v[124:127]
    buffer_load_dwordx4 v[84:87], v212, s[4:7], s33 offen offset:1024 sc1
    v_mfma_f32_16x16x32_bf16 v[124:127], a[220:223], v[44:47], v[124:127]
    s_waitcnt lgkmcnt(4)
    v_mfma_f32_16x16x32_bf16 v[128:131], a[192:195], v[32:35], v[128:131]
    ds_read_b128 a[216:219], v215 offset:48128
    v_mfma_f32_16x16x32_bf16 v[128:131], a[196:199], v[40:43], v[128:131]
    ds_read_b128 a[220:223], v215 offset:58368
    v_mfma_f32_16x16x32_bf16 v[132:135], a[192:195], v[36:39], v[132:135]
    buffer_load_dwordx4 v[88:91], v213, s[4:7], s33 offen offset:0 sc1
    v_mfma_f32_16x16x32_bf16 v[132:135], a[196:199], v[44:47], v[132:135]
    s_waitcnt lgkmcnt(4)
    v_mfma_f32_16x16x32_bf16 v[136:139], a[200:203], v[32:35], v[136:139]
    ds_read_b128 a[192:195], v215 offset:49152
    v_mfma_f32_16x16x32_bf16 v[136:139], a[204:207], v[40:43], v[136:139]
    ds_read_b128 a[196:199], v215 offset:59392
    v_mfma_f32_16x16x32_bf16 v[140:143], a[200:203], v[36:39], v[140:143]
    buffer_load_dwordx4 v[92:95], v213, s[4:7], s33 offen offset:1024 sc1
    v_mfma_f32_16x16x32_bf16 v[140:143], a[204:207], v[44:47], v[140:143]
    s_waitcnt lgkmcnt(4)
    s_add_u32 s33, s33, 8192
    v_mfma_f32_16x16x32_bf16 v[144:147], a[208:211], v[32:35], v[144:147]
    ds_read_b128 a[200:203], v215 offset:50176
    v_mfma_f32_16x16x32_bf16 v[144:147], a[212:215], v[40:43], v[144:147]
    ds_read_b128 a[204:207], v215 offset:60416
    v_mfma_f32_16x16x32_bf16 v[148:151], a[208:211], v[36:39], v[148:151]
    v_mfma_f32_16x16x32_bf16 v[148:151], a[212:215], v[44:47], v[148:151]
    s_barrier
    s_waitcnt lgkmcnt(4)
    s_add_u32 m0, s31, 118784
    v_mfma_f32_16x16x32_bf16 v[152:155], a[216:219], v[32:35], v[152:155]
    ds_read_b128 a[208:211], v212 offset:0
    v_mfma_f32_16x16x32_bf16 v[152:155], a[220:223], v[40:43], v[152:155]
    ds_read_b128 a[212:215], v212 offset:10240
    v_mfma_f32_16x16x32_bf16 v[156:159], a[216:219], v[36:39], v[156:159]
    buffer_load_dwordx4 v212, s[8:11], s34 offen offset:0 lds
    v_mfma_f32_16x16x32_bf16 v[156:159], a[220:223], v[44:47], v[156:159]
    s_waitcnt lgkmcnt(4)
    v_mfma_f32_16x16x32_bf16 v[160:163], a[192:195], v[32:35], v[160:163]
    ds_read_b128 a[216:219], v212 offset:1024
    v_mfma_f32_16x16x32_bf16 v[160:163], a[196:199], v[40:43], v[160:163]
    ds_read_b128 a[220:223], v212 offset:11264
    v_mfma_f32_16x16x32_bf16 v[164:167], a[192:195], v[36:39], v[164:167]
    buffer_load_dwordx4 v212, s[8:11], s34 offen offset:1024 lds
    v_mfma_f32_16x16x32_bf16 v[164:167], a[196:199], v[44:47], v[164:167]
    s_waitcnt lgkmcnt(4)
    v_mfma_f32_16x16x32_bf16 v[168:171], a[200:203], v[32:35], v[168:171]
    ds_read_b128 a[192:195], v212 offset:2048
    v_mfma_f32_16x16x32_bf16 v[168:171], a[204:207], v[40:43], v[168:171]
    ds_read_b128 a[196:199], v212 offset:12288
    v_mfma_f32_16x16x32_bf16 v[172:175], a[200:203], v[36:39], v[172:175]
    buffer_load_dwordx4 v212, s[8:11], s34 offen offset:2048 lds
    v_mfma_f32_16x16x32_bf16 v[172:175], a[204:207], v[44:47], v[172:175]
    s_waitcnt vmcnt(21) lgkmcnt(4)
    v_mfma_f32_16x16x32_bf16 v[96:99], a[208:211], v[48:51], v[96:99]
    ds_read_b128 a[200:203], v212 offset:3072
    v_accvgpr_read_b32 v192, a224
    v_mfma_f32_16x16x32_bf16 v[96:99], a[212:215], v[56:59], v[96:99]
    ds_read_b128 a[204:207], v212 offset:13312
    v_accvgpr_read_b32 v193, a225
    v_mfma_f32_16x16x32_bf16 v[100:103], a[208:211], v[52:55], v[100:103]
    buffer_load_dwordx4 v212, s[8:11], s34 offen offset:3072 lds
    v_mfma_f32_16x16x32_bf16 v[100:103], a[212:215], v[60:63], v[100:103]
    s_waitcnt lgkmcnt(4)
    s_add_u32 m0, s31, 122880
    v_accvgpr_read_b32 v194, a226
    v_mfma_f32_16x16x32_bf16 v[104:107], a[216:219], v[48:51], v[104:107]
    ds_read_b128 a[208:211], v212 offset:4096
    v_accvgpr_read_b32 v195, a227
    v_mfma_f32_16x16x32_bf16 v[104:107], a[220:223], v[56:59], v[104:107]
    ds_read_b128 a[212:215], v212 offset:14336
    v_accvgpr_read_b32 v200, a228
    v_mfma_f32_16x16x32_bf16 v[108:111], a[216:219], v[52:55], v[108:111]
    buffer_load_dwordx4 v213, s[8:11], s34 offen offset:0 lds
    v_mfma_f32_16x16x32_bf16 v[108:111], a[220:223], v[60:63], v[108:111]
    s_waitcnt lgkmcnt(4)
    s_add_u32 s34, s34, 81920
    v_accvgpr_read_b32 v201, a229
    v_mfma_f32_16x16x32_bf16 v[112:115], a[192:195], v[48:51], v[112:115]
    ds_read_b128 a[216:219], v212 offset:5120
    v_accvgpr_read_b32 v202, a230
    v_mfma_f32_16x16x32_bf16 v[112:115], a[196:199], v[56:59], v[112:115]
    ds_read_b128 a[220:223], v212 offset:15360
    v_accvgpr_read_b32 v203, a231
    v_mfma_f32_16x16x32_bf16 v[116:119], a[192:195], v[52:55], v[116:119]
    buffer_load_dwordx4 v[0:3], v212, s[4:7], s33 offen offset:0 sc1
    v_mfma_f32_16x16x32_bf16 v[116:119], a[196:199], v[60:63], v[116:119]
    s_waitcnt lgkmcnt(4)
    v_accvgpr_read_b32 v204, a232
    v_mfma_f32_16x16x32_bf16 v[120:123], a[200:203], v[48:51], v[120:123]
    ds_read_b128 a[192:195], v212 offset:6144
    v_accvgpr_read_b32 v205, a233
    v_mfma_f32_16x16x32_bf16 v[120:123], a[204:207], v[56:59], v[120:123]
    ds_read_b128 a[196:199], v212 offset:16384
    v_accvgpr_read_b32 v206, a234
    v_mfma_f32_16x16x32_bf16 v[124:127], a[200:203], v[52:55], v[124:127]
    buffer_load_dwordx4 v[4:7], v212, s[4:7], s33 offen offset:1024 sc1
    v_mfma_f32_16x16x32_bf16 v[124:127], a[204:207], v[60:63], v[124:127]
    s_waitcnt lgkmcnt(4)
    v_accvgpr_read_b32 v207, a235
    v_mfma_f32_16x16x32_bf16 v[128:131], a[208:211], v[48:51], v[128:131]
    ds_read_b128 a[200:203], v212 offset:7168
    v_mfma_f32_16x16x32_bf16 v[128:131], a[212:215], v[56:59], v[128:131]
    ds_read_b128 a[204:207], v212 offset:17408
    v_mfma_f32_16x16x32_bf16 v[132:135], a[208:211], v[52:55], v[132:135]
    buffer_load_dwordx4 v[8:11], v213, s[4:7], s33 offen offset:0 sc1
    v_mfma_f32_16x16x32_bf16 v[132:135], a[212:215], v[60:63], v[132:135]
    s_waitcnt lgkmcnt(4)
    v_mfma_f32_16x16x32_bf16 v[136:139], a[216:219], v[48:51], v[136:139]
    ds_read_b128 a[208:211], v212 offset:8192
    v_mfma_f32_16x16x32_bf16 v[136:139], a[220:223], v[56:59], v[136:139]
    ds_read_b128 a[212:215], v212 offset:18432
    v_mfma_f32_16x16x32_bf16 v[140:143], a[216:219], v[52:55], v[140:143]
    buffer_load_dwordx4 v[12:15], v213, s[4:7], s33 offen offset:1024 sc1
    v_mfma_f32_16x16x32_bf16 v[140:143], a[220:223], v[60:63], v[140:143]
    s_waitcnt lgkmcnt(4)
    s_add_u32 s33, s33, 8192
    v_mfma_f32_16x16x32_bf16 v[144:147], a[192:195], v[48:51], v[144:147]
    ds_read_b128 a[216:219], v212 offset:9216
    v_mfma_f32_16x16x32_bf16 v[144:147], a[196:199], v[56:59], v[144:147]
    ds_read_b128 a[220:223], v212 offset:19456
    v_mfma_f32_16x16x32_bf16 v[148:151], a[192:195], v[52:55], v[148:151]
    v_mfma_f32_16x16x32_bf16 v[148:151], a[196:199], v[60:63], v[148:151]
    s_barrier
    s_waitcnt lgkmcnt(4)
    s_add_u32 m0, s31, 139264
    v_mfma_f32_16x16x32_bf16 v[152:155], a[200:203], v[48:51], v[152:155]
    ds_read_b128 a[192:195], v212 offset:20480
    v_mfma_f32_16x16x32_bf16 v[152:155], a[204:207], v[56:59], v[152:155]
    ds_read_b128 a[196:199], v212 offset:30720
    v_mfma_f32_16x16x32_bf16 v[156:159], a[200:203], v[52:55], v[156:159]
    buffer_load_dwordx4 v212, s[8:11], s34 offen offset:0 lds
    v_mfma_f32_16x16x32_bf16 v[156:159], a[204:207], v[60:63], v[156:159]
    s_waitcnt lgkmcnt(4)
    v_mfma_f32_16x16x32_bf16 v[160:163], a[208:211], v[48:51], v[160:163]
    ds_read_b128 a[200:203], v212 offset:21504
    v_mfma_f32_16x16x32_bf16 v[160:163], a[212:215], v[56:59], v[160:163]
    ds_read_b128 a[204:207], v212 offset:31744
    v_mfma_f32_16x16x32_bf16 v[164:167], a[208:211], v[52:55], v[164:167]
    buffer_load_dwordx4 v212, s[8:11], s34 offen offset:1024 lds
    v_mfma_f32_16x16x32_bf16 v[164:167], a[212:215], v[60:63], v[164:167]
    s_waitcnt lgkmcnt(4)
    v_mfma_f32_16x16x32_bf16 v[168:171], a[216:219], v[48:51], v[168:171]
    ds_read_b128 a[208:211], v212 offset:22528
    v_mfma_f32_16x16x32_bf16 v[168:171], a[220:223], v[56:59], v[168:171]
    ds_read_b128 a[212:215], v212 offset:32768
    v_mfma_f32_16x16x32_bf16 v[172:175], a[216:219], v[52:55], v[172:175]
    buffer_load_dwordx4 v212, s[8:11], s34 offen offset:2048 lds
    v_mfma_f32_16x16x32_bf16 v[172:175], a[220:223], v[60:63], v[172:175]
    s_waitcnt vmcnt(21) lgkmcnt(4)
    v_mfma_f32_16x16x32_bf16 v[96:99], a[192:195], v[64:67], v[96:99]
    ds_read_b128 a[216:219], v212 offset:23552
    v_mfma_f32_16x16x32_bf16 v[96:99], a[196:199], v[72:75], v[96:99]
    ds_read_b128 a[220:223], v212 offset:33792
    v_mfma_f32_16x16x32_bf16 v[100:103], a[192:195], v[68:71], v[100:103]
    buffer_load_dwordx4 v212, s[8:11], s34 offen offset:3072 lds
    v_mfma_f32_16x16x32_bf16 v[100:103], a[196:199], v[76:79], v[100:103]
    s_waitcnt lgkmcnt(4)
    s_add_u32 m0, s31, 143360
    v_mfma_f32_16x16x32_bf16 v[104:107], a[200:203], v[64:67], v[104:107]
    ds_read_b128 a[192:195], v212 offset:24576
    v_mfma_f32_16x16x32_bf16 v[104:107], a[204:207], v[72:75], v[104:107]
    ds_read_b128 a[196:199], v212 offset:34816
    v_mfma_f32_16x16x32_bf16 v[108:111], a[200:203], v[68:71], v[108:111]
    buffer_load_dwordx4 v213, s[8:11], s34 offen offset:0 lds
    v_mfma_f32_16x16x32_bf16 v[108:111], a[204:207], v[76:79], v[108:111]
    s_waitcnt lgkmcnt(4)
    s_add_u32 s34, s34, 81920
    v_mfma_f32_16x16x32_bf16 v[112:115], a[208:211], v[64:67], v[112:115]
    ds_read_b128 a[200:203], v212 offset:25600
    v_mfma_f32_16x16x32_bf16 v[112:115], a[212:215], v[72:75], v[112:115]
    ds_read_b128 a[204:207], v212 offset:35840
    v_mfma_f32_16x16x32_bf16 v[116:119], a[208:211], v[68:71], v[116:119]
    buffer_load_dwordx4 v[16:19], v212, s[4:7], s33 offen offset:0 sc1
    v_mfma_f32_16x16x32_bf16 v[116:119], a[212:215], v[76:79], v[116:119]
    s_waitcnt lgkmcnt(4)
    v_mfma_f32_16x16x32_bf16 v[120:123], a[216:219], v[64:67], v[120:123]
    ds_read_b128 a[208:211], v212 offset:26624
    v_mfma_f32_16x16x32_bf16 v[120:123], a[220:223], v[72:75], v[120:123]
    ds_read_b128 a[212:215], v212 offset:36864
    v_mfma_f32_16x16x32_bf16 v[124:127], a[216:219], v[68:71], v[124:127]
    buffer_load_dwordx4 v[20:23], v212, s[4:7], s33 offen offset:1024 sc1
    v_mfma_f32_16x16x32_bf16 v[124:127], a[220:223], v[76:79], v[124:127]
    s_waitcnt lgkmcnt(4)
    v_mfma_f32_16x16x32_bf16 v[128:131], a[192:195], v[64:67], v[128:131]
    ds_read_b128 a[216:219], v212 offset:27648
    v_mfma_f32_16x16x32_bf16 v[128:131], a[196:199], v[72:75], v[128:131]
    ds_read_b128 a[220:223], v212 offset:37888
    v_mfma_f32_16x16x32_bf16 v[132:135], a[192:195], v[68:71], v[132:135]
    buffer_load_dwordx4 v[24:27], v213, s[4:7], s33 offen offset:0 sc1
    v_mfma_f32_16x16x32_bf16 v[132:135], a[196:199], v[76:79], v[132:135]
    s_waitcnt lgkmcnt(4)
    v_mfma_f32_16x16x32_bf16 v[136:139], a[200:203], v[64:67], v[136:139]
    ds_read_b128 a[192:195], v212 offset:28672
    v_mfma_f32_16x16x32_bf16 v[136:139], a[204:207], v[72:75], v[136:139]
    ds_read_b128 a[196:199], v212 offset:38912
    v_mfma_f32_16x16x32_bf16 v[140:143], a[200:203], v[68:71], v[140:143]
    buffer_load_dwordx4 v[28:31], v213, s[4:7], s33 offen offset:1024 sc1
    v_mfma_f32_16x16x32_bf16 v[140:143], a[204:207], v[76:79], v[140:143]
    s_waitcnt lgkmcnt(4)
    s_add_u32 s33, s33, 8192
    v_mfma_f32_16x16x32_bf16 v[144:147], a[208:211], v[64:67], v[144:147]
    ds_read_b128 a[200:203], v212 offset:29696
    v_mfma_f32_16x16x32_bf16 v[144:147], a[212:215], v[72:75], v[144:147]
    ds_read_b128 a[204:207], v212 offset:39936
    v_mfma_f32_16x16x32_bf16 v[148:151], a[208:211], v[68:71], v[148:151]
    v_mfma_f32_16x16x32_bf16 v[148:151], a[212:215], v[76:79], v[148:151]
    s_barrier
    s_waitcnt lgkmcnt(4)
    s_add_u32 m0, s31, 0
    v_mfma_f32_16x16x32_bf16 v[152:155], a[216:219], v[64:67], v[152:155]
    ds_read_b128 a[208:211], v212 offset:40960
    v_mfma_f32_16x16x32_bf16 v[152:155], a[220:223], v[72:75], v[152:155]
    ds_read_b128 a[212:215], v212 offset:51200
    v_mfma_f32_16x16x32_bf16 v[156:159], a[216:219], v[68:71], v[156:159]
    buffer_load_dwordx4 v212, s[8:11], s34 offen offset:0 lds
    v_mfma_f32_16x16x32_bf16 v[156:159], a[220:223], v[76:79], v[156:159]
    s_waitcnt lgkmcnt(4)
    v_mfma_f32_16x16x32_bf16 v[160:163], a[192:195], v[64:67], v[160:163]
    ds_read_b128 a[216:219], v212 offset:41984
    v_mfma_f32_16x16x32_bf16 v[160:163], a[196:199], v[72:75], v[160:163]
    ds_read_b128 a[220:223], v212 offset:52224
    v_mfma_f32_16x16x32_bf16 v[164:167], a[192:195], v[68:71], v[164:167]
    buffer_load_dwordx4 v212, s[8:11], s34 offen offset:1024 lds
    v_mfma_f32_16x16x32_bf16 v[164:167], a[196:199], v[76:79], v[164:167]
    s_waitcnt lgkmcnt(4)
    v_mfma_f32_16x16x32_bf16 v[168:171], a[200:203], v[64:67], v[168:171]
    ds_read_b128 a[192:195], v212 offset:43008
    v_mfma_f32_16x16x32_bf16 v[168:171], a[204:207], v[72:75], v[168:171]
    ds_read_b128 a[196:199], v212 offset:53248
    v_mfma_f32_16x16x32_bf16 v[172:175], a[200:203], v[68:71], v[172:175]
    buffer_load_dwordx4 v212, s[8:11], s34 offen offset:2048 lds
    v_mfma_f32_16x16x32_bf16 v[172:175], a[204:207], v[76:79], v[172:175]
    s_waitcnt vmcnt(21) lgkmcnt(4)
    v_mfma_f32_16x16x32_bf16 v[96:99], a[208:211], v[80:83], v[96:99]
    ds_read_b128 a[200:203], v212 offset:44032
    v_mfma_f32_16x16x32_bf16 v[96:99], a[212:215], v[88:91], v[96:99]
    ds_read_b128 a[204:207], v212 offset:54272
    v_mfma_f32_16x16x32_bf16 v[100:103], a[208:211], v[84:87], v[100:103]
    buffer_load_dwordx4 v212, s[8:11], s34 offen offset:3072 lds
    v_mfma_f32_16x16x32_bf16 v[100:103], a[212:215], v[92:95], v[100:103]
    s_waitcnt lgkmcnt(4)
    s_add_u32 m0, s31, 4096
    v_mfma_f32_16x16x32_bf16 v[104:107], a[216:219], v[80:83], v[104:107]
    ds_read_b128 a[208:211], v212 offset:45056
    v_mfma_f32_16x16x32_bf16 v[104:107], a[220:223], v[88:91], v[104:107]
    ds_read_b128 a[212:215], v212 offset:55296
    v_mfma_f32_16x16x32_bf16 v[108:111], a[216:219], v[84:87], v[108:111]
    buffer_load_dwordx4 v213, s[8:11], s34 offen offset:0 lds
    v_mfma_f32_16x16x32_bf16 v[108:111], a[220:223], v[92:95], v[108:111]
    s_waitcnt lgkmcnt(4)
    s_add_u32 s34, s34, 81920
    v_mfma_f32_16x16x32_bf16 v[112:115], a[192:195], v[80:83], v[112:115]
    ds_read_b128 a[216:219], v212 offset:46080
    v_mfma_f32_16x16x32_bf16 v[112:115], a[196:199], v[88:91], v[112:115]
    ds_read_b128 a[220:223], v212 offset:56320
    v_mfma_f32_16x16x32_bf16 v[116:119], a[192:195], v[84:87], v[116:119]
    buffer_load_dwordx4 v[32:35], v212, s[4:7], s33 offen offset:0 sc1
    v_mfma_f32_16x16x32_bf16 v[116:119], a[196:199], v[92:95], v[116:119]
    s_waitcnt lgkmcnt(4)
    v_mfma_f32_16x16x32_bf16 v[120:123], a[200:203], v[80:83], v[120:123]
    ds_read_b128 a[192:195], v212 offset:47104
    v_mfma_f32_16x16x32_bf16 v[120:123], a[204:207], v[88:91], v[120:123]
    ds_read_b128 a[196:199], v212 offset:57344
    v_mfma_f32_16x16x32_bf16 v[124:127], a[200:203], v[84:87], v[124:127]
    buffer_load_dwordx4 v[36:39], v212, s[4:7], s33 offen offset:1024 sc1
    v_mfma_f32_16x16x32_bf16 v[124:127], a[204:207], v[92:95], v[124:127]
    s_waitcnt lgkmcnt(4)
    buffer_load_dword v248, v241, s[72:75], s78 offen sc1
    v_mfma_f32_16x16x32_bf16 v[128:131], a[208:211], v[80:83], v[128:131]
    ds_read_b128 a[200:203], v212 offset:48128
    v_mfma_f32_16x16x32_bf16 v[128:131], a[212:215], v[88:91], v[128:131]
    ds_read_b128 a[204:207], v212 offset:58368
    v_mfma_f32_16x16x32_bf16 v[132:135], a[208:211], v[84:87], v[132:135]
    buffer_load_dwordx4 v[40:43], v213, s[4:7], s33 offen offset:0 sc1
    v_mfma_f32_16x16x32_bf16 v[132:135], a[212:215], v[92:95], v[132:135]
    s_waitcnt lgkmcnt(4)
    v_mfma_f32_16x16x32_bf16 v[136:139], a[216:219], v[80:83], v[136:139]
    ds_read_b128 a[208:211], v212 offset:49152
    v_mfma_f32_16x16x32_bf16 v[136:139], a[220:223], v[88:91], v[136:139]
    ds_read_b128 a[212:215], v212 offset:59392
    v_mfma_f32_16x16x32_bf16 v[140:143], a[216:219], v[84:87], v[140:143]
    buffer_load_dwordx4 v[44:47], v213, s[4:7], s33 offen offset:1024 sc1
    v_mfma_f32_16x16x32_bf16 v[140:143], a[220:223], v[92:95], v[140:143]
    s_waitcnt lgkmcnt(4)
    s_add_u32 s33, s33, 8192
    v_mfma_f32_16x16x32_bf16 v[144:147], a[192:195], v[80:83], v[144:147]
    ds_read_b128 a[216:219], v212 offset:50176
    v_mfma_f32_16x16x32_bf16 v[144:147], a[196:199], v[88:91], v[144:147]
    ds_read_b128 a[220:223], v212 offset:60416
    v_mfma_f32_16x16x32_bf16 v[148:151], a[192:195], v[84:87], v[148:151]
    v_mfma_f32_16x16x32_bf16 v[148:151], a[196:199], v[92:95], v[148:151]
    s_barrier
    s_waitcnt lgkmcnt(4)
    s_add_u32 m0, s31, 20480
    v_mfma_f32_16x16x32_bf16 v[152:155], a[200:203], v[80:83], v[152:155]
    ds_read_b128 a[192:195], v215 offset:0
    v_mfma_f32_16x16x32_bf16 v[152:155], a[204:207], v[88:91], v[152:155]
    ds_read_b128 a[196:199], v215 offset:10240
    v_mfma_f32_16x16x32_bf16 v[156:159], a[200:203], v[84:87], v[156:159]
    buffer_load_dwordx4 v212, s[8:11], s34 offen offset:0 lds
    v_mfma_f32_16x16x32_bf16 v[156:159], a[204:207], v[92:95], v[156:159]
    s_waitcnt lgkmcnt(4)
    v_mfma_f32_16x16x32_bf16 v[160:163], a[208:211], v[80:83], v[160:163]
    ds_read_b128 a[200:203], v215 offset:1024
    v_mfma_f32_16x16x32_bf16 v[160:163], a[212:215], v[88:91], v[160:163]
    ds_read_b128 a[204:207], v215 offset:11264
    v_mfma_f32_16x16x32_bf16 v[164:167], a[208:211], v[84:87], v[164:167]
    buffer_load_dwordx4 v212, s[8:11], s34 offen offset:1024 lds
    v_mfma_f32_16x16x32_bf16 v[164:167], a[212:215], v[92:95], v[164:167]
    s_waitcnt lgkmcnt(4)
    v_mfma_f32_16x16x32_bf16 v[168:171], a[216:219], v[80:83], v[168:171]
    ds_read_b128 a[208:211], v215 offset:2048
    v_mfma_f32_16x16x32_bf16 v[168:171], a[220:223], v[88:91], v[168:171]
    ds_read_b128 a[212:215], v215 offset:12288
    v_mfma_f32_16x16x32_bf16 v[172:175], a[216:219], v[84:87], v[172:175]
    buffer_load_dwordx4 v212, s[8:11], s34 offen offset:2048 lds
    v_mfma_f32_16x16x32_bf16 v[172:175], a[220:223], v[92:95], v[172:175]
    s_waitcnt vmcnt(22) lgkmcnt(4)
    v_mfma_f32_16x16x32_bf16 v[96:99], a[192:195], v[0:3], v[96:99]
    ds_read_b128 a[216:219], v215 offset:3072
    v_mfma_f32_16x16x32_bf16 v[96:99], a[196:199], v[8:11], v[96:99]
    ds_read_b128 a[220:223], v215 offset:13312
    v_mfma_f32_16x16x32_bf16 v[100:103], a[192:195], v[4:7], v[100:103]
    buffer_load_dwordx4 v212, s[8:11], s34 offen offset:3072 lds
    v_mfma_f32_16x16x32_bf16 v[100:103], a[196:199], v[12:15], v[100:103]
    s_waitcnt lgkmcnt(4)
    s_add_u32 m0, s31, 24576
    v_mfma_f32_16x16x32_bf16 v[104:107], a[200:203], v[0:3], v[104:107]
    ds_read_b128 a[192:195], v215 offset:4096
    v_mfma_f32_16x16x32_bf16 v[104:107], a[204:207], v[8:11], v[104:107]
    ds_read_b128 a[196:199], v215 offset:14336
    v_mfma_f32_16x16x32_bf16 v[108:111], a[200:203], v[4:7], v[108:111]
    buffer_load_dwordx4 v213, s[8:11], s34 offen offset:0 lds
    v_mfma_f32_16x16x32_bf16 v[108:111], a[204:207], v[12:15], v[108:111]
    s_waitcnt lgkmcnt(4)
    s_add_u32 s34, s34, 81920
    v_mfma_f32_16x16x32_bf16 v[112:115], a[208:211], v[0:3], v[112:115]
    ds_read_b128 a[200:203], v215 offset:5120
    v_mfma_f32_16x16x32_bf16 v[112:115], a[212:215], v[8:11], v[112:115]
    ds_read_b128 a[204:207], v215 offset:15360
    v_mfma_f32_16x16x32_bf16 v[116:119], a[208:211], v[4:7], v[116:119]
    buffer_load_dwordx4 v[48:51], v212, s[4:7], s33 offen offset:0 sc1
    v_mfma_f32_16x16x32_bf16 v[116:119], a[212:215], v[12:15], v[116:119]
    s_waitcnt lgkmcnt(4)
    v_mfma_f32_16x16x32_bf16 v[120:123], a[216:219], v[0:3], v[120:123]
    ds_read_b128 a[208:211], v215 offset:6144
    v_mfma_f32_16x16x32_bf16 v[120:123], a[220:223], v[8:11], v[120:123]
    ds_read_b128 a[212:215], v215 offset:16384
    v_mfma_f32_16x16x32_bf16 v[124:127], a[216:219], v[4:7], v[124:127]
    buffer_load_dwordx4 v[52:55], v212, s[4:7], s33 offen offset:1024 sc1
    v_mfma_f32_16x16x32_bf16 v[124:127], a[220:223], v[12:15], v[124:127]
    s_waitcnt lgkmcnt(4)
    v_mfma_f32_16x16x32_bf16 v[128:131], a[192:195], v[0:3], v[128:131]
    ds_read_b128 a[216:219], v215 offset:7168
    v_mfma_f32_16x16x32_bf16 v[128:131], a[196:199], v[8:11], v[128:131]
    ds_read_b128 a[220:223], v215 offset:17408
    v_mfma_f32_16x16x32_bf16 v[132:135], a[192:195], v[4:7], v[132:135]
    buffer_load_dwordx4 v[56:59], v213, s[4:7], s33 offen offset:0 sc1
    v_mfma_f32_16x16x32_bf16 v[132:135], a[196:199], v[12:15], v[132:135]
    s_waitcnt lgkmcnt(4)
    v_mfma_f32_16x16x32_bf16 v[136:139], a[200:203], v[0:3], v[136:139]
    ds_read_b128 a[192:195], v215 offset:8192
    v_mfma_f32_16x16x32_bf16 v[136:139], a[204:207], v[8:11], v[136:139]
    ds_read_b128 a[196:199], v215 offset:18432
    v_mfma_f32_16x16x32_bf16 v[140:143], a[200:203], v[4:7], v[140:143]
    buffer_load_dwordx4 v[60:63], v213, s[4:7], s33 offen offset:1024 sc1
    v_mfma_f32_16x16x32_bf16 v[140:143], a[204:207], v[12:15], v[140:143]
    s_waitcnt lgkmcnt(4)
    s_add_u32 s33, s33, 8192
    v_mfma_f32_16x16x32_bf16 v[144:147], a[208:211], v[0:3], v[144:147]
    ds_read_b128 a[200:203], v215 offset:9216
    v_mfma_f32_16x16x32_bf16 v[144:147], a[212:215], v[8:11], v[144:147]
    ds_read_b128 a[204:207], v215 offset:19456
    v_mfma_f32_16x16x32_bf16 v[148:151], a[208:211], v[4:7], v[148:151]
    v_mfma_f32_16x16x32_bf16 v[148:151], a[212:215], v[12:15], v[148:151]
    s_barrier
    s_waitcnt lgkmcnt(4)
    s_add_u32 m0, s31, 40960
    v_mfma_f32_16x16x32_bf16 v[152:155], a[216:219], v[0:3], v[152:155]
    ds_read_b128 a[208:211], v215 offset:20480
    v_mfma_f32_16x16x32_bf16 v[152:155], a[220:223], v[8:11], v[152:155]
    ds_read_b128 a[212:215], v215 offset:30720
    v_mfma_f32_16x16x32_bf16 v[156:159], a[216:219], v[4:7], v[156:159]
    buffer_load_dwordx4 v212, s[8:11], s34 offen offset:0 lds
    v_mfma_f32_16x16x32_bf16 v[156:159], a[220:223], v[12:15], v[156:159]
    s_waitcnt lgkmcnt(4)
    v_mfma_f32_16x16x32_bf16 v[160:163], a[192:195], v[0:3], v[160:163]
    ds_read_b128 a[216:219], v215 offset:21504
    v_mfma_f32_16x16x32_bf16 v[160:163], a[196:199], v[8:11], v[160:163]
    ds_read_b128 a[220:223], v215 offset:31744
    v_mfma_f32_16x16x32_bf16 v[164:167], a[192:195], v[4:7], v[164:167]
    buffer_load_dwordx4 v212, s[8:11], s34 offen offset:1024 lds
    v_mfma_f32_16x16x32_bf16 v[164:167], a[196:199], v[12:15], v[164:167]
    s_waitcnt lgkmcnt(4)
    v_mfma_f32_16x16x32_bf16 v[168:171], a[200:203], v[0:3], v[168:171]
    ds_read_b128 a[192:195], v215 offset:22528
    v_mfma_f32_16x16x32_bf16 v[168:171], a[204:207], v[8:11], v[168:171]
    ds_read_b128 a[196:199], v215 offset:32768
    v_mfma_f32_16x16x32_bf16 v[172:175], a[200:203], v[4:7], v[172:175]
    buffer_load_dwordx4 v212, s[8:11], s34 offen offset:2048 lds
    v_mfma_f32_16x16x32_bf16 v[172:175], a[204:207], v[12:15], v[172:175]
    s_waitcnt vmcnt(22) lgkmcnt(4)
    v_mfma_f32_16x16x32_bf16 v[96:99], a[208:211], v[16:19], v[96:99]
    ds_read_b128 a[200:203], v215 offset:23552
    v_mfma_f32_16x16x32_bf16 v[96:99], a[212:215], v[24:27], v[96:99]
    ds_read_b128 a[204:207], v215 offset:33792
    v_mfma_f32_16x16x32_bf16 v[100:103], a[208:211], v[20:23], v[100:103]
    buffer_load_dwordx4 v212, s[8:11], s34 offen offset:3072 lds
    v_mfma_f32_16x16x32_bf16 v[100:103], a[212:215], v[28:31], v[100:103]
    s_waitcnt lgkmcnt(4)
    s_add_u32 m0, s31, 45056
    s_waitcnt vmcnt(15)
    v_cmp_ne_u32 vcc, v217, v248
    v_mfma_f32_16x16x32_bf16 v[104:107], a[216:219], v[16:19], v[104:107]
    ds_read_b128 a[208:211], v215 offset:24576
    v_mfma_f32_16x16x32_bf16 v[104:107], a[220:223], v[24:27], v[104:107]
    ds_read_b128 a[212:215], v215 offset:34816
    v_mfma_f32_16x16x32_bf16 v[108:111], a[216:219], v[20:23], v[108:111]
    buffer_load_dwordx4 v213, s[8:11], s34 offen offset:0 lds
    v_mfma_f32_16x16x32_bf16 v[108:111], a[220:223], v[28:31], v[108:111]
    s_waitcnt lgkmcnt(4)
    s_add_u32 s34, s34, 81920
    s_or_b32 s80, vcc_lo, vcc_hi
    v_mfma_f32_16x16x32_bf16 v[112:115], a[192:195], v[16:19], v[112:115]
    ds_read_b128 a[216:219], v215 offset:25600
    v_mfma_f32_16x16x32_bf16 v[112:115], a[196:199], v[24:27], v[112:115]
    ds_read_b128 a[220:223], v215 offset:35840
    s_add_u32 s40, s92, 40960
    v_mfma_f32_16x16x32_bf16 v[116:119], a[192:195], v[20:23], v[116:119]
    buffer_load_dwordx4 v[64:67], v212, s[4:7], s33 offen offset:0 sc1
    buffer_load_dwordx4 v[0:3], v212, s[60:63], s40 offen sc1
    v_mfma_f32_16x16x32_bf16 v[116:119], a[196:199], v[28:31], v[116:119]
    s_waitcnt lgkmcnt(4)
    v_mfma_f32_16x16x32_bf16 v[120:123], a[200:203], v[16:19], v[120:123]
    ds_read_b128 a[192:195], v215 offset:26624
    v_mfma_f32_16x16x32_bf16 v[120:123], a[204:207], v[24:27], v[120:123]
    ds_read_b128 a[196:199], v215 offset:36864
    s_add_u32 s40, s93, 40960
    v_mfma_f32_16x16x32_bf16 v[124:127], a[200:203], v[20:23], v[124:127]
    buffer_load_dwordx4 v[68:71], v212, s[4:7], s33 offen offset:1024 sc1
    buffer_load_dwordx4 v[4:7], v212, s[60:63], s40 offen sc1
    v_mfma_f32_16x16x32_bf16 v[124:127], a[204:207], v[28:31], v[124:127]
    s_waitcnt lgkmcnt(4)
    v_mfma_f32_16x16x32_bf16 v[128:131], a[208:211], v[16:19], v[128:131]
    ds_read_b128 a[200:203], v215 offset:27648
    v_mfma_f32_16x16x32_bf16 v[128:131], a[212:215], v[24:27], v[128:131]
    ds_read_b128 a[204:207], v215 offset:37888
    s_add_u32 s40, s94, 40960
    v_mfma_f32_16x16x32_bf16 v[132:135], a[208:211], v[20:23], v[132:135]
    buffer_load_dwordx4 v[72:75], v213, s[4:7], s33 offen offset:0 sc1
    buffer_load_dwordx4 v[8:11], v212, s[60:63], s40 offen sc1
    v_mfma_f32_16x16x32_bf16 v[132:135], a[212:215], v[28:31], v[132:135]
    s_waitcnt lgkmcnt(4)
    v_mfma_f32_16x16x32_bf16 v[136:139], a[216:219], v[16:19], v[136:139]
    ds_read_b128 a[208:211], v215 offset:28672
    v_mfma_f32_16x16x32_bf16 v[136:139], a[220:223], v[24:27], v[136:139]
    ds_read_b128 a[212:215], v215 offset:38912
    v_mfma_f32_16x16x32_bf16 v[140:143], a[216:219], v[20:23], v[140:143]
    buffer_load_dwordx4 v[76:79], v213, s[4:7], s33 offen offset:1024 sc1
    ds_read_b128 v[12:15], v240 offset:20480
    v_mfma_f32_16x16x32_bf16 v[140:143], a[220:223], v[28:31], v[140:143]
    s_waitcnt lgkmcnt(5)
    s_add_u32 s33, s33, 8192
    v_mfma_f32_16x16x32_bf16 v[144:147], a[192:195], v[16:19], v[144:147]
    ds_read_b128 a[216:219], v215 offset:29696
    v_mfma_f32_16x16x32_bf16 v[144:147], a[196:199], v[24:27], v[144:147]
    ds_read_b128 a[220:223], v215 offset:39936
    v_mfma_f32_16x16x32_bf16 v[148:151], a[192:195], v[20:23], v[148:151]
    v_mfma_f32_16x16x32_bf16 v[148:151], a[196:199], v[28:31], v[148:151]
    s_barrier
    s_waitcnt lgkmcnt(5)
    v_mfma_f32_16x16x32_bf16 v[152:155], a[200:203], v[16:19], v[152:155]
    ds_read_b128 a[192:195], v215 offset:40960
    v_mfma_f32_16x16x32_bf16 v[152:155], a[204:207], v[24:27], v[152:155]
    ds_read_b128 a[196:199], v215 offset:51200
    v_mfma_f32_16x16x32_bf16 v[156:159], a[200:203], v[20:23], v[156:159]
    v_mfma_f32_16x16x32_bf16 v[156:159], a[204:207], v[28:31], v[156:159]
    s_waitcnt lgkmcnt(5)
    v_mfma_f32_16x16x32_bf16 v[160:163], a[208:211], v[16:19], v[160:163]
    ds_read_b128 a[200:203], v215 offset:41984
    v_mfma_f32_16x16x32_bf16 v[160:163], a[212:215], v[24:27], v[160:163]
    ds_read_b128 a[204:207], v215 offset:52224
    v_mfma_f32_16x16x32_bf16 v[164:167], a[208:211], v[20:23], v[164:167]
    v_mfma_f32_16x16x32_bf16 v[164:167], a[212:215], v[28:31], v[164:167]
    s_waitcnt lgkmcnt(4)
    v_mfma_f32_16x16x32_bf16 v[168:171], a[216:219], v[16:19], v[168:171]
    ds_read_b128 a[208:211], v215 offset:43008
    v_mfma_f32_16x16x32_bf16 v[168:171], a[220:223], v[24:27], v[168:171]
    ds_read_b128 a[212:215], v215 offset:53248
    v_mfma_f32_16x16x32_bf16 v[172:175], a[216:219], v[20:23], v[172:175]
    v_mfma_f32_16x16x32_bf16 v[172:175], a[220:223], v[28:31], v[172:175]
    s_waitcnt vmcnt(21) lgkmcnt(4)
    v_mfma_f32_16x16x32_bf16 v[96:99], a[192:195], v[32:35], v[96:99]
    ds_read_b128 a[216:219], v215 offset:44032
    v_mfma_f32_16x16x32_bf16 v[96:99], a[196:199], v[40:43], v[96:99]
    ds_read_b128 a[220:223], v215 offset:54272
    v_mfma_f32_16x16x32_bf16 v[100:103], a[192:195], v[36:39], v[100:103]
    v_mfma_f32_16x16x32_bf16 v[100:103], a[196:199], v[44:47], v[100:103]
    s_waitcnt lgkmcnt(4)
    v_mfma_f32_16x16x32_bf16 v[104:107], a[200:203], v[32:35], v[104:107]
    ds_read_b128 a[192:195], v215 offset:45056
    v_mfma_f32_16x16x32_bf16 v[104:107], a[204:207], v[40:43], v[104:107]
    ds_read_b128 a[196:199], v215 offset:55296
    v_mfma_f32_16x16x32_bf16 v[108:111], a[200:203], v[36:39], v[108:111]
    v_mfma_f32_16x16x32_bf16 v[108:111], a[204:207], v[44:47], v[108:111]
    s_waitcnt lgkmcnt(4)
    v_mfma_f32_16x16x32_bf16 v[112:115], a[208:211], v[32:35], v[112:115]
    ds_read_b128 a[200:203], v215 offset:46080
    v_mfma_f32_16x16x32_bf16 v[112:115], a[212:215], v[40:43], v[112:115]
    ds_read_b128 a[204:207], v215 offset:56320
    s_add_u32 s40, s92, 40960
    v_mfma_f32_16x16x32_bf16 v[116:119], a[208:211], v[36:39], v[116:119]
    buffer_load_dwordx4 v[80:83], v212, s[4:7], s33 offen offset:0 sc1
    buffer_load_dwordx4 v[16:19], v213, s[60:63], s40 offen sc1
    v_mfma_f32_16x16x32_bf16 v[116:119], a[212:215], v[44:47], v[116:119]
    s_waitcnt lgkmcnt(4)
    v_mfma_f32_16x16x32_bf16 v[120:123], a[216:219], v[32:35], v[120:123]
    ds_read_b128 a[208:211], v215 offset:47104
    v_mfma_f32_16x16x32_bf16 v[120:123], a[220:223], v[40:43], v[120:123]
    ds_read_b128 a[212:215], v215 offset:57344
    s_add_u32 s40, s93, 40960
    v_mfma_f32_16x16x32_bf16 v[124:127], a[216:219], v[36:39], v[124:127]
    buffer_load_dwordx4 v[84:87], v212, s[4:7], s33 offen offset:1024 sc1
    buffer_load_dwordx4 v[20:23], v213, s[60:63], s40 offen sc1
    v_mfma_f32_16x16x32_bf16 v[124:127], a[220:223], v[44:47], v[124:127]
    s_waitcnt lgkmcnt(4)
    v_mfma_f32_16x16x32_bf16 v[128:131], a[192:195], v[32:35], v[128:131]
    ds_read_b128 a[216:219], v215 offset:48128
    v_mfma_f32_16x16x32_bf16 v[128:131], a[196:199], v[40:43], v[128:131]
    ds_read_b128 a[220:223], v215 offset:58368
    s_add_u32 s40, s94, 40960
    v_mfma_f32_16x16x32_bf16 v[132:135], a[192:195], v[36:39], v[132:135]
    buffer_load_dwordx4 v[88:91], v213, s[4:7], s33 offen offset:0 sc1
    buffer_load_dwordx4 v[24:27], v213, s[60:63], s40 offen sc1
    v_mfma_f32_16x16x32_bf16 v[132:135], a[196:199], v[44:47], v[132:135]
    s_waitcnt lgkmcnt(4)
    v_mfma_f32_16x16x32_bf16 v[136:139], a[200:203], v[32:35], v[136:139]
    ds_read_b128 a[192:195], v215 offset:49152
    v_mfma_f32_16x16x32_bf16 v[136:139], a[204:207], v[40:43], v[136:139]
    ds_read_b128 a[196:199], v215 offset:59392
    v_mfma_f32_16x16x32_bf16 v[140:143], a[200:203], v[36:39], v[140:143]
    buffer_load_dwordx4 v[92:95], v213, s[4:7], s33 offen offset:1024 sc1
    ds_read_b128 v[28:31], v240 offset:24576
    v_mfma_f32_16x16x32_bf16 v[140:143], a[204:207], v[44:47], v[140:143]
    s_waitcnt lgkmcnt(5)
    s_add_u32 s33, s33, 8192
    v_mfma_f32_16x16x32_bf16 v[144:147], a[208:211], v[32:35], v[144:147]
    ds_read_b128 a[200:203], v215 offset:50176
    v_mfma_f32_16x16x32_bf16 v[144:147], a[212:215], v[40:43], v[144:147]
    ds_read_b128 a[204:207], v215 offset:60416
    v_mfma_f32_16x16x32_bf16 v[148:151], a[208:211], v[36:39], v[148:151]
    v_mfma_f32_16x16x32_bf16 v[148:151], a[212:215], v[44:47], v[148:151]
    s_barrier
    s_waitcnt lgkmcnt(5)
    v_mfma_f32_16x16x32_bf16 v[152:155], a[216:219], v[32:35], v[152:155]
    ds_read_b128 a[208:211], v212 offset:0
    v_mfma_f32_16x16x32_bf16 v[152:155], a[220:223], v[40:43], v[152:155]
    ds_read_b128 a[212:215], v212 offset:10240
    v_mfma_f32_16x16x32_bf16 v[156:159], a[216:219], v[36:39], v[156:159]
    v_mfma_f32_16x16x32_bf16 v[156:159], a[220:223], v[44:47], v[156:159]
    s_waitcnt lgkmcnt(5)
    v_mfma_f32_16x16x32_bf16 v[160:163], a[192:195], v[32:35], v[160:163]
    ds_read_b128 a[216:219], v212 offset:1024
    v_mfma_f32_16x16x32_bf16 v[160:163], a[196:199], v[40:43], v[160:163]
    ds_read_b128 a[220:223], v212 offset:11264
    v_mfma_f32_16x16x32_bf16 v[164:167], a[192:195], v[36:39], v[164:167]
    v_mfma_f32_16x16x32_bf16 v[164:167], a[196:199], v[44:47], v[164:167]
    s_waitcnt lgkmcnt(4)
    v_mfma_f32_16x16x32_bf16 v[168:171], a[200:203], v[32:35], v[168:171]
    ds_read_b128 a[192:195], v212 offset:2048
    v_mfma_f32_16x16x32_bf16 v[168:171], a[204:207], v[40:43], v[168:171]
    ds_read_b128 a[196:199], v212 offset:12288
    v_mfma_f32_16x16x32_bf16 v[172:175], a[200:203], v[36:39], v[172:175]
    v_mfma_f32_16x16x32_bf16 v[172:175], a[204:207], v[44:47], v[172:175]
    s_waitcnt vmcnt(19) lgkmcnt(4)
    v_mfma_f32_16x16x32_bf16 v[96:99], a[208:211], v[48:51], v[96:99]
    ds_read_b128 a[200:203], v212 offset:3072
    v_mfma_f32_16x16x32_bf16 v[96:99], a[212:215], v[56:59], v[96:99]
    ds_read_b128 a[204:207], v212 offset:13312
    v_mfma_f32_16x16x32_bf16 v[100:103], a[208:211], v[52:55], v[100:103]
    v_mfma_f32_16x16x32_bf16 v[100:103], a[212:215], v[60:63], v[100:103]
    s_waitcnt lgkmcnt(4)
    v_mfma_f32_16x16x32_bf16 v[104:107], a[216:219], v[48:51], v[104:107]
    ds_read_b128 a[208:211], v212 offset:4096
    v_mfma_f32_16x16x32_bf16 v[104:107], a[220:223], v[56:59], v[104:107]
    ds_read_b128 a[212:215], v212 offset:14336
    v_mfma_f32_16x16x32_bf16 v[108:111], a[216:219], v[52:55], v[108:111]
    v_mfma_f32_16x16x32_bf16 v[108:111], a[220:223], v[60:63], v[108:111]
    s_waitcnt lgkmcnt(4)
    v_mfma_f32_16x16x32_bf16 v[112:115], a[192:195], v[48:51], v[112:115]
    ds_read_b128 a[216:219], v212 offset:5120
    v_mfma_f32_16x16x32_bf16 v[112:115], a[196:199], v[56:59], v[112:115]
    ds_read_b128 a[220:223], v212 offset:15360
    s_add_u32 s40, s92, 40960
    s_add_u32 s40, s40, s50
    v_mfma_f32_16x16x32_bf16 v[116:119], a[192:195], v[52:55], v[116:119]
    buffer_load_dwordx4 v[32:35], v214, s[60:63], s40 offen sc1
    v_mfma_f32_16x16x32_bf16 v[116:119], a[196:199], v[60:63], v[116:119]
    s_waitcnt lgkmcnt(4)
    v_mfma_f32_16x16x32_bf16 v[120:123], a[200:203], v[48:51], v[120:123]
    ds_read_b128 a[192:195], v212 offset:6144
    v_mfma_f32_16x16x32_bf16 v[120:123], a[204:207], v[56:59], v[120:123]
    ds_read_b128 a[196:199], v212 offset:16384
    s_add_u32 s40, s93, 40960
    s_add_u32 s40, s40, s50
    v_mfma_f32_16x16x32_bf16 v[124:127], a[200:203], v[52:55], v[124:127]
    buffer_load_dwordx4 v[36:39], v214, s[60:63], s40 offen sc1
    v_mfma_f32_16x16x32_bf16 v[124:127], a[204:207], v[60:63], v[124:127]
    s_waitcnt lgkmcnt(4)
    v_mfma_f32_16x16x32_bf16 v[128:131], a[208:211], v[48:51], v[128:131]
    ds_read_b128 a[200:203], v212 offset:7168
    v_mfma_f32_16x16x32_bf16 v[128:131], a[212:215], v[56:59], v[128:131]
    ds_read_b128 a[204:207], v212 offset:17408
    s_add_u32 s40, s94, 40960
    s_add_u32 s40, s40, s50
    v_mfma_f32_16x16x32_bf16 v[132:135], a[208:211], v[52:55], v[132:135]
    buffer_load_dwordx4 v[40:43], v214, s[60:63], s40 offen sc1
    v_mfma_f32_16x16x32_bf16 v[132:135], a[212:215], v[60:63], v[132:135]
    s_waitcnt lgkmcnt(4)
    v_mfma_f32_16x16x32_bf16 v[136:139], a[216:219], v[48:51], v[136:139]
    ds_read_b128 a[208:211], v212 offset:8192
    v_mfma_f32_16x16x32_bf16 v[136:139], a[220:223], v[56:59], v[136:139]
    ds_read_b128 a[212:215], v212 offset:18432
    v_mfma_f32_16x16x32_bf16 v[140:143], a[216:219], v[52:55], v[140:143]
    ds_read_b128 v[44:47], v240 offset:28672
    v_mfma_f32_16x16x32_bf16 v[140:143], a[220:223], v[60:63], v[140:143]
    s_waitcnt lgkmcnt(5)
    v_mfma_f32_16x16x32_bf16 v[144:147], a[192:195], v[48:51], v[144:147]
    ds_read_b128 a[216:219], v212 offset:9216
    v_mfma_f32_16x16x32_bf16 v[144:147], a[196:199], v[56:59], v[144:147]
    ds_read_b128 a[220:223], v212 offset:19456
    v_mfma_f32_16x16x32_bf16 v[148:151], a[192:195], v[52:55], v[148:151]
    v_mfma_f32_16x16x32_bf16 v[148:151], a[196:199], v[60:63], v[148:151]
    s_barrier
    s_waitcnt lgkmcnt(5)
    v_mfma_f32_16x16x32_bf16 v[152:155], a[200:203], v[48:51], v[152:155]
    ds_read_b128 a[192:195], v212 offset:20480
    v_mfma_f32_16x16x32_bf16 v[152:155], a[204:207], v[56:59], v[152:155]
    ds_read_b128 a[196:199], v212 offset:30720
    v_mfma_f32_16x16x32_bf16 v[156:159], a[200:203], v[52:55], v[156:159]
    v_mfma_f32_16x16x32_bf16 v[156:159], a[204:207], v[60:63], v[156:159]
    s_waitcnt lgkmcnt(5)
    v_mfma_f32_16x16x32_bf16 v[160:163], a[208:211], v[48:51], v[160:163]
    ds_read_b128 a[200:203], v212 offset:21504
    v_mfma_f32_16x16x32_bf16 v[160:163], a[212:215], v[56:59], v[160:163]
    ds_read_b128 a[204:207], v212 offset:31744
    v_mfma_f32_16x16x32_bf16 v[164:167], a[208:211], v[52:55], v[164:167]
    v_mfma_f32_16x16x32_bf16 v[164:167], a[212:215], v[60:63], v[164:167]
    s_waitcnt lgkmcnt(4)
    v_mfma_f32_16x16x32_bf16 v[168:171], a[216:219], v[48:51], v[168:171]
    ds_read_b128 a[208:211], v212 offset:22528
    v_mfma_f32_16x16x32_bf16 v[168:171], a[220:223], v[56:59], v[168:171]
    ds_read_b128 a[212:215], v212 offset:32768
    v_mfma_f32_16x16x32_bf16 v[172:175], a[216:219], v[52:55], v[172:175]
    v_mfma_f32_16x16x32_bf16 v[172:175], a[220:223], v[60:63], v[172:175]
    s_waitcnt vmcnt(10) lgkmcnt(4)
    v_mfma_f32_16x16x32_bf16 v[96:99], a[192:195], v[64:67], v[96:99]
    ds_read_b128 a[216:219], v212 offset:23552
    v_mfma_f32_16x16x32_bf16 v[96:99], a[196:199], v[72:75], v[96:99]
    ds_read_b128 a[220:223], v212 offset:33792
    v_mfma_f32_16x16x32_bf16 v[100:103], a[192:195], v[68:71], v[100:103]
    v_mfma_f32_16x16x32_bf16 v[100:103], a[196:199], v[76:79], v[100:103]
    s_waitcnt lgkmcnt(4)
    v_mfma_f32_16x16x32_bf16 v[104:107], a[200:203], v[64:67], v[104:107]
    ds_read_b128 a[192:195], v212 offset:24576
    v_mfma_f32_16x16x32_bf16 v[104:107], a[204:207], v[72:75], v[104:107]
    ds_read_b128 a[196:199], v212 offset:34816
    v_mfma_f32_16x16x32_bf16 v[108:111], a[200:203], v[68:71], v[108:111]
    v_mfma_f32_16x16x32_bf16 v[108:111], a[204:207], v[76:79], v[108:111]
    s_waitcnt lgkmcnt(4)
    v_mfma_f32_16x16x32_bf16 v[112:115], a[208:211], v[64:67], v[112:115]
    ds_read_b128 a[200:203], v212 offset:25600
    v_mfma_f32_16x16x32_bf16 v[112:115], a[212:215], v[72:75], v[112:115]
    ds_read_b128 a[204:207], v212 offset:35840
    v_mfma_f32_16x16x32_bf16 v[116:119], a[208:211], v[68:71], v[116:119]
    v_mfma_f32_16x16x32_bf16 v[116:119], a[212:215], v[76:79], v[116:119]
    s_waitcnt lgkmcnt(4)
    v_mfma_f32_16x16x32_bf16 v[120:123], a[216:219], v[64:67], v[120:123]
    ds_read_b128 a[208:211], v212 offset:26624
    v_mfma_f32_16x16x32_bf16 v[120:123], a[220:223], v[72:75], v[120:123]
    ds_read_b128 a[212:215], v212 offset:36864
    v_mfma_f32_16x16x32_bf16 v[124:127], a[216:219], v[68:71], v[124:127]
    v_mfma_f32_16x16x32_bf16 v[124:127], a[220:223], v[76:79], v[124:127]
    s_waitcnt lgkmcnt(4)
    v_mfma_f32_16x16x32_bf16 v[128:131], a[192:195], v[64:67], v[128:131]
    ds_read_b128 a[216:219], v212 offset:27648
    v_mfma_f32_16x16x32_bf16 v[128:131], a[196:199], v[72:75], v[128:131]
    ds_read_b128 a[220:223], v212 offset:37888
    v_mfma_f32_16x16x32_bf16 v[132:135], a[192:195], v[68:71], v[132:135]
    v_mfma_f32_16x16x32_bf16 v[132:135], a[196:199], v[76:79], v[132:135]
    s_waitcnt lgkmcnt(4)
    v_mfma_f32_16x16x32_bf16 v[136:139], a[200:203], v[64:67], v[136:139]
    ds_read_b128 a[192:195], v212 offset:28672
    v_mfma_f32_16x16x32_bf16 v[136:139], a[204:207], v[72:75], v[136:139]
    ds_read_b128 a[196:199], v212 offset:38912
    v_mfma_f32_16x16x32_bf16 v[140:143], a[200:203], v[68:71], v[140:143]
    v_mfma_f32_16x16x32_bf16 v[140:143], a[204:207], v[76:79], v[140:143]
    s_waitcnt lgkmcnt(4)
    v_mfma_f32_16x16x32_bf16 v[144:147], a[208:211], v[64:67], v[144:147]
    ds_read_b128 a[200:203], v212 offset:29696
    v_mfma_f32_16x16x32_bf16 v[144:147], a[212:215], v[72:75], v[144:147]
    ds_read_b128 a[204:207], v212 offset:39936
    v_mfma_f32_16x16x32_bf16 v[148:151], a[208:211], v[68:71], v[148:151]
    v_mfma_f32_16x16x32_bf16 v[148:151], a[212:215], v[76:79], v[148:151]
    s_barrier
    s_waitcnt lgkmcnt(4)
    v_mfma_f32_16x16x32_bf16 v[152:155], a[216:219], v[64:67], v[152:155]
    ds_read_b128 a[208:211], v212 offset:40960
    v_mfma_f32_16x16x32_bf16 v[152:155], a[220:223], v[72:75], v[152:155]
    ds_read_b128 a[212:215], v212 offset:51200
    v_mfma_f32_16x16x32_bf16 v[156:159], a[216:219], v[68:71], v[156:159]
    v_mfma_f32_16x16x32_bf16 v[156:159], a[220:223], v[76:79], v[156:159]
    s_waitcnt lgkmcnt(4)
    v_mfma_f32_16x16x32_bf16 v[160:163], a[192:195], v[64:67], v[160:163]
    ds_read_b128 a[216:219], v212 offset:41984
    v_mfma_f32_16x16x32_bf16 v[160:163], a[196:199], v[72:75], v[160:163]
    ds_read_b128 a[220:223], v212 offset:52224
    v_mfma_f32_16x16x32_bf16 v[164:167], a[192:195], v[68:71], v[164:167]
    v_mfma_f32_16x16x32_bf16 v[164:167], a[196:199], v[76:79], v[164:167]
    s_waitcnt lgkmcnt(4)
    v_mfma_f32_16x16x32_bf16 v[168:171], a[200:203], v[64:67], v[168:171]
    ds_read_b128 a[192:195], v212 offset:43008
    v_mfma_f32_16x16x32_bf16 v[168:171], a[204:207], v[72:75], v[168:171]
    ds_read_b128 a[196:199], v212 offset:53248
    v_mfma_f32_16x16x32_bf16 v[172:175], a[200:203], v[68:71], v[172:175]
    v_mfma_f32_16x16x32_bf16 v[172:175], a[204:207], v[76:79], v[172:175]
    s_waitcnt vmcnt(3) lgkmcnt(4)
    v_mfma_f32_16x16x32_bf16 v[96:99], a[208:211], v[80:83], v[96:99]
    ds_read_b128 a[200:203], v212 offset:44032
    v_mfma_f32_16x16x32_bf16 v[96:99], a[212:215], v[88:91], v[96:99]
    ds_read_b128 a[204:207], v212 offset:54272
    v_mfma_f32_16x16x32_bf16 v[100:103], a[208:211], v[84:87], v[100:103]
    v_mfma_f32_16x16x32_bf16 v[100:103], a[212:215], v[92:95], v[100:103]
    s_waitcnt lgkmcnt(4)
    v_mfma_f32_16x16x32_bf16 v[104:107], a[216:219], v[80:83], v[104:107]
    ds_read_b128 a[208:211], v212 offset:45056
    v_mfma_f32_16x16x32_bf16 v[104:107], a[220:223], v[88:91], v[104:107]
    ds_read_b128 a[212:215], v212 offset:55296
    v_mfma_f32_16x16x32_bf16 v[108:111], a[216:219], v[84:87], v[108:111]
    v_mfma_f32_16x16x32_bf16 v[108:111], a[220:223], v[92:95], v[108:111]
    s_waitcnt lgkmcnt(4)
    v_mfma_f32_16x16x32_bf16 v[112:115], a[192:195], v[80:83], v[112:115]
    ds_read_b128 a[216:219], v212 offset:46080
    v_mfma_f32_16x16x32_bf16 v[112:115], a[196:199], v[88:91], v[112:115]
    ds_read_b128 a[220:223], v212 offset:56320
    v_cvt_pk_bf16_f32 v176, v96, v97
    v_cvt_pk_bf16_f32 v177, v98, v99
    v_mfma_f32_16x16x32_bf16 v[116:119], a[192:195], v[84:87], v[116:119]
    v_cvt_pk_bf16_f32 v178, v100, v101
    v_cvt_pk_bf16_f32 v179, v102, v103
    v_mfma_f32_16x16x32_bf16 v[116:119], a[196:199], v[92:95], v[116:119]
    s_waitcnt lgkmcnt(4)
    buffer_store_dwordx4 v[176:179], v212, s[60:63], s17 offen offset:0 sc1
    ds_write_b128 v242, v[176:179] offset:0
    v_mfma_f32_16x16x32_bf16 v[120:123], a[200:203], v[80:83], v[120:123]
    ds_read_b128 a[192:195], v212 offset:47104
    v_mfma_f32_16x16x32_bf16 v[120:123], a[204:207], v[88:91], v[120:123]
    ds_read_b128 a[196:199], v212 offset:57344
    v_cvt_pk_bf16_f32 v180, v104, v105
    v_cvt_pk_bf16_f32 v181, v106, v107
    v_mfma_f32_16x16x32_bf16 v[124:127], a[200:203], v[84:87], v[124:127]
    v_cvt_pk_bf16_f32 v182, v108, v109
    v_cvt_pk_bf16_f32 v183, v110, v111
    v_mfma_f32_16x16x32_bf16 v[124:127], a[204:207], v[92:95], v[124:127]
    s_waitcnt lgkmcnt(5)
    buffer_store_dwordx4 v[180:183], v212, s[60:63], s17 offen offset:1024 sc1
    ds_write_b128 v242, v[180:183] offset:1024
    v_mfma_f32_16x16x32_bf16 v[128:131], a[208:211], v[80:83], v[128:131]
    ds_read_b128 a[200:203], v212 offset:48128
    v_mfma_f32_16x16x32_bf16 v[128:131], a[212:215], v[88:91], v[128:131]
    ds_read_b128 a[204:207], v212 offset:58368
    v_cvt_pk_bf16_f32 v184, v112, v113
    v_cvt_pk_bf16_f32 v185, v114, v115
    v_mfma_f32_16x16x32_bf16 v[132:135], a[208:211], v[84:87], v[132:135]
    v_cvt_pk_bf16_f32 v186, v116, v117
    v_cvt_pk_bf16_f32 v187, v118, v119
    v_mfma_f32_16x16x32_bf16 v[132:135], a[212:215], v[92:95], v[132:135]
    s_waitcnt lgkmcnt(6)
    buffer_store_dwordx4 v[184:187], v212, s[60:63], s17 offen offset:2048 sc1
    ds_write_b128 v242, v[184:187] offset:2048
    v_mfma_f32_16x16x32_bf16 v[136:139], a[216:219], v[80:83], v[136:139]
    ds_read_b128 a[208:211], v212 offset:49152
    v_mfma_f32_16x16x32_bf16 v[136:139], a[220:223], v[88:91], v[136:139]
    ds_read_b128 a[212:215], v212 offset:59392
    v_cvt_pk_bf16_f32 v188, v120, v121
    v_cvt_pk_bf16_f32 v189, v122, v123
    v_mfma_f32_16x16x32_bf16 v[140:143], a[216:219], v[84:87], v[140:143]
    v_cvt_pk_bf16_f32 v190, v124, v125
    v_cvt_pk_bf16_f32 v191, v126, v127
    v_mfma_f32_16x16x32_bf16 v[140:143], a[220:223], v[92:95], v[140:143]
    s_waitcnt lgkmcnt(6)
    buffer_store_dwordx4 v[188:191], v212, s[60:63], s17 offen offset:3072 sc1
    ds_write_b128 v242, v[188:191] offset:3072
    v_mfma_f32_16x16x32_bf16 v[144:147], a[192:195], v[80:83], v[144:147]
    ds_read_b128 a[216:219], v212 offset:50176
    v_mfma_f32_16x16x32_bf16 v[144:147], a[196:199], v[88:91], v[144:147]
    ds_read_b128 a[220:223], v212 offset:60416
    v_cvt_pk_bf16_f32 v176, v128, v129
    v_cvt_pk_bf16_f32 v177, v130, v131
    v_mfma_f32_16x16x32_bf16 v[148:151], a[192:195], v[84:87], v[148:151]
    v_cvt_pk_bf16_f32 v178, v132, v133
    v_cvt_pk_bf16_f32 v179, v134, v135
    v_mfma_f32_16x16x32_bf16 v[148:151], a[196:199], v[92:95], v[148:151]
    s_waitcnt lgkmcnt(6)
    buffer_store_dwordx4 v[176:179], v213, s[60:63], s17 offen offset:0 sc1
    ds_write_b128 v242, v[176:179] offset:4096
    v_mfma_f32_16x16x32_bf16 v[152:155], a[200:203], v[80:83], v[152:155]
    v_mfma_f32_16x16x32_bf16 v[152:155], a[204:207], v[88:91], v[152:155]
    v_cvt_pk_bf16_f32 v180, v136, v137
    v_cvt_pk_bf16_f32 v181, v138, v139
    v_mfma_f32_16x16x32_bf16 v[156:159], a[200:203], v[84:87], v[156:159]
    v_cvt_pk_bf16_f32 v182, v140, v141
    v_cvt_pk_bf16_f32 v183, v142, v143
    v_mfma_f32_16x16x32_bf16 v[156:159], a[204:207], v[92:95], v[156:159]
    s_waitcnt lgkmcnt(4)
    buffer_store_dwordx4 v[180:183], v213, s[60:63], s17 offen offset:1024 sc1
    ds_write_b128 v242, v[180:183] offset:5120
    v_mfma_f32_16x16x32_bf16 v[160:163], a[208:211], v[80:83], v[160:163]
    v_mfma_f32_16x16x32_bf16 v[160:163], a[212:215], v[88:91], v[160:163]
    v_cvt_pk_bf16_f32 v184, v144, v145
    v_cvt_pk_bf16_f32 v185, v146, v147
    v_mfma_f32_16x16x32_bf16 v[164:167], a[208:211], v[84:87], v[164:167]
    v_cvt_pk_bf16_f32 v186, v148, v149
    v_cvt_pk_bf16_f32 v187, v150, v151
    v_mfma_f32_16x16x32_bf16 v[164:167], a[212:215], v[92:95], v[164:167]
    s_waitcnt lgkmcnt(2)
    buffer_store_dwordx4 v[184:187], v213, s[60:63], s17 offen offset:2048 sc1
    ds_write_b128 v242, v[184:187] offset:6144
    v_mfma_f32_16x16x32_bf16 v[168:171], a[216:219], v[80:83], v[168:171]
    v_mfma_f32_16x16x32_bf16 v[168:171], a[220:223], v[88:91], v[168:171]
    v_cvt_pk_bf16_f32 v188, v152, v153
    v_cvt_pk_bf16_f32 v189, v154, v155
    v_mfma_f32_16x16x32_bf16 v[172:175], a[216:219], v[84:87], v[172:175]
    v_cvt_pk_bf16_f32 v190, v156, v157
    v_cvt_pk_bf16_f32 v191, v158, v159
    v_mfma_f32_16x16x32_bf16 v[172:175], a[220:223], v[92:95], v[172:175]
    buffer_store_dwordx4 v[188:191], v213, s[60:63], s17 offen offset:3072 sc1
    ds_write_b128 v242, v[188:191] offset:7168
    s_nop 5
    v_cvt_pk_bf16_f32 v176, v160, v161
    v_cvt_pk_bf16_f32 v177, v162, v163
    v_cvt_pk_bf16_f32 v178, v164, v165
    v_cvt_pk_bf16_f32 v179, v166, v167
    buffer_store_dwordx4 v[176:179], v214, s[60:63], s17 offen offset:0 sc1
    ds_write_b128 v242, v[176:179] offset:8192
    v_cvt_pk_bf16_f32 v180, v168, v169
    v_cvt_pk_bf16_f32 v181, v170, v171
    v_cvt_pk_bf16_f32 v182, v172, v173
    v_cvt_pk_bf16_f32 v183, v174, v175
    buffer_store_dwordx4 v[180:183], v214, s[60:63], s17 offen offset:1024 sc1
    ds_write_b128 v242, v[180:183] offset:9216
    s_waitcnt vmcnt(10) lgkmcnt(0)
    s_barrier
    ds_read_b128 v[108:111], v240 offset:0
    ds_read_b128 v[124:127], v240 offset:4096
    ds_read_b128 v[140:143], v240 offset:8192
    s_cmp_eq_u32 s80, 0
    s_cbranch_scc1 K2_fok
K2_fpoll:
    buffer_load_dword v238, v241, s[72:75], s78 offen sc1
    s_sub_u32 s51, s51, 1
    s_waitcnt vmcnt(0)
    v_cmp_ne_u32 vcc, v217, v238
    s_cmp_eq_u32 s51, 0
    s_cbranch_scc1 K2_fre
    s_cbranch_vccnz K2_fpoll
K2_fre:
    s_add_u32 s40, s92, 40960
    buffer_load_dwordx4 v[0:3], v212, s[60:63], s40 offen sc1
    s_add_u32 s40, s93, 40960
    buffer_load_dwordx4 v[4:7], v212, s[60:63], s40 offen sc1
    s_add_u32 s40, s94, 40960
    buffer_load_dwordx4 v[8:11], v212, s[60:63], s40 offen sc1
    s_add_u32 s40, s92, 40960
    buffer_load_dwordx4 v[16:19], v213, s[60:63], s40 offen sc1
    s_add_u32 s40, s93, 40960
    buffer_load_dwordx4 v[20:23], v213, s[60:63], s40 offen sc1
    s_add_u32 s40, s94, 40960
    buffer_load_dwordx4 v[24:27], v213, s[60:63], s40 offen sc1
    s_add_u32 s40, s92, 40960
    s_add_u32 s40, s40, s50
    buffer_load_dwordx4 v[32:35], v214, s[60:63], s40 offen sc1
    s_add_u32 s40, s93, 40960
    s_add_u32 s40, s40, s50
    buffer_load_dwordx4 v[36:39], v214, s[60:63], s40 offen sc1
    s_add_u32 s40, s94, 40960
    s_add_u32 s40, s40, s50
    buffer_load_dwordx4 v[40:43], v214, s[60:63], s40 offen sc1
    s_max_u32 s51, s51, 1
    s_waitcnt vmcnt(0)
K2_fok:
    s_mov_b32 s43, 0xffff0000
    v_lshlrev_b32 v144, 16, v0
    v_and_b32 v145, s43, v0
    v_lshlrev_b32 v146, 16, v1
    v_and_b32 v147, s43, v1
    v_lshlrev_b32 v148, 16, v2
    v_and_b32 v149, s43, v2
    v_lshlrev_b32 v150, 16, v3
    v_and_b32 v151, s43, v3
    v_lshlrev_b32 v60, 16, v4
    v_and_b32 v61, s43, v4
    v_lshlrev_b32 v62, 16, v5
    v_and_b32 v63, s43, v5
    v_lshlrev_b32 v64, 16, v6
    v_and_b32 v65, s43, v6
    v_lshlrev_b32 v66, 16, v7
    v_and_b32 v67, s43, v7
    v_pk_add_f32 v[144:145], v[144:145], v[60:61]
    v_pk_add_f32 v[146:147], v[146:147], v[62:63]
    v_pk_add_f32 v[148:149], v[148:149], v[64:65]
    v_pk_add_f32 v[150:151], v[150:151], v[66:67]
    v_lshlrev_b32 v60, 16, v8
    v_and_b32 v61, s43, v8
    v_lshlrev_b32 v62, 16, v9
    v_and_b32 v63, s43, v9
    v_lshlrev_b32 v64, 16, v10
    v_and_b32 v65, s43, v10
    v_lshlrev_b32 v66, 16, v11
    v_and_b32 v67, s43, v11
    v_pk_add_f32 v[144:145], v[144:145], v[60:61]
    v_pk_add_f32 v[146:147], v[146:147], v[62:63]
    v_pk_add_f32 v[148:149], v[148:149], v[64:65]
    v_pk_add_f32 v[150:151], v[150:151], v[66:67]
    v_lshlrev_b32 v60, 16, v12
    v_and_b32 v61, s43, v12
    v_lshlrev_b32 v62, 16, v13
    v_and_b32 v63, s43, v13
    v_lshlrev_b32 v64, 16, v14
    v_and_b32 v65, s43, v14
    v_lshlrev_b32 v66, 16, v15
    v_and_b32 v67, s43, v15
    v_pk_add_f32 v[144:145], v[144:145], v[60:61]
    v_pk_add_f32 v[146:147], v[146:147], v[62:63]
    v_pk_add_f32 v[148:149], v[148:149], v[64:65]
    v_pk_add_f32 v[150:151], v[150:151], v[66:67]
    v_mul_f32 v60, s95, v144
    v_mul_f32 v61, s95, v145
    v_mul_f32 v62, s95, v146
    v_mul_f32 v63, s95, v147
    v_mul_f32 v64, s95, v148
    v_mul_f32 v65, s95, v149
    v_mul_f32 v66, s95, v150
    v_mul_f32 v67, s95, v151
    v_exp_f32 v60, v60
    v_exp_f32 v61, v61
    v_exp_f32 v62, v62
    v_exp_f32 v63, v63
    v_exp_f32 v64, v64
    v_exp_f32 v65, v65
    v_exp_f32 v66, v66
    v_exp_f32 v67, v67
    v_lshlrev_b32 v68, 16, v192
    v_and_b32 v69, s43, v192
    v_lshlrev_b32 v70, 16, v193
    v_and_b32 v71, s43, v193
    v_lshlrev_b32 v72, 16, v194
    v_and_b32 v73, s43, v194
    v_lshlrev_b32 v74, 16, v195
    v_and_b32 v75, s43, v195
    v_add_f32 v60, 1.0, v60
    v_add_f32 v61, 1.0, v61
    v_add_f32 v62, 1.0, v62
    v_add_f32 v63, 1.0, v63
    v_add_f32 v64, 1.0, v64
    v_add_f32 v65, 1.0, v65
    v_add_f32 v66, 1.0, v66
    v_add_f32 v67, 1.0, v67
    v_rcp_f32 v60, v60
    v_rcp_f32 v61, v61
    v_rcp_f32 v62, v62
    v_rcp_f32 v63, v63
    v_rcp_f32 v64, v64
    v_rcp_f32 v65, v65
    v_rcp_f32 v66, v66
    v_rcp_f32 v67, v67
    s_nop 0
    v_pk_mul_f32 v[144:145], v[144:145], v[60:61]
    v_pk_mul_f32 v[146:147], v[146:147], v[62:63]
    v_pk_mul_f32 v[148:149], v[148:149], v[64:65]
    v_pk_mul_f32 v[150:151], v[150:151], v[66:67]
    v_lshlrev_b32 v152, 16, v16
    v_and_b32 v153, s43, v16
    v_lshlrev_b32 v154, 16, v17
    v_and_b32 v155, s43, v17
    v_lshlrev_b32 v156, 16, v18
    v_and_b32 v157, s43, v18
    v_lshlrev_b32 v158, 16, v19
    v_and_b32 v159, s43, v19
    v_lshlrev_b32 v60, 16, v20
    v_and_b32 v61, s43, v20
    v_lshlrev_b32 v62, 16, v21
    v_and_b32 v63, s43, v21
    v_lshlrev_b32 v64, 16, v22
    v_and_b32 v65, s43, v22
    v_lshlrev_b32 v66, 16, v23
    v_and_b32 v67, s43, v23
    v_pk_add_f32 v[152:153], v[152:153], v[60:61]
    v_pk_add_f32 v[154:155], v[154:155], v[62:63]
    v_pk_add_f32 v[156:157], v[156:157], v[64:65]
    v_pk_add_f32 v[158:159], v[158:159], v[66:67]
    v_lshlrev_b32 v60, 16, v24
    v_and_b32 v61, s43, v24
    v_lshlrev_b32 v62, 16, v25
    v_and_b32 v63, s43, v25
    v_lshlrev_b32 v64, 16, v26
    v_and_b32 v65, s43, v26
    v_lshlrev_b32 v66, 16, v27
    v_and_b32 v67, s43, v27
    v_pk_add_f32 v[152:153], v[152:153], v[60:61]
    v_pk_add_f32 v[154:155], v[154:155], v[62:63]
    v_pk_add_f32 v[156:157], v[156:157], v[64:65]
    v_pk_add_f32 v[158:159], v[158:159], v[66:67]
    v_lshlrev_b32 v60, 16, v28
    v_and_b32 v61, s43, v28
    v_lshlrev_b32 v62, 16, v29
    v_and_b32 v63, s43, v29
    v_lshlrev_b32 v64, 16, v30
    v_and_b32 v65, s43, v30
    v_lshlrev_b32 v66, 16, v31
    v_and_b32 v67, s43, v31
    v_pk_add_f32 v[152:153], v[152:153], v[60:61]
    v_pk_add_f32 v[154:155], v[154:155], v[62:63]
    v_pk_add_f32 v[156:157], v[156:157], v[64:65]
    v_pk_add_f32 v[158:159], v[158:159], v[66:67]
    v_mul_f32 v60, s95, v152
    v_mul_f32 v61, s95, v153
    v_mul_f32 v62, s95, v154
    v_mul_f32 v63, s95, v155
    v_mul_f32 v64, s95, v156
    v_mul_f32 v65, s95, v157
    v_mul_f32 v66, s95, v158
    v_mul_f32 v67, s95, v159
    v_exp_f32 v60, v60
    v_exp_f32 v61, v61
    v_exp_f32 v62, v62
    v_exp_f32 v63, v63
    v_exp_f32 v64, v64
    v_exp_f32 v65, v65
    v_exp_f32 v66, v66
    v_exp_f32 v67, v67
    v_lshlrev_b32 v76, 16, v200
    v_and_b32 v77, s43, v200
    v_lshlrev_b32 v78, 16, v201
    v_and_b32 v79, s43, v201
    v_lshlrev_b32 v80, 16, v202
    v_and_b32 v81, s43, v202
    v_lshlrev_b32 v82, 16, v203
    v_and_b32 v83, s43, v203
    v_add_f32 v60, 1.0, v60
    v_add_f32 v61, 1.0, v61
    v_add_f32 v62, 1.0, v62
    v_add_f32 v63, 1.0, v63
    v_add_f32 v64, 1.0, v64
    v_add_f32 v65, 1.0, v65
    v_add_f32 v66, 1.0, v66
    v_add_f32 v67, 1.0, v67
    v_rcp_f32 v60, v60
    v_rcp_f32 v61, v61
    v_rcp_f32 v62, v62
    v_rcp_f32 v63, v63
    v_rcp_f32 v64, v64
    v_rcp_f32 v65, v65
    v_rcp_f32 v66, v66
    v_rcp_f32 v67, v67
    s_add_u32 s40, s92, s50
    buffer_load_dwordx4 v[96:99], v212, s[60:63], s92 offen sc1
    buffer_load_dwordx4 v[112:115], v213, s[60:63], s92 offen sc1
    buffer_load_dwordx4 v[128:131], v214, s[60:63], s40 offen sc1
    s_add_u32 s40, s93, s50
    buffer_load_dwordx4 v[100:103], v212, s[60:63], s93 offen sc1
    buffer_load_dwordx4 v[116:119], v213, s[60:63], s93 offen sc1
    buffer_load_dwordx4 v[132:135], v214, s[60:63], s40 offen sc1
    s_add_u32 s40, s94, s50
    buffer_load_dwordx4 v[104:107], v212, s[60:63], s94 offen sc1
    buffer_load_dwordx4 v[120:123], v213, s[60:63], s94 offen sc1
    buffer_load_dwordx4 v[136:139], v214, s[60:63], s40 offen sc1
    v_pk_mul_f32 v[152:153], v[152:153], v[60:61]
    v_pk_mul_f32 v[154:155], v[154:155], v[62:63]
    v_pk_mul_f32 v[156:157], v[156:157], v[64:65]
    v_pk_mul_f32 v[158:159], v[158:159], v[66:67]
    v_lshlrev_b32 v160, 16, v32
    v_and_b32 v161, s43, v32
    v_lshlrev_b32 v162, 16, v33
    v_and_b32 v163, s43, v33
    v_lshlrev_b32 v164, 16, v34
    v_and_b32 v165, s43, v34
    v_lshlrev_b32 v166, 16, v35
    v_and_b32 v167, s43, v35
    v_lshlrev_b32 v60, 16, v36
    v_and_b32 v61, s43, v36
    v_lshlrev_b32 v62, 16, v37
    v_and_b32 v63, s43, v37
    v_lshlrev_b32 v64, 16, v38
    v_and_b32 v65, s43, v38
    v_lshlrev_b32 v66, 16, v39
    v_and_b32 v67, s43, v39
    v_pk_add_f32 v[160:161], v[160:161], v[60:61]
    v_pk_add_f32 v[162:163], v[162:163], v[62:63]
    v_pk_add_f32 v[164:165], v[164:165], v[64:65]
    v_pk_add_f32 v[166:167], v[166:167], v[66:67]
    v_lshlrev_b32 v60, 16, v40
    v_and_b32 v61, s43, v40
    v_lshlrev_b32 v62, 16, v41
    v_and_b32 v63, s43, v41
    v_lshlrev_b32 v64, 16, v42
    v_and_b32 v65, s43, v42
    v_lshlrev_b32 v66, 16, v43
    v_and_b32 v67, s43, v43
    v_pk_add_f32 v[160:161], v[160:161], v[60:61]
    v_pk_add_f32 v[162:163], v[162:163], v[62:63]
    v_pk_add_f32 v[164:165], v[164:165], v[64:65]
    v_pk_add_f32 v[166:167], v[166:167], v[66:67]
    v_lshlrev_b32 v60, 16, v44
    v_and_b32 v61, s43, v44
    v_lshlrev_b32 v62, 16, v45
    v_and_b32 v63, s43, v45
    v_lshlrev_b32 v64, 16, v46
    v_and_b32 v65, s43, v46
    v_lshlrev_b32 v66, 16, v47
    v_and_b32 v67, s43, v47
    v_pk_add_f32 v[160:161], v[160:161], v[60:61]
    v_pk_add_f32 v[162:163], v[162:163], v[62:63]
    v_pk_add_f32 v[164:165], v[164:165], v[64:65]
    v_pk_add_f32 v[166:167], v[166:167], v[66:67]
    v_mul_f32 v60, s95, v160
    v_mul_f32 v61, s95, v161
    v_mul_f32 v62, s95, v162
    v_mul_f32 v63, s95, v163
    v_mul_f32 v64, s95, v164
    v_mul_f32 v65, s95, v165
    v_mul_f32 v66, s95, v166
    v_mul_f32 v67, s95, v167
    v_exp_f32 v60, v60
    v_exp_f32 v61, v61
    v_exp_f32 v62, v62
    v_exp_f32 v63, v63
    v_exp_f32 v64, v64
    v_exp_f32 v65, v65
    v_exp_f32 v66, v66
    v_exp_f32 v67, v67
    v_lshlrev_b32 v84, 16, v204
    v_and_b32 v85, s43, v204
    v_lshlrev_b32 v86, 16, v205
    v_and_b32 v87, s43, v205
    v_lshlrev_b32 v88, 16, v206
    v_and_b32 v89, s43, v206
    v_lshlrev_b32 v90, 16, v207
    v_and_b32 v91, s43, v207
    v_add_f32 v60, 1.0, v60
    v_add_f32 v61, 1.0, v61
    v_add_f32 v62, 1.0, v62
    v_add_f32 v63, 1.0, v63
    v_add_f32 v64, 1.0, v64
    v_add_f32 v65, 1.0, v65
    v_add_f32 v66, 1.0, v66
    v_add_f32 v67, 1.0, v67
    v_rcp_f32 v60, v60
    v_rcp_f32 v61, v61
    v_rcp_f32 v62, v62
    v_rcp_f32 v63, v63
    v_rcp_f32 v64, v64
    v_rcp_f32 v65, v65
    v_rcp_f32 v66, v66
    v_rcp_f32 v67, v67
    s_nop 0
    v_pk_mul_f32 v[160:161], v[160:161], v[60:61]
    v_pk_mul_f32 v[162:163], v[162:163], v[62:63]
    v_pk_mul_f32 v[164:165], v[164:165], v[64:65]
    v_pk_mul_f32 v[166:167], v[166:167], v[66:67]
    s_branch K2_schk
K2_spoll:
    s_add_u32 s40, s92, s50
    buffer_load_dwordx4 v[96:99], v212, s[60:63], s92 offen sc1
    buffer_load_dwordx4 v[112:115], v213, s[60:63], s92 offen sc1
    buffer_load_dwordx4 v[128:131], v214, s[60:63], s40 offen sc1
    s_add_u32 s40, s93, s50
    buffer_load_dwordx4 v[100:103], v212, s[60:63], s93 offen sc1
    buffer_load_dwordx4 v[116:119], v213, s[60:63], s93 offen sc1
    buffer_load_dwordx4 v[132:135], v214, s[60:63], s40 offen sc1
    s_add_u32 s40, s94, s50
    buffer_load_dwordx4 v[104:107], v212, s[60:63], s94 offen sc1
    buffer_load_dwordx4 v[120:123], v213, s[60:63], s94 offen sc1
    buffer_load_dwordx4 v[136:139], v214, s[60:63], s40 offen sc1
K2_schk:
    s_waitcnt vmcnt(0) lgkmcnt(0)
    v_max_u32 v238, v96, v97
    v_max3_u32 v238, v238, v98, v99
    v_max3_u32 v238, v238, v100, v101
    v_max3_u32 v238, v238, v102, v103
    v_max3_u32 v238, v238, v104, v105
    v_max3_u32 v238, v238, v106, v107
    v_max3_u32 v238, v238, v112, v113
    v_max3_u32 v238, v238, v114, v115
    v_max3_u32 v238, v238, v116, v117
    v_max3_u32 v238, v238, v118, v119
    v_max3_u32 v238, v238, v120, v121
    v_max3_u32 v238, v238, v122, v123
    v_max3_u32 v238, v238, v128, v129
    v_max3_u32 v238, v238, v130, v131
    v_max3_u32 v238, v238, v132, v133
    v_max3_u32 v238, v238, v134, v135
    v_max3_u32 v238, v238, v136, v137
    v_max3_u32 v238, v238, v138, v139
    v_cmp_eq_u32 vcc, -1, v238
    s_cbranch_vccz K2_sok
    s_cmp_eq_u32 s51, 0
    s_cbranch_scc1 K2_sok
    s_sub_u32 s51, s51, 1
    s_sleep 1
    s_branch K2_spoll
K2_sok:
    v_lshlrev_b32 v0, 16, v96
    v_and_b32 v1, s43, v96
    v_lshlrev_b32 v2, 16, v97
    v_and_b32 v3, s43, v97
    v_lshlrev_b32 v4, 16, v98
    v_and_b32 v5, s43, v98
    v_lshlrev_b32 v6, 16, v99
    v_and_b32 v7, s43, v99
    v_lshlrev_b32 v16, 16, v100
    v_and_b32 v17, s43, v100
    v_lshlrev_b32 v18, 16, v101
    v_and_b32 v19, s43, v101
    v_lshlrev_b32 v20, 16, v102
    v_and_b32 v21, s43, v102
    v_lshlrev_b32 v22, 16, v103
    v_and_b32 v23, s43, v103
    v_pk_add_f32 v[0:1], v[0:1], v[16:17]
    v_pk_add_f32 v[2:3], v[2:3], v[18:19]
    v_pk_add_f32 v[4:5], v[4:5], v[20:21]
    v_pk_add_f32 v[6:7], v[6:7], v[22:23]
    v_lshlrev_b32 v16, 16, v104
    v_and_b32 v17, s43, v104
    v_lshlrev_b32 v18, 16, v105
    v_and_b32 v19, s43, v105
    v_lshlrev_b32 v20, 16, v106
    v_and_b32 v21, s43, v106
    v_lshlrev_b32 v22, 16, v107
    v_and_b32 v23, s43, v107
    v_pk_add_f32 v[0:1], v[0:1], v[16:17]
    v_pk_add_f32 v[2:3], v[2:3], v[18:19]
    v_pk_add_f32 v[4:5], v[4:5], v[20:21]
    v_pk_add_f32 v[6:7], v[6:7], v[22:23]
    v_lshlrev_b32 v16, 16, v108
    v_and_b32 v17, s43, v108
    v_lshlrev_b32 v18, 16, v109
    v_and_b32 v19, s43, v109
    v_lshlrev_b32 v20, 16, v110
    v_and_b32 v21, s43, v110
    v_lshlrev_b32 v22, 16, v111
    v_and_b32 v23, s43, v111
    v_pk_add_f32 v[0:1], v[0:1], v[16:17]
    v_pk_add_f32 v[2:3], v[2:3], v[18:19]
    v_pk_add_f32 v[4:5], v[4:5], v[20:21]
    v_pk_add_f32 v[6:7], v[6:7], v[22:23]
    v_pk_fma_f32 v[0:1], v[0:1], v[144:145], v[68:69]
    v_pk_fma_f32 v[2:3], v[2:3], v[146:147], v[70:71]
    v_pk_fma_f32 v[4:5], v[4:5], v[148:149], v[72:73]
    v_pk_fma_f32 v[6:7], v[6:7], v[150:151], v[74:75]
    v_cvt_pk_bf16_f32 v32, v0, v1
    v_cvt_pk_bf16_f32 v33, v2, v3
    v_cvt_pk_bf16_f32 v34, v4, v5
    v_cvt_pk_bf16_f32 v35, v6, v7
    buffer_store_dwordx2 v[32:33], v216, s[68:71], 0 offen offset:0
    buffer_store_dwordx2 v[34:35], v219, s[68:71], 0 offen offset:0
    v_lshlrev_b32 v8, 16, v112
    v_and_b32 v9, s43, v112
    v_lshlrev_b32 v10, 16, v113
    v_and_b32 v11, s43, v113
    v_lshlrev_b32 v12, 16, v114
    v_and_b32 v13, s43, v114
    v_lshlrev_b32 v14, 16, v115
    v_and_b32 v15, s43, v115
    v_lshlrev_b32 v24, 16, v116
    v_and_b32 v25, s43, v116
    v_lshlrev_b32 v26, 16, v117
    v_and_b32 v27, s43, v117
    v_lshlrev_b32 v28, 16, v118
    v_and_b32 v29, s43, v118
    v_lshlrev_b32 v30, 16, v119
    v_and_b32 v31, s43, v119
    v_pk_add_f32 v[8:9], v[8:9], v[24:25]
    v_pk_add_f32 v[10:11], v[10:11], v[26:27]
    v_pk_add_f32 v[12:13], v[12:13], v[28:29]
    v_pk_add_f32 v[14:15], v[14:15], v[30:31]
    v_lshlrev_b32 v24, 16, v120
    v_and_b32 v25, s43, v120
    v_lshlrev_b32 v26, 16, v121
    v_and_b32 v27, s43, v121
    v_lshlrev_b32 v28, 16, v122
    v_and_b32 v29, s43, v122
    v_lshlrev_b32 v30, 16, v123
    v_and_b32 v31, s43, v123
    v_pk_add_f32 v[8:9], v[8:9], v[24:25]
    v_pk_add_f32 v[10:11], v[10:11], v[26:27]
    v_pk_add_f32 v[12:13], v[12:13], v[28:29]
    v_pk_add_f32 v[14:15], v[14:15], v[30:31]
    v_lshlrev_b32 v24, 16, v124
    v_and_b32 v25, s43, v124
    v_lshlrev_b32 v26, 16, v125
    v_and_b32 v27, s43, v125
    v_lshlrev_b32 v28, 16, v126
    v_and_b32 v29, s43, v126
    v_lshlrev_b32 v30, 16, v127
    v_and_b32 v31, s43, v127
    v_pk_add_f32 v[8:9], v[8:9], v[24:25]
    v_pk_add_f32 v[10:11], v[10:11], v[26:27]
    v_pk_add_f32 v[12:13], v[12:13], v[28:29]
    v_pk_add_f32 v[14:15], v[14:15], v[30:31]
    v_pk_fma_f32 v[8:9], v[8:9], v[152:153], v[76:77]
    v_pk_fma_f32 v[10:11], v[10:11], v[154:155], v[78:79]
    v_pk_fma_f32 v[12:13], v[12:13], v[156:157], v[80:81]
    v_pk_fma_f32 v[14:15], v[14:15], v[158:159], v[82:83]
    v_cvt_pk_bf16_f32 v36, v8, v9
    v_cvt_pk_bf16_f32 v37, v10, v11
    v_cvt_pk_bf16_f32 v38, v12, v13
    v_cvt_pk_bf16_f32 v39, v14, v15
    buffer_store_dwordx2 v[36:37], v216, s[68:71], 0 offen offset:128
    buffer_store_dwordx2 v[38:39], v219, s[68:71], 0 offen offset:128
    v_lshlrev_b32 v0, 16, v128
    v_and_b32 v1, s43, v128
    v_lshlrev_b32 v2, 16, v129
    v_and_b32 v3, s43, v129
    v_lshlrev_b32 v4, 16, v130
    v_and_b32 v5, s43, v130
    v_lshlrev_b32 v6, 16, v131
    v_and_b32 v7, s43, v131
    v_lshlrev_b32 v16, 16, v132
    v_and_b32 v17, s43, v132
    v_lshlrev_b32 v18, 16, v133
    v_and_b32 v19, s43, v133
    v_lshlrev_b32 v20, 16, v134
    v_and_b32 v21, s43, v134
    v_lshlrev_b32 v22, 16, v135
    v_and_b32 v23, s43, v135
    v_pk_add_f32 v[0:1], v[0:1], v[16:17]
    v_pk_add_f32 v[2:3], v[2:3], v[18:19]
    v_pk_add_f32 v[4:5], v[4:5], v[20:21]
    v_pk_add_f32 v[6:7], v[6:7], v[22:23]
    v_lshlrev_b32 v16, 16, v136
    v_and_b32 v17, s43, v136
    v_lshlrev_b32 v18, 16, v137
    v_and_b32 v19, s43, v137
    v_lshlrev_b32 v20, 16, v138
    v_and_b32 v21, s43, v138
    v_lshlrev_b32 v22, 16, v139
    v_and_b32 v23, s43, v139
    v_pk_add_f32 v[0:1], v[0:1], v[16:17]
    v_pk_add_f32 v[2:3], v[2:3], v[18:19]
    v_pk_add_f32 v[4:5], v[4:5], v[20:21]
    v_pk_add_f32 v[6:7], v[6:7], v[22:23]
    v_lshlrev_b32 v16, 16, v140
    v_and_b32 v17, s43, v140
    v_lshlrev_b32 v18, 16, v141
    v_and_b32 v19, s43, v141
    v_lshlrev_b32 v20, 16, v142
    v_and_b32 v21, s43, v142
    v_lshlrev_b32 v22, 16, v143
    v_and_b32 v23, s43, v143
    v_pk_add_f32 v[0:1], v[0:1], v[16:17]
    v_pk_add_f32 v[2:3], v[2:3], v[18:19]
    v_pk_add_f32 v[4:5], v[4:5], v[20:21]
    v_pk_add_f32 v[6:7], v[6:7], v[22:23]
    v_pk_fma_f32 v[0:1], v[0:1], v[160:161], v[84:85]
    v_pk_fma_f32 v[2:3], v[2:3], v[162:163], v[86:87]
    v_pk_fma_f32 v[4:5], v[4:5], v[164:165], v[88:89]
    v_pk_fma_f32 v[6:7], v[6:7], v[166:167], v[90:91]
    v_cvt_pk_bf16_f32 v40, v0, v1
    v_cvt_pk_bf16_f32 v41, v2, v3
    v_cvt_pk_bf16_f32 v42, v4, v5
    v_cvt_pk_bf16_f32 v43, v6, v7
    buffer_store_dwordx2 v[40:41], v216, s[68:71], s50 offen offset:256
    buffer_store_dwordx2 v[42:43], v219, s[68:71], s50 offen offset:256
K2_done:
    s_endpgm
K2_pslow0:
    s_add_u32 s35, s35, 1
    s_cmp_gt_u32 s35, 1048576
    s_cbranch_scc1 K2_pok0
    buffer_load_dword v248, v218, s[72:75], s15 offen sc1
    s_waitcnt vmcnt(0)
    s_branch K2_pchk0
K2_pslow1:
    s_add_u32 s35, s35, 1
    s_cmp_gt_u32 s35, 1048576
    s_cbranch_scc1 K2_pok1
    buffer_load_dword v248, v218, s[72:75], s15 offen sc1
    s_waitcnt vmcnt(0)
    s_branch K2_pchk1
K2_f1slow:
    s_add_u32 s35, s35, 1
    s_cmp_gt_u32 s35, 262144
    s_cbranch_scc1 K2_f1ok
    s_sleep 2
    buffer_load_dwordx4 v[228:231], v225, s[72:75], 0 offen sc1
    s_waitcnt vmcnt(0)
    s_branch K2_f1chk
K2_rare_P0:
    s_call_b64 s[38:39], K2_fix1
    s_branch K2_ret_P0
K2_rare_L0:
    s_call_b64 s[38:39], K2_fix0
    s_branch K2_ret_L0
K2_rare_L1:
    s_call_b64 s[38:39], K2_fix1
    s_branch K2_ret_L1
K2_rare_L2:
    s_call_b64 s[38:39], K2_fix0
    s_branch K2_ret_L2
K2_rare_L3:
    s_call_b64 s[38:39], K2_fix1
    s_branch K2_ret_L3
K2_rare_P61:
    s_call_b64 s[38:39], K2_fix0
    s_branch K2_ret_P61
K2_rare_P62:
    s_call_b64 s[38:39], K2_fix1
    s_branch K2_ret_P62
K2_fix0:
    s_nop 7
    v_max3_f32 v236, v96, v97, v98
    v_max3_f32 v236, v236, v99, v100
    v_max3_f32 v236, v236, v101, v102
    v_max_f32 v236, v236, v103
    v_mov_b32 v240, v236
    s_nop 1
    v_permlane32_swap_b32 v240, v236
    v_max_f32 v236, v236, v240
    v_mov_b32 v240, v236
    s_nop 1
    v_permlane16_swap_b32 v240, v236
    v_max_f32 v236, v236, v240
    v_max_f32 v236, 0, v236
    v_sub_f32 v160, v160, v236
    v_sub_f32 v161, v161, v236
    v_sub_f32 v162, v162, v236
    v_sub_f32 v163, v163, v236
    v_sub_f32 v176, v96, v236
    v_sub_f32 v177, v97, v236
    v_sub_f32 v178, v98, v236
    v_sub_f32 v179, v99, v236
    v_sub_f32 v180, v100, v236
    v_sub_f32 v181, v101, v236
    v_sub_f32 v182, v102, v236
    v_sub_f32 v183, v103, v236
    v_exp_f32 v176, v176
    v_exp_f32 v177, v177
    v_exp_f32 v178, v178
    v_exp_f32 v179, v179
    v_exp_f32 v180, v180
    v_exp_f32 v181, v181
    v_exp_f32 v182, v182
    v_exp_f32 v183, v183
    v_add_f32 v192, v176, v177
    v_add_f32 v192, v192, v178
    v_add_f32 v192, v192, v179
    v_add_f32 v192, v192, v180
    v_add_f32 v192, v192, v181
    v_add_f32 v192, v192, v182
    v_add_f32 v192, v192, v183
    v_cvt_pk_bf16_f32 v128, v176, v177
    v_cvt_pk_bf16_f32 v129, v178, v179
    v_cvt_pk_bf16_f32 v130, v180, v181
    v_cvt_pk_bf16_f32 v131, v182, v183
    v_sub_f32 v236, 0, v236
    v_exp_f32 v236, v236
    s_nop 0
    v_mul_f32 v196, v196, v236
    v_accvgpr_read_b32 v176, a0
    v_accvgpr_read_b32 v177, a1
    v_accvgpr_read_b32 v178, a2
    v_accvgpr_read_b32 v179, a3
    v_mul_f32 v176, v176, v236
    v_mul_f32 v177, v177, v236
    v_mul_f32 v178, v178, v236
    v_mul_f32 v179, v179, v236
    v_accvgpr_write_b32 a0, v176
    v_accvgpr_write_b32 a1, v177
    v_accvgpr_write_b32 a2, v178
    v_accvgpr_write_b32 a3, v179
    v_accvgpr_read_b32 v176, a16
    v_accvgpr_read_b32 v177, a17
    v_accvgpr_read_b32 v178, a18
    v_accvgpr_read_b32 v179, a19
    v_mul_f32 v176, v176, v236
    v_mul_f32 v177, v177, v236
    v_mul_f32 v178, v178, v236
    v_mul_f32 v179, v179, v236
    v_accvgpr_write_b32 a16, v176
    v_accvgpr_write_b32 a17, v177
    v_accvgpr_write_b32 a18, v178
    v_accvgpr_write_b32 a19, v179
    v_accvgpr_read_b32 v176, a32
    v_accvgpr_read_b32 v177, a33
    v_accvgpr_read_b32 v178, a34
    v_accvgpr_read_b32 v179, a35
    v_mul_f32 v176, v176, v236
    v_mul_f32 v177, v177, v236
    v_mul_f32 v178, v178, v236
    v_mul_f32 v179, v179, v236
    v_accvgpr_write_b32 a32, v176
    v_accvgpr_write_b32 a33, v177
    v_accvgpr_write_b32 a34, v178
    v_accvgpr_write_b32 a35, v179
    v_accvgpr_read_b32 v176, a48
    v_accvgpr_read_b32 v177, a49
    v_accvgpr_read_b32 v178, a50
    v_accvgpr_read_b32 v179, a51
    v_mul_f32 v176, v176, v236
    v_mul_f32 v177, v177, v236
    v_mul_f32 v178, v178, v236
    v_mul_f32 v179, v179, v236
    v_accvgpr_write_b32 a48, v176
    v_accvgpr_write_b32 a49, v177
    v_accvgpr_write_b32 a50, v178
    v_accvgpr_write_b32 a51, v179
    v_accvgpr_read_b32 v176, a64
    v_accvgpr_read_b32 v177, a65
    v_accvgpr_read_b32 v178, a66
    v_accvgpr_read_b32 v179, a67
    v_mul_f32 v176, v176, v236
    v_mul_f32 v177, v177, v236
    v_mul_f32 v178, v178, v236
    v_mul_f32 v179, v179, v236
    v_accvgpr_write_b32 a64, v176
    v_accvgpr_write_b32 a65, v177
    v_accvgpr_write_b32 a66, v178
    v_accvgpr_write_b32 a67, v179
    v_accvgpr_read_b32 v176, a80
    v_accvgpr_read_b32 v177, a81
    v_accvgpr_read_b32 v178, a82
    v_accvgpr_read_b32 v179, a83
    v_mul_f32 v176, v176, v236
    v_mul_f32 v177, v177, v236
    v_mul_f32 v178, v178, v236
    v_mul_f32 v179, v179, v236
    v_accvgpr_write_b32 a80, v176
    v_accvgpr_write_b32 a81, v177
    v_accvgpr_write_b32 a82, v178
    v_accvgpr_write_b32 a83, v179
    v_accvgpr_read_b32 v176, a96
    v_accvgpr_read_b32 v177, a97
    v_accvgpr_read_b32 v178, a98
    v_accvgpr_read_b32 v179, a99
    v_mul_f32 v176, v176, v236
    v_mul_f32 v177, v177, v236
    v_mul_f32 v178, v178, v236
    v_mul_f32 v179, v179, v236
    v_accvgpr_write_b32 a96, v176
    v_accvgpr_write_b32 a97, v177
    v_accvgpr_write_b32 a98, v178
    v_accvgpr_write_b32 a99, v179
    v_accvgpr_read_b32 v176, a112
    v_accvgpr_read_b32 v177, a113
    v_accvgpr_read_b32 v178, a114
    v_accvgpr_read_b32 v179, a115
    v_mul_f32 v176, v176, v236
    v_mul_f32 v177, v177, v236
    v_mul_f32 v178, v178, v236
    v_mul_f32 v179, v179, v236
    v_accvgpr_write_b32 a112, v176
    v_accvgpr_write_b32 a113, v177
    v_accvgpr_write_b32 a114, v178
    v_accvgpr_write_b32 a115, v179
    v_accvgpr_read_b32 v176, a128
    v_accvgpr_read_b32 v177, a129
    v_accvgpr_read_b32 v178, a130
    v_accvgpr_read_b32 v179, a131
    v_mul_f32 v176, v176, v236
    v_mul_f32 v177, v177, v236
    v_mul_f32 v178, v178, v236
    v_mul_f32 v179, v179, v236
    v_accvgpr_write_b32 a128, v176
    v_accvgpr_write_b32 a129, v177
    v_accvgpr_write_b32 a130, v178
    v_accvgpr_write_b32 a131, v179
    v_accvgpr_read_b32 v176, a144
    v_accvgpr_read_b32 v177, a145
    v_accvgpr_read_b32 v178, a146
    v_accvgpr_read_b32 v179, a147
    v_mul_f32 v176, v176, v236
    v_mul_f32 v177, v177, v236
    v_mul_f32 v178, v178, v236
    v_mul_f32 v179, v179, v236
    v_accvgpr_write_b32 a144, v176
    v_accvgpr_write_b32 a145, v177
    v_accvgpr_write_b32 a146, v178
    v_accvgpr_write_b32 a147, v179
    v_accvgpr_read_b32 v176, a160
    v_accvgpr_read_b32 v177, a161
    v_accvgpr_read_b32 v178, a162
    v_accvgpr_read_b32 v179, a163
    v_mul_f32 v176, v176, v236
    v_mul_f32 v177, v177, v236
    v_mul_f32 v178, v178, v236
    v_mul_f32 v179, v179, v236
    v_accvgpr_write_b32 a160, v176
    v_accvgpr_write_b32 a161, v177
    v_accvgpr_write_b32 a162, v178
    v_accvgpr_write_b32 a163, v179
    v_accvgpr_read_b32 v176, a176
    v_accvgpr_read_b32 v177, a177
    v_accvgpr_read_b32 v178, a178
    v_accvgpr_read_b32 v179, a179
    v_mul_f32 v176, v176, v236
    v_mul_f32 v177, v177, v236
    v_mul_f32 v178, v178, v236
    v_mul_f32 v179, v179, v236
    v_accvgpr_write_b32 a176, v176
    v_accvgpr_write_b32 a177, v177
    v_accvgpr_write_b32 a178, v178
    v_accvgpr_write_b32 a179, v179
    v_max3_f32 v237, v104, v105, v106
    v_max3_f32 v237, v237, v107, v108
    v_max3_f32 v237, v237, v109, v110
    v_max_f32 v237, v237, v111
    v_mov_b32 v240, v237
    s_nop 1
    v_permlane32_swap_b32 v240, v237
    v_max_f32 v237, v237, v240
    v_mov_b32 v240, v237
    s_nop 1
    v_permlane16_swap_b32 v240, v237
    v_max_f32 v237, v237, v240
    v_max_f32 v237, 0, v237
    v_sub_f32 v164, v164, v237
    v_sub_f32 v165, v165, v237
    v_sub_f32 v166, v166, v237
    v_sub_f32 v167, v167, v237
    v_sub_f32 v176, v104, v237
    v_sub_f32 v177, v105, v237
    v_sub_f32 v178, v106, v237
    v_sub_f32 v179, v107, v237
    v_sub_f32 v180, v108, v237
    v_sub_f32 v181, v109, v237
    v_sub_f32 v182, v110, v237
    v_sub_f32 v183, v111, v237
    v_exp_f32 v176, v176
    v_exp_f32 v177, v177
    v_exp_f32 v178, v178
    v_exp_f32 v179, v179
    v_exp_f32 v180, v180
    v_exp_f32 v181, v181
    v_exp_f32 v182, v182
    v_exp_f32 v183, v183
    v_add_f32 v193, v176, v177
    v_add_f32 v193, v193, v178
    v_add_f32 v193, v193, v179
    v_add_f32 v193, v193, v180
    v_add_f32 v193, v193, v181
    v_add_f32 v193, v193, v182
    v_add_f32 v193, v193, v183
    v_cvt_pk_bf16_f32 v132, v176, v177
    v_cvt_pk_bf16_f32 v133, v178, v179
    v_cvt_pk_bf16_f32 v134, v180, v181
    v_cvt_pk_bf16_f32 v135, v182, v183
    v_sub_f32 v237, 0, v237
    v_exp_f32 v237, v237
    s_nop 0
    v_mul_f32 v197, v197, v237
    v_accvgpr_read_b32 v176, a4
    v_accvgpr_read_b32 v177, a5
    v_accvgpr_read_b32 v178, a6
    v_accvgpr_read_b32 v179, a7
    v_mul_f32 v176, v176, v237
    v_mul_f32 v177, v177, v237
    v_mul_f32 v178, v178, v237
    v_mul_f32 v179, v179, v237
    v_accvgpr_write_b32 a4, v176
    v_accvgpr_write_b32 a5, v177
    v_accvgpr_write_b32 a6, v178
    v_accvgpr_write_b32 a7, v179
    v_accvgpr_read_b32 v176, a20
    v_accvgpr_read_b32 v177, a21
    v_accvgpr_read_b32 v178, a22
    v_accvgpr_read_b32 v179, a23
    v_mul_f32 v176, v176, v237
    v_mul_f32 v177, v177, v237
    v_mul_f32 v178, v178, v237
    v_mul_f32 v179, v179, v237
    v_accvgpr_write_b32 a20, v176
    v_accvgpr_write_b32 a21, v177
    v_accvgpr_write_b32 a22, v178
    v_accvgpr_write_b32 a23, v179
    v_accvgpr_read_b32 v176, a36
    v_accvgpr_read_b32 v177, a37
    v_accvgpr_read_b32 v178, a38
    v_accvgpr_read_b32 v179, a39
    v_mul_f32 v176, v176, v237
    v_mul_f32 v177, v177, v237
    v_mul_f32 v178, v178, v237
    v_mul_f32 v179, v179, v237
    v_accvgpr_write_b32 a36, v176
    v_accvgpr_write_b32 a37, v177
    v_accvgpr_write_b32 a38, v178
    v_accvgpr_write_b32 a39, v179
    v_accvgpr_read_b32 v176, a52
    v_accvgpr_read_b32 v177, a53
    v_accvgpr_read_b32 v178, a54
    v_accvgpr_read_b32 v179, a55
    v_mul_f32 v176, v176, v237
    v_mul_f32 v177, v177, v237
    v_mul_f32 v178, v178, v237
    v_mul_f32 v179, v179, v237
    v_accvgpr_write_b32 a52, v176
    v_accvgpr_write_b32 a53, v177
    v_accvgpr_write_b32 a54, v178
    v_accvgpr_write_b32 a55, v179
    v_accvgpr_read_b32 v176, a68
    v_accvgpr_read_b32 v177, a69
    v_accvgpr_read_b32 v178, a70
    v_accvgpr_read_b32 v179, a71
    v_mul_f32 v176, v176, v237
    v_mul_f32 v177, v177, v237
    v_mul_f32 v178, v178, v237
    v_mul_f32 v179, v179, v237
    v_accvgpr_write_b32 a68, v176
    v_accvgpr_write_b32 a69, v177
    v_accvgpr_write_b32 a70, v178
    v_accvgpr_write_b32 a71, v179
    v_accvgpr_read_b32 v176, a84
    v_accvgpr_read_b32 v177, a85
    v_accvgpr_read_b32 v178, a86
    v_accvgpr_read_b32 v179, a87
    v_mul_f32 v176, v176, v237
    v_mul_f32 v177, v177, v237
    v_mul_f32 v178, v178, v237
    v_mul_f32 v179, v179, v237
    v_accvgpr_write_b32 a84, v176
    v_accvgpr_write_b32 a85, v177
    v_accvgpr_write_b32 a86, v178
    v_accvgpr_write_b32 a87, v179
    v_accvgpr_read_b32 v176, a100
    v_accvgpr_read_b32 v177, a101
    v_accvgpr_read_b32 v178, a102
    v_accvgpr_read_b32 v179, a103
    v_mul_f32 v176, v176, v237
    v_mul_f32 v177, v177, v237
    v_mul_f32 v178, v178, v237
    v_mul_f32 v179, v179, v237
    v_accvgpr_write_b32 a100, v176
    v_accvgpr_write_b32 a101, v177
    v_accvgpr_write_b32 a102, v178
    v_accvgpr_write_b32 a103, v179
    v_accvgpr_read_b32 v176, a116
    v_accvgpr_read_b32 v177, a117
    v_accvgpr_read_b32 v178, a118
    v_accvgpr_read_b32 v179, a119
    v_mul_f32 v176, v176, v237
    v_mul_f32 v177, v177, v237
    v_mul_f32 v178, v178, v237
    v_mul_f32 v179, v179, v237
    v_accvgpr_write_b32 a116, v176
    v_accvgpr_write_b32 a117, v177
    v_accvgpr_write_b32 a118, v178
    v_accvgpr_write_b32 a119, v179
    v_accvgpr_read_b32 v176, a132
    v_accvgpr_read_b32 v177, a133
    v_accvgpr_read_b32 v178, a134
    v_accvgpr_read_b32 v179, a135
    v_mul_f32 v176, v176, v237
    v_mul_f32 v177, v177, v237
    v_mul_f32 v178, v178, v237
    v_mul_f32 v179, v179, v237
    v_accvgpr_write_b32 a132, v176
    v_accvgpr_write_b32 a133, v177
    v_accvgpr_write_b32 a134, v178
    v_accvgpr_write_b32 a135, v179
    v_accvgpr_read_b32 v176, a148
    v_accvgpr_read_b32 v177, a149
    v_accvgpr_read_b32 v178, a150
    v_accvgpr_read_b32 v179, a151
    v_mul_f32 v176, v176, v237
    v_mul_f32 v177, v177, v237
    v_mul_f32 v178, v178, v237
    v_mul_f32 v179, v179, v237
    v_accvgpr_write_b32 a148, v176
    v_accvgpr_write_b32 a149, v177
    v_accvgpr_write_b32 a150, v178
    v_accvgpr_write_b32 a151, v179
    v_accvgpr_read_b32 v176, a164
    v_accvgpr_read_b32 v177, a165
    v_accvgpr_read_b32 v178, a166
    v_accvgpr_read_b32 v179, a167
    v_mul_f32 v176, v176, v237
    v_mul_f32 v177, v177, v237
    v_mul_f32 v178, v178, v237
    v_mul_f32 v179, v179, v237
    v_accvgpr_write_b32 a164, v176
    v_accvgpr_write_b32 a165, v177
    v_accvgpr_write_b32 a166, v178
    v_accvgpr_write_b32 a167, v179
    v_accvgpr_read_b32 v176, a180
    v_accvgpr_read_b32 v177, a181
    v_accvgpr_read_b32 v178, a182
    v_accvgpr_read_b32 v179, a183
    v_mul_f32 v176, v176, v237
    v_mul_f32 v177, v177, v237
    v_mul_f32 v178, v178, v237
    v_mul_f32 v179, v179, v237
    v_accvgpr_write_b32 a180, v176
    v_accvgpr_write_b32 a181, v177
    v_accvgpr_write_b32 a182, v178
    v_accvgpr_write_b32 a183, v179
    v_max3_f32 v238, v112, v113, v114
    v_max3_f32 v238, v238, v115, v116
    v_max3_f32 v238, v238, v117, v118
    v_max_f32 v238, v238, v119
    v_mov_b32 v240, v238
    s_nop 1
    v_permlane32_swap_b32 v240, v238
    v_max_f32 v238, v238, v240
    v_mov_b32 v240, v238
    s_nop 1
    v_permlane16_swap_b32 v240, v238
    v_max_f32 v238, v238, v240
    v_max_f32 v238, 0, v238
    v_sub_f32 v168, v168, v238
    v_sub_f32 v169, v169, v238
    v_sub_f32 v170, v170, v238
    v_sub_f32 v171, v171, v238
    v_sub_f32 v176, v112, v238
    v_sub_f32 v177, v113, v238
    v_sub_f32 v178, v114, v238
    v_sub_f32 v179, v115, v238
    v_sub_f32 v180, v116, v238
    v_sub_f32 v181, v117, v238
    v_sub_f32 v182, v118, v238
    v_sub_f32 v183, v119, v238
    v_exp_f32 v176, v176
    v_exp_f32 v177, v177
    v_exp_f32 v178, v178
    v_exp_f32 v179, v179
    v_exp_f32 v180, v180
    v_exp_f32 v181, v181
    v_exp_f32 v182, v182
    v_exp_f32 v183, v183
    v_add_f32 v194, v176, v177
    v_add_f32 v194, v194, v178
    v_add_f32 v194, v194, v179
    v_add_f32 v194, v194, v180
    v_add_f32 v194, v194, v181
    v_add_f32 v194, v194, v182
    v_add_f32 v194, v194, v183
    v_cvt_pk_bf16_f32 v136, v176, v177
    v_cvt_pk_bf16_f32 v137, v178, v179
    v_cvt_pk_bf16_f32 v138, v180, v181
    v_cvt_pk_bf16_f32 v139, v182, v183
    v_sub_f32 v238, 0, v238
    v_exp_f32 v238, v238
    s_nop 0
    v_mul_f32 v198, v198, v238
    v_accvgpr_read_b32 v176, a8
    v_accvgpr_read_b32 v177, a9
    v_accvgpr_read_b32 v178, a10
    v_accvgpr_read_b32 v179, a11
    v_mul_f32 v176, v176, v238
    v_mul_f32 v177, v177, v238
    v_mul_f32 v178, v178, v238
    v_mul_f32 v179, v179, v238
    v_accvgpr_write_b32 a8, v176
    v_accvgpr_write_b32 a9, v177
    v_accvgpr_write_b32 a10, v178
    v_accvgpr_write_b32 a11, v179
    v_accvgpr_read_b32 v176, a24
    v_accvgpr_read_b32 v177, a25
    v_accvgpr_read_b32 v178, a26
    v_accvgpr_read_b32 v179, a27
    v_mul_f32 v176, v176, v238
    v_mul_f32 v177, v177, v238
    v_mul_f32 v178, v178, v238
    v_mul_f32 v179, v179, v238
    v_accvgpr_write_b32 a24, v176
    v_accvgpr_write_b32 a25, v177
    v_accvgpr_write_b32 a26, v178
    v_accvgpr_write_b32 a27, v179
    v_accvgpr_read_b32 v176, a40
    v_accvgpr_read_b32 v177, a41
    v_accvgpr_read_b32 v178, a42
    v_accvgpr_read_b32 v179, a43
    v_mul_f32 v176, v176, v238
    v_mul_f32 v177, v177, v238
    v_mul_f32 v178, v178, v238
    v_mul_f32 v179, v179, v238
    v_accvgpr_write_b32 a40, v176
    v_accvgpr_write_b32 a41, v177
    v_accvgpr_write_b32 a42, v178
    v_accvgpr_write_b32 a43, v179
    v_accvgpr_read_b32 v176, a56
    v_accvgpr_read_b32 v177, a57
    v_accvgpr_read_b32 v178, a58
    v_accvgpr_read_b32 v179, a59
    v_mul_f32 v176, v176, v238
    v_mul_f32 v177, v177, v238
    v_mul_f32 v178, v178, v238
    v_mul_f32 v179, v179, v238
    v_accvgpr_write_b32 a56, v176
    v_accvgpr_write_b32 a57, v177
    v_accvgpr_write_b32 a58, v178
    v_accvgpr_write_b32 a59, v179
    v_accvgpr_read_b32 v176, a72
    v_accvgpr_read_b32 v177, a73
    v_accvgpr_read_b32 v178, a74
    v_accvgpr_read_b32 v179, a75
    v_mul_f32 v176, v176, v238
    v_mul_f32 v177, v177, v238
    v_mul_f32 v178, v178, v238
    v_mul_f32 v179, v179, v238
    v_accvgpr_write_b32 a72, v176
    v_accvgpr_write_b32 a73, v177
    v_accvgpr_write_b32 a74, v178
    v_accvgpr_write_b32 a75, v179
    v_accvgpr_read_b32 v176, a88
    v_accvgpr_read_b32 v177, a89
    v_accvgpr_read_b32 v178, a90
    v_accvgpr_read_b32 v179, a91
    v_mul_f32 v176, v176, v238
    v_mul_f32 v177, v177, v238
    v_mul_f32 v178, v178, v238
    v_mul_f32 v179, v179, v238
    v_accvgpr_write_b32 a88, v176
    v_accvgpr_write_b32 a89, v177
    v_accvgpr_write_b32 a90, v178
    v_accvgpr_write_b32 a91, v179
    v_accvgpr_read_b32 v176, a104
    v_accvgpr_read_b32 v177, a105
    v_accvgpr_read_b32 v178, a106
    v_accvgpr_read_b32 v179, a107
    v_mul_f32 v176, v176, v238
    v_mul_f32 v177, v177, v238
    v_mul_f32 v178, v178, v238
    v_mul_f32 v179, v179, v238
    v_accvgpr_write_b32 a104, v176
    v_accvgpr_write_b32 a105, v177
    v_accvgpr_write_b32 a106, v178
    v_accvgpr_write_b32 a107, v179
    v_accvgpr_read_b32 v176, a120
    v_accvgpr_read_b32 v177, a121
    v_accvgpr_read_b32 v178, a122
    v_accvgpr_read_b32 v179, a123
    v_mul_f32 v176, v176, v238
    v_mul_f32 v177, v177, v238
    v_mul_f32 v178, v178, v238
    v_mul_f32 v179, v179, v238
    v_accvgpr_write_b32 a120, v176
    v_accvgpr_write_b32 a121, v177
    v_accvgpr_write_b32 a122, v178
    v_accvgpr_write_b32 a123, v179
    v_accvgpr_read_b32 v176, a136
    v_accvgpr_read_b32 v177, a137
    v_accvgpr_read_b32 v178, a138
    v_accvgpr_read_b32 v179, a139
    v_mul_f32 v176, v176, v238
    v_mul_f32 v177, v177, v238
    v_mul_f32 v178, v178, v238
    v_mul_f32 v179, v179, v238
    v_accvgpr_write_b32 a136, v176
    v_accvgpr_write_b32 a137, v177
    v_accvgpr_write_b32 a138, v178
    v_accvgpr_write_b32 a139, v179
    v_accvgpr_read_b32 v176, a152
    v_accvgpr_read_b32 v177, a153
    v_accvgpr_read_b32 v178, a154
    v_accvgpr_read_b32 v179, a155
    v_mul_f32 v176, v176, v238
    v_mul_f32 v177, v177, v238
    v_mul_f32 v178, v178, v238
    v_mul_f32 v179, v179, v238
    v_accvgpr_write_b32 a152, v176
    v_accvgpr_write_b32 a153, v177
    v_accvgpr_write_b32 a154, v178
    v_accvgpr_write_b32 a155, v179
    v_accvgpr_read_b32 v176, a168
    v_accvgpr_read_b32 v177, a169
    v_accvgpr_read_b32 v178, a170
    v_accvgpr_read_b32 v179, a171
    v_mul_f32 v176, v176, v238
    v_mul_f32 v177, v177, v238
    v_mul_f32 v178, v178, v238
    v_mul_f32 v179, v179, v238
    v_accvgpr_write_b32 a168, v176
    v_accvgpr_write_b32 a169, v177
    v_accvgpr_write_b32 a170, v178
    v_accvgpr_write_b32 a171, v179
    v_accvgpr_read_b32 v176, a184
    v_accvgpr_read_b32 v177, a185
    v_accvgpr_read_b32 v178, a186
    v_accvgpr_read_b32 v179, a187
    v_mul_f32 v176, v176, v238
    v_mul_f32 v177, v177, v238
    v_mul_f32 v178, v178, v238
    v_mul_f32 v179, v179, v238
    v_accvgpr_write_b32 a184, v176
    v_accvgpr_write_b32 a185, v177
    v_accvgpr_write_b32 a186, v178
    v_accvgpr_write_b32 a187, v179
    v_max3_f32 v239, v120, v121, v122
    v_max3_f32 v239, v239, v123, v124
    v_max3_f32 v239, v239, v125, v126
    v_max_f32 v239, v239, v127
    v_mov_b32 v240, v239
    s_nop 1
    v_permlane32_swap_b32 v240, v239
    v_max_f32 v239, v239, v240
    v_mov_b32 v240, v239
    s_nop 1
    v_permlane16_swap_b32 v240, v239
    v_max_f32 v239, v239, v240
    v_max_f32 v239, 0, v239
    v_sub_f32 v172, v172, v239
    v_sub_f32 v173, v173, v239
    v_sub_f32 v174, v174, v239
    v_sub_f32 v175, v175, v239
    v_sub_f32 v176, v120, v239
    v_sub_f32 v177, v121, v239
    v_sub_f32 v178, v122, v239
    v_sub_f32 v179, v123, v239
    v_sub_f32 v180, v124, v239
    v_sub_f32 v181, v125, v239
    v_sub_f32 v182, v126, v239
    v_sub_f32 v183, v127, v239
    v_exp_f32 v176, v176
    v_exp_f32 v177, v177
    v_exp_f32 v178, v178
    v_exp_f32 v179, v179
    v_exp_f32 v180, v180
    v_exp_f32 v181, v181
    v_exp_f32 v182, v182
    v_exp_f32 v183, v183
    v_add_f32 v195, v176, v177
    v_add_f32 v195, v195, v178
    v_add_f32 v195, v195, v179
    v_add_f32 v195, v195, v180
    v_add_f32 v195, v195, v181
    v_add_f32 v195, v195, v182
    v_add_f32 v195, v195, v183
    v_cvt_pk_bf16_f32 v140, v176, v177
    v_cvt_pk_bf16_f32 v141, v178, v179
    v_cvt_pk_bf16_f32 v142, v180, v181
    v_cvt_pk_bf16_f32 v143, v182, v183
    v_sub_f32 v239, 0, v239
    v_exp_f32 v239, v239
    s_nop 0
    v_mul_f32 v199, v199, v239
    v_accvgpr_read_b32 v176, a12
    v_accvgpr_read_b32 v177, a13
    v_accvgpr_read_b32 v178, a14
    v_accvgpr_read_b32 v179, a15
    v_mul_f32 v176, v176, v239
    v_mul_f32 v177, v177, v239
    v_mul_f32 v178, v178, v239
    v_mul_f32 v179, v179, v239
    v_accvgpr_write_b32 a12, v176
    v_accvgpr_write_b32 a13, v177
    v_accvgpr_write_b32 a14, v178
    v_accvgpr_write_b32 a15, v179
    v_accvgpr_read_b32 v176, a28
    v_accvgpr_read_b32 v177, a29
    v_accvgpr_read_b32 v178, a30
    v_accvgpr_read_b32 v179, a31
    v_mul_f32 v176, v176, v239
    v_mul_f32 v177, v177, v239
    v_mul_f32 v178, v178, v239
    v_mul_f32 v179, v179, v239
    v_accvgpr_write_b32 a28, v176
    v_accvgpr_write_b32 a29, v177
    v_accvgpr_write_b32 a30, v178
    v_accvgpr_write_b32 a31, v179
    v_accvgpr_read_b32 v176, a44
    v_accvgpr_read_b32 v177, a45
    v_accvgpr_read_b32 v178, a46
    v_accvgpr_read_b32 v179, a47
    v_mul_f32 v176, v176, v239
    v_mul_f32 v177, v177, v239
    v_mul_f32 v178, v178, v239
    v_mul_f32 v179, v179, v239
    v_accvgpr_write_b32 a44, v176
    v_accvgpr_write_b32 a45, v177
    v_accvgpr_write_b32 a46, v178
    v_accvgpr_write_b32 a47, v179
    v_accvgpr_read_b32 v176, a60
    v_accvgpr_read_b32 v177, a61
    v_accvgpr_read_b32 v178, a62
    v_accvgpr_read_b32 v179, a63
    v_mul_f32 v176, v176, v239
    v_mul_f32 v177, v177, v239
    v_mul_f32 v178, v178, v239
    v_mul_f32 v179, v179, v239
    v_accvgpr_write_b32 a60, v176
    v_accvgpr_write_b32 a61, v177
    v_accvgpr_write_b32 a62, v178
    v_accvgpr_write_b32 a63, v179
    v_accvgpr_read_b32 v176, a76
    v_accvgpr_read_b32 v177, a77
    v_accvgpr_read_b32 v178, a78
    v_accvgpr_read_b32 v179, a79
    v_mul_f32 v176, v176, v239
    v_mul_f32 v177, v177, v239
    v_mul_f32 v178, v178, v239
    v_mul_f32 v179, v179, v239
    v_accvgpr_write_b32 a76, v176
    v_accvgpr_write_b32 a77, v177
    v_accvgpr_write_b32 a78, v178
    v_accvgpr_write_b32 a79, v179
    v_accvgpr_read_b32 v176, a92
    v_accvgpr_read_b32 v177, a93
    v_accvgpr_read_b32 v178, a94
    v_accvgpr_read_b32 v179, a95
    v_mul_f32 v176, v176, v239
    v_mul_f32 v177, v177, v239
    v_mul_f32 v178, v178, v239
    v_mul_f32 v179, v179, v239
    v_accvgpr_write_b32 a92, v176
    v_accvgpr_write_b32 a93, v177
    v_accvgpr_write_b32 a94, v178
    v_accvgpr_write_b32 a95, v179
    v_accvgpr_read_b32 v176, a108
    v_accvgpr_read_b32 v177, a109
    v_accvgpr_read_b32 v178, a110
    v_accvgpr_read_b32 v179, a111
    v_mul_f32 v176, v176, v239
    v_mul_f32 v177, v177, v239
    v_mul_f32 v178, v178, v239
    v_mul_f32 v179, v179, v239
    v_accvgpr_write_b32 a108, v176
    v_accvgpr_write_b32 a109, v177
    v_accvgpr_write_b32 a110, v178
    v_accvgpr_write_b32 a111, v179
    v_accvgpr_read_b32 v176, a124
    v_accvgpr_read_b32 v177, a125
    v_accvgpr_read_b32 v178, a126
    v_accvgpr_read_b32 v179, a127
    v_mul_f32 v176, v176, v239
    v_mul_f32 v177, v177, v239
    v_mul_f32 v178, v178, v239
    v_mul_f32 v179, v179, v239
    v_accvgpr_write_b32 a124, v176
    v_accvgpr_write_b32 a125, v177
    v_accvgpr_write_b32 a126, v178
    v_accvgpr_write_b32 a127, v179
    v_accvgpr_read_b32 v176, a140
    v_accvgpr_read_b32 v177, a141
    v_accvgpr_read_b32 v178, a142
    v_accvgpr_read_b32 v179, a143
    v_mul_f32 v176, v176, v239
    v_mul_f32 v177, v177, v239
    v_mul_f32 v178, v178, v239
    v_mul_f32 v179, v179, v239
    v_accvgpr_write_b32 a140, v176
    v_accvgpr_write_b32 a141, v177
    v_accvgpr_write_b32 a142, v178
    v_accvgpr_write_b32 a143, v179
    v_accvgpr_read_b32 v176, a156
    v_accvgpr_read_b32 v177, a157
    v_accvgpr_read_b32 v178, a158
    v_accvgpr_read_b32 v179, a159
    v_mul_f32 v176, v176, v239
    v_mul_f32 v177, v177, v239
    v_mul_f32 v178, v178, v239
    v_mul_f32 v179, v179, v239
    v_accvgpr_write_b32 a156, v176
    v_accvgpr_write_b32 a157, v177
    v_accvgpr_write_b32 a158, v178
    v_accvgpr_write_b32 a159, v179
    v_accvgpr_read_b32 v176, a172
    v_accvgpr_read_b32 v177, a173
    v_accvgpr_read_b32 v178, a174
    v_accvgpr_read_b32 v179, a175
    v_mul_f32 v176, v176, v239
    v_mul_f32 v177, v177, v239
    v_mul_f32 v178, v178, v239
    v_mul_f32 v179, v179, v239
    v_accvgpr_write_b32 a172, v176
    v_accvgpr_write_b32 a173, v177
    v_accvgpr_write_b32 a174, v178
    v_accvgpr_write_b32 a175, v179
    v_accvgpr_read_b32 v176, a188
    v_accvgpr_read_b32 v177, a189
    v_accvgpr_read_b32 v178, a190
    v_accvgpr_read_b32 v179, a191
    v_mul_f32 v176, v176, v239
    v_mul_f32 v177, v177, v239
    v_mul_f32 v178, v178, v239
    v_mul_f32 v179, v179, v239
    v_accvgpr_write_b32 a188, v176
    v_accvgpr_write_b32 a189, v177
    v_accvgpr_write_b32 a190, v178
    v_accvgpr_write_b32 a191, v179
    s_nop 1
    s_setpc_b64 s[38:39]
K2_fix1:
    s_nop 7
    v_max3_f32 v236, v96, v97, v98
    v_max3_f32 v236, v236, v99, v100
    v_max3_f32 v236, v236, v101, v102
    v_max_f32 v236, v236, v103
    v_mov_b32 v240, v236
    s_nop 1
    v_permlane32_swap_b32 v240, v236
    v_max_f32 v236, v236, v240
    v_mov_b32 v240, v236
    s_nop 1
    v_permlane16_swap_b32 v240, v236
    v_max_f32 v236, v236, v240
    v_max_f32 v236, 0, v236
    v_sub_f32 v160, v160, v236
    v_sub_f32 v161, v161, v236
    v_sub_f32 v162, v162, v236
    v_sub_f32 v163, v163, v236
    v_sub_f32 v176, v96, v236
    v_sub_f32 v177, v97, v236
    v_sub_f32 v178, v98, v236
    v_sub_f32 v179, v99, v236
    v_sub_f32 v180, v100, v236
    v_sub_f32 v181, v101, v236
    v_sub_f32 v182, v102, v236
    v_sub_f32 v183, v103, v236
    v_exp_f32 v176, v176
    v_exp_f32 v177, v177
    v_exp_f32 v178, v178
    v_exp_f32 v179, v179
    v_exp_f32 v180, v180
    v_exp_f32 v181, v181
    v_exp_f32 v182, v182
    v_exp_f32 v183, v183
    v_add_f32 v192, v176, v177
    v_add_f32 v192, v192, v178
    v_add_f32 v192, v192, v179
    v_add_f32 v192, v192, v180
    v_add_f32 v192, v192, v181
    v_add_f32 v192, v192, v182
    v_add_f32 v192, v192, v183
    v_cvt_pk_bf16_f32 v144, v176, v177
    v_cvt_pk_bf16_f32 v145, v178, v179
    v_cvt_pk_bf16_f32 v146, v180, v181
    v_cvt_pk_bf16_f32 v147, v182, v183
    v_sub_f32 v236, 0, v236
    v_exp_f32 v236, v236
    s_nop 0
    v_mul_f32 v196, v196, v236
    v_accvgpr_read_b32 v176, a0
    v_accvgpr_read_b32 v177, a1
    v_accvgpr_read_b32 v178, a2
    v_accvgpr_read_b32 v179, a3
    v_mul_f32 v176, v176, v236
    v_mul_f32 v177, v177, v236
    v_mul_f32 v178, v178, v236
    v_mul_f32 v179, v179, v236
    v_accvgpr_write_b32 a0, v176
    v_accvgpr_write_b32 a1, v177
    v_accvgpr_write_b32 a2, v178
    v_accvgpr_write_b32 a3, v179
    v_accvgpr_read_b32 v176, a16
    v_accvgpr_read_b32 v177, a17
    v_accvgpr_read_b32 v178, a18
    v_accvgpr_read_b32 v179, a19
    v_mul_f32 v176, v176, v236
    v_mul_f32 v177, v177, v236
    v_mul_f32 v178, v178, v236
    v_mul_f32 v179, v179, v236
    v_accvgpr_write_b32 a16, v176
    v_accvgpr_write_b32 a17, v177
    v_accvgpr_write_b32 a18, v178
    v_accvgpr_write_b32 a19, v179
    v_accvgpr_read_b32 v176, a32
    v_accvgpr_read_b32 v177, a33
    v_accvgpr_read_b32 v178, a34
    v_accvgpr_read_b32 v179, a35
    v_mul_f32 v176, v176, v236
    v_mul_f32 v177, v177, v236
    v_mul_f32 v178, v178, v236
    v_mul_f32 v179, v179, v236
    v_accvgpr_write_b32 a32, v176
    v_accvgpr_write_b32 a33, v177
    v_accvgpr_write_b32 a34, v178
    v_accvgpr_write_b32 a35, v179
    v_accvgpr_read_b32 v176, a48
    v_accvgpr_read_b32 v177, a49
    v_accvgpr_read_b32 v178, a50
    v_accvgpr_read_b32 v179, a51
    v_mul_f32 v176, v176, v236
    v_mul_f32 v177, v177, v236
    v_mul_f32 v178, v178, v236
    v_mul_f32 v179, v179, v236
    v_accvgpr_write_b32 a48, v176
    v_accvgpr_write_b32 a49, v177
    v_accvgpr_write_b32 a50, v178
    v_accvgpr_write_b32 a51, v179
    v_accvgpr_read_b32 v176, a64
    v_accvgpr_read_b32 v177, a65
    v_accvgpr_read_b32 v178, a66
    v_accvgpr_read_b32 v179, a67
    v_mul_f32 v176, v176, v236
    v_mul_f32 v177, v177, v236
    v_mul_f32 v178, v178, v236
    v_mul_f32 v179, v179, v236
    v_accvgpr_write_b32 a64, v176
    v_accvgpr_write_b32 a65, v177
    v_accvgpr_write_b32 a66, v178
    v_accvgpr_write_b32 a67, v179
    v_accvgpr_read_b32 v176, a80
    v_accvgpr_read_b32 v177, a81
    v_accvgpr_read_b32 v178, a82
    v_accvgpr_read_b32 v179, a83
    v_mul_f32 v176, v176, v236
    v_mul_f32 v177, v177, v236
    v_mul_f32 v178, v178, v236
    v_mul_f32 v179, v179, v236
    v_accvgpr_write_b32 a80, v176
    v_accvgpr_write_b32 a81, v177
    v_accvgpr_write_b32 a82, v178
    v_accvgpr_write_b32 a83, v179
    v_accvgpr_read_b32 v176, a96
    v_accvgpr_read_b32 v177, a97
    v_accvgpr_read_b32 v178, a98
    v_accvgpr_read_b32 v179, a99
    v_mul_f32 v176, v176, v236
    v_mul_f32 v177, v177, v236
    v_mul_f32 v178, v178, v236
    v_mul_f32 v179, v179, v236
    v_accvgpr_write_b32 a96, v176
    v_accvgpr_write_b32 a97, v177
    v_accvgpr_write_b32 a98, v178
    v_accvgpr_write_b32 a99, v179
    v_accvgpr_read_b32 v176, a112
    v_accvgpr_read_b32 v177, a113
    v_accvgpr_read_b32 v178, a114
    v_accvgpr_read_b32 v179, a115
    v_mul_f32 v176, v176, v236
    v_mul_f32 v177, v177, v236
    v_mul_f32 v178, v178, v236
    v_mul_f32 v179, v179, v236
    v_accvgpr_write_b32 a112, v176
    v_accvgpr_write_b32 a113, v177
    v_accvgpr_write_b32 a114, v178
    v_accvgpr_write_b32 a115, v179
    v_accvgpr_read_b32 v176, a128
    v_accvgpr_read_b32 v177, a129
    v_accvgpr_read_b32 v178, a130
    v_accvgpr_read_b32 v179, a131
    v_mul_f32 v176, v176, v236
    v_mul_f32 v177, v177, v236
    v_mul_f32 v178, v178, v236
    v_mul_f32 v179, v179, v236
    v_accvgpr_write_b32 a128, v176
    v_accvgpr_write_b32 a129, v177
    v_accvgpr_write_b32 a130, v178
    v_accvgpr_write_b32 a131, v179
    v_accvgpr_read_b32 v176, a144
    v_accvgpr_read_b32 v177, a145
    v_accvgpr_read_b32 v178, a146
    v_accvgpr_read_b32 v179, a147
    v_mul_f32 v176, v176, v236
    v_mul_f32 v177, v177, v236
    v_mul_f32 v178, v178, v236
    v_mul_f32 v179, v179, v236
    v_accvgpr_write_b32 a144, v176
    v_accvgpr_write_b32 a145, v177
    v_accvgpr_write_b32 a146, v178
    v_accvgpr_write_b32 a147, v179
    v_accvgpr_read_b32 v176, a160
    v_accvgpr_read_b32 v177, a161
    v_accvgpr_read_b32 v178, a162
    v_accvgpr_read_b32 v179, a163
    v_mul_f32 v176, v176, v236
    v_mul_f32 v177, v177, v236
    v_mul_f32 v178, v178, v236
    v_mul_f32 v179, v179, v236
    v_accvgpr_write_b32 a160, v176
    v_accvgpr_write_b32 a161, v177
    v_accvgpr_write_b32 a162, v178
    v_accvgpr_write_b32 a163, v179
    v_accvgpr_read_b32 v176, a176
    v_accvgpr_read_b32 v177, a177
    v_accvgpr_read_b32 v178, a178
    v_accvgpr_read_b32 v179, a179
    v_mul_f32 v176, v176, v236
    v_mul_f32 v177, v177, v236
    v_mul_f32 v178, v178, v236
    v_mul_f32 v179, v179, v236
    v_accvgpr_write_b32 a176, v176
    v_accvgpr_write_b32 a177, v177
    v_accvgpr_write_b32 a178, v178
    v_accvgpr_write_b32 a179, v179
    v_max3_f32 v237, v104, v105, v106
    v_max3_f32 v237, v237, v107, v108
    v_max3_f32 v237, v237, v109, v110
    v_max_f32 v237, v237, v111
    v_mov_b32 v240, v237
    s_nop 1
    v_permlane32_swap_b32 v240, v237
    v_max_f32 v237, v237, v240
    v_mov_b32 v240, v237
    s_nop 1
    v_permlane16_swap_b32 v240, v237
    v_max_f32 v237, v237, v240
    v_max_f32 v237, 0, v237
    v_sub_f32 v164, v164, v237
    v_sub_f32 v165, v165, v237
    v_sub_f32 v166, v166, v237
    v_sub_f32 v167, v167, v237
    v_sub_f32 v176, v104, v237
    v_sub_f32 v177, v105, v237
    v_sub_f32 v178, v106, v237
    v_sub_f32 v179, v107, v237
    v_sub_f32 v180, v108, v237
    v_sub_f32 v181, v109, v237
    v_sub_f32 v182, v110, v237
    v_sub_f32 v183, v111, v237
    v_exp_f32 v176, v176
    v_exp_f32 v177, v177
    v_exp_f32 v178, v178
    v_exp_f32 v179, v179
    v_exp_f32 v180, v180
    v_exp_f32 v181, v181
    v_exp_f32 v182, v182
    v_exp_f32 v183, v183
    v_add_f32 v193, v176, v177
    v_add_f32 v193, v193, v178
    v_add_f32 v193, v193, v179
    v_add_f32 v193, v193, v180
    v_add_f32 v193, v193, v181
    v_add_f32 v193, v193, v182
    v_add_f32 v193, v193, v183
    v_cvt_pk_bf16_f32 v148, v176, v177
    v_cvt_pk_bf16_f32 v149, v178, v179
    v_cvt_pk_bf16_f32 v150, v180, v181
    v_cvt_pk_bf16_f32 v151, v182, v183
    v_sub_f32 v237, 0, v237
    v_exp_f32 v237, v237
    s_nop 0
    v_mul_f32 v197, v197, v237
    v_accvgpr_read_b32 v176, a4
    v_accvgpr_read_b32 v177, a5
    v_accvgpr_read_b32 v178, a6
    v_accvgpr_read_b32 v179, a7
    v_mul_f32 v176, v176, v237
    v_mul_f32 v177, v177, v237
    v_mul_f32 v178, v178, v237
    v_mul_f32 v179, v179, v237
    v_accvgpr_write_b32 a4, v176
    v_accvgpr_write_b32 a5, v177
    v_accvgpr_write_b32 a6, v178
    v_accvgpr_write_b32 a7, v179
    v_accvgpr_read_b32 v176, a20
    v_accvgpr_read_b32 v177, a21
    v_accvgpr_read_b32 v178, a22
    v_accvgpr_read_b32 v179, a23
    v_mul_f32 v176, v176, v237
    v_mul_f32 v177, v177, v237
    v_mul_f32 v178, v178, v237
    v_mul_f32 v179, v179, v237
    v_accvgpr_write_b32 a20, v176
    v_accvgpr_write_b32 a21, v177
    v_accvgpr_write_b32 a22, v178
    v_accvgpr_write_b32 a23, v179
    v_accvgpr_read_b32 v176, a36
    v_accvgpr_read_b32 v177, a37
    v_accvgpr_read_b32 v178, a38
    v_accvgpr_read_b32 v179, a39
    v_mul_f32 v176, v176, v237
    v_mul_f32 v177, v177, v237
    v_mul_f32 v178, v178, v237
    v_mul_f32 v179, v179, v237
    v_accvgpr_write_b32 a36, v176
    v_accvgpr_write_b32 a37, v177
    v_accvgpr_write_b32 a38, v178
    v_accvgpr_write_b32 a39, v179
    v_accvgpr_read_b32 v176, a52
    v_accvgpr_read_b32 v177, a53
    v_accvgpr_read_b32 v178, a54
    v_accvgpr_read_b32 v179, a55
    v_mul_f32 v176, v176, v237
    v_mul_f32 v177, v177, v237
    v_mul_f32 v178, v178, v237
    v_mul_f32 v179, v179, v237
    v_accvgpr_write_b32 a52, v176
    v_accvgpr_write_b32 a53, v177
    v_accvgpr_write_b32 a54, v178
    v_accvgpr_write_b32 a55, v179
    v_accvgpr_read_b32 v176, a68
    v_accvgpr_read_b32 v177, a69
    v_accvgpr_read_b32 v178, a70
    v_accvgpr_read_b32 v179, a71
    v_mul_f32 v176, v176, v237
    v_mul_f32 v177, v177, v237
    v_mul_f32 v178, v178, v237
    v_mul_f32 v179, v179, v237
    v_accvgpr_write_b32 a68, v176
    v_accvgpr_write_b32 a69, v177
    v_accvgpr_write_b32 a70, v178
    v_accvgpr_write_b32 a71, v179
    v_accvgpr_read_b32 v176, a84
    v_accvgpr_read_b32 v177, a85
    v_accvgpr_read_b32 v178, a86
    v_accvgpr_read_b32 v179, a87
    v_mul_f32 v176, v176, v237
    v_mul_f32 v177, v177, v237
    v_mul_f32 v178, v178, v237
    v_mul_f32 v179, v179, v237
    v_accvgpr_write_b32 a84, v176
    v_accvgpr_write_b32 a85, v177
    v_accvgpr_write_b32 a86, v178
    v_accvgpr_write_b32 a87, v179
    v_accvgpr_read_b32 v176, a100
    v_accvgpr_read_b32 v177, a101
    v_accvgpr_read_b32 v178, a102
    v_accvgpr_read_b32 v179, a103
    v_mul_f32 v176, v176, v237
    v_mul_f32 v177, v177, v237
    v_mul_f32 v178, v178, v237
    v_mul_f32 v179, v179, v237
    v_accvgpr_write_b32 a100, v176
    v_accvgpr_write_b32 a101, v177
    v_accvgpr_write_b32 a102, v178
    v_accvgpr_write_b32 a103, v179
    v_accvgpr_read_b32 v176, a116
    v_accvgpr_read_b32 v177, a117
    v_accvgpr_read_b32 v178, a118
    v_accvgpr_read_b32 v179, a119
    v_mul_f32 v176, v176, v237
    v_mul_f32 v177, v177, v237
    v_mul_f32 v178, v178, v237
    v_mul_f32 v179, v179, v237
    v_accvgpr_write_b32 a116, v176
    v_accvgpr_write_b32 a117, v177
    v_accvgpr_write_b32 a118, v178
    v_accvgpr_write_b32 a119, v179
    v_accvgpr_read_b32 v176, a132
    v_accvgpr_read_b32 v177, a133
    v_accvgpr_read_b32 v178, a134
    v_accvgpr_read_b32 v179, a135
    v_mul_f32 v176, v176, v237
    v_mul_f32 v177, v177, v237
    v_mul_f32 v178, v178, v237
    v_mul_f32 v179, v179, v237
    v_accvgpr_write_b32 a132, v176
    v_accvgpr_write_b32 a133, v177
    v_accvgpr_write_b32 a134, v178
    v_accvgpr_write_b32 a135, v179
    v_accvgpr_read_b32 v176, a148
    v_accvgpr_read_b32 v177, a149
    v_accvgpr_read_b32 v178, a150
    v_accvgpr_read_b32 v179, a151
    v_mul_f32 v176, v176, v237
    v_mul_f32 v177, v177, v237
    v_mul_f32 v178, v178, v237
    v_mul_f32 v179, v179, v237
    v_accvgpr_write_b32 a148, v176
    v_accvgpr_write_b32 a149, v177
    v_accvgpr_write_b32 a150, v178
    v_accvgpr_write_b32 a151, v179
    v_accvgpr_read_b32 v176, a164
    v_accvgpr_read_b32 v177, a165
    v_accvgpr_read_b32 v178, a166
    v_accvgpr_read_b32 v179, a167
    v_mul_f32 v176, v176, v237
    v_mul_f32 v177, v177, v237
    v_mul_f32 v178, v178, v237
    v_mul_f32 v179, v179, v237
    v_accvgpr_write_b32 a164, v176
    v_accvgpr_write_b32 a165, v177
    v_accvgpr_write_b32 a166, v178
    v_accvgpr_write_b32 a167, v179
    v_accvgpr_read_b32 v176, a180
    v_accvgpr_read_b32 v177, a181
    v_accvgpr_read_b32 v178, a182
    v_accvgpr_read_b32 v179, a183
    v_mul_f32 v176, v176, v237
    v_mul_f32 v177, v177, v237
    v_mul_f32 v178, v178, v237
    v_mul_f32 v179, v179, v237
    v_accvgpr_write_b32 a180, v176
    v_accvgpr_write_b32 a181, v177
    v_accvgpr_write_b32 a182, v178
    v_accvgpr_write_b32 a183, v179
    v_max3_f32 v238, v112, v113, v114
    v_max3_f32 v238, v238, v115, v116
    v_max3_f32 v238, v238, v117, v118
    v_max_f32 v238, v238, v119
    v_mov_b32 v240, v238
    s_nop 1
    v_permlane32_swap_b32 v240, v238
    v_max_f32 v238, v238, v240
    v_mov_b32 v240, v238
    s_nop 1
    v_permlane16_swap_b32 v240, v238
    v_max_f32 v238, v238, v240
    v_max_f32 v238, 0, v238
    v_sub_f32 v168, v168, v238
    v_sub_f32 v169, v169, v238
    v_sub_f32 v170, v170, v238
    v_sub_f32 v171, v171, v238
    v_sub_f32 v176, v112, v238
    v_sub_f32 v177, v113, v238
    v_sub_f32 v178, v114, v238
    v_sub_f32 v179, v115, v238
    v_sub_f32 v180, v116, v238
    v_sub_f32 v181, v117, v238
    v_sub_f32 v182, v118, v238
    v_sub_f32 v183, v119, v238
    v_exp_f32 v176, v176
    v_exp_f32 v177, v177
    v_exp_f32 v178, v178
    v_exp_f32 v179, v179
    v_exp_f32 v180, v180
    v_exp_f32 v181, v181
    v_exp_f32 v182, v182
    v_exp_f32 v183, v183
    v_add_f32 v194, v176, v177
    v_add_f32 v194, v194, v178
    v_add_f32 v194, v194, v179
    v_add_f32 v194, v194, v180
    v_add_f32 v194, v194, v181
    v_add_f32 v194, v194, v182
    v_add_f32 v194, v194, v183
    v_cvt_pk_bf16_f32 v152, v176, v177
    v_cvt_pk_bf16_f32 v153, v178, v179
    v_cvt_pk_bf16_f32 v154, v180, v181
    v_cvt_pk_bf16_f32 v155, v182, v183
    v_sub_f32 v238, 0, v238
    v_exp_f32 v238, v238
    s_nop 0
    v_mul_f32 v198, v198, v238
    v_accvgpr_read_b32 v176, a8
    v_accvgpr_read_b32 v177, a9
    v_accvgpr_read_b32 v178, a10
    v_accvgpr_read_b32 v179, a11
    v_mul_f32 v176, v176, v238
    v_mul_f32 v177, v177, v238
    v_mul_f32 v178, v178, v238
    v_mul_f32 v179, v179, v238
    v_accvgpr_write_b32 a8, v176
    v_accvgpr_write_b32 a9, v177
    v_accvgpr_write_b32 a10, v178
    v_accvgpr_write_b32 a11, v179
    v_accvgpr_read_b32 v176, a24
    v_accvgpr_read_b32 v177, a25
    v_accvgpr_read_b32 v178, a26
    v_accvgpr_read_b32 v179, a27
    v_mul_f32 v176, v176, v238
    v_mul_f32 v177, v177, v238
    v_mul_f32 v178, v178, v238
    v_mul_f32 v179, v179, v238
    v_accvgpr_write_b32 a24, v176
    v_accvgpr_write_b32 a25, v177
    v_accvgpr_write_b32 a26, v178
    v_accvgpr_write_b32 a27, v179
    v_accvgpr_read_b32 v176, a40
    v_accvgpr_read_b32 v177, a41
    v_accvgpr_read_b32 v178, a42
    v_accvgpr_read_b32 v179, a43
    v_mul_f32 v176, v176, v238
    v_mul_f32 v177, v177, v238
    v_mul_f32 v178, v178, v238
    v_mul_f32 v179, v179, v238
    v_accvgpr_write_b32 a40, v176
    v_accvgpr_write_b32 a41, v177
    v_accvgpr_write_b32 a42, v178
    v_accvgpr_write_b32 a43, v179
    v_accvgpr_read_b32 v176, a56
    v_accvgpr_read_b32 v177, a57
    v_accvgpr_read_b32 v178, a58
    v_accvgpr_read_b32 v179, a59
    v_mul_f32 v176, v176, v238
    v_mul_f32 v177, v177, v238
    v_mul_f32 v178, v178, v238
    v_mul_f32 v179, v179, v238
    v_accvgpr_write_b32 a56, v176
    v_accvgpr_write_b32 a57, v177
    v_accvgpr_write_b32 a58, v178
    v_accvgpr_write_b32 a59, v179
    v_accvgpr_read_b32 v176, a72
    v_accvgpr_read_b32 v177, a73
    v_accvgpr_read_b32 v178, a74
    v_accvgpr_read_b32 v179, a75
    v_mul_f32 v176, v176, v238
    v_mul_f32 v177, v177, v238
    v_mul_f32 v178, v178, v238
    v_mul_f32 v179, v179, v238
    v_accvgpr_write_b32 a72, v176
    v_accvgpr_write_b32 a73, v177
    v_accvgpr_write_b32 a74, v178
    v_accvgpr_write_b32 a75, v179
    v_accvgpr_read_b32 v176, a88
    v_accvgpr_read_b32 v177, a89
    v_accvgpr_read_b32 v178, a90
    v_accvgpr_read_b32 v179, a91
    v_mul_f32 v176, v176, v238
    v_mul_f32 v177, v177, v238
    v_mul_f32 v178, v178, v238
    v_mul_f32 v179, v179, v238
    v_accvgpr_write_b32 a88, v176
    v_accvgpr_write_b32 a89, v177
    v_accvgpr_write_b32 a90, v178
    v_accvgpr_write_b32 a91, v179
    v_accvgpr_read_b32 v176, a104
    v_accvgpr_read_b32 v177, a105
    v_accvgpr_read_b32 v178, a106
    v_accvgpr_read_b32 v179, a107
    v_mul_f32 v176, v176, v238
    v_mul_f32 v177, v177, v238
    v_mul_f32 v178, v178, v238
    v_mul_f32 v179, v179, v238
    v_accvgpr_write_b32 a104, v176
    v_accvgpr_write_b32 a105, v177
    v_accvgpr_write_b32 a106, v178
    v_accvgpr_write_b32 a107, v179
    v_accvgpr_read_b32 v176, a120
    v_accvgpr_read_b32 v177, a121
    v_accvgpr_read_b32 v178, a122
    v_accvgpr_read_b32 v179, a123
    v_mul_f32 v176, v176, v238
    v_mul_f32 v177, v177, v238
    v_mul_f32 v178, v178, v238
    v_mul_f32 v179, v179, v238
    v_accvgpr_write_b32 a120, v176
    v_accvgpr_write_b32 a121, v177
    v_accvgpr_write_b32 a122, v178
    v_accvgpr_write_b32 a123, v179
    v_accvgpr_read_b32 v176, a136
    v_accvgpr_read_b32 v177, a137
    v_accvgpr_read_b32 v178, a138
    v_accvgpr_read_b32 v179, a139
    v_mul_f32 v176, v176, v238
    v_mul_f32 v177, v177, v238
    v_mul_f32 v178, v178, v238
    v_mul_f32 v179, v179, v238
    v_accvgpr_write_b32 a136, v176
    v_accvgpr_write_b32 a137, v177
    v_accvgpr_write_b32 a138, v178
    v_accvgpr_write_b32 a139, v179
    v_accvgpr_read_b32 v176, a152
    v_accvgpr_read_b32 v177, a153
    v_accvgpr_read_b32 v178, a154
    v_accvgpr_read_b32 v179, a155
    v_mul_f32 v176, v176, v238
    v_mul_f32 v177, v177, v238
    v_mul_f32 v178, v178, v238
    v_mul_f32 v179, v179, v238
    v_accvgpr_write_b32 a152, v176
    v_accvgpr_write_b32 a153, v177
    v_accvgpr_write_b32 a154, v178
    v_accvgpr_write_b32 a155, v179
    v_accvgpr_read_b32 v176, a168
    v_accvgpr_read_b32 v177, a169
    v_accvgpr_read_b32 v178, a170
    v_accvgpr_read_b32 v179, a171
    v_mul_f32 v176, v176, v238
    v_mul_f32 v177, v177, v238
    v_mul_f32 v178, v178, v238
    v_mul_f32 v179, v179, v238
    v_accvgpr_write_b32 a168, v176
    v_accvgpr_write_b32 a169, v177
    v_accvgpr_write_b32 a170, v178
    v_accvgpr_write_b32 a171, v179
    v_accvgpr_read_b32 v176, a184
    v_accvgpr_read_b32 v177, a185
    v_accvgpr_read_b32 v178, a186
    v_accvgpr_read_b32 v179, a187
    v_mul_f32 v176, v176, v238
    v_mul_f32 v177, v177, v238
    v_mul_f32 v178, v178, v238
    v_mul_f32 v179, v179, v238
    v_accvgpr_write_b32 a184, v176
    v_accvgpr_write_b32 a185, v177
    v_accvgpr_write_b32 a186, v178
    v_accvgpr_write_b32 a187, v179
    v_max3_f32 v239, v120, v121, v122
    v_max3_f32 v239, v239, v123, v124
    v_max3_f32 v239, v239, v125, v126
    v_max_f32 v239, v239, v127
    v_mov_b32 v240, v239
    s_nop 1
    v_permlane32_swap_b32 v240, v239
    v_max_f32 v239, v239, v240
    v_mov_b32 v240, v239
    s_nop 1
    v_permlane16_swap_b32 v240, v239
    v_max_f32 v239, v239, v240
    v_max_f32 v239, 0, v239
    v_sub_f32 v172, v172, v239
    v_sub_f32 v173, v173, v239
    v_sub_f32 v174, v174, v239
    v_sub_f32 v175, v175, v239
    v_sub_f32 v176, v120, v239
    v_sub_f32 v177, v121, v239
    v_sub_f32 v178, v122, v239
    v_sub_f32 v179, v123, v239
    v_sub_f32 v180, v124, v239
    v_sub_f32 v181, v125, v239
    v_sub_f32 v182, v126, v239
    v_sub_f32 v183, v127, v239
    v_exp_f32 v176, v176
    v_exp_f32 v177, v177
    v_exp_f32 v178, v178
    v_exp_f32 v179, v179
    v_exp_f32 v180, v180
    v_exp_f32 v181, v181
    v_exp_f32 v182, v182
    v_exp_f32 v183, v183
    v_add_f32 v195, v176, v177
    v_add_f32 v195, v195, v178
    v_add_f32 v195, v195, v179
    v_add_f32 v195, v195, v180
    v_add_f32 v195, v195, v181
    v_add_f32 v195, v195, v182
    v_add_f32 v195, v195, v183
    v_cvt_pk_bf16_f32 v156, v176, v177
    v_cvt_pk_bf16_f32 v157, v178, v179
    v_cvt_pk_bf16_f32 v158, v180, v181
    v_cvt_pk_bf16_f32 v159, v182, v183
    v_sub_f32 v239, 0, v239
    v_exp_f32 v239, v239
    s_nop 0
    v_mul_f32 v199, v199, v239
    v_accvgpr_read_b32 v176, a12
    v_accvgpr_read_b32 v177, a13
    v_accvgpr_read_b32 v178, a14
    v_accvgpr_read_b32 v179, a15
    v_mul_f32 v176, v176, v239
    v_mul_f32 v177, v177, v239
    v_mul_f32 v178, v178, v239
    v_mul_f32 v179, v179, v239
    v_accvgpr_write_b32 a12, v176
    v_accvgpr_write_b32 a13, v177
    v_accvgpr_write_b32 a14, v178
    v_accvgpr_write_b32 a15, v179
    v_accvgpr_read_b32 v176, a28
    v_accvgpr_read_b32 v177, a29
    v_accvgpr_read_b32 v178, a30
    v_accvgpr_read_b32 v179, a31
    v_mul_f32 v176, v176, v239
    v_mul_f32 v177, v177, v239
    v_mul_f32 v178, v178, v239
    v_mul_f32 v179, v179, v239
    v_accvgpr_write_b32 a28, v176
    v_accvgpr_write_b32 a29, v177
    v_accvgpr_write_b32 a30, v178
    v_accvgpr_write_b32 a31, v179
    v_accvgpr_read_b32 v176, a44
    v_accvgpr_read_b32 v177, a45
    v_accvgpr_read_b32 v178, a46
    v_accvgpr_read_b32 v179, a47
    v_mul_f32 v176, v176, v239
    v_mul_f32 v177, v177, v239
    v_mul_f32 v178, v178, v239
    v_mul_f32 v179, v179, v239
    v_accvgpr_write_b32 a44, v176
    v_accvgpr_write_b32 a45, v177
    v_accvgpr_write_b32 a46, v178
    v_accvgpr_write_b32 a47, v179
    v_accvgpr_read_b32 v176, a60
    v_accvgpr_read_b32 v177, a61
    v_accvgpr_read_b32 v178, a62
    v_accvgpr_read_b32 v179, a63
    v_mul_f32 v176, v176, v239
    v_mul_f32 v177, v177, v239
    v_mul_f32 v178, v178, v239
    v_mul_f32 v179, v179, v239
    v_accvgpr_write_b32 a60, v176
    v_accvgpr_write_b32 a61, v177
    v_accvgpr_write_b32 a62, v178
    v_accvgpr_write_b32 a63, v179
    v_accvgpr_read_b32 v176, a76
    v_accvgpr_read_b32 v177, a77
    v_accvgpr_read_b32 v178, a78
    v_accvgpr_read_b32 v179, a79
    v_mul_f32 v176, v176, v239
    v_mul_f32 v177, v177, v239
    v_mul_f32 v178, v178, v239
    v_mul_f32 v179, v179, v239
    v_accvgpr_write_b32 a76, v176
    v_accvgpr_write_b32 a77, v177
    v_accvgpr_write_b32 a78, v178
    v_accvgpr_write_b32 a79, v179
    v_accvgpr_read_b32 v176, a92
    v_accvgpr_read_b32 v177, a93
    v_accvgpr_read_b32 v178, a94
    v_accvgpr_read_b32 v179, a95
    v_mul_f32 v176, v176, v239
    v_mul_f32 v177, v177, v239
    v_mul_f32 v178, v178, v239
    v_mul_f32 v179, v179, v239
    v_accvgpr_write_b32 a92, v176
    v_accvgpr_write_b32 a93, v177
    v_accvgpr_write_b32 a94, v178
    v_accvgpr_write_b32 a95, v179
    v_accvgpr_read_b32 v176, a108
    v_accvgpr_read_b32 v177, a109
    v_accvgpr_read_b32 v178, a110
    v_accvgpr_read_b32 v179, a111
    v_mul_f32 v176, v176, v239
    v_mul_f32 v177, v177, v239
    v_mul_f32 v178, v178, v239
    v_mul_f32 v179, v179, v239
    v_accvgpr_write_b32 a108, v176
    v_accvgpr_write_b32 a109, v177
    v_accvgpr_write_b32 a110, v178
    v_accvgpr_write_b32 a111, v179
    v_accvgpr_read_b32 v176, a124
    v_accvgpr_read_b32 v177, a125
    v_accvgpr_read_b32 v178, a126
    v_accvgpr_read_b32 v179, a127
    v_mul_f32 v176, v176, v239
    v_mul_f32 v177, v177, v239
    v_mul_f32 v178, v178, v239
    v_mul_f32 v179, v179, v239
    v_accvgpr_write_b32 a124, v176
    v_accvgpr_write_b32 a125, v177
    v_accvgpr_write_b32 a126, v178
    v_accvgpr_write_b32 a127, v179
    v_accvgpr_read_b32 v176, a140
    v_accvgpr_read_b32 v177, a141
    v_accvgpr_read_b32 v178, a142
    v_accvgpr_read_b32 v179, a143
    v_mul_f32 v176, v176, v239
    v_mul_f32 v177, v177, v239
    v_mul_f32 v178, v178, v239
    v_mul_f32 v179, v179, v239
    v_accvgpr_write_b32 a140, v176
    v_accvgpr_write_b32 a141, v177
    v_accvgpr_write_b32 a142, v178
    v_accvgpr_write_b32 a143, v179
    v_accvgpr_read_b32 v176, a156
    v_accvgpr_read_b32 v177, a157
    v_accvgpr_read_b32 v178, a158
    v_accvgpr_read_b32 v179, a159
    v_mul_f32 v176, v176, v239
    v_mul_f32 v177, v177, v239
    v_mul_f32 v178, v178, v239
    v_mul_f32 v179, v179, v239
    v_accvgpr_write_b32 a156, v176
    v_accvgpr_write_b32 a157, v177
    v_accvgpr_write_b32 a158, v178
    v_accvgpr_write_b32 a159, v179
    v_accvgpr_read_b32 v176, a172
    v_accvgpr_read_b32 v177, a173
    v_accvgpr_read_b32 v178, a174
    v_accvgpr_read_b32 v179, a175
    v_mul_f32 v176, v176, v239
    v_mul_f32 v177, v177, v239
    v_mul_f32 v178, v178, v239
    v_mul_f32 v179, v179, v239
    v_accvgpr_write_b32 a172, v176
    v_accvgpr_write_b32 a173, v177
    v_accvgpr_write_b32 a174, v178
    v_accvgpr_write_b32 a175, v179
    v_accvgpr_read_b32 v176, a188
    v_accvgpr_read_b32 v177, a189
    v_accvgpr_read_b32 v178, a190
    v_accvgpr_read_b32 v179, a191
    v_mul_f32 v176, v176, v239
    v_mul_f32 v177, v177, v239
    v_mul_f32 v178, v178, v239
    v_mul_f32 v179, v179, v239
    v_accvgpr_write_b32 a188, v176
    v_accvgpr_write_b32 a189, v177
    v_accvgpr_write_b32 a190, v178
    v_accvgpr_write_b32 a191, v179
    s_nop 1
    s_setpc_b64 s[38:39]
K2_end:
.section .rodata,"a"
.p2align 6
.amdhsa_kernel recurrent_scan__mha_block_cached__glu_gated_swiglu__prompt_kernel
  .amdhsa_next_free_vgpr 512
  .amdhsa_next_free_sgpr 100
  .amdhsa_accum_offset 256
  .amdhsa_group_segment_fixed_size 0
  .amdhsa_kernarg_size 96
  .amdhsa_user_sgpr_count 2
  .amdhsa_user_sgpr_kernarg_segment_ptr 1
  .amdhsa_system_sgpr_workgroup_id_x 1
.end_amdhsa_kernel
```
